```python
import torch

def _softmax(x, axis=-1):
    return torch.softmax(x, dim=axis)
def _gelu(x):
    return torch.nn.functional.gelu(x, approximate="tanh")
def _silu(x):
    return torch.nn.functional.silu(x)
def _sigmoid(x):
    return torch.sigmoid(x)
def _layernorm(x, axis=-1, eps=1e-5):
    m = x.mean(dim=axis, keepdim=True)
    v = x.var(dim=axis, keepdim=True, unbiased=False)
    return (x - m) / torch.sqrt(v + eps)
def _scatter_add(tgt, idx, src, axis=0):
    return tgt.clone().index_add_(axis, idx, src)
def _segment_sum(src, seg, n):
    out = torch.zeros((n,) + src.shape[1:], dtype=src.dtype)
    return out.index_add_(0, seg, src)
def _pad(x, pw):
    flat = tuple(v for pair in reversed(pw) for v in pair)
    return torch.nn.functional.pad(x, flat)

kernel_name = 'gated_mix__mha_block__glu_gated_glu__prompt'

def setup_inputs():

    _w = (lambda a: (lambda t: t.to(torch.bfloat16) if t.is_floating_point() else t)(torch.as_tensor(a)))
    def _A_setup():
        B, S, D, H = 1, 2048, 512, 32
        return {
            "x": _w((lambda *s: torch.randn(*s, dtype=torch.bfloat16) * 0.05)(B, S, D)),
            "wqkv": _w((lambda *s: torch.randn(*s, dtype=torch.bfloat16) * 0.8)(D, 3 * D)),
            "wo": _w((lambda *s: torch.randn(*s, dtype=torch.bfloat16) * 0.1)(D, D)),
        }
    _A_in = _A_setup()

    def _B_setup():
        B, S, D, F = 1, 2048, 512, 1792
        return {
            "x": _w((lambda *s: torch.randn(*s, dtype=torch.bfloat16) * 0.05)(B, S, D)),
            "w_gate": _w((lambda *s: torch.randn(*s, dtype=torch.bfloat16) * 0.4)(D, F)),
            "w_up": _w((lambda *s: torch.randn(*s, dtype=torch.bfloat16) * 0.05)(D, F)),
            "w_down": _w((lambda *s: torch.randn(*s, dtype=torch.bfloat16) * 0.05)(F, D)),
        }
    _B_in = _B_setup()

    return {
        "A_x": _A_in["x"],
        "A_wqkv": _A_in["wqkv"],
        "A_wo": _A_in["wo"],
        "B_x": _B_in["x"],
        "B_w_gate": _B_in["w_gate"],
        "B_w_up": _B_in["w_up"],
        "B_w_down": _B_in["w_down"],
        "gate_w": _w((lambda *s: torch.randn(*s, dtype=torch.bfloat16) * 0.05)(512) * 16.0),
    }

def reference(A_x, A_wqkv, A_wo, B_x, B_w_gate, B_w_up, B_w_down, gate_w):
    def _A_ref(x, wqkv, wo):
        B, S, D = x.shape
        H = 32
        Dh = D // H
        qkv = (lambda x, *d: x.permute(*d))((x @ wqkv).reshape(B, S, 3, H, Dh), 2, 0, 3, 1, 4)
        q, k, v = qkv[0], qkv[1], qkv[2]
        scores = torch.einsum("bhqd,bhkd->bhqk", q, k) * (Dh ** -0.5)
        p = _softmax(scores, axis=-1)
        o = torch.einsum("bhqk,bhkd->bhqd", p, v)
        return (lambda x, *d: x.permute(*d))(o, 0, 2, 1, 3).reshape(B, S, D) @ wo

    def _B_ref(x, w_gate, w_up, w_down):
        g = torch.einsum("bsd,df->bsf", x, w_gate)
        u = torch.einsum("bsd,df->bsf", x, w_up)
        h = _sigmoid(g) * u
        return torch.einsum("bsf,fd->bsd", h, w_down)

    x = A_x
    g = _sigmoid((x * gate_w).sum(-1, keepdims=True))
    a = _A_ref(x, A_wqkv, A_wo)
    b = _B_ref(x, B_w_gate, B_w_up, B_w_down)
    return g * a + (1 - g) * b
```

```asm
; @launch grid=(256,1,1) block=(512,1,1) lds=163840
.amdgcn_target "amdgcn-amd-amdhsa--gfx950"
.text
.p2align 12
.globl gated_mix__mha_block__glu_gated_glu__prompt_kernel
.p2align 8
.type gated_mix__mha_block__glu_gated_glu__prompt_kernel,@function
gated_mix__mha_block__glu_gated_glu__prompt_kernel:
 s_cmp_ge_u32 s2, 256
 s_cbranch_scc1 L_end
 s_load_dwordx16 s[64:79], s[0:1], 0
 s_load_dwordx4 s[80:83], s[0:1], 64
 s_load_dwordx2 s[84:85], s[0:1], 80
 v_lshrrev_b32 v104, 3, v0
 v_lshrrev_b32 v1, 6, v0
 v_and_b32 v105, 7, v0
 v_readfirstlane_b32 s52, v1
 v_and_b32 v0, 63, v0
 s_and_b32 s54, s2, 7
 s_lshr_b32 s55, s2, 3
 s_lshr_b32 s59, s54, 1
 s_lshr_b32 s58, s55, 3
 s_and_b32 s62, s55, 7
 s_and_b32 s63, s54, 1
 s_lshl_b32 s63, s63, 3
 s_add_u32 s56, s62, s63
 s_lshl_b32 s57, s59, 2
 s_add_u32 s57, s57, s58
 s_add_u32 s60, s58, s62
 s_and_b32 s60, s60, 1
 s_mul_i32 s60, s60, 2
 s_mul_i32 s62, s59, 2
 s_add_u32 s60, s60, s62
 s_lshr_b32 s62, s56, 3
 s_mul_i32 s62, s62, 4
 s_add_u32 s60, s60, s62
 s_lshl_b32 s53, s52, 10
 v_bfe_u32 v107, v104, 1, 3
 v_xor_b32 v107, v105, v107
 v_lshlrev_b32 v107, 4, v107
 v_lshl_add_u32 v1, v104, 10, v107
 s_lshl_b32 s62, s56, 17
 v_add_u32 v1, s62, v1
 v_and_b32 v106, 2, v104
 v_bfe_u32 v107, v104, 3, 1
 v_lshl_or_b32 v106, v107, 2, v106
 v_xor_b32 v106, v105, v106
 v_lshlrev_b32 v106, 4, v106
 v_mul_u32_u24 v2, 3072, v104
 s_lshl_b32 s62, s57, 7
 s_add_u32 s62, s62, 1024
 v_add3_u32 v2, v2, s62, v106
 s_mul_i32 s62, s59, 7
 s_lshl_b32 s63, s58, 1
 s_add_u32 s3, s62, s63
 s_lshl_b32 s62, s3, 7
 s_lshl_b32 s63, s59, 8
 s_cmp_lt_u32 s58, 3
 s_movk_i32 s61, 3072
 s_cselect_b32 s61, 3584, s61
 s_cselect_b32 s62, s62, s63
 s_cselect_b32 s87, 0, 128
 v_mul_u32_u24 v107, s61, v104
 v_add3_u32 v3, v107, s62, v106
 v_lshlrev_b32 v126, 4, v0
 s_mov_b32 s10, 1572864
 s_cselect_b32 s14, 1835008, s10
 s_mov_b32 s18, s14
 s_mov_b32 s6, 2097152
 s_mov_b32 s7, 0x20000
 s_mov_b32 s11, 0x20000
 s_mov_b32 s15, 0x20000
 s_mov_b32 s19, 0x20000
 s_lshl_b32 s61, s61, 6
 s_and_b32 s91, s60, 7
 s_lshl_b32 s86, s91, 7
 s_mul_i32 s88, s91, 196608
 s_mul_i32 s89, s91, s61
 s_mov_b32 m0, s53
 s_cmp_lt_u32 s58, 3
 s_waitcnt lgkmcnt(0)
 s_mov_b64 s[4:5], s[64:65]
 buffer_load_dwordx4 v1, s[4:7], s86 offen lds
 s_cselect_b64 s[12:13], s[72:73], s[66:67]
 s_cselect_b64 s[16:17], s[74:75], s[66:67]
 s_add_u32 m0, s53, 8192
 s_add_u32 s86, s86, 65536
 buffer_load_dwordx4 v1, s[4:7], s86 offen lds
 s_add_u32 m0, s53, 65536
 s_mov_b64 s[8:9], s[66:67]
 buffer_load_dwordx4 v2, s[8:11], s88 offen lds
 s_add_u32 m0, s53, 98304
 s_nop 0
 buffer_load_dwordx4 v3, s[12:15], s89 offen lds
 s_add_u32 m0, s53, 106496
 s_add_u32 s89, s89, s87
 buffer_load_dwordx4 v3, s[16:19], s89 offen lds
 s_cmp_lg_u32 s52, 1
 s_cbranch_scc1 L_s_1
 s_getpc_b64 s[98:99]
L_pc:
 s_cmp_ge_u32 s57, 8
 s_cselect_b32 s62, L_v1-L_v0, 0
 s_cselect_b32 s63, L_v3-L_v2, 0
 s_add_u32 s63, s63, L_v2-L_v0
 s_cmp_eq_u32 s58, 3
 s_cselect_b32 s63, s63, s62
 s_add_u32 s63, s63, L_v0-L_pc
 s_and_b32 s62, s55, 7
 s_mul_i32 s62, s62, 28
 v_add_u32 v16, s62, v0
 v_lshl_add_u32 v16, v16, 7, s63
 v_min_u32 v16, L_codeend-L_pc-4, v16
 v_mov_b32 v17, s99
 v_add_co_u32 v16, vcc, s98, v16
 s_nop 1
 v_addc_co_u32 v17, vcc, 0, v17, vcc
 s_mov_b64 exec, (1<<28)-1
 global_load_dword v125, v[16:17], off
 s_mov_b64 exec, -1
L_s_1:
 s_mov_b64 s[28:29], s[84:85]
 s_mov_b32 s30, 16777216
 s_mov_b32 s31, 0x20000
 s_mov_b64 s[20:21], s[72:73]
 s_mov_b32 s22, 1835008
 s_mov_b32 s23, 0x20000
 s_mov_b64 s[24:25], s[74:75]
 s_mov_b32 s26, 1835008
 s_mov_b32 s27, 0x20000
 s_cmp_lt_u32 s58, 3
 s_addc_u32 s63, s3, 0
 v_mul_u32_u24 v107, 3584, v104
 s_lshl_b32 s62, s63, 7
 v_add3_u32 v4, v107, s62, v106
 s_cmp_lg_u32 s2, 0
 s_cbranch_scc1 L_s_2
 v_mov_b32 v16, 0
 v_mov_b32 v17, 0
 v_mov_b32 v18, 0
 v_mov_b32 v19, 0
 s_mul_i32 s62, s52, 3072
 buffer_store_dwordx4 v[16:19], v126, s[28:31], s62 offen offset:0 sc1
 buffer_store_dwordx4 v[16:19], v126, s[28:31], s62 offen offset:1024 sc1
 buffer_store_dwordx4 v[16:19], v126, s[28:31], s62 offen offset:2048 sc1
L_s_2:
 s_mov_b64 s[48:49], s[78:79]
 s_mov_b32 s50, 1024
 s_mov_b32 s51, 0x20000
 s_mov_b64 s[32:33], s[76:77]
 s_mov_b32 s34, 1835008
 s_mov_b32 s35, 0x20000
 s_mov_b64 s[36:37], s[68:69]
 s_mov_b32 s38, 524288
 s_mov_b32 s39, 0x20000
 s_mov_b64 s[40:41], s[80:81]
 s_mov_b32 s42, 2097152
 s_mov_b32 s43, 0x20000
 s_mov_b64 s[44:45], s[82:83]
 s_mov_b32 s46, 256
 s_mov_b32 s47, 0x20000
 s_lshl_b32 s62, s56, 7
 s_lshl_b32 s63, s57, 3
 s_add_u32 s62, s62, s63
 s_add_u32 s62, s62, s52
 s_lshl_b32 s80, s62, 10
 s_lshl_b32 s65, s62, 2
 s_add_u32 s65, s65, 15376
 s_mov_b32 s74, s3
 s_cmp_lt_u32 s58, 3
 s_addc_u32 s75, s3, 0
 s_and_b32 s93, s52, 3
 s_lshr_b32 s94, s52, 2
 s_lshl_b32 s95, s56, 2
 s_add_u32 s95, s95, s93
 s_mov_b32 s96, 0x0000ffff
 s_mov_b32 s97, 0x0000ffff
 s_lshr_b32 s73, s55, 2
 v_and_b32 v106, 6, v104
 v_xor_b32 v106, v105, v106
 v_lshlrev_b32 v106, 4, v106
 v_lshl_add_u32 v106, v104, 10, v106
 s_lshl_b32 s63, s73, 7
 v_add_u32 v116, s63, v106
 v_lshl_add_u32 v117, v0, 10, s63
 v_and_b32 v104, 15, v0
 v_lshrrev_b32 v105, 4, v0
 v_lshrrev_b32 v106, 1, v104
 v_xor_b32 v106, v106, v105
 v_lshlrev_b32 v106, 4, v106
 v_lshl_add_u32 v106, v104, 7, v106
 s_lshl_b32 s62, s93, 12
 v_add_u32 v5, s62, v106
 v_xor_b32 v6, 64, v5
 v_bfe_u32 v106, v0, 2, 2
 v_lshl_add_u32 v107, v105, 3, v106
 v_lshlrev_b32 v107, 7, v107
 v_and_b32 v108, 3, v0
 v_lshl_add_u32 v107, v108, 3, v107
 v_bfe_u32 v108, v0, 3, 2
 s_lshl_b32 s62, s94, 1
 v_xor_b32 v108, s62, v108
 v_lshl_add_u32 v11, v108, 5, v107
 v_xor_b32 v12, 32, v11
 v_add_u32 v7, 65536, v11
 v_add_u32 v9, 98304, v11
 v_add_u32 v8, 65536, v12
 v_add_u32 v10, 98304, v12
 v_lshlrev_b32 v106, 4, v104
 v_lshl_add_u32 v122, v105, 9, v106
 s_lshl_b32 s62, s95, 7
 s_add_u32 s62, s62, 16384
 v_lshl_add_u32 v119, v104, 2, s62
 s_and_b32 s62, s55, 3
 s_lshl_b32 s64, s54, 2
 s_add_u32 s64, s64, s62
 s_lshl_b32 s66, s64, 17
 s_add_u32 s66, s66, 3145728
 s_add_u32 s66, s66, s53
 s_lshl_b32 s76, s73, 2
 s_add_u32 s76, s76, s93
 s_lshl_b32 s76, s76, 1
 s_add_u32 s76, s76, s94
 v_bfe_u32 v106, v0, 4, 1
 v_lshlrev_b32 v107, 2, v104
 v_lshl_add_u32 v106, v106, 10, v107
 s_lshl_b32 s62, s54, 7
 v_add_u32 v106, s62, v106
 s_lshr_b32 s62, s54, 1
 s_lshl_b32 s62, s62, 9
 s_add_u32 s62, s62, 384
 s_lshl_b32 s63, s73, 3
 s_add_u32 s62, s62, s63
 v_and_b32 v108, 1, v0
 v_cmp_gt_u32 vcc, 32, v0
 v_lshl_add_u32 v108, v108, 2, s62
 s_nop 0
 v_cndmask_b32 v120, v108, v106, vcc
 v_mov_b32 v112, 0xdddddddd
 v_bfe_u32 v106, v0, 3, 2
 v_and_b32 v107, 3, v0
 v_lshl_or_b32 v106, v106, 2, v107
 v_bfe_u32 v107, v0, 2, 1
 v_lshl_or_b32 v106, v107, 4, v106
 v_and_b32 v107, 32, v0
 v_or_b32 v106, v106, v107
 s_lshl_b32 s62, s94, 11
 s_add_u32 s62, s62, 0x10000
 v_lshl_add_u32 v113, v106, 4, s62
 v_lshrrev_b32 v107, 1, v107
 v_or_b32 v106, v104, v107
 v_lshl_add_u32 v114, v106, 4, s62
 v_and_b32 v106, 31, v0
 s_lshl_b32 s62, s76, 7
 s_add_u32 s62, s62, 16384
 v_lshl_add_u32 v123, v106, 2, s62
 s_lshl_b32 s71, s64, 1
 s_and_b32 s62, s52, 1
 s_add_u32 s71, s71, s62
 s_lshr_b32 s72, s52, 1
 s_lshl_b32 s62, s71, 7
 s_add_u32 s62, s62, 4096
 v_lshl_add_u32 v115, v106, 2, s62
 v_add_u32 v107, 4294955008, v123
 v_cmp_gt_u32 vcc, 32, v0
 s_nop 1
 v_cndmask_b32 v115, v107, v115, vcc
 v_lshrrev_b32 v106, 2, v0
 v_lshlrev_b32 v106, 7, v106
 v_and_b32 v107, 3, v0
 v_lshl_add_u32 v106, v107, 3, v106
 v_bfe_u32 v104, v0, 3, 2
 v_lshl_add_u32 v106, v104, 5, v106
 s_lshl_b32 s62, s72, 13
 v_add_u32 v124, s62, v106
 s_lshl_b32 s85, s64, 6
 s_add_u32 s85, s85, s76
 s_lshl_b32 s85, s85, 10
 s_add_u32 s85, s85, 1048576
 s_xor_b32 s3, s85, 1024
 s_and_b32 s0, s73, 0
 s_lshl_b32 s0, s0, 16
 s_and_b32 s84, s73, 3
 s_lshl_b32 s84, s84, 15
 s_mul_i32 s69, s71, 114688
 s_mul_i32 s62, s72, 28672
 s_add_u32 s69, s69, s62
 s_add_u32 s69, s69, 9437184
 s_and_b32 s62, s55, 3
 s_lshl_b32 s62, s62, 1
 s_mov_b32 s81, s54
 s_cmp_ge_u32 s81, 7
 s_cselect_b32 s62, 7, 0
 s_sub_u32 s81, s81, s62
 v_mov_b32 v118, 0
 s_add_u32 s91, s60, 1
 s_and_b32 s91, s91, 7
 s_add_u32 m0, s53, 16384
 s_lshl_b32 s86, s91, 7
 buffer_load_dwordx4 v1, s[4:7], s86 offen lds
 s_add_u32 m0, s53, 24576
 s_add_u32 s86, s86, 65536
 buffer_load_dwordx4 v1, s[4:7], s86 offen lds
 s_add_u32 m0, s53, 73728
 s_mul_i32 s88, s91, 196608
 buffer_load_dwordx4 v2, s[8:11], s88 offen lds
 s_add_u32 m0, s53, 114688
 s_mul_i32 s89, s91, s61
 buffer_load_dwordx4 v3, s[12:15], s89 offen lds
 s_add_u32 m0, s53, 122880
 s_add_u32 s89, s89, s87
 buffer_load_dwordx4 v3, s[16:19], s89 offen lds
 s_cmp_eq_u32 s58, 3
 s_cbranch_scc1 L_d2
 s_cmp_ge_u32 s57, 8
 s_cbranch_scc1 L_v1
 s_branch L_v0
L_d2:
 s_cmp_ge_u32 s57, 8
 s_cbranch_scc1 L_v3
 s_branch L_v2
L_end:
 s_endpgm
.p2align 12
.skip 1024
L_v0:
 s_waitcnt vmcnt(5)
 s_barrier
 ds_read_b128 v[128:131], v5 offset:0
 ds_read_b128 v[132:135], v5 offset:2048
 ds_read_b128 v[136:139], v6 offset:0
 ds_read_b128 v[140:143], v6 offset:2048
 ds_read_b64_tr_b16 v[80:81], v7 offset:0
 ds_read_b64_tr_b16 v[82:83], v7 offset:512
 ds_read_b64_tr_b16 v[84:85], v7 offset:4096
 ds_read_b64_tr_b16 v[86:87], v7 offset:4608
 ds_read_b64_tr_b16 v[88:89], v8 offset:0
 ds_read_b64_tr_b16 v[90:91], v8 offset:512
 ds_read_b64_tr_b16 v[92:93], v8 offset:4096
 ds_read_b64_tr_b16 v[94:95], v8 offset:4608
 s_waitcnt lgkmcnt(4)
 v_mfma_f32_16x16x32_bf16 v[16:19], v[80:83], v[128:131], 0
 s_setprio 1
 ds_read_b64_tr_b16 v[96:97], v9 offset:0
 v_mfma_f32_16x16x32_bf16 v[16:19], v[84:87], v[136:139], v[16:19]
 ds_read_b64_tr_b16 v[98:99], v9 offset:512
 v_mfma_f32_16x16x32_bf16 v[20:23], v[80:83], v[132:135], 0
 ds_read_b64_tr_b16 v[100:101], v9 offset:4096
 v_mfma_f32_16x16x32_bf16 v[20:23], v[84:87], v[140:143], v[20:23]
 s_setprio 0
 ds_read_b64_tr_b16 v[102:103], v9 offset:4608
 s_add_u32 s91, s60, 2
 s_and_b32 s91, s91, 7
 s_add_u32 m0, s53, 32768
 s_lshl_b32 s86, s91, 7
 buffer_load_dwordx4 v1, s[4:7], s86 offen lds
 s_waitcnt lgkmcnt(4)
 v_mfma_f32_16x16x32_bf16 v[24:27], v[88:91], v[128:131], 0
 s_setprio 1
 ds_read_b64_tr_b16 v[80:81], v10 offset:0
 v_mfma_f32_16x16x32_bf16 v[24:27], v[92:95], v[136:139], v[24:27]
 ds_read_b64_tr_b16 v[82:83], v10 offset:512
 v_mfma_f32_16x16x32_bf16 v[28:31], v[88:91], v[132:135], 0
 ds_read_b64_tr_b16 v[84:85], v10 offset:4096
 v_mfma_f32_16x16x32_bf16 v[28:31], v[92:95], v[140:143], v[28:31]
 s_setprio 0
 ds_read_b64_tr_b16 v[86:87], v10 offset:4608
 s_add_u32 m0, s53, 40960
 s_add_u32 s86, s86, 65536
 buffer_load_dwordx4 v1, s[4:7], s86 offen lds
 s_waitcnt lgkmcnt(4)
 v_mfma_f32_16x16x32_bf16 v[32:35], v[96:99], v[128:131], 0
 s_setprio 1
 ds_read_b64_tr_b16 v[88:89], v9 offset:8192
 v_mfma_f32_16x16x32_bf16 v[32:35], v[100:103], v[136:139], v[32:35]
 ds_read_b64_tr_b16 v[90:91], v9 offset:8704
 v_mfma_f32_16x16x32_bf16 v[36:39], v[96:99], v[132:135], 0
 ds_read_b64_tr_b16 v[92:93], v9 offset:12288
 v_mfma_f32_16x16x32_bf16 v[36:39], v[100:103], v[140:143], v[36:39]
 s_setprio 0
 ds_read_b64_tr_b16 v[94:95], v9 offset:12800
 s_and_b32 s62, s55, 7
 s_mul_i32 s62, s62, 229376
 s_bitcmp1_b32 s54, 0
 s_cselect_b32 s62, 0x10000000, s62
 buffer_load_dword v125, v4, s[20:23], s62 offen
 buffer_load_dword v125, v4, s[24:27], s62 offen
 s_waitcnt lgkmcnt(4)
 v_mfma_f32_16x16x32_bf16 v[40:43], v[80:83], v[128:131], 0
 s_setprio 1
 ds_read_b64_tr_b16 v[96:97], v10 offset:8192
 v_mfma_f32_16x16x32_bf16 v[40:43], v[84:87], v[136:139], v[40:43]
 ds_read_b64_tr_b16 v[98:99], v10 offset:8704
 v_mfma_f32_16x16x32_bf16 v[44:47], v[80:83], v[132:135], 0
 ds_read_b64_tr_b16 v[100:101], v10 offset:12288
 v_mfma_f32_16x16x32_bf16 v[44:47], v[84:87], v[140:143], v[44:47]
 s_setprio 0
 ds_read_b64_tr_b16 v[102:103], v10 offset:12800
 s_add_u32 m0, s53, 81920
 s_mul_i32 s88, s91, 196608
 buffer_load_dwordx4 v2, s[8:11], s88 offen lds
 s_waitcnt vmcnt(7)
 s_barrier
 s_or_b32 s62, s2, s52
 s_cbranch_scc0 L_x_1001
L_r_1002:
 s_waitcnt lgkmcnt(4)
 v_mfma_f32_16x16x32_bf16 v[48:51], v[88:91], v[128:131], 0
 s_setprio 1
 ds_read_b128 v[144:147], v5 offset:16384
 ds_read_b64_tr_b16 v[80:81], v7 offset:8192
 v_mfma_f32_16x16x32_bf16 v[48:51], v[92:95], v[136:139], v[48:51]
 ds_read_b128 v[148:151], v5 offset:18432
 ds_read_b64_tr_b16 v[82:83], v7 offset:8704
 v_mfma_f32_16x16x32_bf16 v[52:55], v[88:91], v[132:135], 0
 ds_read_b128 v[152:155], v6 offset:16384
 ds_read_b64_tr_b16 v[84:85], v7 offset:12288
 v_mfma_f32_16x16x32_bf16 v[52:55], v[92:95], v[140:143], v[52:55]
 s_setprio 0
 ds_read_b128 v[156:159], v6 offset:18432
 ds_read_b64_tr_b16 v[86:87], v7 offset:12800
 s_add_u32 m0, s53, 131072
 s_mul_i32 s89, s91, s61
 buffer_load_dwordx4 v3, s[12:15], s89 offen lds
 s_add_u32 m0, s53, 139264
 s_add_u32 s89, s89, s87
 buffer_load_dwordx4 v3, s[16:19], s89 offen lds
 s_waitcnt lgkmcnt(8)
 v_mfma_f32_16x16x32_bf16 v[56:59], v[96:99], v[128:131], 0
 s_setprio 1
 ds_read_b64_tr_b16 v[88:89], v8 offset:8192
 v_mfma_f32_16x16x32_bf16 v[56:59], v[100:103], v[136:139], v[56:59]
 ds_read_b64_tr_b16 v[90:91], v8 offset:8704
 v_mfma_f32_16x16x32_bf16 v[60:63], v[96:99], v[132:135], 0
 ds_read_b64_tr_b16 v[92:93], v8 offset:12288
 v_mfma_f32_16x16x32_bf16 v[60:63], v[100:103], v[140:143], v[60:63]
 s_setprio 0
 ds_read_b64_tr_b16 v[94:95], v8 offset:12800
 s_add_u32 s91, s60, 3
 s_and_b32 s91, s91, 7
 s_add_u32 m0, s53, 49152
 s_lshl_b32 s86, s91, 7
 buffer_load_dwordx4 v1, s[4:7], s86 offen lds
 s_waitcnt vmcnt(8)
 s_barrier
 s_waitcnt lgkmcnt(4)
 v_mfma_f32_16x16x32_bf16 v[16:19], v[80:83], v[144:147], v[16:19]
 s_setprio 1
 ds_read_b64_tr_b16 v[96:97], v9 offset:16384
 v_mfma_f32_16x16x32_bf16 v[16:19], v[84:87], v[152:155], v[16:19]
 ds_read_b64_tr_b16 v[98:99], v9 offset:16896
 v_mfma_f32_16x16x32_bf16 v[20:23], v[80:83], v[148:151], v[20:23]
 ds_read_b64_tr_b16 v[100:101], v9 offset:20480
 v_mfma_f32_16x16x32_bf16 v[20:23], v[84:87], v[156:159], v[20:23]
 s_setprio 0
 ds_read_b64_tr_b16 v[102:103], v9 offset:20992
 s_add_u32 m0, s53, 57344
 s_add_u32 s86, s86, 65536
 buffer_load_dwordx4 v1, s[4:7], s86 offen lds
 buffer_load_dwordx4 v[64:67], v126, s[4:7], s80 offen
 buffer_load_dwordx4 v[68:71], v126, s[48:51], 0 offen
 s_waitcnt lgkmcnt(4)
 v_mfma_f32_16x16x32_bf16 v[24:27], v[88:91], v[144:147], v[24:27]
 s_setprio 1
 ds_read_b64_tr_b16 v[80:81], v10 offset:16384
 v_mfma_f32_16x16x32_bf16 v[24:27], v[92:95], v[152:155], v[24:27]
 ds_read_b64_tr_b16 v[82:83], v10 offset:16896
 v_mfma_f32_16x16x32_bf16 v[28:31], v[88:91], v[148:151], v[28:31]
 ds_read_b64_tr_b16 v[84:85], v10 offset:20480
 v_mfma_f32_16x16x32_bf16 v[28:31], v[92:95], v[156:159], v[28:31]
 s_setprio 0
 ds_read_b64_tr_b16 v[86:87], v10 offset:20992
 s_add_u32 m0, s53, 90112
 s_mul_i32 s88, s91, 196608
 buffer_load_dwordx4 v2, s[8:11], s88 offen lds
 s_waitcnt lgkmcnt(4)
 v_mfma_f32_16x16x32_bf16 v[32:35], v[96:99], v[144:147], v[32:35]
 s_setprio 1
 ds_read_b64_tr_b16 v[88:89], v9 offset:24576
 v_mfma_f32_16x16x32_bf16 v[32:35], v[100:103], v[152:155], v[32:35]
 ds_read_b64_tr_b16 v[90:91], v9 offset:25088
 v_mfma_f32_16x16x32_bf16 v[36:39], v[96:99], v[148:151], v[36:39]
 ds_read_b64_tr_b16 v[92:93], v9 offset:28672
 v_mfma_f32_16x16x32_bf16 v[36:39], v[100:103], v[156:159], v[36:39]
 s_setprio 0
 ds_read_b64_tr_b16 v[94:95], v9 offset:29184
 s_add_u32 m0, s53, 147456
 s_mul_i32 s89, s91, s61
 buffer_load_dwordx4 v3, s[12:15], s89 offen lds
 s_waitcnt lgkmcnt(4)
 v_mfma_f32_16x16x32_bf16 v[40:43], v[80:83], v[144:147], v[40:43]
 s_setprio 1
 ds_read_b64_tr_b16 v[96:97], v10 offset:24576
 v_mfma_f32_16x16x32_bf16 v[40:43], v[84:87], v[152:155], v[40:43]
 ds_read_b64_tr_b16 v[98:99], v10 offset:25088
 v_mfma_f32_16x16x32_bf16 v[44:47], v[80:83], v[148:151], v[44:47]
 ds_read_b64_tr_b16 v[100:101], v10 offset:28672
 v_mfma_f32_16x16x32_bf16 v[44:47], v[84:87], v[156:159], v[44:47]
 s_setprio 0
 ds_read_b64_tr_b16 v[102:103], v10 offset:29184
 s_add_u32 m0, s53, 155648
 s_add_u32 s89, s89, s87
 buffer_load_dwordx4 v3, s[16:19], s89 offen lds
 s_waitcnt vmcnt(7)
 s_barrier
 s_waitcnt lgkmcnt(4)
 v_mfma_f32_16x16x32_bf16 v[48:51], v[88:91], v[144:147], v[48:51]
 s_setprio 1
 ds_read_b128 v[160:163], v5 offset:32768
 ds_read_b64_tr_b16 v[80:81], v7 offset:16384
 v_mfma_f32_16x16x32_bf16 v[48:51], v[92:95], v[152:155], v[48:51]
 ds_read_b128 v[164:167], v5 offset:34816
 ds_read_b64_tr_b16 v[82:83], v7 offset:16896
 v_mfma_f32_16x16x32_bf16 v[52:55], v[88:91], v[148:151], v[52:55]
 ds_read_b128 v[168:171], v6 offset:32768
 ds_read_b64_tr_b16 v[84:85], v7 offset:20480
 v_mfma_f32_16x16x32_bf16 v[52:55], v[92:95], v[156:159], v[52:55]
 s_setprio 0
 ds_read_b128 v[172:175], v6 offset:34816
 ds_read_b64_tr_b16 v[86:87], v7 offset:20992
 s_add_u32 s91, s60, 4
 s_and_b32 s91, s91, 7
 s_add_u32 m0, s53, 0
 s_lshl_b32 s86, s91, 7
 buffer_load_dwordx4 v1, s[4:7], s86 offen lds
 s_waitcnt lgkmcnt(8)
 v_mfma_f32_16x16x32_bf16 v[56:59], v[96:99], v[144:147], v[56:59]
 s_setprio 1
 ds_read_b64_tr_b16 v[88:89], v8 offset:16384
 v_mfma_f32_16x16x32_bf16 v[56:59], v[100:103], v[152:155], v[56:59]
 ds_read_b64_tr_b16 v[90:91], v8 offset:16896
 v_mfma_f32_16x16x32_bf16 v[60:63], v[96:99], v[148:151], v[60:63]
 ds_read_b64_tr_b16 v[92:93], v8 offset:20480
 v_mfma_f32_16x16x32_bf16 v[60:63], v[100:103], v[156:159], v[60:63]
 s_setprio 0
 ds_read_b64_tr_b16 v[94:95], v8 offset:20992
 s_add_u32 m0, s53, 8192
 s_add_u32 s86, s86, 65536
 buffer_load_dwordx4 v1, s[4:7], s86 offen lds
 s_waitcnt lgkmcnt(4)
 v_mfma_f32_16x16x32_bf16 v[16:19], v[80:83], v[160:163], v[16:19]
 s_setprio 1
 ds_read_b64_tr_b16 v[96:97], v9 offset:32768
 v_mfma_f32_16x16x32_bf16 v[16:19], v[84:87], v[168:171], v[16:19]
 ds_read_b64_tr_b16 v[98:99], v9 offset:33280
 v_mfma_f32_16x16x32_bf16 v[20:23], v[80:83], v[164:167], v[20:23]
 ds_read_b64_tr_b16 v[100:101], v9 offset:36864
 v_mfma_f32_16x16x32_bf16 v[20:23], v[84:87], v[172:175], v[20:23]
 s_setprio 0
 ds_read_b64_tr_b16 v[102:103], v9 offset:37376
 s_add_u32 m0, s53, 65536
 s_mul_i32 s88, s91, 196608
 buffer_load_dwordx4 v2, s[8:11], s88 offen lds
 s_waitcnt lgkmcnt(4)
 v_mfma_f32_16x16x32_bf16 v[24:27], v[88:91], v[160:163], v[24:27]
 s_setprio 1
 ds_read_b64_tr_b16 v[80:81], v10 offset:32768
 v_mfma_f32_16x16x32_bf16 v[24:27], v[92:95], v[168:171], v[24:27]
 ds_read_b64_tr_b16 v[82:83], v10 offset:33280
 v_mfma_f32_16x16x32_bf16 v[28:31], v[88:91], v[164:167], v[28:31]
 ds_read_b64_tr_b16 v[84:85], v10 offset:36864
 v_mfma_f32_16x16x32_bf16 v[28:31], v[92:95], v[172:175], v[28:31]
 s_setprio 0
 ds_read_b64_tr_b16 v[86:87], v10 offset:37376
 s_add_u32 m0, s53, 98304
 s_mul_i32 s89, s91, s61
 buffer_load_dwordx4 v3, s[12:15], s89 offen lds
 s_waitcnt lgkmcnt(4)
 v_mfma_f32_16x16x32_bf16 v[32:35], v[96:99], v[160:163], v[32:35]
 s_setprio 1
 ds_read_b64_tr_b16 v[88:89], v9 offset:40960
 v_mfma_f32_16x16x32_bf16 v[32:35], v[100:103], v[168:171], v[32:35]
 ds_read_b64_tr_b16 v[90:91], v9 offset:41472
 v_mfma_f32_16x16x32_bf16 v[36:39], v[96:99], v[164:167], v[36:39]
 ds_read_b64_tr_b16 v[92:93], v9 offset:45056
 v_mfma_f32_16x16x32_bf16 v[36:39], v[100:103], v[172:175], v[36:39]
 s_setprio 0
 ds_read_b64_tr_b16 v[94:95], v9 offset:45568
 s_add_u32 m0, s53, 106496
 s_add_u32 s89, s89, s87
 buffer_load_dwordx4 v3, s[16:19], s89 offen lds
 v_mov_b32 v76, -1
 v_mov_b32 v77, -1
 v_mov_b32 v78, -1
 v_mov_b32 v79, -1
 s_lshl_b32 s67, s58, 3
 s_add_u32 s67, s67, s52
 s_waitcnt lgkmcnt(4)
 v_mfma_f32_16x16x32_bf16 v[40:43], v[80:83], v[160:163], v[40:43]
 s_setprio 1
 ds_read_b64_tr_b16 v[96:97], v10 offset:40960
 v_mfma_f32_16x16x32_bf16 v[40:43], v[84:87], v[168:171], v[40:43]
 ds_read_b64_tr_b16 v[98:99], v10 offset:41472
 v_mfma_f32_16x16x32_bf16 v[44:47], v[80:83], v[164:167], v[44:47]
 ds_read_b64_tr_b16 v[100:101], v10 offset:45056
 v_mfma_f32_16x16x32_bf16 v[44:47], v[84:87], v[172:175], v[44:47]
 s_setprio 0
 ds_read_b64_tr_b16 v[102:103], v10 offset:45568
 s_lshl_b32 s67, s67, 4
 s_add_u32 s67, s67, s56
 s_lshl_b32 s67, s67, 2
 s_add_u32 s67, s67, s59
 s_lshl_b32 s67, s67, 10
 s_add_u32 s67, s67, 1048576
 buffer_store_dwordx4 v[76:79], v126, s[28:31], s67 offen offset:0 sc1
 s_waitcnt vmcnt(2)
 s_barrier
 s_waitcnt lgkmcnt(4)
 v_mfma_f32_16x16x32_bf16 v[48:51], v[88:91], v[160:163], v[48:51]
 s_setprio 1
 ds_read_b128 v[176:179], v5 offset:49152
 ds_read_b64_tr_b16 v[80:81], v7 offset:24576
 v_mfma_f32_16x16x32_bf16 v[48:51], v[92:95], v[168:171], v[48:51]
 ds_read_b128 v[180:183], v5 offset:51200
 ds_read_b64_tr_b16 v[82:83], v7 offset:25088
 v_mfma_f32_16x16x32_bf16 v[52:55], v[88:91], v[164:167], v[52:55]
 ds_read_b128 v[184:187], v6 offset:49152
 ds_read_b64_tr_b16 v[84:85], v7 offset:28672
 v_mfma_f32_16x16x32_bf16 v[52:55], v[92:95], v[172:175], v[52:55]
 s_setprio 0
 ds_read_b128 v[188:191], v6 offset:51200
 ds_read_b64_tr_b16 v[86:87], v7 offset:29184
 s_add_u32 s91, s60, 5
 s_and_b32 s91, s91, 7
 s_add_u32 m0, s53, 16384
 s_lshl_b32 s86, s91, 7
 buffer_load_dwordx4 v1, s[4:7], s86 offen lds
 s_waitcnt lgkmcnt(8)
 v_mfma_f32_16x16x32_bf16 v[56:59], v[96:99], v[160:163], v[56:59]
 s_setprio 1
 ds_read_b64_tr_b16 v[88:89], v8 offset:24576
 v_mfma_f32_16x16x32_bf16 v[56:59], v[100:103], v[168:171], v[56:59]
 ds_read_b64_tr_b16 v[90:91], v8 offset:25088
 v_mfma_f32_16x16x32_bf16 v[60:63], v[96:99], v[164:167], v[60:63]
 ds_read_b64_tr_b16 v[92:93], v8 offset:28672
 v_mfma_f32_16x16x32_bf16 v[60:63], v[100:103], v[172:175], v[60:63]
 s_setprio 0
 ds_read_b64_tr_b16 v[94:95], v8 offset:29184
 s_add_u32 m0, s53, 24576
 s_add_u32 s86, s86, 65536
 buffer_load_dwordx4 v1, s[4:7], s86 offen lds
 v_mov_b32 v13, 0
 v_lshlrev_b32 v73, 16, v68
 v_and_b32 v75, 0xffff0000, v68
 v_lshlrev_b32 v72, 16, v64
 v_and_b32 v74, 0xffff0000, v64
 v_fmac_f32 v13, v72, v73
 v_fmac_f32 v13, v74, v75
 v_lshlrev_b32 v73, 16, v69
 v_and_b32 v75, 0xffff0000, v69
 s_waitcnt lgkmcnt(4)
 v_mfma_f32_16x16x32_bf16 v[16:19], v[80:83], v[176:179], v[16:19]
 s_setprio 1
 ds_read_b64_tr_b16 v[96:97], v9 offset:49152
 v_mfma_f32_16x16x32_bf16 v[16:19], v[84:87], v[184:187], v[16:19]
 ds_read_b64_tr_b16 v[98:99], v9 offset:49664
 v_mfma_f32_16x16x32_bf16 v[20:23], v[80:83], v[180:183], v[20:23]
 ds_read_b64_tr_b16 v[100:101], v9 offset:53248
 v_mfma_f32_16x16x32_bf16 v[20:23], v[84:87], v[188:191], v[20:23]
 s_setprio 0
 ds_read_b64_tr_b16 v[102:103], v9 offset:53760
 s_add_u32 m0, s53, 73728
 s_mul_i32 s88, s91, 196608
 buffer_load_dwordx4 v2, s[8:11], s88 offen lds
 v_lshlrev_b32 v72, 16, v65
 v_and_b32 v74, 0xffff0000, v65
 v_fmac_f32 v13, v72, v73
 v_fmac_f32 v13, v74, v75
 v_lshlrev_b32 v73, 16, v70
 v_and_b32 v75, 0xffff0000, v70
 v_lshlrev_b32 v72, 16, v66
 v_and_b32 v74, 0xffff0000, v66
 v_fmac_f32 v13, v72, v73
 s_waitcnt lgkmcnt(4)
 v_mfma_f32_16x16x32_bf16 v[24:27], v[88:91], v[176:179], v[24:27]
 s_setprio 1
 ds_read_b64_tr_b16 v[80:81], v10 offset:49152
 v_mfma_f32_16x16x32_bf16 v[24:27], v[92:95], v[184:187], v[24:27]
 ds_read_b64_tr_b16 v[82:83], v10 offset:49664
 v_mfma_f32_16x16x32_bf16 v[28:31], v[88:91], v[180:183], v[28:31]
 ds_read_b64_tr_b16 v[84:85], v10 offset:53248
 v_mfma_f32_16x16x32_bf16 v[28:31], v[92:95], v[188:191], v[28:31]
 s_setprio 0
 ds_read_b64_tr_b16 v[86:87], v10 offset:53760
 s_add_u32 m0, s53, 114688
 s_mul_i32 s89, s91, s61
 buffer_load_dwordx4 v3, s[12:15], s89 offen lds
 v_fmac_f32 v13, v74, v75
 v_lshlrev_b32 v73, 16, v71
 v_and_b32 v75, 0xffff0000, v71
 v_lshlrev_b32 v72, 16, v67
 v_and_b32 v74, 0xffff0000, v67
 v_fmac_f32 v13, v72, v73
 v_fmac_f32 v13, v74, v75
 s_nop 1
 v_add_f32_dpp v13, v13, v13 row_shr:1 row_mask:0xf bank_mask:0xf
 s_waitcnt lgkmcnt(4)
 v_mfma_f32_16x16x32_bf16 v[32:35], v[96:99], v[176:179], v[32:35]
 s_setprio 1
 ds_read_b64_tr_b16 v[88:89], v9 offset:57344
 v_mfma_f32_16x16x32_bf16 v[32:35], v[100:103], v[184:187], v[32:35]
 ds_read_b64_tr_b16 v[90:91], v9 offset:57856
 v_mfma_f32_16x16x32_bf16 v[36:39], v[96:99], v[180:183], v[36:39]
 ds_read_b64_tr_b16 v[92:93], v9 offset:61440
 v_mfma_f32_16x16x32_bf16 v[36:39], v[100:103], v[188:191], v[36:39]
 s_setprio 0
 ds_read_b64_tr_b16 v[94:95], v9 offset:61952
 s_add_u32 m0, s53, 122880
 s_add_u32 s89, s89, s87
 buffer_load_dwordx4 v3, s[16:19], s89 offen lds
 v_add_f32_dpp v13, v13, v13 row_shr:2 row_mask:0xf bank_mask:0xf
 s_waitcnt lgkmcnt(4)
 v_mfma_f32_16x16x32_bf16 v[40:43], v[80:83], v[176:179], v[40:43]
 s_setprio 1
 ds_read_b64_tr_b16 v[96:97], v10 offset:57344
 v_mfma_f32_16x16x32_bf16 v[40:43], v[84:87], v[184:187], v[40:43]
 ds_read_b64_tr_b16 v[98:99], v10 offset:57856
 v_mfma_f32_16x16x32_bf16 v[44:47], v[80:83], v[180:183], v[44:47]
 ds_read_b64_tr_b16 v[100:101], v10 offset:61440
 v_mfma_f32_16x16x32_bf16 v[44:47], v[84:87], v[188:191], v[44:47]
 s_setprio 0
 ds_read_b64_tr_b16 v[102:103], v10 offset:61952
 v_add_f32_dpp v13, v13, v13 row_shr:4 row_mask:0xf bank_mask:0xf
 s_waitcnt vmcnt(6)
 s_barrier
 s_cmp_lg_u32 s52, 0
 s_cbranch_scc1 L_s_1003
 buffer_load_dword v121, v118, s[44:47], 0 offen sc1
L_s_1003:
 s_waitcnt lgkmcnt(4)
 v_mfma_f32_16x16x32_bf16 v[48:51], v[88:91], v[176:179], v[48:51]
 s_setprio 1
 ds_read_b128 v[192:195], v5 offset:0
 ds_read_b64_tr_b16 v[80:81], v7 offset:0
 v_mfma_f32_16x16x32_bf16 v[48:51], v[92:95], v[184:187], v[48:51]
 ds_read_b128 v[196:199], v5 offset:2048
 ds_read_b64_tr_b16 v[82:83], v7 offset:512
 v_mfma_f32_16x16x32_bf16 v[52:55], v[88:91], v[180:183], v[52:55]
 ds_read_b128 v[200:203], v6 offset:0
 ds_read_b64_tr_b16 v[84:85], v7 offset:4096
 v_mfma_f32_16x16x32_bf16 v[52:55], v[92:95], v[188:191], v[52:55]
 s_setprio 0
 ds_read_b128 v[204:207], v6 offset:2048
 ds_read_b64_tr_b16 v[86:87], v7 offset:4608
 s_add_u32 s91, s60, 6
 s_and_b32 s91, s91, 7
 s_add_u32 m0, s53, 32768
 s_lshl_b32 s86, s91, 7
 buffer_load_dwordx4 v1, s[4:7], s86 offen lds
 s_waitcnt lgkmcnt(8)
 v_mfma_f32_16x16x32_bf16 v[56:59], v[96:99], v[176:179], v[56:59]
 s_setprio 1
 ds_read_b64_tr_b16 v[88:89], v8 offset:0
 v_mfma_f32_16x16x32_bf16 v[56:59], v[100:103], v[184:187], v[56:59]
 ds_read_b64_tr_b16 v[90:91], v8 offset:512
 v_mfma_f32_16x16x32_bf16 v[60:63], v[96:99], v[180:183], v[60:63]
 ds_read_b64_tr_b16 v[92:93], v8 offset:4096
 v_mfma_f32_16x16x32_bf16 v[60:63], v[100:103], v[188:191], v[60:63]
 s_setprio 0
 ds_read_b64_tr_b16 v[94:95], v8 offset:4608
 s_add_u32 m0, s53, 40960
 s_add_u32 s86, s86, 65536
 buffer_load_dwordx4 v1, s[4:7], s86 offen lds
 v_add_f32_dpp v13, v13, v13 row_shr:8 row_mask:0xf bank_mask:0xf
 s_waitcnt lgkmcnt(4)
 v_mfma_f32_16x16x32_bf16 v[16:19], v[80:83], v[192:195], v[16:19]
 s_setprio 1
 ds_read_b64_tr_b16 v[96:97], v9 offset:0
 v_mfma_f32_16x16x32_bf16 v[16:19], v[84:87], v[200:203], v[16:19]
 ds_read_b64_tr_b16 v[98:99], v9 offset:512
 v_mfma_f32_16x16x32_bf16 v[20:23], v[80:83], v[196:199], v[20:23]
 ds_read_b64_tr_b16 v[100:101], v9 offset:4096
 v_mfma_f32_16x16x32_bf16 v[20:23], v[84:87], v[204:207], v[20:23]
 s_setprio 0
 ds_read_b64_tr_b16 v[102:103], v9 offset:4608
 s_add_u32 m0, s53, 81920
 s_mul_i32 s88, s91, 196608
 buffer_load_dwordx4 v2, s[8:11], s88 offen lds
 v_add_f32_dpp v13, v13, v13 row_bcast:15 row_mask:0xa bank_mask:0xf
 s_waitcnt lgkmcnt(4)
 v_mfma_f32_16x16x32_bf16 v[24:27], v[88:91], v[192:195], v[24:27]
 s_setprio 1
 ds_read_b64_tr_b16 v[80:81], v10 offset:0
 v_mfma_f32_16x16x32_bf16 v[24:27], v[92:95], v[200:203], v[24:27]
 ds_read_b64_tr_b16 v[82:83], v10 offset:512
 v_mfma_f32_16x16x32_bf16 v[28:31], v[88:91], v[196:199], v[28:31]
 ds_read_b64_tr_b16 v[84:85], v10 offset:4096
 v_mfma_f32_16x16x32_bf16 v[28:31], v[92:95], v[204:207], v[28:31]
 s_setprio 0
 ds_read_b64_tr_b16 v[86:87], v10 offset:4608
 s_add_u32 m0, s53, 131072
 s_mul_i32 s89, s91, s61
 buffer_load_dwordx4 v3, s[12:15], s89 offen lds
 v_add_f32_dpp v13, v13, v13 row_bcast:31 row_mask:0xc bank_mask:0xf
 s_waitcnt lgkmcnt(4)
 v_mfma_f32_16x16x32_bf16 v[32:35], v[96:99], v[192:195], v[32:35]
 s_setprio 1
 ds_read_b64_tr_b16 v[88:89], v9 offset:8192
 v_mfma_f32_16x16x32_bf16 v[32:35], v[100:103], v[200:203], v[32:35]
 ds_read_b64_tr_b16 v[90:91], v9 offset:8704
 v_mfma_f32_16x16x32_bf16 v[36:39], v[96:99], v[196:199], v[36:39]
 ds_read_b64_tr_b16 v[92:93], v9 offset:12288
 v_mfma_f32_16x16x32_bf16 v[36:39], v[100:103], v[204:207], v[36:39]
 s_setprio 0
 ds_read_b64_tr_b16 v[94:95], v9 offset:12800
 s_add_u32 m0, s53, 139264
 s_add_u32 s89, s89, s87
 buffer_load_dwordx4 v3, s[16:19], s89 offen lds
 v_mul_f32 v13, 0x3fb8aa3b, v13
 v_or_b32 v13, 1, v13
 s_waitcnt lgkmcnt(4)
 v_mfma_f32_16x16x32_bf16 v[40:43], v[80:83], v[192:195], v[40:43]
 s_setprio 1
 ds_read_b64_tr_b16 v[96:97], v10 offset:8192
 v_mfma_f32_16x16x32_bf16 v[40:43], v[84:87], v[200:203], v[40:43]
 ds_read_b64_tr_b16 v[98:99], v10 offset:8704
 v_mfma_f32_16x16x32_bf16 v[44:47], v[80:83], v[196:199], v[44:47]
 ds_read_b64_tr_b16 v[100:101], v10 offset:12288
 v_mfma_f32_16x16x32_bf16 v[44:47], v[84:87], v[204:207], v[44:47]
 s_setprio 0
 ds_read_b64_tr_b16 v[102:103], v10 offset:12800
 s_cmp_lg_u32 s52, 0
 s_cbranch_scc1 L_s_1004
 s_waitcnt vmcnt(5)
 v_cmp_eq_u32 vcc, 0, v121
 s_nop 0
 s_cmp_lg_u64 vcc, 0
 s_cbranch_scc1 L_x_1005
L_r_1006:
L_s_1004:
 s_waitcnt vmcnt(5)
 s_barrier
 s_mov_b32 exec_lo, 0
 s_mov_b32 exec_hi, 0x80000000
 buffer_store_dword v13, v126, s[28:31], s65 offen sc1
 s_mov_b64 exec, -1
 s_waitcnt lgkmcnt(4)
 v_mfma_f32_16x16x32_bf16 v[48:51], v[88:91], v[192:195], v[48:51]
 s_setprio 1
 ds_read_b128 v[208:211], v5 offset:16384
 ds_read_b64_tr_b16 v[80:81], v7 offset:8192
 v_mfma_f32_16x16x32_bf16 v[48:51], v[92:95], v[200:203], v[48:51]
 ds_read_b128 v[212:215], v5 offset:18432
 ds_read_b64_tr_b16 v[82:83], v7 offset:8704
 v_mfma_f32_16x16x32_bf16 v[52:55], v[88:91], v[196:199], v[52:55]
 ds_read_b128 v[216:219], v6 offset:16384
 ds_read_b64_tr_b16 v[84:85], v7 offset:12288
 v_mfma_f32_16x16x32_bf16 v[52:55], v[92:95], v[204:207], v[52:55]
 s_setprio 0
 ds_read_b128 v[220:223], v6 offset:18432
 ds_read_b64_tr_b16 v[86:87], v7 offset:12800
 s_add_u32 s91, s60, 7
 s_and_b32 s91, s91, 7
 s_add_u32 m0, s53, 49152
 s_lshl_b32 s86, s91, 7
 buffer_load_dwordx4 v1, s[4:7], s86 offen lds
 s_waitcnt lgkmcnt(8)
 v_mfma_f32_16x16x32_bf16 v[56:59], v[96:99], v[192:195], v[56:59]
 s_setprio 1
 ds_read_b64_tr_b16 v[88:89], v8 offset:8192
 v_mfma_f32_16x16x32_bf16 v[56:59], v[100:103], v[200:203], v[56:59]
 ds_read_b64_tr_b16 v[90:91], v8 offset:8704
 v_mfma_f32_16x16x32_bf16 v[60:63], v[96:99], v[196:199], v[60:63]
 ds_read_b64_tr_b16 v[92:93], v8 offset:12288
 v_mfma_f32_16x16x32_bf16 v[60:63], v[100:103], v[204:207], v[60:63]
 s_setprio 0
 ds_read_b64_tr_b16 v[94:95], v8 offset:12800
 s_add_u32 m0, s53, 57344
 s_add_u32 s86, s86, 65536
 buffer_load_dwordx4 v1, s[4:7], s86 offen lds
 s_waitcnt lgkmcnt(4)
 v_mfma_f32_16x16x32_bf16 v[16:19], v[80:83], v[208:211], v[16:19]
 s_setprio 1
 ds_read_b64_tr_b16 v[96:97], v9 offset:16384
 v_mfma_f32_16x16x32_bf16 v[16:19], v[84:87], v[216:219], v[16:19]
 ds_read_b64_tr_b16 v[98:99], v9 offset:16896
 v_mfma_f32_16x16x32_bf16 v[20:23], v[80:83], v[212:215], v[20:23]
 ds_read_b64_tr_b16 v[100:101], v9 offset:20480
 v_mfma_f32_16x16x32_bf16 v[20:23], v[84:87], v[220:223], v[20:23]
 s_setprio 0
 ds_read_b64_tr_b16 v[102:103], v9 offset:20992
 s_add_u32 m0, s53, 90112
 s_mul_i32 s88, s91, 196608
 buffer_load_dwordx4 v2, s[8:11], s88 offen lds
 s_waitcnt lgkmcnt(4)
 v_mfma_f32_16x16x32_bf16 v[24:27], v[88:91], v[208:211], v[24:27]
 s_setprio 1
 ds_read_b64_tr_b16 v[80:81], v10 offset:16384
 v_mfma_f32_16x16x32_bf16 v[24:27], v[92:95], v[216:219], v[24:27]
 ds_read_b64_tr_b16 v[82:83], v10 offset:16896
 v_mfma_f32_16x16x32_bf16 v[28:31], v[88:91], v[212:215], v[28:31]
 ds_read_b64_tr_b16 v[84:85], v10 offset:20480
 v_mfma_f32_16x16x32_bf16 v[28:31], v[92:95], v[220:223], v[28:31]
 s_setprio 0
 ds_read_b64_tr_b16 v[86:87], v10 offset:20992
 s_add_u32 m0, s53, 147456
 s_mul_i32 s89, s91, s61
 buffer_load_dwordx4 v3, s[12:15], s89 offen lds
 s_waitcnt lgkmcnt(4)
 v_mfma_f32_16x16x32_bf16 v[32:35], v[96:99], v[208:211], v[32:35]
 s_setprio 1
 ds_read_b64_tr_b16 v[88:89], v9 offset:24576
 v_mfma_f32_16x16x32_bf16 v[32:35], v[100:103], v[216:219], v[32:35]
 ds_read_b64_tr_b16 v[90:91], v9 offset:25088
 v_mfma_f32_16x16x32_bf16 v[36:39], v[96:99], v[212:215], v[36:39]
 ds_read_b64_tr_b16 v[92:93], v9 offset:28672
 v_mfma_f32_16x16x32_bf16 v[36:39], v[100:103], v[220:223], v[36:39]
 s_setprio 0
 ds_read_b64_tr_b16 v[94:95], v9 offset:29184
 s_add_u32 m0, s53, 155648
 s_add_u32 s89, s89, s87
 buffer_load_dwordx4 v3, s[16:19], s89 offen lds
 s_waitcnt lgkmcnt(4)
 v_mfma_f32_16x16x32_bf16 v[40:43], v[80:83], v[208:211], v[40:43]
 s_setprio 1
 ds_read_b64_tr_b16 v[96:97], v10 offset:24576
 v_mfma_f32_16x16x32_bf16 v[40:43], v[84:87], v[216:219], v[40:43]
 ds_read_b64_tr_b16 v[98:99], v10 offset:25088
 v_mfma_f32_16x16x32_bf16 v[44:47], v[80:83], v[212:215], v[44:47]
 ds_read_b64_tr_b16 v[100:101], v10 offset:28672
 v_mfma_f32_16x16x32_bf16 v[44:47], v[84:87], v[220:223], v[44:47]
 s_setprio 0
 ds_read_b64_tr_b16 v[102:103], v10 offset:29184
 s_waitcnt vmcnt(6)
 s_barrier
 s_waitcnt lgkmcnt(4)
 v_mfma_f32_16x16x32_bf16 v[48:51], v[88:91], v[208:211], v[48:51]
 s_setprio 1
 ds_read_b128 v[224:227], v5 offset:32768
 ds_read_b64_tr_b16 v[80:81], v7 offset:16384
 v_mfma_f32_16x16x32_bf16 v[48:51], v[92:95], v[216:219], v[48:51]
 ds_read_b128 v[228:231], v5 offset:34816
 ds_read_b64_tr_b16 v[82:83], v7 offset:16896
 v_mfma_f32_16x16x32_bf16 v[52:55], v[88:91], v[212:215], v[52:55]
 ds_read_b128 v[232:235], v6 offset:32768
 ds_read_b64_tr_b16 v[84:85], v7 offset:20480
 v_mfma_f32_16x16x32_bf16 v[52:55], v[92:95], v[220:223], v[52:55]
 s_setprio 0
 ds_read_b128 v[236:239], v6 offset:34816
 ds_read_b64_tr_b16 v[86:87], v7 offset:20992
 s_add_u32 s91, s60, 0
 s_and_b32 s91, s91, 7
 s_add_u32 m0, s53, 98304
 s_mul_i32 s90, s91, 229376
 buffer_load_dwordx4 v4, s[20:23], s90 offen lds
 s_waitcnt lgkmcnt(8)
 v_mfma_f32_16x16x32_bf16 v[56:59], v[96:99], v[208:211], v[56:59]
 s_setprio 1
 ds_read_b64_tr_b16 v[88:89], v8 offset:16384
 v_mfma_f32_16x16x32_bf16 v[56:59], v[100:103], v[216:219], v[56:59]
 ds_read_b64_tr_b16 v[90:91], v8 offset:16896
 v_mfma_f32_16x16x32_bf16 v[60:63], v[96:99], v[212:215], v[60:63]
 ds_read_b64_tr_b16 v[92:93], v8 offset:20480
 v_mfma_f32_16x16x32_bf16 v[60:63], v[100:103], v[220:223], v[60:63]
 s_setprio 0
 ds_read_b64_tr_b16 v[94:95], v8 offset:20992
 s_add_u32 m0, s53, 106496
 s_nop 0
 buffer_load_dwordx4 v4, s[24:27], s90 offen lds
 s_waitcnt lgkmcnt(4)
 v_mfma_f32_16x16x32_bf16 v[16:19], v[80:83], v[224:227], v[16:19]
 s_setprio 1
 ds_read_b64_tr_b16 v[96:97], v9 offset:32768
 v_mfma_f32_16x16x32_bf16 v[16:19], v[84:87], v[232:235], v[16:19]
 ds_read_b64_tr_b16 v[98:99], v9 offset:33280
 v_mfma_f32_16x16x32_bf16 v[20:23], v[80:83], v[228:231], v[20:23]
 ds_read_b64_tr_b16 v[100:101], v9 offset:36864
 v_mfma_f32_16x16x32_bf16 v[20:23], v[84:87], v[236:239], v[20:23]
 s_setprio 0
 ds_read_b64_tr_b16 v[102:103], v9 offset:37376
 s_add_u32 s91, s60, 1
 s_and_b32 s91, s91, 7
 s_add_u32 m0, s53, 0
 s_mul_i32 s90, s91, 229376
 buffer_load_dwordx4 v4, s[20:23], s90 offen lds
 s_waitcnt lgkmcnt(4)
 v_mfma_f32_16x16x32_bf16 v[24:27], v[88:91], v[224:227], v[24:27]
 s_setprio 1
 ds_read_b64_tr_b16 v[80:81], v10 offset:32768
 v_mfma_f32_16x16x32_bf16 v[24:27], v[92:95], v[232:235], v[24:27]
 ds_read_b64_tr_b16 v[82:83], v10 offset:33280
 v_mfma_f32_16x16x32_bf16 v[28:31], v[88:91], v[228:231], v[28:31]
 ds_read_b64_tr_b16 v[84:85], v10 offset:36864
 v_mfma_f32_16x16x32_bf16 v[28:31], v[92:95], v[236:239], v[28:31]
 s_setprio 0
 ds_read_b64_tr_b16 v[86:87], v10 offset:37376
 s_add_u32 m0, s53, 8192
 s_nop 0
 buffer_load_dwordx4 v4, s[24:27], s90 offen lds
 s_waitcnt vmcnt(4)
 s_barrier
 s_waitcnt lgkmcnt(4)
 v_mfma_f32_16x16x32_bf16 v[32:35], v[96:99], v[224:227], v[32:35]
 s_setprio 1
 ds_read_b128 v[240:243], v5 offset:49152
 ds_read_b64_tr_b16 v[88:89], v7 offset:24576
 v_mfma_f32_16x16x32_bf16 v[32:35], v[100:103], v[232:235], v[32:35]
 ds_read_b128 v[244:247], v5 offset:51200
 ds_read_b64_tr_b16 v[90:91], v7 offset:25088
 v_mfma_f32_16x16x32_bf16 v[36:39], v[96:99], v[228:231], v[36:39]
 ds_read_b128 v[248:251], v6 offset:49152
 ds_read_b64_tr_b16 v[92:93], v7 offset:28672
 v_mfma_f32_16x16x32_bf16 v[36:39], v[100:103], v[236:239], v[36:39]
 s_setprio 0
 ds_read_b128 v[252:255], v6 offset:51200
 ds_read_b64_tr_b16 v[94:95], v7 offset:29184
 s_add_u32 s91, s60, 2
 s_and_b32 s91, s91, 7
 s_add_u32 m0, s53, 114688
 s_mul_i32 s90, s91, 229376
 buffer_load_dwordx4 v4, s[20:23], s90 offen lds
 s_waitcnt lgkmcnt(8)
 v_mfma_f32_16x16x32_bf16 v[40:43], v[80:83], v[224:227], v[40:43]
 s_setprio 1
 ds_read_b64_tr_b16 v[96:97], v8 offset:24576
 v_mfma_f32_16x16x32_bf16 v[40:43], v[84:87], v[232:235], v[40:43]
 ds_read_b64_tr_b16 v[98:99], v8 offset:25088
 v_mfma_f32_16x16x32_bf16 v[44:47], v[80:83], v[228:231], v[44:47]
 ds_read_b64_tr_b16 v[100:101], v8 offset:28672
 v_mfma_f32_16x16x32_bf16 v[44:47], v[84:87], v[236:239], v[44:47]
 s_setprio 0
 ds_read_b64_tr_b16 v[102:103], v8 offset:29184
 s_add_u32 m0, s53, 122880
 s_nop 0
 buffer_load_dwordx4 v4, s[24:27], s90 offen lds
 buffer_load_dword v14, v119, s[28:31], 0 offen sc1
 buffer_load_dword v15, v119, s[28:31], 0 offen offset:64 sc1
 s_waitcnt lgkmcnt(4)
 v_mfma_f32_16x16x32_bf16 v[16:19], v[88:91], v[240:243], v[16:19]
 s_setprio 1
 ds_read_b64_tr_b16 v[80:81], v9 offset:49152
 v_mfma_f32_16x16x32_bf16 v[16:19], v[92:95], v[248:251], v[16:19]
 ds_read_b64_tr_b16 v[82:83], v9 offset:49664
 v_mfma_f32_16x16x32_bf16 v[20:23], v[88:91], v[244:247], v[20:23]
 ds_read_b64_tr_b16 v[84:85], v9 offset:53248
 v_mfma_f32_16x16x32_bf16 v[20:23], v[92:95], v[252:255], v[20:23]
 s_setprio 0
 ds_read_b64_tr_b16 v[86:87], v9 offset:53760
 s_add_u32 s91, s60, 3
 s_and_b32 s91, s91, 7
 s_add_u32 m0, s53, 16384
 s_mul_i32 s90, s91, 229376
 buffer_load_dwordx4 v4, s[20:23], s90 offen lds
 s_waitcnt lgkmcnt(4)
 v_mfma_f32_16x16x32_bf16 v[24:27], v[96:99], v[240:243], v[24:27]
 s_setprio 1
 ds_read_b64_tr_b16 v[88:89], v10 offset:49152
 v_mfma_f32_16x16x32_bf16 v[24:27], v[100:103], v[248:251], v[24:27]
 ds_read_b64_tr_b16 v[90:91], v10 offset:49664
 v_mfma_f32_16x16x32_bf16 v[28:31], v[96:99], v[244:247], v[28:31]
 ds_read_b64_tr_b16 v[92:93], v10 offset:53248
 v_mfma_f32_16x16x32_bf16 v[28:31], v[100:103], v[252:255], v[28:31]
 s_setprio 0
 ds_read_b64_tr_b16 v[94:95], v10 offset:53760
 s_add_u32 m0, s53, 24576
 s_nop 0
 buffer_load_dwordx4 v4, s[24:27], s90 offen lds
 s_waitcnt lgkmcnt(4)
 v_mfma_f32_16x16x32_bf16 v[32:35], v[80:83], v[240:243], v[32:35]
 s_setprio 1
 ds_read_b64_tr_b16 v[96:97], v9 offset:40960
 v_mfma_f32_16x16x32_bf16 v[32:35], v[84:87], v[248:251], v[32:35]
 ds_read_b64_tr_b16 v[98:99], v9 offset:41472
 v_mfma_f32_16x16x32_bf16 v[36:39], v[80:83], v[244:247], v[36:39]
 ds_read_b64_tr_b16 v[100:101], v9 offset:45056
 v_mfma_f32_16x16x32_bf16 v[36:39], v[84:87], v[252:255], v[36:39]
 s_setprio 0
 ds_read_b64_tr_b16 v[102:103], v9 offset:45568
 s_lshl_b32 s67, s57, 1
 s_add_u32 s67, s67, s94
 s_lshl_b32 s67, s67, 18
 s_lshl_b32 s68, s95, 11
 s_add_u32 s67, s67, s68
 s_add_u32 s67, s67, 3145728
 s_add_u32 s68, s67, 131072
 v_mul_f32 v16, 0x3eb8aa3b, v16
 v_mul_f32 v17, 0x3eb8aa3b, v17
 v_mul_f32 v18, 0x3eb8aa3b, v18
 v_mul_f32 v19, 0x3eb8aa3b, v19
 v_mul_f32 v20, 0x3eb8aa3b, v20
 v_mul_f32 v21, 0x3eb8aa3b, v21
 v_mul_f32 v22, 0x3eb8aa3b, v22
 s_waitcnt lgkmcnt(4)
 v_mfma_f32_16x16x32_bf16 v[40:43], v[88:91], v[240:243], v[40:43]
 s_setprio 1
 ds_read_b64_tr_b16 v[80:81], v9 offset:57344
 v_mfma_f32_16x16x32_bf16 v[40:43], v[92:95], v[248:251], v[40:43]
 ds_read_b64_tr_b16 v[82:83], v9 offset:57856
 v_mfma_f32_16x16x32_bf16 v[44:47], v[88:91], v[244:247], v[44:47]
 ds_read_b64_tr_b16 v[84:85], v9 offset:61440
 v_mfma_f32_16x16x32_bf16 v[44:47], v[92:95], v[252:255], v[44:47]
 s_setprio 0
 ds_read_b64_tr_b16 v[86:87], v9 offset:61952
 v_mul_f32 v23, 0x3eb8aa3b, v23
 v_mul_f32 v24, 0x3eb8aa3b, v24
 v_mul_f32 v25, 0x3eb8aa3b, v25
 v_mul_f32 v26, 0x3eb8aa3b, v26
 v_mul_f32 v27, 0x3eb8aa3b, v27
 v_mul_f32 v28, 0x3eb8aa3b, v28
 v_mul_f32 v29, 0x3eb8aa3b, v29
 v_mul_f32 v30, 0x3eb8aa3b, v30
 v_mul_f32 v31, 0x3eb8aa3b, v31
 v_cvt_pk_bf16_f32 v104, v16, v17
 s_waitcnt lgkmcnt(4)
 v_mfma_f32_16x16x32_bf16 v[48:51], v[96:99], v[224:227], v[48:51]
 s_setprio 1
 ds_read_b64_tr_b16 v[88:89], v10 offset:40960
 v_mfma_f32_16x16x32_bf16 v[48:51], v[100:103], v[232:235], v[48:51]
 ds_read_b64_tr_b16 v[90:91], v10 offset:41472
 v_mfma_f32_16x16x32_bf16 v[52:55], v[96:99], v[228:231], v[52:55]
 ds_read_b64_tr_b16 v[92:93], v10 offset:45056
 v_mfma_f32_16x16x32_bf16 v[52:55], v[100:103], v[236:239], v[52:55]
 s_setprio 0
 ds_read_b64_tr_b16 v[94:95], v10 offset:45568
 v_cvt_pk_bf16_f32 v105, v18, v19
 v_cvt_pk_bf16_f32 v106, v20, v21
 v_cvt_pk_bf16_f32 v107, v22, v23
 v_cvt_pk_bf16_f32 v108, v24, v25
 v_cvt_pk_bf16_f32 v109, v26, v27
 v_cvt_pk_bf16_f32 v110, v28, v29
 v_cvt_pk_bf16_f32 v111, v30, v31
 v_permlane16_swap_b32 v104, v106
 v_permlane16_swap_b32 v105, v107
 s_waitcnt lgkmcnt(4)
 v_mfma_f32_16x16x32_bf16 v[48:51], v[80:83], v[240:243], v[48:51]
 s_setprio 1
 ds_read_b64_tr_b16 v[96:97], v10 offset:57344
 v_mfma_f32_16x16x32_bf16 v[48:51], v[84:87], v[248:251], v[48:51]
 ds_read_b64_tr_b16 v[98:99], v10 offset:57856
 v_mfma_f32_16x16x32_bf16 v[52:55], v[80:83], v[244:247], v[52:55]
 ds_read_b64_tr_b16 v[100:101], v10 offset:61440
 v_mfma_f32_16x16x32_bf16 v[52:55], v[84:87], v[252:255], v[52:55]
 s_setprio 0
 ds_read_b64_tr_b16 v[102:103], v10 offset:61952
 v_permlane16_swap_b32 v108, v110
 v_permlane16_swap_b32 v109, v111
 buffer_store_dwordx4 v[104:107], v126, s[28:31], s67 offen offset:0 sc1
 buffer_store_dwordx4 v[108:111], v126, s[28:31], s68 offen offset:0 sc1
 s_waitcnt vmcnt(2) lgkmcnt(4)
 s_barrier
 v_mfma_f32_16x16x32_bf16 v[56:59], v[88:91], v[224:227], v[56:59]
 s_setprio 1
 ds_read_b64_tr_b16 v[80:81], v9 offset:0
 v_mfma_f32_16x16x32_bf16 v[56:59], v[92:95], v[232:235], v[56:59]
 ds_read_b64_tr_b16 v[82:83], v9 offset:512
 v_mfma_f32_16x16x32_bf16 v[60:63], v[88:91], v[228:231], v[60:63]
 ds_read_b64_tr_b16 v[84:85], v9 offset:4096
 v_mfma_f32_16x16x32_bf16 v[60:63], v[92:95], v[236:239], v[60:63]
 s_setprio 0
 ds_read_b64_tr_b16 v[86:87], v9 offset:4608
 s_add_u32 s91, s60, 4
 s_and_b32 s91, s91, 7
 s_add_u32 m0, s53, 131072
 s_mul_i32 s90, s91, 229376
 buffer_load_dwordx4 v4, s[20:23], s90 offen lds
 s_waitcnt lgkmcnt(4)
 v_mfma_f32_16x16x32_bf16 v[56:59], v[96:99], v[240:243], v[56:59]
 s_setprio 1
 ds_read_b64_tr_b16 v[88:89], v10 offset:0
 v_mfma_f32_16x16x32_bf16 v[56:59], v[100:103], v[248:251], v[56:59]
 ds_read_b64_tr_b16 v[90:91], v10 offset:512
 v_mfma_f32_16x16x32_bf16 v[60:63], v[96:99], v[244:247], v[60:63]
 ds_read_b64_tr_b16 v[92:93], v10 offset:4096
 v_mfma_f32_16x16x32_bf16 v[60:63], v[100:103], v[252:255], v[60:63]
 s_setprio 0
 ds_read_b64_tr_b16 v[94:95], v10 offset:4608
 s_add_u32 m0, s53, 139264
 s_nop 0
 buffer_load_dwordx4 v4, s[24:27], s90 offen lds
 s_waitcnt lgkmcnt(4)
 v_mfma_f32_16x16x32_bf16 v[16:19], v[80:83], v[128:131], 0
 s_setprio 1
 ds_read_b64_tr_b16 v[96:97], v9 offset:8192
 v_mfma_f32_16x16x32_bf16 v[16:19], v[84:87], v[136:139], v[16:19]
 ds_read_b64_tr_b16 v[98:99], v9 offset:8704
 v_mfma_f32_16x16x32_bf16 v[20:23], v[80:83], v[132:135], 0
 ds_read_b64_tr_b16 v[100:101], v9 offset:12288
 v_mfma_f32_16x16x32_bf16 v[20:23], v[84:87], v[140:143], v[20:23]
 s_setprio 0
 ds_read_b64_tr_b16 v[102:103], v9 offset:12800
 s_add_u32 s91, s60, 5
 s_and_b32 s91, s91, 7
 s_add_u32 m0, s53, 32768
 s_mul_i32 s90, s91, 229376
 buffer_load_dwordx4 v4, s[20:23], s90 offen lds
 s_mul_i32 s67, s95, 114688
 s_lshl_b32 s68, s74, 1
 s_add_u32 s68, s68, s94
 s_lshl_b32 s68, s68, 11
 s_add_u32 s67, s67, s68
 s_add_u32 s67, s67, 9437184
 v_mul_f32 v32, 0xbfb8aa3b, v32
 s_waitcnt lgkmcnt(4)
 v_mfma_f32_16x16x32_bf16 v[24:27], v[88:91], v[128:131], 0
 s_setprio 1
 ds_read_b64_tr_b16 v[80:81], v10 offset:8192
 v_mfma_f32_16x16x32_bf16 v[24:27], v[92:95], v[136:139], v[24:27]
 ds_read_b64_tr_b16 v[82:83], v10 offset:8704
 v_mfma_f32_16x16x32_bf16 v[28:31], v[88:91], v[132:135], 0
 ds_read_b64_tr_b16 v[84:85], v10 offset:12288
 v_mfma_f32_16x16x32_bf16 v[28:31], v[92:95], v[140:143], v[28:31]
 s_setprio 0
 ds_read_b64_tr_b16 v[86:87], v10 offset:12800
 s_add_u32 m0, s53, 40960
 s_nop 0
 buffer_load_dwordx4 v4, s[24:27], s90 offen lds
 v_mul_f32 v33, 0xbfb8aa3b, v33
 v_mul_f32 v34, 0xbfb8aa3b, v34
 v_mul_f32 v35, 0xbfb8aa3b, v35
 v_mul_f32 v40, 0xbfb8aa3b, v40
 s_waitcnt lgkmcnt(4)
 v_mfma_f32_16x16x32_bf16 v[64:67], v[96:99], v[128:131], 0
 s_setprio 1
 ds_read_b64_tr_b16 v[88:89], v11 offset:0
 v_mfma_f32_16x16x32_bf16 v[64:67], v[100:103], v[136:139], v[64:67]
 ds_read_b64_tr_b16 v[90:91], v11 offset:512
 v_mfma_f32_16x16x32_bf16 v[68:71], v[96:99], v[132:135], 0
 ds_read_b64_tr_b16 v[92:93], v11 offset:4096
 v_mfma_f32_16x16x32_bf16 v[68:71], v[100:103], v[140:143], v[68:71]
 s_setprio 0
 ds_read_b64_tr_b16 v[94:95], v11 offset:4608
 v_mul_f32 v41, 0xbfb8aa3b, v41
 v_mul_f32 v42, 0xbfb8aa3b, v42
 v_mul_f32 v43, 0xbfb8aa3b, v43
 v_exp_f32 v32, v32
 v_exp_f32 v33, v33
 v_exp_f32 v34, v34
 s_waitcnt lgkmcnt(4)
 v_mfma_f32_16x16x32_bf16 v[72:75], v[80:83], v[128:131], 0
 s_setprio 1
 ds_read_b64_tr_b16 v[96:97], v12 offset:0
 v_mfma_f32_16x16x32_bf16 v[72:75], v[84:87], v[136:139], v[72:75]
 ds_read_b64_tr_b16 v[98:99], v12 offset:512
 v_mfma_f32_16x16x32_bf16 v[76:79], v[80:83], v[132:135], 0
 ds_read_b64_tr_b16 v[100:101], v12 offset:4096
 v_mfma_f32_16x16x32_bf16 v[76:79], v[84:87], v[140:143], v[76:79]
 s_setprio 0
 ds_read_b64_tr_b16 v[102:103], v12 offset:4608
 v_exp_f32 v35, v35
 v_exp_f32 v40, v40
 v_exp_f32 v41, v41
 v_exp_f32 v42, v42
 v_exp_f32 v43, v43
 s_waitcnt lgkmcnt(4)
 v_mfma_f32_16x16x32_bf16 v[16:19], v[88:91], v[144:147], v[16:19]
 s_setprio 1
 ds_read_b64_tr_b16 v[80:81], v11 offset:8192
 v_mfma_f32_16x16x32_bf16 v[16:19], v[92:95], v[152:155], v[16:19]
 ds_read_b64_tr_b16 v[82:83], v11 offset:8704
 v_mfma_f32_16x16x32_bf16 v[20:23], v[88:91], v[148:151], v[20:23]
 ds_read_b64_tr_b16 v[84:85], v11 offset:12288
 v_mfma_f32_16x16x32_bf16 v[20:23], v[92:95], v[156:159], v[20:23]
 s_setprio 0
 ds_read_b64_tr_b16 v[86:87], v11 offset:12800
 v_min_u32 v13, v14, v15
 v_cmp_eq_u32 vcc, 0, v13
 s_nop 0
 s_cmp_lg_u64 vcc, 0
 s_cbranch_scc1 L_x_1008
L_r_1009:
 v_exp_f32 v14, v14
 v_exp_f32 v15, v15
 v_add_f32 v14, 1.0, v14
 v_add_f32 v15, 1.0, v15
 v_min_f32 v14, 0x71800000, v14
 v_min_f32 v15, 0x71800000, v15
 v_fma_f32 v32, v32, v14, v14
 v_fma_f32 v33, v33, v14, v14
 v_fma_f32 v34, v34, v14, v14
 v_fma_f32 v35, v35, v14, v14
 s_waitcnt lgkmcnt(4)
 v_mfma_f32_16x16x32_bf16 v[24:27], v[96:99], v[144:147], v[24:27]
 s_setprio 1
 ds_read_b64_tr_b16 v[88:89], v12 offset:8192
 v_mfma_f32_16x16x32_bf16 v[24:27], v[100:103], v[152:155], v[24:27]
 ds_read_b64_tr_b16 v[90:91], v12 offset:8704
 v_mfma_f32_16x16x32_bf16 v[28:31], v[96:99], v[148:151], v[28:31]
 ds_read_b64_tr_b16 v[92:93], v12 offset:12288
 v_mfma_f32_16x16x32_bf16 v[28:31], v[100:103], v[156:159], v[28:31]
 s_setprio 0
 ds_read_b64_tr_b16 v[94:95], v12 offset:12800
 v_fma_f32 v40, v40, v14, v14
 v_fma_f32 v41, v41, v14, v14
 v_fma_f32 v42, v42, v14, v14
 v_fma_f32 v43, v43, v14, v14
 v_rcp_f32 v32, v32
 v_rcp_f32 v33, v33
 v_rcp_f32 v34, v34
 s_waitcnt lgkmcnt(4)
 v_mfma_f32_16x16x32_bf16 v[64:67], v[80:83], v[144:147], v[64:67]
 s_setprio 1
 ds_read_b64_tr_b16 v[96:97], v9 offset:16384
 v_mfma_f32_16x16x32_bf16 v[64:67], v[84:87], v[152:155], v[64:67]
 ds_read_b64_tr_b16 v[98:99], v9 offset:16896
 v_mfma_f32_16x16x32_bf16 v[68:71], v[80:83], v[148:151], v[68:71]
 ds_read_b64_tr_b16 v[100:101], v9 offset:20480
 v_mfma_f32_16x16x32_bf16 v[68:71], v[84:87], v[156:159], v[68:71]
 s_setprio 0
 ds_read_b64_tr_b16 v[102:103], v9 offset:20992
 v_rcp_f32 v35, v35
 v_rcp_f32 v40, v40
 v_rcp_f32 v41, v41
 v_rcp_f32 v42, v42
 v_rcp_f32 v43, v43
 s_waitcnt lgkmcnt(4)
 v_mfma_f32_16x16x32_bf16 v[72:75], v[88:91], v[144:147], v[72:75]
 s_setprio 1
 ds_read_b64_tr_b16 v[80:81], v10 offset:16384
 v_mfma_f32_16x16x32_bf16 v[72:75], v[92:95], v[152:155], v[72:75]
 ds_read_b64_tr_b16 v[82:83], v10 offset:16896
 v_mfma_f32_16x16x32_bf16 v[76:79], v[88:91], v[148:151], v[76:79]
 ds_read_b64_tr_b16 v[84:85], v10 offset:20480
 v_mfma_f32_16x16x32_bf16 v[76:79], v[92:95], v[156:159], v[76:79]
 s_setprio 0
 ds_read_b64_tr_b16 v[86:87], v10 offset:20992
 v_mul_f32 v32, v32, v48
 v_mul_f32 v33, v33, v49
 v_mul_f32 v34, v34, v50
 v_mul_f32 v35, v35, v51
 v_mul_f32 v40, v40, v56
 v_mul_f32 v41, v41, v57
 v_mul_f32 v42, v42, v58
 v_mul_f32 v43, v43, v59
 v_cvt_pk_bf16_f32 v104, v32, v33
 s_waitcnt lgkmcnt(4)
 v_mfma_f32_16x16x32_bf16 v[16:19], v[96:99], v[160:163], v[16:19]
 s_setprio 1
 ds_read_b64_tr_b16 v[88:89], v9 offset:24576
 v_mfma_f32_16x16x32_bf16 v[16:19], v[100:103], v[168:171], v[16:19]
 ds_read_b64_tr_b16 v[90:91], v9 offset:25088
 v_mfma_f32_16x16x32_bf16 v[20:23], v[96:99], v[164:167], v[20:23]
 ds_read_b64_tr_b16 v[92:93], v9 offset:28672
 v_mfma_f32_16x16x32_bf16 v[20:23], v[100:103], v[172:175], v[20:23]
 s_setprio 0
 ds_read_b64_tr_b16 v[94:95], v9 offset:29184
 v_cvt_pk_bf16_f32 v105, v34, v35
 v_cvt_pk_bf16_f32 v106, v40, v41
 v_cvt_pk_bf16_f32 v107, v42, v43
 v_mul_f32 v36, 0xbfb8aa3b, v36
 v_mul_f32 v37, 0xbfb8aa3b, v37
 v_mul_f32 v38, 0xbfb8aa3b, v38
 v_mul_f32 v39, 0xbfb8aa3b, v39
 v_mul_f32 v44, 0xbfb8aa3b, v44
 v_mul_f32 v45, 0xbfb8aa3b, v45
 s_waitcnt vmcnt(0)
 s_barrier
 s_cmp_lg_u32 s52, 0
 s_cbranch_scc1 L_s_1011
 s_lshl_b32 s62, s57, 7
 s_lshl_b32 s63, s56, 2
 s_add_u32 s62, s62, s63
 s_mov_b64 exec, 1
 buffer_store_dword v112, v126, s[28:31], s62 offen sc1
 s_mov_b64 exec, -1
L_s_1011:
 s_waitcnt lgkmcnt(4)
 v_mfma_f32_16x16x32_bf16 v[24:27], v[80:83], v[160:163], v[24:27]
 s_setprio 1
 ds_read_b64_tr_b16 v[96:97], v10 offset:24576
 v_mfma_f32_16x16x32_bf16 v[24:27], v[84:87], v[168:171], v[24:27]
 ds_read_b64_tr_b16 v[98:99], v10 offset:25088
 v_mfma_f32_16x16x32_bf16 v[28:31], v[80:83], v[164:167], v[28:31]
 ds_read_b64_tr_b16 v[100:101], v10 offset:28672
 v_mfma_f32_16x16x32_bf16 v[28:31], v[84:87], v[172:175], v[28:31]
 s_setprio 0
 ds_read_b64_tr_b16 v[102:103], v10 offset:29184
 s_add_u32 s91, s60, 6
 s_and_b32 s91, s91, 7
 s_add_u32 m0, s53, 147456
 s_mul_i32 s90, s91, 229376
 buffer_load_dwordx4 v4, s[20:23], s90 offen lds
 v_mul_f32 v46, 0xbfb8aa3b, v46
 v_mul_f32 v47, 0xbfb8aa3b, v47
 v_exp_f32 v36, v36
 s_waitcnt lgkmcnt(4)
 v_mfma_f32_16x16x32_bf16 v[64:67], v[88:91], v[160:163], v[64:67]
 s_setprio 1
 ds_read_b64_tr_b16 v[80:81], v11 offset:16384
 v_mfma_f32_16x16x32_bf16 v[64:67], v[92:95], v[168:171], v[64:67]
 ds_read_b64_tr_b16 v[82:83], v11 offset:16896
 v_mfma_f32_16x16x32_bf16 v[68:71], v[88:91], v[164:167], v[68:71]
 ds_read_b64_tr_b16 v[84:85], v11 offset:20480
 v_mfma_f32_16x16x32_bf16 v[68:71], v[92:95], v[172:175], v[68:71]
 s_setprio 0
 ds_read_b64_tr_b16 v[86:87], v11 offset:20992
 s_add_u32 m0, s53, 155648
 s_nop 0
 buffer_load_dwordx4 v4, s[24:27], s90 offen lds
 v_exp_f32 v37, v37
 v_exp_f32 v38, v38
 s_waitcnt lgkmcnt(4)
 v_mfma_f32_16x16x32_bf16 v[72:75], v[96:99], v[160:163], v[72:75]
 s_setprio 1
 ds_read_b64_tr_b16 v[88:89], v12 offset:16384
 v_mfma_f32_16x16x32_bf16 v[72:75], v[100:103], v[168:171], v[72:75]
 ds_read_b64_tr_b16 v[90:91], v12 offset:16896
 v_mfma_f32_16x16x32_bf16 v[76:79], v[96:99], v[164:167], v[76:79]
 ds_read_b64_tr_b16 v[92:93], v12 offset:20480
 v_mfma_f32_16x16x32_bf16 v[76:79], v[100:103], v[172:175], v[76:79]
 s_setprio 0
 ds_read_b64_tr_b16 v[94:95], v12 offset:20992
 s_add_u32 s91, s60, 7
 s_and_b32 s91, s91, 7
 s_add_u32 m0, s53, 49152
 s_mul_i32 s90, s91, 229376
 buffer_load_dwordx4 v4, s[20:23], s90 offen lds
 v_exp_f32 v39, v39
 v_exp_f32 v44, v44
 s_waitcnt lgkmcnt(4)
 v_mfma_f32_16x16x32_bf16 v[16:19], v[80:83], v[176:179], v[16:19]
 s_setprio 1
 ds_read_b64_tr_b16 v[96:97], v11 offset:24576
 v_mfma_f32_16x16x32_bf16 v[16:19], v[84:87], v[184:187], v[16:19]
 ds_read_b64_tr_b16 v[98:99], v11 offset:25088
 v_mfma_f32_16x16x32_bf16 v[20:23], v[80:83], v[180:183], v[20:23]
 ds_read_b64_tr_b16 v[100:101], v11 offset:28672
 v_mfma_f32_16x16x32_bf16 v[20:23], v[84:87], v[188:191], v[20:23]
 s_setprio 0
 ds_read_b64_tr_b16 v[102:103], v11 offset:29184
 s_add_u32 m0, s53, 57344
 s_nop 0
 buffer_load_dwordx4 v4, s[24:27], s90 offen lds
 v_exp_f32 v45, v45
 v_exp_f32 v46, v46
 s_waitcnt lgkmcnt(4)
 v_mfma_f32_16x16x32_bf16 v[24:27], v[88:91], v[176:179], v[24:27]
 s_setprio 1
 ds_read_b64_tr_b16 v[80:81], v12 offset:24576
 v_mfma_f32_16x16x32_bf16 v[24:27], v[92:95], v[184:187], v[24:27]
 ds_read_b64_tr_b16 v[82:83], v12 offset:25088
 v_mfma_f32_16x16x32_bf16 v[28:31], v[88:91], v[180:183], v[28:31]
 ds_read_b64_tr_b16 v[84:85], v12 offset:28672
 v_mfma_f32_16x16x32_bf16 v[28:31], v[92:95], v[188:191], v[28:31]
 s_setprio 0
 ds_read_b64_tr_b16 v[86:87], v12 offset:29184
 v_exp_f32 v47, v47
 v_fma_f32 v36, v36, v15, v15
 v_fma_f32 v37, v37, v15, v15
 v_fma_f32 v38, v38, v15, v15
 v_fma_f32 v39, v39, v15, v15
 v_fma_f32 v44, v44, v15, v15
 v_fma_f32 v45, v45, v15, v15
 v_fma_f32 v46, v46, v15, v15
 s_waitcnt lgkmcnt(4)
 v_mfma_f32_16x16x32_bf16 v[64:67], v[96:99], v[176:179], v[64:67]
 s_setprio 1
 ds_read_b64_tr_b16 v[88:89], v9 offset:32768
 v_mfma_f32_16x16x32_bf16 v[64:67], v[100:103], v[184:187], v[64:67]
 ds_read_b64_tr_b16 v[90:91], v9 offset:33280
 v_mfma_f32_16x16x32_bf16 v[68:71], v[96:99], v[180:183], v[68:71]
 ds_read_b64_tr_b16 v[92:93], v9 offset:36864
 v_mfma_f32_16x16x32_bf16 v[68:71], v[100:103], v[188:191], v[68:71]
 s_setprio 0
 ds_read_b64_tr_b16 v[94:95], v9 offset:37376
 v_fma_f32 v47, v47, v15, v15
 buffer_store_dwordx4 v[104:107], v122, s[28:31], s67 offen offset:0 sc1
 v_rcp_f32 v36, v36
 v_rcp_f32 v37, v37
 s_waitcnt lgkmcnt(4)
 v_mfma_f32_16x16x32_bf16 v[72:75], v[80:83], v[176:179], v[72:75]
 s_setprio 1
 ds_read_b64_tr_b16 v[96:97], v10 offset:32768
 v_mfma_f32_16x16x32_bf16 v[72:75], v[84:87], v[184:187], v[72:75]
 ds_read_b64_tr_b16 v[98:99], v10 offset:33280
 v_mfma_f32_16x16x32_bf16 v[76:79], v[80:83], v[180:183], v[76:79]
 ds_read_b64_tr_b16 v[100:101], v10 offset:36864
 v_mfma_f32_16x16x32_bf16 v[76:79], v[84:87], v[188:191], v[76:79]
 s_setprio 0
 ds_read_b64_tr_b16 v[102:103], v10 offset:37376
 v_rcp_f32 v38, v38
 v_rcp_f32 v39, v39
 v_rcp_f32 v44, v44
 v_rcp_f32 v45, v45
 v_rcp_f32 v46, v46
 s_waitcnt lgkmcnt(4)
 v_mfma_f32_16x16x32_bf16 v[16:19], v[88:91], v[192:195], v[16:19]
 s_setprio 1
 ds_read_b64_tr_b16 v[80:81], v9 offset:40960
 v_mfma_f32_16x16x32_bf16 v[16:19], v[92:95], v[200:203], v[16:19]
 ds_read_b64_tr_b16 v[82:83], v9 offset:41472
 v_mfma_f32_16x16x32_bf16 v[20:23], v[88:91], v[196:199], v[20:23]
 ds_read_b64_tr_b16 v[84:85], v9 offset:45056
 v_mfma_f32_16x16x32_bf16 v[20:23], v[92:95], v[204:207], v[20:23]
 s_setprio 0
 ds_read_b64_tr_b16 v[86:87], v9 offset:45568
 v_rcp_f32 v47, v47
 v_mul_f32 v36, v36, v52
 v_mul_f32 v37, v37, v53
 v_mul_f32 v38, v38, v54
 v_mul_f32 v39, v39, v55
 v_mul_f32 v44, v44, v60
 v_mul_f32 v45, v45, v61
 v_mul_f32 v46, v46, v62
 s_waitcnt lgkmcnt(4)
 v_mfma_f32_16x16x32_bf16 v[24:27], v[96:99], v[192:195], v[24:27]
 s_setprio 1
 ds_read_b64_tr_b16 v[88:89], v10 offset:40960
 v_mfma_f32_16x16x32_bf16 v[24:27], v[100:103], v[200:203], v[24:27]
 ds_read_b64_tr_b16 v[90:91], v10 offset:41472
 v_mfma_f32_16x16x32_bf16 v[28:31], v[96:99], v[196:199], v[28:31]
 ds_read_b64_tr_b16 v[92:93], v10 offset:45056
 v_mfma_f32_16x16x32_bf16 v[28:31], v[100:103], v[204:207], v[28:31]
 s_setprio 0
 ds_read_b64_tr_b16 v[94:95], v10 offset:45568
 v_mul_f32 v47, v47, v63
 v_cvt_pk_bf16_f32 v108, v36, v37
 v_cvt_pk_bf16_f32 v109, v38, v39
 v_cvt_pk_bf16_f32 v110, v44, v45
 v_cvt_pk_bf16_f32 v111, v46, v47
 buffer_store_dwordx4 v[108:111], v122, s[28:31], s67 offen offset:256 sc1
 s_waitcnt vmcnt(2)
 s_barrier
 s_waitcnt lgkmcnt(4)
 v_mfma_f32_16x16x32_bf16 v[64:67], v[80:83], v[192:195], v[64:67]
 s_setprio 1
 ds_read_b64_tr_b16 v[96:97], v11 offset:32768
 v_mfma_f32_16x16x32_bf16 v[64:67], v[84:87], v[200:203], v[64:67]
 ds_read_b64_tr_b16 v[98:99], v11 offset:33280
 v_mfma_f32_16x16x32_bf16 v[68:71], v[80:83], v[196:199], v[68:71]
 ds_read_b64_tr_b16 v[100:101], v11 offset:36864
 v_mfma_f32_16x16x32_bf16 v[68:71], v[84:87], v[204:207], v[68:71]
 s_setprio 0
 ds_read_b64_tr_b16 v[102:103], v11 offset:37376
 v_and_b32 v129, 0x1b, v0
 v_cmp_eq_u32 vcc, 16, v129
 v_mov_b32 v129, 0x3f803f80
 s_nop 0
 v_cndmask_b32 v128, 0, v129, vcc
 v_mov_b32 v129, v128
 v_mov_b32 v130, v128
 v_mov_b32 v131, v128
 v_mov_b32 v132, v128
 s_waitcnt lgkmcnt(4)
 v_mfma_f32_16x16x32_bf16 v[72:75], v[88:91], v[192:195], v[72:75]
 s_setprio 1
 ds_read_b64_tr_b16 v[80:81], v9 offset:49152
 v_mfma_f32_16x16x32_bf16 v[72:75], v[92:95], v[200:203], v[72:75]
 ds_read_b64_tr_b16 v[82:83], v9 offset:49664
 v_mfma_f32_16x16x32_bf16 v[76:79], v[88:91], v[196:199], v[76:79]
 ds_read_b64_tr_b16 v[84:85], v9 offset:53248
 v_mfma_f32_16x16x32_bf16 v[76:79], v[92:95], v[204:207], v[76:79]
 s_setprio 0
 ds_read_b64_tr_b16 v[86:87], v9 offset:53760
 v_mov_b32 v133, v128
 v_mov_b32 v134, v128
 v_mov_b32 v135, v128
 v_mov_b32 v136, v128
 v_mov_b32 v137, v128
 v_mov_b32 v138, v128
 v_mov_b32 v139, v128
 v_mov_b32 v140, v128
 v_mov_b32 v141, v128
 s_waitcnt lgkmcnt(4)
 v_mfma_f32_16x16x32_bf16 v[16:19], v[96:99], v[208:211], v[16:19]
 s_setprio 1
 ds_read_b64_tr_b16 v[88:89], v11 offset:49152
 v_mfma_f32_16x16x32_bf16 v[16:19], v[100:103], v[216:219], v[16:19]
 ds_read_b64_tr_b16 v[90:91], v11 offset:49664
 v_mfma_f32_16x16x32_bf16 v[20:23], v[96:99], v[212:215], v[20:23]
 ds_read_b64_tr_b16 v[92:93], v11 offset:53248
 v_mfma_f32_16x16x32_bf16 v[20:23], v[100:103], v[220:223], v[20:23]
 s_setprio 0
 ds_read_b64_tr_b16 v[94:95], v11 offset:53760
 v_mov_b32 v142, v128
 v_mov_b32 v143, v128
 v_mov_b32 v152, 0
 v_mov_b32 v153, 0
 v_mov_b32 v154, 0
 v_mov_b32 v155, 0
 v_xor_b32 v1, 32, v124
 v_xor_b32 v2, 64, v124
 v_xor_b32 v3, 96, v124
 s_waitcnt lgkmcnt(4)
 v_mfma_f32_16x16x32_bf16 v[16:19], v[80:83], v[224:227], v[16:19]
 s_setprio 1
 ds_read_b64_tr_b16 v[96:97], v12 offset:32768
 v_mfma_f32_16x16x32_bf16 v[16:19], v[84:87], v[232:235], v[16:19]
 ds_read_b64_tr_b16 v[98:99], v12 offset:33280
 v_mfma_f32_16x16x32_bf16 v[20:23], v[80:83], v[228:231], v[20:23]
 ds_read_b64_tr_b16 v[100:101], v12 offset:36864
 v_mfma_f32_16x16x32_bf16 v[20:23], v[84:87], v[236:239], v[20:23]
 s_setprio 0
 ds_read_b64_tr_b16 v[102:103], v12 offset:37376
 v_add_u32 v5, 98304, v124
 v_add_u32 v6, 98304, v1
 s_xor_b32 s68, s52, 4
 s_mul_i32 s68, s68, 2304
 s_add_u32 s68, s68, 98304
 v_add_u32 v7, s68, v126
 v_lshl_add_u32 v119, v0, 2, s68
 s_mul_i32 s68, s52, 2304
 s_add_u32 s68, s68, 98304
 v_add_u32 v8, s68, v126
 v_lshl_add_u32 v4, v0, 2, s68
 s_mul_i32 s67, s95, 114688
 s_waitcnt lgkmcnt(4)
 v_mfma_f32_16x16x32_bf16 v[16:19], v[88:91], v[240:243], v[16:19]
 s_setprio 1
 ds_read_b64_tr_b16 v[80:81], v10 offset:49152
 v_mfma_f32_16x16x32_bf16 v[16:19], v[92:95], v[248:251], v[16:19]
 ds_read_b64_tr_b16 v[82:83], v10 offset:49664
 v_mfma_f32_16x16x32_bf16 v[20:23], v[88:91], v[244:247], v[20:23]
 ds_read_b64_tr_b16 v[84:85], v10 offset:53248
 v_mfma_f32_16x16x32_bf16 v[20:23], v[92:95], v[252:255], v[20:23]
 s_setprio 0
 ds_read_b64_tr_b16 v[86:87], v10 offset:53760
 s_lshl_b32 s68, s75, 1
 s_add_u32 s68, s68, s94
 s_lshl_b32 s68, s68, 11
 s_add_u32 s67, s67, s68
 s_add_u32 s67, s67, 9437184
 buffer_load_dword v121, v120, s[28:31], 0 offen sc1
 s_waitcnt lgkmcnt(4)
 v_mfma_f32_16x16x32_bf16 v[24:27], v[96:99], v[208:211], v[24:27]
 s_setprio 1
 ds_read_b64_tr_b16 v[88:89], v12 offset:49152
 v_mfma_f32_16x16x32_bf16 v[24:27], v[100:103], v[216:219], v[24:27]
 ds_read_b64_tr_b16 v[90:91], v12 offset:49664
 v_mfma_f32_16x16x32_bf16 v[28:31], v[96:99], v[212:215], v[28:31]
 ds_read_b64_tr_b16 v[92:93], v12 offset:53248
 v_mfma_f32_16x16x32_bf16 v[28:31], v[100:103], v[220:223], v[28:31]
 s_setprio 0
 ds_read_b64_tr_b16 v[94:95], v12 offset:53760
 v_mul_f32 v16, 0xbfb8aa3b, v16
 v_mul_f32 v17, 0xbfb8aa3b, v17
 v_mul_f32 v18, 0xbfb8aa3b, v18
 v_mul_f32 v19, 0xbfb8aa3b, v19
 v_mul_f32 v20, 0xbfb8aa3b, v20
 v_mul_f32 v21, 0xbfb8aa3b, v21
 v_mul_f32 v22, 0xbfb8aa3b, v22
 v_mul_f32 v23, 0xbfb8aa3b, v23
 v_exp_f32 v16, v16
 v_exp_f32 v17, v17
 s_waitcnt lgkmcnt(4)
 v_mfma_f32_16x16x32_bf16 v[24:27], v[80:83], v[224:227], v[24:27]
 s_setprio 1
 ds_read_b64_tr_b16 v[96:97], v11 offset:40960
 v_mfma_f32_16x16x32_bf16 v[24:27], v[84:87], v[232:235], v[24:27]
 ds_read_b64_tr_b16 v[98:99], v11 offset:41472
 v_mfma_f32_16x16x32_bf16 v[28:31], v[80:83], v[228:231], v[28:31]
 ds_read_b64_tr_b16 v[100:101], v11 offset:45056
 v_mfma_f32_16x16x32_bf16 v[28:31], v[84:87], v[236:239], v[28:31]
 s_setprio 0
 ds_read_b64_tr_b16 v[102:103], v11 offset:45568
 v_exp_f32 v18, v18
 v_exp_f32 v19, v19
 v_exp_f32 v20, v20
 v_exp_f32 v21, v21
 v_exp_f32 v22, v22
 v_exp_f32 v23, v23
 s_waitcnt lgkmcnt(4)
 v_mfma_f32_16x16x32_bf16 v[24:27], v[88:91], v[240:243], v[24:27]
 s_setprio 1
 ds_read_b64_tr_b16 v[80:81], v9 offset:57344
 v_mfma_f32_16x16x32_bf16 v[24:27], v[92:95], v[248:251], v[24:27]
 ds_read_b64_tr_b16 v[82:83], v9 offset:57856
 v_mfma_f32_16x16x32_bf16 v[28:31], v[88:91], v[244:247], v[28:31]
 ds_read_b64_tr_b16 v[84:85], v9 offset:61440
 v_mfma_f32_16x16x32_bf16 v[28:31], v[92:95], v[252:255], v[28:31]
 s_setprio 0
 ds_read_b64_tr_b16 v[86:87], v9 offset:61952
 v_fma_f32 v16, v16, v14, v14
 v_fma_f32 v17, v17, v14, v14
 v_fma_f32 v18, v18, v14, v14
 v_fma_f32 v19, v19, v14, v14
 v_fma_f32 v20, v20, v15, v15
 v_fma_f32 v21, v21, v15, v15
 v_fma_f32 v22, v22, v15, v15
 v_fma_f32 v23, v23, v15, v15
 v_rcp_f32 v16, v16
 v_rcp_f32 v17, v17
 s_waitcnt vmcnt(0)
 v_cmp_eq_u32 vcc, 0, v121
 s_nop 0
 s_cmp_lg_u64 vcc, 0
 s_cbranch_scc1 L_x_1012
L_r_1013:
 s_waitcnt lgkmcnt(4)
 v_mfma_f32_16x16x32_bf16 v[64:67], v[96:99], v[208:211], v[64:67]
 s_setprio 1
 ds_read_b64_tr_b16 v[88:89], v11 offset:57344
 v_mfma_f32_16x16x32_bf16 v[64:67], v[100:103], v[216:219], v[64:67]
 ds_read_b64_tr_b16 v[90:91], v11 offset:57856
 v_mfma_f32_16x16x32_bf16 v[68:71], v[96:99], v[212:215], v[68:71]
 ds_read_b64_tr_b16 v[92:93], v11 offset:61440
 v_mfma_f32_16x16x32_bf16 v[68:71], v[100:103], v[220:223], v[68:71]
 s_setprio 0
 ds_read_b64_tr_b16 v[94:95], v11 offset:61952
 s_add_u32 m0, s53, 65536
 s_add_u32 s63, s66, 0
 buffer_load_dwordx4 v126, s[28:31], s63 offen sc1 lds
 v_rcp_f32 v18, v18
 v_rcp_f32 v19, v19
 v_rcp_f32 v20, v20
 s_waitcnt lgkmcnt(4)
 v_mfma_f32_16x16x32_bf16 v[64:67], v[80:83], v[224:227], v[64:67]
 s_setprio 1
 ds_read_b64_tr_b16 v[96:97], v12 offset:40960
 v_mfma_f32_16x16x32_bf16 v[64:67], v[84:87], v[232:235], v[64:67]
 ds_read_b64_tr_b16 v[98:99], v12 offset:41472
 v_mfma_f32_16x16x32_bf16 v[68:71], v[80:83], v[228:231], v[68:71]
 ds_read_b64_tr_b16 v[100:101], v12 offset:45056
 v_mfma_f32_16x16x32_bf16 v[68:71], v[84:87], v[236:239], v[68:71]
 s_setprio 0
 ds_read_b64_tr_b16 v[102:103], v12 offset:45568
 s_add_u32 m0, s53, 73728
 s_add_u32 s63, s66, 8192
 buffer_load_dwordx4 v126, s[28:31], s63 offen sc1 lds
 v_rcp_f32 v21, v21
 v_rcp_f32 v22, v22
 v_rcp_f32 v23, v23
 s_waitcnt lgkmcnt(4)
 v_mfma_f32_16x16x32_bf16 v[64:67], v[88:91], v[240:243], v[64:67]
 s_setprio 1
 ds_read_b64_tr_b16 v[80:81], v10 offset:57344
 v_mfma_f32_16x16x32_bf16 v[64:67], v[92:95], v[248:251], v[64:67]
 ds_read_b64_tr_b16 v[82:83], v10 offset:57856
 v_mfma_f32_16x16x32_bf16 v[68:71], v[88:91], v[244:247], v[68:71]
 ds_read_b64_tr_b16 v[84:85], v10 offset:61440
 v_mfma_f32_16x16x32_bf16 v[68:71], v[92:95], v[252:255], v[68:71]
 s_setprio 0
 ds_read_b64_tr_b16 v[86:87], v10 offset:61952
 buffer_load_dwordx4 v[148:151], v126, s[28:31], s85 offen sc1
 buffer_load_dwordx4 v[144:147], v126, s[28:31], s3 offen sc1
 v_mul_f32 v24, 0xbfb8aa3b, v24
 v_mul_f32 v25, 0xbfb8aa3b, v25
 v_mul_f32 v26, 0xbfb8aa3b, v26
 v_mul_f32 v27, 0xbfb8aa3b, v27
 v_mul_f32 v28, 0xbfb8aa3b, v28
 v_mul_f32 v29, 0xbfb8aa3b, v29
 s_waitcnt lgkmcnt(4)
 v_mfma_f32_16x16x32_bf16 v[72:75], v[96:99], v[208:211], v[72:75]
 s_setprio 1
 ds_read_b64_tr_b16 v[88:89], v12 offset:57344
 v_mfma_f32_16x16x32_bf16 v[72:75], v[100:103], v[216:219], v[72:75]
 ds_read_b64_tr_b16 v[90:91], v12 offset:57856
 v_mfma_f32_16x16x32_bf16 v[76:79], v[96:99], v[212:215], v[76:79]
 ds_read_b64_tr_b16 v[92:93], v12 offset:61440
 v_mfma_f32_16x16x32_bf16 v[76:79], v[100:103], v[220:223], v[76:79]
 s_setprio 0
 ds_read_b64_tr_b16 v[94:95], v12 offset:61952
 s_add_u32 m0, s53, 81920
 s_add_u32 s63, s66, 16384
 buffer_load_dwordx4 v126, s[28:31], s63 offen sc1 lds
 v_mul_f32 v30, 0xbfb8aa3b, v30
 v_mul_f32 v31, 0xbfb8aa3b, v31
 v_exp_f32 v24, v24
 v_exp_f32 v25, v25
 s_waitcnt lgkmcnt(4)
 v_mfma_f32_16x16x32_bf16 v[72:75], v[80:83], v[224:227], v[72:75]
 s_setprio 1
 v_mfma_f32_16x16x32_bf16 v[72:75], v[84:87], v[232:235], v[72:75]
 v_mfma_f32_16x16x32_bf16 v[76:79], v[80:83], v[228:231], v[76:79]
 v_mfma_f32_16x16x32_bf16 v[76:79], v[84:87], v[236:239], v[76:79]
 s_setprio 0
 s_add_u32 m0, s53, 90112
 s_add_u32 s63, s66, 24576
 buffer_load_dwordx4 v126, s[28:31], s63 offen sc1 lds
 v_exp_f32 v26, v26
 v_exp_f32 v27, v27
 v_exp_f32 v28, v28
 s_waitcnt lgkmcnt(0)
 v_mfma_f32_16x16x32_bf16 v[72:75], v[88:91], v[240:243], v[72:75]
 s_setprio 1
 v_mfma_f32_16x16x32_bf16 v[72:75], v[92:95], v[248:251], v[72:75]
 v_mfma_f32_16x16x32_bf16 v[76:79], v[88:91], v[244:247], v[76:79]
 v_mfma_f32_16x16x32_bf16 v[76:79], v[92:95], v[252:255], v[76:79]
 s_setprio 0
 v_exp_f32 v29, v29
 v_exp_f32 v30, v30
 v_exp_f32 v31, v31
 v_fma_f32 v24, v24, v14, v14
 v_fma_f32 v25, v25, v14, v14
 v_fma_f32 v26, v26, v14, v14
 v_fma_f32 v27, v27, v14, v14
 v_fma_f32 v28, v28, v15, v15
 v_fma_f32 v29, v29, v15, v15
 v_fma_f32 v30, v30, v15, v15
 v_fma_f32 v31, v31, v15, v15
 v_rcp_f32 v24, v24
 v_rcp_f32 v25, v25
 v_rcp_f32 v26, v26
 v_rcp_f32 v27, v27
 v_rcp_f32 v28, v28
 v_rcp_f32 v29, v29
 v_rcp_f32 v30, v30
 v_rcp_f32 v31, v31
 v_mul_f32 v16, v16, v64
 v_mul_f32 v17, v17, v65
 v_mul_f32 v18, v18, v66
 v_mul_f32 v19, v19, v67
 v_mul_f32 v20, v20, v68
 v_mul_f32 v21, v21, v69
 v_mul_f32 v22, v22, v70
 v_mul_f32 v23, v23, v71
 v_cvt_pk_bf16_f32 v192, v16, v17
 v_cvt_pk_bf16_f32 v193, v18, v19
 v_cvt_pk_bf16_f32 v196, v20, v21
 v_cvt_pk_bf16_f32 v197, v22, v23
 v_mfma_f32_32x32x16_bf16 v[32:47], v[152:155], v[152:155], 0
 v_mfma_f32_32x32x16_bf16 v[48:63], v[152:155], v[152:155], 0
 s_waitcnt vmcnt(2)
 v_max3_u32 v13, v144, v145, v146
 v_max3_u32 v13, v13, v147, v148
 v_max3_u32 v13, v13, v149, v150
 v_max_u32 v13, v13, v151
 v_cmp_eq_u32 vcc, -1, v13
 s_nop 0
 s_cmp_lg_u64 vcc, 0
 s_cbranch_scc1 L_x_1015
L_r_1016:
 s_barrier
 ds_read_b128 v[104:107], v113 offset:0
 s_mov_b64 exec, s[96:97]
 ds_read_b128 v[128:131], v114 offset:1024
 ds_read_b128 v[132:135], v114 offset:1536
 s_mov_b64 exec, -1
 v_mul_f32 v24, v24, v72
 v_mul_f32 v25, v25, v73
 v_mul_f32 v26, v26, v74
 v_mul_f32 v27, v27, v75
 v_mul_f32 v28, v28, v76
 v_mul_f32 v29, v29, v77
 v_mul_f32 v30, v30, v78
 v_mul_f32 v31, v31, v79
 v_cvt_pk_bf16_f32 v194, v24, v25
 v_cvt_pk_bf16_f32 v195, v26, v27
 v_cvt_pk_bf16_f32 v198, v28, v29
 v_cvt_pk_bf16_f32 v199, v30, v31
 s_waitcnt lgkmcnt(2)
 v_mfma_f32_32x32x16_bf16 v[160:175], v[104:107], v[144:147], 0
 v_add_u32 v14, 98304, v2
 v_add_u32 v15, 98304, v3
 v_mov_b32 v152, -1
 v_mov_b32 v153, -1
 v_mov_b32 v154, -1
 v_mov_b32 v155, -1
 s_lshl_b32 s70, s95, 4
 s_add_u32 s70, s70, s57
 s_lshl_b32 s70, s70, 1
 s_add_u32 s70, s70, s94
 s_lshl_b32 s68, s70, 10
 s_add_u32 s68, s68, 7340032
 s_waitcnt lgkmcnt(0)
 v_exp_f32 v160, v160
 v_exp_f32 v161, v161
 ds_read_b128 v[108:111], v113 offset:4096
 s_setprio 3
 v_exp_f32 v162, v162
 v_exp_f32 v163, v163
 v_exp_f32 v164, v164
 v_mfma_f32_32x32x16_bf16 v[176:191], v[104:107], v[148:151], 0
 v_exp_f32 v165, v165
 v_exp_f32 v166, v166
 v_exp_f32 v167, v167
 v_exp_f32 v168, v168
 v_exp_f32 v169, v169
 v_smfmac_f32_32x32x32_bf16 v[32:47], v[128:131], v[160:167], v112
 s_mov_b64 exec, s[96:97]
 ds_read_b128 v[136:139], v114 offset:5120
 ds_read_b128 v[140:143], v114 offset:5632
 s_mov_b64 exec, -1
 v_exp_f32 v170, v170
 v_exp_f32 v171, v171
 v_exp_f32 v172, v172
 v_exp_f32 v173, v173
 buffer_store_dwordx4 v[192:195], v122, s[28:31], s67 offen offset:0 sc1
 v_exp_f32 v174, v174
 v_exp_f32 v175, v175
 v_exp_f32 v176, v176
 v_exp_f32 v177, v177
 v_smfmac_f32_32x32x32_bf16 v[32:47], v[132:135], v[168:175], v112
 s_waitcnt lgkmcnt(0)
 v_exp_f32 v178, v178
 v_exp_f32 v179, v179
 v_exp_f32 v180, v180
 v_mfma_f32_32x32x16_bf16 v[160:175], v[108:111], v[144:147], 0
 buffer_store_dwordx4 v[196:199], v122, s[28:31], s67 offen offset:256 sc1
 v_exp_f32 v181, v181
 v_exp_f32 v182, v182
 v_exp_f32 v183, v183
 v_exp_f32 v184, v184
 v_exp_f32 v185, v185
 v_smfmac_f32_32x32x32_bf16 v[48:63], v[128:131], v[176:183], v112
 buffer_store_dwordx4 v[152:155], v126, s[28:31], s68 offen offset:0 sc1
 v_exp_f32 v186, v186
 v_exp_f32 v187, v187
 v_exp_f32 v188, v188
 v_exp_f32 v189, v189
 v_exp_f32 v190, v190
 v_exp_f32 v191, v191
 v_exp_f32 v160, v160
 v_exp_f32 v161, v161
 v_smfmac_f32_32x32x32_bf16 v[48:63], v[132:135], v[184:191], v112
 ds_read_b128 v[104:107], v113 offset:8192
 s_setprio 2
 v_exp_f32 v162, v162
 v_exp_f32 v163, v163
 v_exp_f32 v164, v164
 v_mfma_f32_32x32x16_bf16 v[176:191], v[108:111], v[148:151], 0
 v_exp_f32 v165, v165
 v_exp_f32 v166, v166
 v_exp_f32 v167, v167
 v_exp_f32 v168, v168
 v_exp_f32 v169, v169
 v_smfmac_f32_32x32x32_bf16 v[32:47], v[136:139], v[160:167], v112
 s_mov_b64 exec, s[96:97]
 ds_read_b128 v[128:131], v114 offset:9216
 ds_read_b128 v[132:135], v114 offset:9728
 s_mov_b64 exec, -1
 v_exp_f32 v170, v170
 v_exp_f32 v171, v171
 v_exp_f32 v172, v172
 v_exp_f32 v173, v173
 s_add_u32 m0, s53, 98304
 s_add_u32 s63, s66, 32768
 buffer_load_dwordx4 v126, s[28:31], s63 offen sc1 lds
 v_exp_f32 v174, v174
 v_exp_f32 v175, v175
 v_exp_f32 v176, v176
 v_exp_f32 v177, v177
 v_smfmac_f32_32x32x32_bf16 v[32:47], v[140:143], v[168:175], v112
 s_waitcnt lgkmcnt(0)
 v_exp_f32 v178, v178
 v_exp_f32 v179, v179
 v_exp_f32 v180, v180
 v_mfma_f32_32x32x16_bf16 v[160:175], v[104:107], v[144:147], 0
 s_add_u32 m0, s53, 106496
 s_add_u32 s63, s66, 40960
 buffer_load_dwordx4 v126, s[28:31], s63 offen sc1 lds
 v_exp_f32 v181, v181
 v_exp_f32 v182, v182
 v_exp_f32 v183, v183
 v_exp_f32 v184, v184
 v_exp_f32 v185, v185
 v_smfmac_f32_32x32x32_bf16 v[48:63], v[136:139], v[176:183], v112
 s_add_u32 m0, s53, 114688
 s_add_u32 s63, s66, 49152
 buffer_load_dwordx4 v126, s[28:31], s63 offen sc1 lds
 v_exp_f32 v186, v186
 v_exp_f32 v187, v187
 v_exp_f32 v188, v188
 v_exp_f32 v189, v189
 v_exp_f32 v190, v190
 v_exp_f32 v191, v191
 v_exp_f32 v160, v160
 v_exp_f32 v161, v161
 v_smfmac_f32_32x32x32_bf16 v[48:63], v[140:143], v[184:191], v112
 ds_read_b128 v[108:111], v113 offset:12288
 s_setprio 1
 v_exp_f32 v162, v162
 v_exp_f32 v163, v163
 v_exp_f32 v164, v164
 v_mfma_f32_32x32x16_bf16 v[176:191], v[104:107], v[148:151], 0
 v_exp_f32 v165, v165
 v_exp_f32 v166, v166
 v_exp_f32 v167, v167
 v_exp_f32 v168, v168
 v_exp_f32 v169, v169
 v_smfmac_f32_32x32x32_bf16 v[32:47], v[128:131], v[160:167], v112
 s_mov_b64 exec, s[96:97]
 ds_read_b128 v[136:139], v114 offset:13312
 ds_read_b128 v[140:143], v114 offset:13824
 s_mov_b64 exec, -1
 v_exp_f32 v170, v170
 v_exp_f32 v171, v171
 v_exp_f32 v172, v172
 v_exp_f32 v173, v173
 v_exp_f32 v174, v174
 v_exp_f32 v175, v175
 v_exp_f32 v176, v176
 v_exp_f32 v177, v177
 v_smfmac_f32_32x32x32_bf16 v[32:47], v[132:135], v[168:175], v112
 s_waitcnt lgkmcnt(0)
 v_exp_f32 v178, v178
 v_exp_f32 v179, v179
 v_exp_f32 v180, v180
 v_mfma_f32_32x32x16_bf16 v[160:175], v[108:111], v[144:147], 0
 s_add_u32 m0, s53, 122880
 s_add_u32 s63, s66, 57344
 buffer_load_dwordx4 v126, s[28:31], s63 offen sc1 lds
 v_exp_f32 v181, v181
 v_exp_f32 v182, v182
 v_exp_f32 v183, v183
 v_exp_f32 v184, v184
 v_exp_f32 v185, v185
 v_smfmac_f32_32x32x32_bf16 v[48:63], v[128:131], v[176:183], v112
 s_setprio 0
 s_add_u32 s82, s81, 0
 s_cmp_ge_u32 s82, 7
 s_cselect_b32 s63, 7, 0
 s_sub_u32 s82, s82, s63
 s_add_u32 m0, s53, 0
 s_lshl_b32 s82, s82, 16
 buffer_load_dwordx4 v116, s[32:35], s82 offen lds
 v_exp_f32 v186, v186
 v_exp_f32 v187, v187
 v_exp_f32 v188, v188
 v_exp_f32 v189, v189
 v_exp_f32 v190, v190
 v_exp_f32 v191, v191
 s_waitcnt vmcnt(8)
 s_barrier
 v_exp_f32 v160, v160
 v_exp_f32 v161, v161
 v_smfmac_f32_32x32x32_bf16 v[48:63], v[132:135], v[184:191], v112
 ds_read_b128 v[104:107], v113 offset:16384
 s_setprio 3
 v_exp_f32 v162, v162
 v_exp_f32 v163, v163
 v_exp_f32 v164, v164
 v_mfma_f32_32x32x16_bf16 v[176:191], v[108:111], v[148:151], 0
 v_exp_f32 v165, v165
 v_exp_f32 v166, v166
 v_exp_f32 v167, v167
 v_exp_f32 v168, v168
 v_exp_f32 v169, v169
 v_smfmac_f32_32x32x32_bf16 v[32:47], v[136:139], v[160:167], v112
 s_mov_b64 exec, s[96:97]
 ds_read_b128 v[128:131], v114 offset:17408
 ds_read_b128 v[132:135], v114 offset:17920
 s_mov_b64 exec, -1
 v_exp_f32 v170, v170
 v_exp_f32 v171, v171
 v_exp_f32 v172, v172
 v_exp_f32 v173, v173
 v_exp_f32 v174, v174
 v_exp_f32 v175, v175
 v_exp_f32 v176, v176
 v_exp_f32 v177, v177
 v_smfmac_f32_32x32x32_bf16 v[32:47], v[140:143], v[168:175], v112
 s_waitcnt lgkmcnt(0)
 v_exp_f32 v178, v178
 v_exp_f32 v179, v179
 v_exp_f32 v180, v180
 v_mfma_f32_32x32x16_bf16 v[160:175], v[104:107], v[144:147], 0
 v_exp_f32 v181, v181
 v_exp_f32 v182, v182
 v_exp_f32 v183, v183
 v_exp_f32 v184, v184
 v_exp_f32 v185, v185
 v_smfmac_f32_32x32x32_bf16 v[48:63], v[136:139], v[176:183], v112
 s_add_u32 m0, s53, 8192
 s_add_u32 s82, s82, 458752
 buffer_load_dwordx4 v116, s[32:35], s82 offen lds
 v_exp_f32 v186, v186
 v_exp_f32 v187, v187
 v_exp_f32 v188, v188
 v_exp_f32 v189, v189
 v_exp_f32 v190, v190
 v_exp_f32 v191, v191
 v_exp_f32 v160, v160
 v_exp_f32 v161, v161
 v_smfmac_f32_32x32x32_bf16 v[48:63], v[140:143], v[184:191], v112
 ds_read_b128 v[108:111], v113 offset:20480
 v_exp_f32 v162, v162
 v_exp_f32 v163, v163
 v_exp_f32 v164, v164
 v_mfma_f32_32x32x16_bf16 v[176:191], v[104:107], v[148:151], 0
 v_exp_f32 v165, v165
 v_exp_f32 v166, v166
 v_exp_f32 v167, v167
 v_exp_f32 v168, v168
 v_exp_f32 v169, v169
 v_smfmac_f32_32x32x32_bf16 v[32:47], v[128:131], v[160:167], v112
 s_mov_b64 exec, s[96:97]
 ds_read_b128 v[136:139], v114 offset:21504
 ds_read_b128 v[140:143], v114 offset:22016
 s_mov_b64 exec, -1
 v_exp_f32 v170, v170
 v_exp_f32 v171, v171
 v_exp_f32 v172, v172
 v_exp_f32 v173, v173
 v_exp_f32 v174, v174
 v_exp_f32 v175, v175
 v_exp_f32 v176, v176
 v_exp_f32 v177, v177
 v_smfmac_f32_32x32x32_bf16 v[32:47], v[132:135], v[168:175], v112
 s_waitcnt lgkmcnt(0)
 v_exp_f32 v178, v178
 v_exp_f32 v179, v179
 v_exp_f32 v180, v180
 v_mfma_f32_32x32x16_bf16 v[160:175], v[108:111], v[144:147], 0
 v_exp_f32 v181, v181
 v_exp_f32 v182, v182
 v_exp_f32 v183, v183
 v_exp_f32 v184, v184
 v_exp_f32 v185, v185
 v_smfmac_f32_32x32x32_bf16 v[48:63], v[128:131], v[176:183], v112
 s_add_u32 m0, s53, 16384
 s_add_u32 s82, s82, 458752
 buffer_load_dwordx4 v116, s[32:35], s82 offen lds
 v_exp_f32 v186, v186
 v_exp_f32 v187, v187
 v_exp_f32 v188, v188
 v_exp_f32 v189, v189
 v_exp_f32 v190, v190
 v_exp_f32 v191, v191
 v_exp_f32 v160, v160
 v_exp_f32 v161, v161
 v_smfmac_f32_32x32x32_bf16 v[48:63], v[132:135], v[184:191], v112
 ds_read_b128 v[104:107], v113 offset:24576
 s_setprio 2
 v_exp_f32 v162, v162
 v_exp_f32 v163, v163
 v_exp_f32 v164, v164
 v_mfma_f32_32x32x16_bf16 v[176:191], v[108:111], v[148:151], 0
 v_exp_f32 v165, v165
 v_exp_f32 v166, v166
 v_exp_f32 v167, v167
 v_exp_f32 v168, v168
 v_exp_f32 v169, v169
 v_smfmac_f32_32x32x32_bf16 v[32:47], v[136:139], v[160:167], v112
 s_mov_b64 exec, s[96:97]
 ds_read_b128 v[128:131], v114 offset:25600
 ds_read_b128 v[132:135], v114 offset:26112
 s_mov_b64 exec, -1
 v_exp_f32 v170, v170
 v_exp_f32 v171, v171
 v_exp_f32 v172, v172
 v_exp_f32 v173, v173
 v_exp_f32 v174, v174
 v_exp_f32 v175, v175
 v_exp_f32 v176, v176
 v_exp_f32 v177, v177
 v_smfmac_f32_32x32x32_bf16 v[32:47], v[140:143], v[168:175], v112
 s_waitcnt lgkmcnt(0)
 v_exp_f32 v178, v178
 v_exp_f32 v179, v179
 v_exp_f32 v180, v180
 v_mfma_f32_32x32x16_bf16 v[160:175], v[104:107], v[144:147], 0
 s_lshl_b32 s62, s70, 2
 s_add_u32 s62, s62, 4096
 s_waitcnt vmcnt(7)
 s_mov_b64 exec, 1
 buffer_store_dword v112, v126, s[28:31], s62 offen sc1
 s_mov_b64 exec, -1
 v_exp_f32 v181, v181
 v_exp_f32 v182, v182
 v_exp_f32 v183, v183
 v_exp_f32 v184, v184
 v_exp_f32 v185, v185
 v_smfmac_f32_32x32x32_bf16 v[48:63], v[136:139], v[176:183], v112
 s_add_u32 m0, s53, 24576
 s_add_u32 s82, s82, 458752
 buffer_load_dwordx4 v116, s[32:35], s82 offen lds
 v_exp_f32 v186, v186
 v_exp_f32 v187, v187
 v_exp_f32 v188, v188
 v_exp_f32 v189, v189
 v_exp_f32 v190, v190
 v_exp_f32 v191, v191
 v_exp_f32 v160, v160
 v_exp_f32 v161, v161
 v_smfmac_f32_32x32x32_bf16 v[48:63], v[140:143], v[184:191], v112
 ds_read_b128 v[108:111], v113 offset:28672
 s_setprio 1
 v_exp_f32 v162, v162
 v_exp_f32 v163, v163
 v_exp_f32 v164, v164
 v_mfma_f32_32x32x16_bf16 v[176:191], v[104:107], v[148:151], 0
 v_exp_f32 v165, v165
 v_exp_f32 v166, v166
 v_exp_f32 v167, v167
 v_exp_f32 v168, v168
 v_exp_f32 v169, v169
 v_smfmac_f32_32x32x32_bf16 v[32:47], v[128:131], v[160:167], v112
 s_mov_b64 exec, s[96:97]
 ds_read_b128 v[136:139], v114 offset:29696
 ds_read_b128 v[140:143], v114 offset:30208
 s_mov_b64 exec, -1
 v_exp_f32 v170, v170
 v_exp_f32 v171, v171
 v_exp_f32 v172, v172
 v_exp_f32 v173, v173
 v_exp_f32 v174, v174
 v_exp_f32 v175, v175
 v_exp_f32 v176, v176
 v_exp_f32 v177, v177
 v_smfmac_f32_32x32x32_bf16 v[32:47], v[132:135], v[168:175], v112
 s_waitcnt lgkmcnt(0)
 v_exp_f32 v178, v178
 v_exp_f32 v179, v179
 v_exp_f32 v180, v180
 v_mfma_f32_32x32x16_bf16 v[160:175], v[108:111], v[144:147], 0
 v_exp_f32 v181, v181
 v_exp_f32 v182, v182
 v_exp_f32 v183, v183
 v_exp_f32 v184, v184
 v_exp_f32 v185, v185
 v_smfmac_f32_32x32x32_bf16 v[48:63], v[128:131], v[176:183], v112
 s_setprio 0
 s_add_u32 s82, s81, 1
 s_cmp_ge_u32 s82, 7
 s_cselect_b32 s63, 7, 0
 s_sub_u32 s82, s82, s63
 s_add_u32 m0, s53, 32768
 s_lshl_b32 s82, s82, 16
 buffer_load_dwordx4 v116, s[32:35], s82 offen lds
 v_exp_f32 v186, v186
 v_exp_f32 v187, v187
 v_exp_f32 v188, v188
 v_exp_f32 v189, v189
 v_exp_f32 v190, v190
 v_exp_f32 v191, v191
 s_waitcnt vmcnt(6)
 s_barrier
 v_exp_f32 v160, v160
 v_exp_f32 v161, v161
 v_smfmac_f32_32x32x32_bf16 v[48:63], v[132:135], v[184:191], v112
 ds_read_b128 v[104:107], v113 offset:32768
 s_setprio 3
 v_exp_f32 v162, v162
 v_exp_f32 v163, v163
 v_exp_f32 v164, v164
 v_mfma_f32_32x32x16_bf16 v[176:191], v[108:111], v[148:151], 0
 v_exp_f32 v165, v165
 v_exp_f32 v166, v166
 v_exp_f32 v167, v167
 v_exp_f32 v168, v168
 v_exp_f32 v169, v169
 v_smfmac_f32_32x32x32_bf16 v[32:47], v[136:139], v[160:167], v112
 s_mov_b64 exec, s[96:97]
 ds_read_b128 v[128:131], v114 offset:33792
 ds_read_b128 v[132:135], v114 offset:34304
 s_mov_b64 exec, -1
 v_exp_f32 v170, v170
 v_exp_f32 v171, v171
 v_exp_f32 v172, v172
 v_exp_f32 v173, v173
 v_exp_f32 v174, v174
 v_exp_f32 v175, v175
 v_exp_f32 v176, v176
 v_exp_f32 v177, v177
 v_smfmac_f32_32x32x32_bf16 v[32:47], v[140:143], v[168:175], v112
 s_waitcnt lgkmcnt(0)
 v_exp_f32 v178, v178
 v_exp_f32 v179, v179
 v_exp_f32 v180, v180
 v_mfma_f32_32x32x16_bf16 v[160:175], v[104:107], v[144:147], 0
 s_add_u32 m0, s53, 65536
 s_add_u32 s63, s66, 65536
 buffer_load_dwordx4 v126, s[28:31], s63 offen sc1 lds
 v_exp_f32 v181, v181
 v_exp_f32 v182, v182
 v_exp_f32 v183, v183
 v_exp_f32 v184, v184
 v_exp_f32 v185, v185
 v_smfmac_f32_32x32x32_bf16 v[48:63], v[136:139], v[176:183], v112
 s_add_u32 m0, s53, 73728
 s_add_u32 s63, s66, 73728
 buffer_load_dwordx4 v126, s[28:31], s63 offen sc1 lds
 v_exp_f32 v186, v186
 v_exp_f32 v187, v187
 v_exp_f32 v188, v188
 v_exp_f32 v189, v189
 v_exp_f32 v190, v190
 v_exp_f32 v191, v191
 v_exp_f32 v160, v160
 v_exp_f32 v161, v161
 v_smfmac_f32_32x32x32_bf16 v[48:63], v[140:143], v[184:191], v112
 ds_read_b128 v[108:111], v113 offset:36864
 v_exp_f32 v162, v162
 v_exp_f32 v163, v163
 v_exp_f32 v164, v164
 v_mfma_f32_32x32x16_bf16 v[176:191], v[104:107], v[148:151], 0
 v_exp_f32 v165, v165
 v_exp_f32 v166, v166
 v_exp_f32 v167, v167
 v_exp_f32 v168, v168
 v_exp_f32 v169, v169
 v_smfmac_f32_32x32x32_bf16 v[32:47], v[128:131], v[160:167], v112
 s_mov_b64 exec, s[96:97]
 ds_read_b128 v[136:139], v114 offset:37888
 ds_read_b128 v[140:143], v114 offset:38400
 s_mov_b64 exec, -1
 v_exp_f32 v170, v170
 v_exp_f32 v171, v171
 v_exp_f32 v172, v172
 v_exp_f32 v173, v173
 v_exp_f32 v174, v174
 v_exp_f32 v175, v175
 v_exp_f32 v176, v176
 v_exp_f32 v177, v177
 v_smfmac_f32_32x32x32_bf16 v[32:47], v[132:135], v[168:175], v112
 s_waitcnt lgkmcnt(0)
 v_exp_f32 v178, v178
 v_exp_f32 v179, v179
 v_exp_f32 v180, v180
 v_mfma_f32_32x32x16_bf16 v[160:175], v[108:111], v[144:147], 0
 s_add_u32 m0, s53, 81920
 s_add_u32 s63, s66, 81920
 buffer_load_dwordx4 v126, s[28:31], s63 offen sc1 lds
 v_exp_f32 v181, v181
 v_exp_f32 v182, v182
 v_exp_f32 v183, v183
 v_exp_f32 v184, v184
 v_exp_f32 v185, v185
 v_smfmac_f32_32x32x32_bf16 v[48:63], v[128:131], v[176:183], v112
 s_add_u32 m0, s53, 90112
 s_add_u32 s63, s66, 90112
 buffer_load_dwordx4 v126, s[28:31], s63 offen sc1 lds
 v_exp_f32 v186, v186
 v_exp_f32 v187, v187
 v_exp_f32 v188, v188
 v_exp_f32 v189, v189
 v_exp_f32 v190, v190
 v_exp_f32 v191, v191
 v_exp_f32 v160, v160
 v_exp_f32 v161, v161
 v_smfmac_f32_32x32x32_bf16 v[48:63], v[132:135], v[184:191], v112
 ds_read_b128 v[104:107], v113 offset:40960
 v_exp_f32 v162, v162
 v_exp_f32 v163, v163
 v_exp_f32 v164, v164
 v_mfma_f32_32x32x16_bf16 v[176:191], v[108:111], v[148:151], 0
 v_exp_f32 v165, v165
 v_exp_f32 v166, v166
 v_exp_f32 v167, v167
 v_exp_f32 v168, v168
 v_exp_f32 v169, v169
 v_smfmac_f32_32x32x32_bf16 v[32:47], v[136:139], v[160:167], v112
 s_mov_b64 exec, s[96:97]
 ds_read_b128 v[128:131], v114 offset:41984
 ds_read_b128 v[132:135], v114 offset:42496
 s_mov_b64 exec, -1
 v_exp_f32 v170, v170
 v_exp_f32 v171, v171
 v_exp_f32 v172, v172
 v_exp_f32 v173, v173
 v_exp_f32 v174, v174
 v_exp_f32 v175, v175
 v_exp_f32 v176, v176
 v_exp_f32 v177, v177
 v_smfmac_f32_32x32x32_bf16 v[32:47], v[140:143], v[168:175], v112
 s_waitcnt lgkmcnt(0)
 v_exp_f32 v178, v178
 v_exp_f32 v179, v179
 v_exp_f32 v180, v180
 v_mfma_f32_32x32x16_bf16 v[160:175], v[104:107], v[144:147], 0
 s_add_u32 m0, s53, 40960
 s_add_u32 s82, s82, 458752
 buffer_load_dwordx4 v116, s[32:35], s82 offen lds
 v_exp_f32 v181, v181
 v_exp_f32 v182, v182
 v_exp_f32 v183, v183
 v_exp_f32 v184, v184
 v_exp_f32 v185, v185
 v_smfmac_f32_32x32x32_bf16 v[48:63], v[136:139], v[176:183], v112
 s_add_u32 m0, s53, 49152
 s_add_u32 s82, s82, 458752
 buffer_load_dwordx4 v116, s[32:35], s82 offen lds
 v_exp_f32 v186, v186
 v_exp_f32 v187, v187
 v_exp_f32 v188, v188
 v_exp_f32 v189, v189
 v_exp_f32 v190, v190
 v_exp_f32 v191, v191
 v_exp_f32 v160, v160
 v_exp_f32 v161, v161
 v_smfmac_f32_32x32x32_bf16 v[48:63], v[140:143], v[184:191], v112
 ds_read_b128 v[108:111], v113 offset:45056
 v_exp_f32 v162, v162
 v_exp_f32 v163, v163
 v_exp_f32 v164, v164
 v_mfma_f32_32x32x16_bf16 v[176:191], v[104:107], v[148:151], 0
 v_exp_f32 v165, v165
 v_exp_f32 v166, v166
 v_exp_f32 v167, v167
 v_exp_f32 v168, v168
 v_exp_f32 v169, v169
 v_smfmac_f32_32x32x32_bf16 v[32:47], v[128:131], v[160:167], v112
 s_mov_b64 exec, s[96:97]
 ds_read_b128 v[136:139], v114 offset:46080
 ds_read_b128 v[140:143], v114 offset:46592
 s_mov_b64 exec, -1
 v_exp_f32 v170, v170
 v_exp_f32 v171, v171
 v_exp_f32 v172, v172
 v_exp_f32 v173, v173
 v_exp_f32 v174, v174
 v_exp_f32 v175, v175
 v_exp_f32 v176, v176
 v_exp_f32 v177, v177
 v_smfmac_f32_32x32x32_bf16 v[32:47], v[132:135], v[168:175], v112
 s_waitcnt lgkmcnt(0)
 v_exp_f32 v178, v178
 v_exp_f32 v179, v179
 v_exp_f32 v180, v180
 v_mfma_f32_32x32x16_bf16 v[160:175], v[108:111], v[144:147], 0
 buffer_load_dword v118, v123, s[28:31], 0 offen sc1
 buffer_load_dword v121, v115, s[28:31], 0 offen sc1
 s_add_u32 m0, s53, 57344
 s_add_u32 s82, s82, 458752
 buffer_load_dwordx4 v116, s[32:35], s82 offen lds
 v_exp_f32 v181, v181
 v_exp_f32 v182, v182
 v_exp_f32 v183, v183
 v_exp_f32 v184, v184
 v_exp_f32 v185, v185
 v_smfmac_f32_32x32x32_bf16 v[48:63], v[128:131], v[176:183], v112
 s_add_u32 s82, s81, 2
 s_cmp_ge_u32 s82, 7
 s_cselect_b32 s63, 7, 0
 s_sub_u32 s82, s82, s63
 s_add_u32 m0, s53, 131072
 s_lshl_b32 s82, s82, 16
 buffer_load_dwordx4 v116, s[32:35], s82 offen lds
 v_exp_f32 v186, v186
 v_exp_f32 v187, v187
 v_exp_f32 v188, v188
 v_exp_f32 v189, v189
 v_exp_f32 v190, v190
 v_exp_f32 v191, v191
 v_exp_f32 v160, v160
 v_exp_f32 v161, v161
 v_smfmac_f32_32x32x32_bf16 v[48:63], v[132:135], v[184:191], v112
 ds_read_b128 v[104:107], v113 offset:49152
 s_setprio 2
 v_exp_f32 v162, v162
 v_exp_f32 v163, v163
 v_exp_f32 v164, v164
 v_mfma_f32_32x32x16_bf16 v[176:191], v[108:111], v[148:151], 0
 v_exp_f32 v165, v165
 v_exp_f32 v166, v166
 v_exp_f32 v167, v167
 v_exp_f32 v168, v168
 v_exp_f32 v169, v169
 v_smfmac_f32_32x32x32_bf16 v[32:47], v[136:139], v[160:167], v112
 s_mov_b64 exec, s[96:97]
 ds_read_b128 v[128:131], v114 offset:50176
 ds_read_b128 v[132:135], v114 offset:50688
 s_mov_b64 exec, -1
 v_exp_f32 v170, v170
 v_exp_f32 v171, v171
 v_exp_f32 v172, v172
 v_exp_f32 v173, v173
 v_exp_f32 v174, v174
 v_exp_f32 v175, v175
 v_exp_f32 v176, v176
 v_exp_f32 v177, v177
 v_smfmac_f32_32x32x32_bf16 v[32:47], v[140:143], v[168:175], v112
 s_waitcnt lgkmcnt(0)
 v_exp_f32 v178, v178
 v_exp_f32 v179, v179
 v_exp_f32 v180, v180
 v_mfma_f32_32x32x16_bf16 v[160:175], v[104:107], v[144:147], 0
 s_add_u32 m0, s53, 139264
 s_add_u32 s82, s82, 458752
 buffer_load_dwordx4 v116, s[32:35], s82 offen lds
 v_exp_f32 v181, v181
 v_exp_f32 v182, v182
 v_exp_f32 v183, v183
 v_exp_f32 v184, v184
 v_exp_f32 v185, v185
 v_smfmac_f32_32x32x32_bf16 v[48:63], v[136:139], v[176:183], v112
 s_add_u32 m0, s53, 147456
 s_add_u32 s82, s82, 458752
 buffer_load_dwordx4 v116, s[32:35], s82 offen lds
 v_exp_f32 v186, v186
 v_exp_f32 v187, v187
 v_exp_f32 v188, v188
 v_exp_f32 v189, v189
 v_exp_f32 v190, v190
 v_exp_f32 v191, v191
 s_waitcnt vmcnt(4)
 v_cmp_eq_u32 vcc, 0, v121
 s_nop 0
 s_cmp_lg_u64 vcc, 0
 s_cbranch_scc1 L_x_1018
L_r_1019:
 v_cmp_eq_u32 vcc, 0, v118
 s_nop 0
 s_cmp_lg_u64 vcc, 0
 s_cbranch_scc1 L_x_1021
L_r_1022:
 v_exp_f32 v160, v160
 v_exp_f32 v161, v161
 v_smfmac_f32_32x32x32_bf16 v[48:63], v[140:143], v[184:191], v112
 ds_read_b128 v[108:111], v113 offset:53248
 v_exp_f32 v162, v162
 v_exp_f32 v163, v163
 v_exp_f32 v164, v164
 v_mfma_f32_32x32x16_bf16 v[176:191], v[104:107], v[148:151], 0
 v_exp_f32 v165, v165
 v_exp_f32 v166, v166
 v_exp_f32 v167, v167
 v_exp_f32 v168, v168
 v_exp_f32 v169, v169
 v_smfmac_f32_32x32x32_bf16 v[32:47], v[128:131], v[160:167], v112
 s_mov_b64 exec, s[96:97]
 ds_read_b128 v[136:139], v114 offset:54272
 ds_read_b128 v[140:143], v114 offset:54784
 s_mov_b64 exec, -1
 v_exp_f32 v170, v170
 v_exp_f32 v171, v171
 v_exp_f32 v172, v172
 v_exp_f32 v173, v173
 v_exp_f32 v174, v174
 v_exp_f32 v175, v175
 v_exp_f32 v118, -v118
 v_exp_f32 v176, v176
 v_exp_f32 v177, v177
 v_smfmac_f32_32x32x32_bf16 v[32:47], v[132:135], v[168:175], v112
 s_waitcnt lgkmcnt(0)
 v_exp_f32 v178, v178
 v_exp_f32 v179, v179
 v_exp_f32 v180, v180
 v_mfma_f32_32x32x16_bf16 v[160:175], v[108:111], v[144:147], 0
 s_add_u32 s83, s81, 0
 s_cmp_ge_u32 s83, 7
 s_cselect_b32 s63, 7, 0
 s_sub_u32 s83, s83, s63
 s_lshl_b32 s83, s83, 12
 s_add_u32 s83, s83, s69
 buffer_load_dwordx4 v[16:19], v122, s[28:31], s83 offen offset:0 sc1
 v_exp_f32 v181, v181
 v_exp_f32 v182, v182
 v_exp_f32 v183, v183
 v_exp_f32 v184, v184
 v_exp_f32 v185, v185
 v_smfmac_f32_32x32x32_bf16 v[48:63], v[128:131], v[176:183], v112
 buffer_load_dwordx4 v[20:23], v122, s[28:31], s83 offen offset:2048 sc1
 v_add_f32 v118, 1.0, v118
 v_rcp_f32 v118, v118
 v_exp_f32 v186, v186
 v_exp_f32 v187, v187
 v_exp_f32 v188, v188
 v_exp_f32 v189, v189
 v_exp_f32 v190, v190
 v_exp_f32 v191, v191
 v_exp_f32 v160, v160
 v_exp_f32 v161, v161
 v_smfmac_f32_32x32x32_bf16 v[48:63], v[132:135], v[184:191], v112
 ds_read_b128 v[104:107], v113 offset:57344
 v_exp_f32 v162, v162
 v_exp_f32 v163, v163
 v_exp_f32 v164, v164
 v_mfma_f32_32x32x16_bf16 v[176:191], v[108:111], v[148:151], 0
 v_exp_f32 v165, v165
 v_exp_f32 v166, v166
 v_exp_f32 v167, v167
 v_exp_f32 v168, v168
 v_exp_f32 v169, v169
 v_smfmac_f32_32x32x32_bf16 v[32:47], v[136:139], v[160:167], v112
 s_mov_b64 exec, s[96:97]
 ds_read_b128 v[128:131], v114 offset:58368
 ds_read_b128 v[132:135], v114 offset:58880
 s_mov_b64 exec, -1
 v_exp_f32 v170, v170
 v_exp_f32 v171, v171
 v_exp_f32 v172, v172
 v_exp_f32 v173, v173
 v_exp_f32 v174, v174
 v_exp_f32 v175, v175
 v_exp_f32 v176, v176
 v_exp_f32 v177, v177
 v_smfmac_f32_32x32x32_bf16 v[32:47], v[140:143], v[168:175], v112
 s_waitcnt lgkmcnt(0)
 s_setprio 1
 v_exp_f32 v178, v178
 v_exp_f32 v179, v179
 v_exp_f32 v180, v180
 v_mfma_f32_32x32x16_bf16 v[160:175], v[104:107], v[144:147], 0
 s_cmp_lg_u32 s72, 1
 s_cbranch_scc1 L_s_1024
 s_and_b32 s62, s71, 7
 s_lshl_b32 s62, s62, 16
 buffer_load_dword v125, v117, s[36:39], s62 offen
L_s_1024:
 buffer_load_dwordx4 v[24:27], v122, s[28:31], s83 offen offset:256 sc1
 v_exp_f32 v181, v181
 v_exp_f32 v182, v182
 v_exp_f32 v183, v183
 v_exp_f32 v184, v184
 v_exp_f32 v185, v185
 v_smfmac_f32_32x32x32_bf16 v[48:63], v[136:139], v[176:183], v112
 buffer_load_dwordx4 v[28:31], v122, s[28:31], s83 offen offset:2304 sc1
 v_exp_f32 v186, v186
 v_exp_f32 v187, v187
 v_exp_f32 v188, v188
 v_exp_f32 v189, v189
 v_exp_f32 v190, v190
 v_exp_f32 v191, v191
 v_exp_f32 v160, v160
 v_exp_f32 v161, v161
 v_smfmac_f32_32x32x32_bf16 v[48:63], v[140:143], v[184:191], v112
 ds_read_b128 v[108:111], v113 offset:61440
 v_exp_f32 v162, v162
 v_exp_f32 v163, v163
 v_exp_f32 v164, v164
 v_mfma_f32_32x32x16_bf16 v[176:191], v[104:107], v[148:151], 0
 v_exp_f32 v165, v165
 v_exp_f32 v166, v166
 v_exp_f32 v167, v167
 v_exp_f32 v168, v168
 v_exp_f32 v169, v169
 v_smfmac_f32_32x32x32_bf16 v[32:47], v[128:131], v[160:167], v112
 s_mov_b64 exec, s[96:97]
 ds_read_b128 v[136:139], v114 offset:62464
 ds_read_b128 v[140:143], v114 offset:62976
 s_mov_b64 exec, -1
 v_exp_f32 v170, v170
 v_exp_f32 v171, v171
 v_exp_f32 v172, v172
 v_exp_f32 v173, v173
 s_add_u32 s83, s81, 1
 s_cmp_ge_u32 s83, 7
 s_cselect_b32 s63, 7, 0
 s_sub_u32 s83, s83, s63
 s_lshl_b32 s83, s83, 12
 s_add_u32 s83, s83, s69
 buffer_load_dwordx4 v[64:67], v122, s[28:31], s83 offen offset:0 sc1
 v_exp_f32 v174, v174
 v_exp_f32 v175, v175
 v_exp_f32 v176, v176
 v_exp_f32 v177, v177
 v_smfmac_f32_32x32x32_bf16 v[32:47], v[132:135], v[168:175], v112
 s_waitcnt lgkmcnt(0)
 v_exp_f32 v178, v178
 v_exp_f32 v179, v179
 v_exp_f32 v180, v180
 v_mfma_f32_32x32x16_bf16 v[160:175], v[108:111], v[144:147], 0
 buffer_load_dwordx4 v[68:71], v122, s[28:31], s83 offen offset:2048 sc1
 v_exp_f32 v181, v181
 v_exp_f32 v182, v182
 v_exp_f32 v183, v183
 v_exp_f32 v184, v184
 v_exp_f32 v185, v185
 v_smfmac_f32_32x32x32_bf16 v[48:63], v[128:131], v[176:183], v112
 s_setprio 0
 s_add_u32 m0, s53, 155648
 s_add_u32 s82, s82, 458752
 buffer_load_dwordx4 v116, s[32:35], s82 offen lds
 v_exp_f32 v186, v186
 v_exp_f32 v187, v187
 v_exp_f32 v188, v188
 v_exp_f32 v189, v189
 v_exp_f32 v190, v190
 v_exp_f32 v191, v191
 s_waitcnt vmcnt(10)
 s_barrier
 v_exp_f32 v160, v160
 v_exp_f32 v161, v161
 v_smfmac_f32_32x32x32_bf16 v[48:63], v[132:135], v[184:191], v112
 ds_read_b128 v[104:107], v113 offset:0
 s_setprio 3
 v_exp_f32 v162, v162
 v_exp_f32 v163, v163
 v_exp_f32 v164, v164
 v_mfma_f32_32x32x16_bf16 v[176:191], v[108:111], v[148:151], 0
 ds_read_b64_tr_b16 v[88:89], v124 offset:0
 ds_read_b64_tr_b16 v[90:91], v124 offset:2048
 v_exp_f32 v165, v165
 v_exp_f32 v166, v166
 v_exp_f32 v167, v167
 v_exp_f32 v168, v168
 v_exp_f32 v169, v169
 v_smfmac_f32_32x32x32_bf16 v[32:47], v[136:139], v[160:167], v112
 ds_read_b64_tr_b16 v[92:93], v124 offset:4096
 ds_read_b64_tr_b16 v[94:95], v124 offset:6144
 s_mov_b64 exec, s[96:97]
 ds_read_b128 v[128:131], v114 offset:1024
 ds_read_b128 v[132:135], v114 offset:1536
 s_mov_b64 exec, -1
 v_exp_f32 v170, v170
 v_exp_f32 v171, v171
 v_exp_f32 v172, v172
 v_exp_f32 v173, v173
 buffer_load_dwordx4 v[72:75], v122, s[28:31], s83 offen offset:256 sc1
 v_exp_f32 v174, v174
 v_exp_f32 v175, v175
 v_exp_f32 v176, v176
 v_exp_f32 v177, v177
 v_smfmac_f32_32x32x32_bf16 v[32:47], v[140:143], v[168:175], v112
 s_waitcnt lgkmcnt(0)
 v_exp_f32 v178, v178
 v_exp_f32 v179, v179
 v_exp_f32 v180, v180
 v_mfma_f32_32x32x16_bf16 v[160:175], v[104:107], v[144:147], 0
 buffer_load_dwordx4 v[76:79], v122, s[28:31], s83 offen offset:2304 sc1
 v_exp_f32 v181, v181
 v_exp_f32 v182, v182
 v_exp_f32 v183, v183
 v_exp_f32 v184, v184
 v_exp_f32 v185, v185
 v_smfmac_f32_32x32x32_bf16 v[48:63], v[136:139], v[176:183], v112
 s_add_u32 m0, s53, 98304
 s_add_u32 s63, s66, 98304
 buffer_load_dwordx4 v126, s[28:31], s63 offen sc1 lds
 v_exp_f32 v186, v186
 v_exp_f32 v187, v187
 v_exp_f32 v188, v188
 v_exp_f32 v189, v189
 s_waitcnt vmcnt(8)
 v_mfma_f32_16x16x32_bf16 v[224:227], v[88:91], v[16:19], 0
 v_mfma_f32_16x16x32_bf16 v[224:227], v[92:95], v[20:23], v[224:227]
 v_exp_f32 v190, v190
 v_exp_f32 v191, v191
 v_exp_f32 v160, v160
 v_exp_f32 v161, v161
 v_smfmac_f32_32x32x32_bf16 v[48:63], v[140:143], v[184:191], v112
 ds_read_b128 v[108:111], v113 offset:4096
 v_exp_f32 v162, v162
 v_exp_f32 v163, v163
 v_exp_f32 v164, v164
 v_mfma_f32_32x32x16_bf16 v[176:191], v[104:107], v[148:151], 0
 ds_read_b64_tr_b16 v[96:97], v1 offset:0
 ds_read_b64_tr_b16 v[98:99], v1 offset:2048
 v_exp_f32 v165, v165
 v_exp_f32 v166, v166
 v_exp_f32 v167, v167
 v_exp_f32 v168, v168
 v_exp_f32 v169, v169
 v_smfmac_f32_32x32x32_bf16 v[32:47], v[128:131], v[160:167], v112
 ds_read_b64_tr_b16 v[100:101], v1 offset:4096
 ds_read_b64_tr_b16 v[102:103], v1 offset:6144
 s_mov_b64 exec, s[96:97]
 ds_read_b128 v[136:139], v114 offset:5120
 ds_read_b128 v[140:143], v114 offset:5632
 s_mov_b64 exec, -1
 v_exp_f32 v170, v170
 v_exp_f32 v171, v171
 v_exp_f32 v172, v172
 v_exp_f32 v173, v173
 s_waitcnt vmcnt(6)
 v_mfma_f32_16x16x32_bf16 v[228:231], v[88:91], v[24:27], 0
 v_mfma_f32_16x16x32_bf16 v[228:231], v[92:95], v[28:31], v[228:231]
 s_add_u32 s83, s81, 2
 s_cmp_ge_u32 s83, 7
 s_cselect_b32 s63, 7, 0
 s_sub_u32 s83, s83, s63
 s_lshl_b32 s83, s83, 12
 s_add_u32 s83, s83, s69
 buffer_load_dwordx4 v[80:83], v122, s[28:31], s83 offen offset:0 sc1
 v_exp_f32 v174, v174
 v_exp_f32 v175, v175
 v_exp_f32 v176, v176
 v_exp_f32 v177, v177
 v_smfmac_f32_32x32x32_bf16 v[32:47], v[132:135], v[168:175], v112
 s_waitcnt lgkmcnt(0)
 v_exp_f32 v178, v178
 v_exp_f32 v179, v179
 v_exp_f32 v180, v180
 v_mfma_f32_32x32x16_bf16 v[160:175], v[108:111], v[144:147], 0
 buffer_load_dwordx4 v[84:87], v122, s[28:31], s83 offen offset:2048 sc1
 v_exp_f32 v181, v181
 v_exp_f32 v182, v182
 v_exp_f32 v183, v183
 v_exp_f32 v184, v184
 v_exp_f32 v185, v185
 v_smfmac_f32_32x32x32_bf16 v[48:63], v[128:131], v[176:183], v112
 s_add_u32 m0, s53, 106496
 s_add_u32 s63, s66, 106496
 buffer_load_dwordx4 v126, s[28:31], s63 offen sc1 lds
 v_exp_f32 v186, v186
 v_exp_f32 v187, v187
 v_exp_f32 v188, v188
 v_exp_f32 v189, v189
 v_mfma_f32_16x16x32_bf16 v[232:235], v[96:99], v[16:19], 0
 v_mfma_f32_16x16x32_bf16 v[232:235], v[100:103], v[20:23], v[232:235]
 v_exp_f32 v190, v190
 v_exp_f32 v191, v191
 v_exp_f32 v160, v160
 v_exp_f32 v161, v161
 v_smfmac_f32_32x32x32_bf16 v[48:63], v[132:135], v[184:191], v112
 ds_read_b128 v[104:107], v113 offset:8192
 v_exp_f32 v162, v162
 v_exp_f32 v163, v163
 v_exp_f32 v164, v164
 v_mfma_f32_32x32x16_bf16 v[176:191], v[108:111], v[148:151], 0
 ds_read_b64_tr_b16 v[88:89], v2 offset:0
 ds_read_b64_tr_b16 v[90:91], v2 offset:2048
 v_exp_f32 v165, v165
 v_exp_f32 v166, v166
 v_exp_f32 v167, v167
 v_exp_f32 v168, v168
 v_exp_f32 v169, v169
 v_smfmac_f32_32x32x32_bf16 v[32:47], v[136:139], v[160:167], v112
 ds_read_b64_tr_b16 v[92:93], v2 offset:4096
 ds_read_b64_tr_b16 v[94:95], v2 offset:6144
 s_mov_b64 exec, s[96:97]
 ds_read_b128 v[128:131], v114 offset:9216
 ds_read_b128 v[132:135], v114 offset:9728
 s_mov_b64 exec, -1
 v_exp_f32 v170, v170
 v_exp_f32 v171, v171
 v_exp_f32 v172, v172
 v_exp_f32 v173, v173
 v_mfma_f32_16x16x32_bf16 v[236:239], v[96:99], v[24:27], 0
 v_mfma_f32_16x16x32_bf16 v[236:239], v[100:103], v[28:31], v[236:239]
 buffer_load_dwordx4 v[152:155], v122, s[28:31], s83 offen offset:256 sc1
 v_exp_f32 v174, v174
 v_exp_f32 v175, v175
 v_exp_f32 v176, v176
 v_exp_f32 v177, v177
 v_smfmac_f32_32x32x32_bf16 v[32:47], v[140:143], v[168:175], v112
 s_waitcnt lgkmcnt(0)
 v_exp_f32 v178, v178
 v_exp_f32 v179, v179
 v_exp_f32 v180, v180
 v_mfma_f32_32x32x16_bf16 v[160:175], v[104:107], v[144:147], 0
 buffer_load_dwordx4 v[156:159], v122, s[28:31], s83 offen offset:2304 sc1
 v_exp_f32 v181, v181
 v_exp_f32 v182, v182
 v_exp_f32 v183, v183
 v_exp_f32 v184, v184
 v_exp_f32 v185, v185
 v_smfmac_f32_32x32x32_bf16 v[48:63], v[136:139], v[176:183], v112
 s_add_u32 m0, s53, 114688
 s_add_u32 s63, s66, 114688
 buffer_load_dwordx4 v126, s[28:31], s63 offen sc1 lds
 v_exp_f32 v186, v186
 v_exp_f32 v187, v187
 v_exp_f32 v188, v188
 v_exp_f32 v189, v189
 v_mfma_f32_16x16x32_bf16 v[240:243], v[88:91], v[16:19], 0
 v_mfma_f32_16x16x32_bf16 v[240:243], v[92:95], v[20:23], v[240:243]
 v_exp_f32 v190, v190
 v_exp_f32 v191, v191
 v_exp_f32 v160, v160
 v_exp_f32 v161, v161
 v_smfmac_f32_32x32x32_bf16 v[48:63], v[140:143], v[184:191], v112
 ds_read_b128 v[108:111], v113 offset:12288
 v_exp_f32 v162, v162
 v_exp_f32 v163, v163
 v_exp_f32 v164, v164
 v_mfma_f32_32x32x16_bf16 v[176:191], v[104:107], v[148:151], 0
 ds_read_b64_tr_b16 v[96:97], v3 offset:0
 ds_read_b64_tr_b16 v[98:99], v3 offset:2048
 v_exp_f32 v165, v165
 v_exp_f32 v166, v166
 v_exp_f32 v167, v167
 v_exp_f32 v168, v168
 v_exp_f32 v169, v169
 v_smfmac_f32_32x32x32_bf16 v[32:47], v[128:131], v[160:167], v112
 ds_read_b64_tr_b16 v[100:101], v3 offset:4096
 ds_read_b64_tr_b16 v[102:103], v3 offset:6144
 s_mov_b64 exec, s[96:97]
 ds_read_b128 v[136:139], v114 offset:13312
 ds_read_b128 v[140:143], v114 offset:13824
 s_mov_b64 exec, -1
 v_exp_f32 v170, v170
 v_exp_f32 v171, v171
 v_exp_f32 v172, v172
 v_exp_f32 v173, v173
 v_mfma_f32_16x16x32_bf16 v[244:247], v[88:91], v[24:27], 0
 v_mfma_f32_16x16x32_bf16 v[244:247], v[92:95], v[28:31], v[244:247]
 s_add_u32 s83, s81, 3
 s_cmp_ge_u32 s83, 7
 s_cselect_b32 s63, 7, 0
 s_sub_u32 s83, s83, s63
 s_lshl_b32 s83, s83, 12
 s_add_u32 s83, s83, s69
 buffer_load_dwordx4 v[192:195], v122, s[28:31], s83 offen offset:0 sc1
 v_exp_f32 v174, v174
 v_exp_f32 v175, v175
 v_exp_f32 v176, v176
 v_exp_f32 v177, v177
 v_smfmac_f32_32x32x32_bf16 v[32:47], v[132:135], v[168:175], v112
 s_waitcnt lgkmcnt(0)
 v_exp_f32 v178, v178
 v_exp_f32 v179, v179
 v_exp_f32 v180, v180
 v_mfma_f32_32x32x16_bf16 v[160:175], v[108:111], v[144:147], 0
 buffer_load_dwordx4 v[196:199], v122, s[28:31], s83 offen offset:2048 sc1
 v_exp_f32 v181, v181
 v_exp_f32 v182, v182
 v_exp_f32 v183, v183
 v_exp_f32 v184, v184
 v_exp_f32 v185, v185
 v_smfmac_f32_32x32x32_bf16 v[48:63], v[128:131], v[176:183], v112
 s_add_u32 m0, s53, 122880
 s_add_u32 s63, s66, 122880
 buffer_load_dwordx4 v126, s[28:31], s63 offen sc1 lds
 v_exp_f32 v186, v186
 v_exp_f32 v187, v187
 v_exp_f32 v188, v188
 v_exp_f32 v189, v189
 v_mfma_f32_16x16x32_bf16 v[248:251], v[96:99], v[16:19], 0
 v_mfma_f32_16x16x32_bf16 v[248:251], v[100:103], v[20:23], v[248:251]
 v_exp_f32 v190, v190
 v_exp_f32 v191, v191
 v_exp_f32 v160, v160
 v_exp_f32 v161, v161
 v_smfmac_f32_32x32x32_bf16 v[48:63], v[132:135], v[184:191], v112
 ds_read_b128 v[104:107], v113 offset:16384
 s_setprio 2
 v_exp_f32 v162, v162
 v_exp_f32 v163, v163
 v_exp_f32 v164, v164
 v_mfma_f32_32x32x16_bf16 v[176:191], v[108:111], v[148:151], 0
 ds_read_b64_tr_b16 v[88:89], v124 offset:32768
 ds_read_b64_tr_b16 v[90:91], v124 offset:34816
 v_exp_f32 v165, v165
 v_exp_f32 v166, v166
 v_exp_f32 v167, v167
 v_exp_f32 v168, v168
 v_exp_f32 v169, v169
 v_smfmac_f32_32x32x32_bf16 v[32:47], v[136:139], v[160:167], v112
 ds_read_b64_tr_b16 v[92:93], v124 offset:36864
 ds_read_b64_tr_b16 v[94:95], v124 offset:38912
 s_mov_b64 exec, s[96:97]
 ds_read_b128 v[128:131], v114 offset:17408
 ds_read_b128 v[132:135], v114 offset:17920
 s_mov_b64 exec, -1
 v_exp_f32 v170, v170
 v_exp_f32 v171, v171
 v_exp_f32 v172, v172
 v_exp_f32 v173, v173
 v_mfma_f32_16x16x32_bf16 v[252:255], v[96:99], v[24:27], 0
 v_mfma_f32_16x16x32_bf16 v[252:255], v[100:103], v[28:31], v[252:255]
 buffer_load_dwordx4 v[200:203], v122, s[28:31], s83 offen offset:256 sc1
 v_exp_f32 v174, v174
 v_exp_f32 v175, v175
 v_exp_f32 v176, v176
 v_exp_f32 v177, v177
 v_smfmac_f32_32x32x32_bf16 v[32:47], v[140:143], v[168:175], v112
 s_waitcnt lgkmcnt(0)
 v_exp_f32 v178, v178
 v_exp_f32 v179, v179
 v_exp_f32 v180, v180
 v_mfma_f32_32x32x16_bf16 v[160:175], v[104:107], v[144:147], 0
 buffer_load_dwordx4 v[204:207], v122, s[28:31], s83 offen offset:2304 sc1
 v_exp_f32 v181, v181
 v_exp_f32 v182, v182
 v_exp_f32 v183, v183
 v_exp_f32 v184, v184
 v_exp_f32 v185, v185
 v_smfmac_f32_32x32x32_bf16 v[48:63], v[136:139], v[176:183], v112
 s_add_u32 s83, s81, 4
 s_cmp_ge_u32 s83, 7
 s_cselect_b32 s63, 7, 0
 s_sub_u32 s83, s83, s63
 s_lshl_b32 s83, s83, 12
 s_add_u32 s83, s83, s69
 buffer_load_dwordx4 v[208:211], v122, s[28:31], s83 offen offset:0 sc1
 v_exp_f32 v186, v186
 v_exp_f32 v187, v187
 v_exp_f32 v188, v188
 v_exp_f32 v189, v189
 s_waitcnt vmcnt(16)
 v_mfma_f32_16x16x32_bf16 v[224:227], v[88:91], v[64:67], v[224:227]
 v_mfma_f32_16x16x32_bf16 v[224:227], v[92:95], v[68:71], v[224:227]
 v_exp_f32 v190, v190
 v_exp_f32 v191, v191
 v_exp_f32 v160, v160
 v_exp_f32 v161, v161
 v_smfmac_f32_32x32x32_bf16 v[48:63], v[140:143], v[184:191], v112
 ds_read_b128 v[108:111], v113 offset:20480
 v_exp_f32 v162, v162
 v_exp_f32 v163, v163
 v_exp_f32 v164, v164
 v_mfma_f32_32x32x16_bf16 v[176:191], v[104:107], v[148:151], 0
 ds_read_b64_tr_b16 v[96:97], v1 offset:32768
 ds_read_b64_tr_b16 v[98:99], v1 offset:34816
 v_exp_f32 v165, v165
 v_exp_f32 v166, v166
 v_exp_f32 v167, v167
 v_exp_f32 v168, v168
 v_exp_f32 v169, v169
 v_smfmac_f32_32x32x32_bf16 v[32:47], v[128:131], v[160:167], v112
 ds_read_b64_tr_b16 v[100:101], v1 offset:36864
 ds_read_b64_tr_b16 v[102:103], v1 offset:38912
 s_mov_b64 exec, s[96:97]
 ds_read_b128 v[136:139], v114 offset:21504
 ds_read_b128 v[140:143], v114 offset:22016
 s_mov_b64 exec, -1
 v_exp_f32 v170, v170
 v_exp_f32 v171, v171
 v_exp_f32 v172, v172
 v_exp_f32 v173, v173
 s_waitcnt vmcnt(13)
 v_mfma_f32_16x16x32_bf16 v[228:231], v[88:91], v[72:75], v[228:231]
 v_mfma_f32_16x16x32_bf16 v[228:231], v[92:95], v[76:79], v[228:231]
 buffer_load_dwordx4 v[212:215], v122, s[28:31], s83 offen offset:2048 sc1
 v_exp_f32 v174, v174
 v_exp_f32 v175, v175
 v_exp_f32 v176, v176
 v_exp_f32 v177, v177
 v_smfmac_f32_32x32x32_bf16 v[32:47], v[132:135], v[168:175], v112
 s_waitcnt lgkmcnt(0)
 v_exp_f32 v178, v178
 v_exp_f32 v179, v179
 v_exp_f32 v180, v180
 v_mfma_f32_32x32x16_bf16 v[160:175], v[108:111], v[144:147], 0
 buffer_load_dwordx4 v[216:219], v122, s[28:31], s83 offen offset:256 sc1
 v_exp_f32 v181, v181
 v_exp_f32 v182, v182
 v_exp_f32 v183, v183
 v_exp_f32 v184, v184
 v_exp_f32 v185, v185
 v_smfmac_f32_32x32x32_bf16 v[48:63], v[128:131], v[176:183], v112
 buffer_load_dwordx4 v[220:223], v122, s[28:31], s83 offen offset:2304 sc1
 v_exp_f32 v186, v186
 v_exp_f32 v187, v187
 v_exp_f32 v188, v188
 v_exp_f32 v189, v189
 v_mfma_f32_16x16x32_bf16 v[232:235], v[96:99], v[64:67], v[232:235]
 v_mfma_f32_16x16x32_bf16 v[232:235], v[100:103], v[68:71], v[232:235]
 v_exp_f32 v190, v190
 v_exp_f32 v191, v191
 v_exp_f32 v160, v160
 v_exp_f32 v161, v161
 v_smfmac_f32_32x32x32_bf16 v[48:63], v[132:135], v[184:191], v112
 ds_read_b128 v[104:107], v113 offset:24576
 v_exp_f32 v162, v162
 v_exp_f32 v163, v163
 v_exp_f32 v164, v164
 v_mfma_f32_32x32x16_bf16 v[176:191], v[108:111], v[148:151], 0
 ds_read_b64_tr_b16 v[88:89], v2 offset:32768
 ds_read_b64_tr_b16 v[90:91], v2 offset:34816
 v_exp_f32 v165, v165
 v_exp_f32 v166, v166
 v_exp_f32 v167, v167
 v_exp_f32 v168, v168
 v_exp_f32 v169, v169
 v_smfmac_f32_32x32x32_bf16 v[32:47], v[136:139], v[160:167], v112
 ds_read_b64_tr_b16 v[92:93], v2 offset:36864
 ds_read_b64_tr_b16 v[94:95], v2 offset:38912
 s_mov_b64 exec, s[96:97]
 ds_read_b128 v[128:131], v114 offset:25600
 ds_read_b128 v[132:135], v114 offset:26112
 s_mov_b64 exec, -1
 v_exp_f32 v170, v170
 v_exp_f32 v171, v171
 v_exp_f32 v172, v172
 v_exp_f32 v173, v173
 v_mfma_f32_16x16x32_bf16 v[236:239], v[96:99], v[72:75], v[236:239]
 v_mfma_f32_16x16x32_bf16 v[236:239], v[100:103], v[76:79], v[236:239]
 s_add_u32 s83, s81, 5
 s_cmp_ge_u32 s83, 7
 s_cselect_b32 s63, 7, 0
 s_sub_u32 s83, s83, s63
 s_lshl_b32 s83, s83, 12
 s_add_u32 s83, s83, s69
 buffer_load_dwordx4 v[16:19], v122, s[28:31], s83 offen offset:0 sc1
 v_exp_f32 v174, v174
 v_exp_f32 v175, v175
 v_exp_f32 v176, v176
 v_exp_f32 v177, v177
 v_smfmac_f32_32x32x32_bf16 v[32:47], v[140:143], v[168:175], v112
 s_waitcnt lgkmcnt(0)
 s_setprio 1
 v_exp_f32 v178, v178
 v_exp_f32 v179, v179
 v_exp_f32 v180, v180
 v_mfma_f32_32x32x16_bf16 v[160:175], v[104:107], v[144:147], 0
 buffer_load_dwordx4 v[20:23], v122, s[28:31], s83 offen offset:2048 sc1
 v_exp_f32 v181, v181
 v_exp_f32 v182, v182
 v_exp_f32 v183, v183
 v_exp_f32 v184, v184
 v_exp_f32 v185, v185
 v_smfmac_f32_32x32x32_bf16 v[48:63], v[136:139], v[176:183], v112
 buffer_load_dwordx4 v[24:27], v122, s[28:31], s83 offen offset:256 sc1
 v_exp_f32 v186, v186
 v_exp_f32 v187, v187
 v_exp_f32 v188, v188
 v_exp_f32 v189, v189
 v_mfma_f32_16x16x32_bf16 v[240:243], v[88:91], v[64:67], v[240:243]
 v_mfma_f32_16x16x32_bf16 v[240:243], v[92:95], v[68:71], v[240:243]
 v_exp_f32 v190, v190
 v_exp_f32 v191, v191
 v_exp_f32 v160, v160
 v_exp_f32 v161, v161
 v_smfmac_f32_32x32x32_bf16 v[48:63], v[140:143], v[184:191], v112
 ds_read_b128 v[108:111], v113 offset:28672
 v_exp_f32 v162, v162
 v_exp_f32 v163, v163
 v_exp_f32 v164, v164
 v_mfma_f32_32x32x16_bf16 v[176:191], v[104:107], v[148:151], 0
 ds_read_b64_tr_b16 v[96:97], v3 offset:32768
 ds_read_b64_tr_b16 v[98:99], v3 offset:34816
 v_exp_f32 v165, v165
 v_exp_f32 v166, v166
 v_exp_f32 v167, v167
 v_exp_f32 v168, v168
 v_exp_f32 v169, v169
 v_smfmac_f32_32x32x32_bf16 v[32:47], v[128:131], v[160:167], v112
 ds_read_b64_tr_b16 v[100:101], v3 offset:36864
 ds_read_b64_tr_b16 v[102:103], v3 offset:38912
 s_mov_b64 exec, s[96:97]
 ds_read_b128 v[136:139], v114 offset:29696
 ds_read_b128 v[140:143], v114 offset:30208
 s_mov_b64 exec, -1
 v_exp_f32 v170, v170
 v_exp_f32 v171, v171
 v_exp_f32 v172, v172
 v_exp_f32 v173, v173
 v_mfma_f32_16x16x32_bf16 v[244:247], v[88:91], v[72:75], v[244:247]
 v_mfma_f32_16x16x32_bf16 v[244:247], v[92:95], v[76:79], v[244:247]
 buffer_load_dwordx4 v[28:31], v122, s[28:31], s83 offen offset:2304 sc1
 v_exp_f32 v174, v174
 v_exp_f32 v175, v175
 v_exp_f32 v176, v176
 v_exp_f32 v177, v177
 v_smfmac_f32_32x32x32_bf16 v[32:47], v[132:135], v[168:175], v112
 s_waitcnt lgkmcnt(0)
 v_exp_f32 v178, v178
 v_exp_f32 v179, v179
 v_exp_f32 v180, v180
 v_mfma_f32_32x32x16_bf16 v[160:175], v[108:111], v[144:147], 0
 v_exp_f32 v181, v181
 v_exp_f32 v182, v182
 v_exp_f32 v183, v183
 v_exp_f32 v184, v184
 v_exp_f32 v185, v185
 v_smfmac_f32_32x32x32_bf16 v[48:63], v[128:131], v[176:183], v112
 s_setprio 0
 v_exp_f32 v186, v186
 v_exp_f32 v187, v187
 v_exp_f32 v188, v188
 v_exp_f32 v189, v189
 v_mfma_f32_16x16x32_bf16 v[248:251], v[96:99], v[64:67], v[248:251]
 v_mfma_f32_16x16x32_bf16 v[248:251], v[100:103], v[68:71], v[248:251]
 v_exp_f32 v190, v190
 v_exp_f32 v191, v191
 s_waitcnt vmcnt(10)
 s_barrier
 v_exp_f32 v160, v160
 v_exp_f32 v161, v161
 v_smfmac_f32_32x32x32_bf16 v[48:63], v[132:135], v[184:191], v112
 ds_read_b128 v[104:107], v113 offset:32768
 s_setprio 3
 v_exp_f32 v162, v162
 v_exp_f32 v163, v163
 v_exp_f32 v164, v164
 v_mfma_f32_32x32x16_bf16 v[176:191], v[108:111], v[148:151], 0
 ds_read_b64_tr_b16 v[88:89], v5 offset:32768
 ds_read_b64_tr_b16 v[90:91], v5 offset:34816
 v_exp_f32 v165, v165
 v_exp_f32 v166, v166
 v_exp_f32 v167, v167
 v_exp_f32 v168, v168
 v_exp_f32 v169, v169
 v_smfmac_f32_32x32x32_bf16 v[32:47], v[136:139], v[160:167], v112
 ds_read_b64_tr_b16 v[92:93], v5 offset:36864
 ds_read_b64_tr_b16 v[94:95], v5 offset:38912
 s_mov_b64 exec, s[96:97]
 ds_read_b128 v[128:131], v114 offset:33792
 ds_read_b128 v[132:135], v114 offset:34304
 s_mov_b64 exec, -1
 v_exp_f32 v170, v170
 v_exp_f32 v171, v171
 v_exp_f32 v172, v172
 v_exp_f32 v173, v173
 v_mfma_f32_16x16x32_bf16 v[252:255], v[96:99], v[72:75], v[252:255]
 v_mfma_f32_16x16x32_bf16 v[252:255], v[100:103], v[76:79], v[252:255]
 v_exp_f32 v174, v174
 v_exp_f32 v175, v175
 v_exp_f32 v176, v176
 v_exp_f32 v177, v177
 v_smfmac_f32_32x32x32_bf16 v[32:47], v[140:143], v[168:175], v112
 s_waitcnt lgkmcnt(0)
 v_exp_f32 v178, v178
 v_exp_f32 v179, v179
 v_exp_f32 v180, v180
 v_mfma_f32_32x32x16_bf16 v[160:175], v[104:107], v[144:147], 0
 s_add_u32 s82, s81, 3
 s_cmp_ge_u32 s82, 7
 s_cselect_b32 s63, 7, 0
 s_sub_u32 s82, s82, s63
 s_add_u32 m0, s53, 0
 s_lshl_b32 s82, s82, 16
 buffer_load_dwordx4 v116, s[32:35], s82 offen lds
 v_exp_f32 v181, v181
 v_exp_f32 v182, v182
 v_exp_f32 v183, v183
 v_exp_f32 v184, v184
 v_exp_f32 v185, v185
 v_smfmac_f32_32x32x32_bf16 v[48:63], v[136:139], v[176:183], v112
 s_add_u32 m0, s53, 8192
 s_add_u32 s82, s82, 458752
 buffer_load_dwordx4 v116, s[32:35], s82 offen lds
 v_exp_f32 v186, v186
 v_exp_f32 v187, v187
 v_exp_f32 v188, v188
 v_exp_f32 v189, v189
 v_mfma_f32_16x16x32_bf16 v[224:227], v[88:91], v[80:83], v[224:227]
 v_mfma_f32_16x16x32_bf16 v[224:227], v[92:95], v[84:87], v[224:227]
 v_exp_f32 v190, v190
 v_exp_f32 v191, v191
 v_exp_f32 v160, v160
 v_exp_f32 v161, v161
 v_smfmac_f32_32x32x32_bf16 v[48:63], v[140:143], v[184:191], v112
 ds_read_b128 v[108:111], v113 offset:36864
 v_exp_f32 v162, v162
 v_exp_f32 v163, v163
 v_exp_f32 v164, v164
 v_mfma_f32_32x32x16_bf16 v[176:191], v[104:107], v[148:151], 0
 ds_read_b64_tr_b16 v[96:97], v6 offset:32768
 ds_read_b64_tr_b16 v[98:99], v6 offset:34816
 v_exp_f32 v165, v165
 v_exp_f32 v166, v166
 v_exp_f32 v167, v167
 v_exp_f32 v168, v168
 v_exp_f32 v169, v169
 v_smfmac_f32_32x32x32_bf16 v[32:47], v[128:131], v[160:167], v112
 ds_read_b64_tr_b16 v[100:101], v6 offset:36864
 ds_read_b64_tr_b16 v[102:103], v6 offset:38912
 s_mov_b64 exec, s[96:97]
 ds_read_b128 v[136:139], v114 offset:37888
 ds_read_b128 v[140:143], v114 offset:38400
 s_mov_b64 exec, -1
 v_exp_f32 v170, v170
 v_exp_f32 v171, v171
 v_exp_f32 v172, v172
 v_exp_f32 v173, v173
 v_mfma_f32_16x16x32_bf16 v[228:231], v[88:91], v[152:155], v[228:231]
 v_mfma_f32_16x16x32_bf16 v[228:231], v[92:95], v[156:159], v[228:231]
 s_add_u32 s83, s81, 6
 s_cmp_ge_u32 s83, 7
 s_cselect_b32 s63, 7, 0
 s_sub_u32 s83, s83, s63
 s_lshl_b32 s83, s83, 12
 s_add_u32 s83, s83, s69
 buffer_load_dwordx4 v[64:67], v122, s[28:31], s83 offen offset:0 sc1
 v_exp_f32 v174, v174
 v_exp_f32 v175, v175
 v_exp_f32 v176, v176
 v_exp_f32 v177, v177
 v_smfmac_f32_32x32x32_bf16 v[32:47], v[132:135], v[168:175], v112
 s_waitcnt lgkmcnt(0)
 v_exp_f32 v178, v178
 v_exp_f32 v179, v179
 v_exp_f32 v180, v180
 v_mfma_f32_32x32x16_bf16 v[160:175], v[108:111], v[144:147], 0
 s_add_u32 m0, s53, 16384
 s_add_u32 s82, s82, 458752
 buffer_load_dwordx4 v116, s[32:35], s82 offen lds
 v_exp_f32 v181, v181
 v_exp_f32 v182, v182
 v_exp_f32 v183, v183
 v_exp_f32 v184, v184
 v_exp_f32 v185, v185
 v_smfmac_f32_32x32x32_bf16 v[48:63], v[128:131], v[176:183], v112
 s_add_u32 m0, s53, 24576
 s_add_u32 s82, s82, 458752
 buffer_load_dwordx4 v116, s[32:35], s82 offen lds
 v_exp_f32 v186, v186
 v_exp_f32 v187, v187
 v_exp_f32 v188, v188
 v_exp_f32 v189, v189
 v_mfma_f32_16x16x32_bf16 v[232:235], v[96:99], v[80:83], v[232:235]
 v_mfma_f32_16x16x32_bf16 v[232:235], v[100:103], v[84:87], v[232:235]
 v_exp_f32 v190, v190
 v_exp_f32 v191, v191
 v_exp_f32 v160, v160
 v_exp_f32 v161, v161
 v_smfmac_f32_32x32x32_bf16 v[48:63], v[132:135], v[184:191], v112
 ds_read_b128 v[104:107], v113 offset:40960
 s_setprio 2
 v_exp_f32 v162, v162
 v_exp_f32 v163, v163
 v_exp_f32 v164, v164
 v_mfma_f32_32x32x16_bf16 v[176:191], v[108:111], v[148:151], 0
 ds_read_b64_tr_b16 v[88:89], v14 offset:32768
 ds_read_b64_tr_b16 v[90:91], v14 offset:34816
 v_exp_f32 v165, v165
 v_exp_f32 v166, v166
 v_exp_f32 v167, v167
 v_exp_f32 v168, v168
 v_exp_f32 v169, v169
 v_smfmac_f32_32x32x32_bf16 v[32:47], v[136:139], v[160:167], v112
 ds_read_b64_tr_b16 v[92:93], v14 offset:36864
 ds_read_b64_tr_b16 v[94:95], v14 offset:38912
 s_mov_b64 exec, s[96:97]
 ds_read_b128 v[128:131], v114 offset:41984
 ds_read_b128 v[132:135], v114 offset:42496
 s_mov_b64 exec, -1
 v_exp_f32 v170, v170
 v_exp_f32 v171, v171
 v_exp_f32 v172, v172
 v_exp_f32 v173, v173
 v_mfma_f32_16x16x32_bf16 v[236:239], v[96:99], v[152:155], v[236:239]
 v_mfma_f32_16x16x32_bf16 v[236:239], v[100:103], v[156:159], v[236:239]
 buffer_load_dwordx4 v[68:71], v122, s[28:31], s83 offen offset:2048 sc1
 v_exp_f32 v174, v174
 v_exp_f32 v175, v175
 v_exp_f32 v176, v176
 v_exp_f32 v177, v177
 v_smfmac_f32_32x32x32_bf16 v[32:47], v[140:143], v[168:175], v112
 s_waitcnt lgkmcnt(0)
 v_exp_f32 v178, v178
 v_exp_f32 v179, v179
 v_exp_f32 v180, v180
 v_mfma_f32_32x32x16_bf16 v[160:175], v[104:107], v[144:147], 0
 s_add_u32 s82, s81, 4
 s_cmp_ge_u32 s82, 7
 s_cselect_b32 s63, 7, 0
 s_sub_u32 s82, s82, s63
 s_add_u32 m0, s53, 32768
 s_lshl_b32 s82, s82, 16
 buffer_load_dwordx4 v116, s[32:35], s82 offen lds
 v_exp_f32 v181, v181
 v_exp_f32 v182, v182
 v_exp_f32 v183, v183
 v_exp_f32 v184, v184
 v_exp_f32 v185, v185
 v_smfmac_f32_32x32x32_bf16 v[48:63], v[136:139], v[176:183], v112
 s_add_u32 m0, s53, 40960
 s_add_u32 s82, s82, 458752
 buffer_load_dwordx4 v116, s[32:35], s82 offen lds
 v_exp_f32 v186, v186
 v_exp_f32 v187, v187
 v_exp_f32 v188, v188
 v_exp_f32 v189, v189
 v_mfma_f32_16x16x32_bf16 v[240:243], v[88:91], v[80:83], v[240:243]
 v_mfma_f32_16x16x32_bf16 v[240:243], v[92:95], v[84:87], v[240:243]
 v_exp_f32 v190, v190
 v_exp_f32 v191, v191
 v_exp_f32 v160, v160
 v_exp_f32 v161, v161
 v_smfmac_f32_32x32x32_bf16 v[48:63], v[140:143], v[184:191], v112
 ds_read_b128 v[108:111], v113 offset:45056
 v_exp_f32 v162, v162
 v_exp_f32 v163, v163
 v_exp_f32 v164, v164
 v_mfma_f32_32x32x16_bf16 v[176:191], v[104:107], v[148:151], 0
 ds_read_b64_tr_b16 v[96:97], v15 offset:32768
 ds_read_b64_tr_b16 v[98:99], v15 offset:34816
 v_exp_f32 v165, v165
 v_exp_f32 v166, v166
 v_exp_f32 v167, v167
 v_exp_f32 v168, v168
 v_exp_f32 v169, v169
 v_smfmac_f32_32x32x32_bf16 v[32:47], v[128:131], v[160:167], v112
 ds_read_b64_tr_b16 v[100:101], v15 offset:36864
 ds_read_b64_tr_b16 v[102:103], v15 offset:38912
 s_mov_b64 exec, s[96:97]
 ds_read_b128 v[136:139], v114 offset:46080
 ds_read_b128 v[140:143], v114 offset:46592
 s_mov_b64 exec, -1
 v_exp_f32 v170, v170
 v_exp_f32 v171, v171
 v_exp_f32 v172, v172
 v_exp_f32 v173, v173
 v_mfma_f32_16x16x32_bf16 v[244:247], v[88:91], v[152:155], v[244:247]
 v_mfma_f32_16x16x32_bf16 v[244:247], v[92:95], v[156:159], v[244:247]
 buffer_load_dwordx4 v[72:75], v122, s[28:31], s83 offen offset:256 sc1
 v_exp_f32 v174, v174
 v_exp_f32 v175, v175
 v_exp_f32 v176, v176
 v_exp_f32 v177, v177
 v_smfmac_f32_32x32x32_bf16 v[32:47], v[132:135], v[168:175], v112
 s_waitcnt lgkmcnt(0)
 s_setprio 1
 v_exp_f32 v178, v178
 v_exp_f32 v179, v179
 v_exp_f32 v180, v180
 v_mfma_f32_32x32x16_bf16 v[160:175], v[108:111], v[144:147], 0
 s_add_u32 m0, s53, 49152
 s_add_u32 s82, s82, 458752
 buffer_load_dwordx4 v116, s[32:35], s82 offen lds
 v_exp_f32 v181, v181
 v_exp_f32 v182, v182
 v_exp_f32 v183, v183
 v_exp_f32 v184, v184
 v_exp_f32 v185, v185
 v_smfmac_f32_32x32x32_bf16 v[48:63], v[128:131], v[176:183], v112
 s_add_u32 m0, s53, 57344
 s_add_u32 s82, s82, 458752
 buffer_load_dwordx4 v116, s[32:35], s82 offen lds
 v_exp_f32 v186, v186
 v_exp_f32 v187, v187
 v_exp_f32 v188, v188
 v_exp_f32 v189, v189
 v_mfma_f32_16x16x32_bf16 v[248:251], v[96:99], v[80:83], v[248:251]
 v_mfma_f32_16x16x32_bf16 v[248:251], v[100:103], v[84:87], v[248:251]
 v_exp_f32 v190, v190
 v_exp_f32 v191, v191
 v_exp_f32 v160, v160
 v_exp_f32 v161, v161
 v_smfmac_f32_32x32x32_bf16 v[48:63], v[132:135], v[184:191], v112
 ds_read_b128 v[104:107], v113 offset:49152
 v_exp_f32 v162, v162
 v_exp_f32 v163, v163
 v_exp_f32 v164, v164
 v_mfma_f32_32x32x16_bf16 v[176:191], v[108:111], v[148:151], 0
 v_exp_f32 v165, v165
 v_exp_f32 v166, v166
 v_exp_f32 v167, v167
 v_exp_f32 v168, v168
 v_exp_f32 v169, v169
 v_smfmac_f32_32x32x32_bf16 v[32:47], v[136:139], v[160:167], v112
 s_mov_b64 exec, s[96:97]
 ds_read_b128 v[128:131], v114 offset:50176
 ds_read_b128 v[132:135], v114 offset:50688
 s_mov_b64 exec, -1
 v_exp_f32 v170, v170
 v_exp_f32 v171, v171
 v_exp_f32 v172, v172
 v_exp_f32 v173, v173
 v_mfma_f32_16x16x32_bf16 v[252:255], v[96:99], v[152:155], v[252:255]
 v_mfma_f32_16x16x32_bf16 v[252:255], v[100:103], v[156:159], v[252:255]
 buffer_load_dwordx4 v[76:79], v122, s[28:31], s83 offen offset:2304 sc1
 v_exp_f32 v174, v174
 v_exp_f32 v175, v175
 v_exp_f32 v176, v176
 v_exp_f32 v177, v177
 v_smfmac_f32_32x32x32_bf16 v[32:47], v[140:143], v[168:175], v112
 s_waitcnt lgkmcnt(0)
 v_exp_f32 v178, v178
 v_exp_f32 v179, v179
 v_exp_f32 v180, v180
 v_mfma_f32_32x32x16_bf16 v[160:175], v[104:107], v[144:147], 0
 s_add_u32 s82, s81, 6
 s_cmp_ge_u32 s82, 7
 s_cselect_b32 s63, 7, 0
 s_sub_u32 s82, s82, s63
 s_add_u32 m0, s53, 65536
 s_lshl_b32 s82, s82, 16
 buffer_load_dwordx4 v116, s[32:35], s82 offen lds
 v_exp_f32 v181, v181
 v_exp_f32 v182, v182
 v_exp_f32 v183, v183
 v_exp_f32 v184, v184
 v_exp_f32 v185, v185
 v_smfmac_f32_32x32x32_bf16 v[48:63], v[136:139], v[176:183], v112
 s_setprio 0
 s_add_u32 m0, s53, 73728
 s_add_u32 s82, s82, 458752
 buffer_load_dwordx4 v116, s[32:35], s82 offen lds
 v_exp_f32 v186, v186
 v_exp_f32 v187, v187
 v_exp_f32 v188, v188
 v_exp_f32 v189, v189
 v_exp_f32 v190, v190
 v_exp_f32 v191, v191
 s_barrier
 v_exp_f32 v160, v160
 v_exp_f32 v161, v161
 v_smfmac_f32_32x32x32_bf16 v[48:63], v[140:143], v[184:191], v112
 ds_read_b128 v[108:111], v113 offset:53248
 s_setprio 3
 v_exp_f32 v162, v162
 v_exp_f32 v163, v163
 v_exp_f32 v164, v164
 v_mfma_f32_32x32x16_bf16 v[176:191], v[104:107], v[148:151], 0
 v_exp_f32 v165, v165
 v_exp_f32 v166, v166
 v_exp_f32 v167, v167
 v_exp_f32 v168, v168
 v_exp_f32 v169, v169
 v_smfmac_f32_32x32x32_bf16 v[32:47], v[128:131], v[160:167], v112
 s_mov_b64 exec, s[96:97]
 ds_read_b128 v[136:139], v114 offset:54272
 ds_read_b128 v[140:143], v114 offset:54784
 s_mov_b64 exec, -1
 v_exp_f32 v170, v170
 v_exp_f32 v171, v171
 v_exp_f32 v172, v172
 v_exp_f32 v173, v173
 v_exp_f32 v174, v174
 v_exp_f32 v175, v175
 v_exp_f32 v176, v176
 v_exp_f32 v177, v177
 v_smfmac_f32_32x32x32_bf16 v[32:47], v[132:135], v[168:175], v112
 s_waitcnt lgkmcnt(0)
 v_exp_f32 v178, v178
 v_exp_f32 v179, v179
 v_exp_f32 v180, v180
 v_mfma_f32_32x32x16_bf16 v[160:175], v[108:111], v[144:147], 0
 s_add_u32 m0, s53, 81920
 s_add_u32 s82, s82, 458752
 buffer_load_dwordx4 v116, s[32:35], s82 offen lds
 v_exp_f32 v181, v181
 v_exp_f32 v182, v182
 v_exp_f32 v183, v183
 v_exp_f32 v184, v184
 v_exp_f32 v185, v185
 v_smfmac_f32_32x32x32_bf16 v[48:63], v[128:131], v[176:183], v112
 s_add_u32 m0, s53, 90112
 s_add_u32 s82, s82, 458752
 buffer_load_dwordx4 v116, s[32:35], s82 offen lds
 v_exp_f32 v186, v186
 v_exp_f32 v187, v187
 v_exp_f32 v188, v188
 v_exp_f32 v189, v189
 v_exp_f32 v190, v190
 v_exp_f32 v191, v191
 v_exp_f32 v160, v160
 v_exp_f32 v161, v161
 v_smfmac_f32_32x32x32_bf16 v[48:63], v[132:135], v[184:191], v112
 ds_read_b128 v[104:107], v113 offset:57344
 s_setprio 2
 v_exp_f32 v162, v162
 v_exp_f32 v163, v163
 v_exp_f32 v164, v164
 v_mfma_f32_32x32x16_bf16 v[176:191], v[108:111], v[148:151], 0
 v_exp_f32 v165, v165
 v_exp_f32 v166, v166
 v_exp_f32 v167, v167
 v_exp_f32 v168, v168
 v_exp_f32 v169, v169
 v_smfmac_f32_32x32x32_bf16 v[32:47], v[136:139], v[160:167], v112
 s_mov_b64 exec, s[96:97]
 ds_read_b128 v[128:131], v114 offset:58368
 ds_read_b128 v[132:135], v114 offset:58880
 s_mov_b64 exec, -1
 v_exp_f32 v170, v170
 v_exp_f32 v171, v171
 v_exp_f32 v172, v172
 v_exp_f32 v173, v173
 v_exp_f32 v174, v174
 v_exp_f32 v175, v175
 v_exp_f32 v176, v176
 v_exp_f32 v177, v177
 v_smfmac_f32_32x32x32_bf16 v[32:47], v[140:143], v[168:175], v112
 s_waitcnt lgkmcnt(0)
 v_exp_f32 v178, v178
 v_exp_f32 v179, v179
 v_exp_f32 v180, v180
 v_mfma_f32_32x32x16_bf16 v[160:175], v[104:107], v[144:147], 0
 ds_read_b128 v[108:111], v113 offset:61440
 s_add_u32 s82, s81, 5
 s_cmp_ge_u32 s82, 7
 s_cselect_b32 s63, 7, 0
 s_sub_u32 s82, s82, s63
 s_add_u32 m0, s53, 131072
 s_lshl_b32 s82, s82, 16
 buffer_load_dwordx4 v116, s[32:35], s82 offen lds
 v_exp_f32 v181, v181
 v_exp_f32 v182, v182
 v_exp_f32 v183, v183
 v_exp_f32 v184, v184
 v_exp_f32 v185, v185
 v_smfmac_f32_32x32x32_bf16 v[48:63], v[136:139], v[176:183], v112
 s_add_u32 m0, s53, 139264
 s_add_u32 s82, s82, 458752
 buffer_load_dwordx4 v116, s[32:35], s82 offen lds
 v_exp_f32 v186, v186
 v_exp_f32 v187, v187
 v_exp_f32 v188, v188
 v_exp_f32 v189, v189
 v_exp_f32 v190, v190
 v_exp_f32 v191, v191
 v_exp_f32 v160, v160
 v_exp_f32 v161, v161
 v_smfmac_f32_32x32x32_bf16 v[48:63], v[140:143], v[184:191], v112
 s_waitcnt lgkmcnt(0)
 s_setprio 1
 v_exp_f32 v162, v162
 v_exp_f32 v163, v163
 v_exp_f32 v164, v164
 v_mfma_f32_32x32x16_bf16 v[176:191], v[108:111], v[144:147], 0
 v_exp_f32 v165, v165
 v_exp_f32 v166, v166
 v_exp_f32 v167, v167
 v_exp_f32 v168, v168
 v_exp_f32 v169, v169
 v_smfmac_f32_32x32x32_bf16 v[32:47], v[128:131], v[160:167], v112
 s_mov_b64 exec, s[96:97]
 ds_read_b128 v[136:139], v114 offset:62464
 ds_read_b128 v[140:143], v114 offset:62976
 s_mov_b64 exec, -1
 v_exp_f32 v170, v170
 v_exp_f32 v171, v171
 v_exp_f32 v172, v172
 v_exp_f32 v173, v173
 v_exp_f32 v174, v174
 v_exp_f32 v175, v175
 v_exp_f32 v176, v176
 v_exp_f32 v177, v177
 v_smfmac_f32_32x32x32_bf16 v[32:47], v[132:135], v[168:175], v112
 s_waitcnt lgkmcnt(0)
 v_exp_f32 v178, v178
 v_exp_f32 v179, v179
 v_exp_f32 v180, v180
 v_mfma_f32_32x32x16_bf16 v[160:175], v[104:107], v[148:151], 0
 s_add_u32 m0, s53, 147456
 s_add_u32 s82, s82, 458752
 buffer_load_dwordx4 v116, s[32:35], s82 offen lds
 v_exp_f32 v181, v181
 v_exp_f32 v182, v182
 v_exp_f32 v183, v183
 v_exp_f32 v184, v184
 v_exp_f32 v185, v185
 v_smfmac_f32_32x32x32_bf16 v[32:47], v[136:139], v[176:183], v112
 s_setprio 0
 s_add_u32 m0, s53, 155648
 s_add_u32 s82, s82, 458752
 buffer_load_dwordx4 v116, s[32:35], s82 offen lds
 v_exp_f32 v186, v186
 v_exp_f32 v187, v187
 v_exp_f32 v188, v188
 v_exp_f32 v189, v189
 v_exp_f32 v190, v190
 v_exp_f32 v191, v191
 v_exp_f32 v160, v160
 v_exp_f32 v161, v161
 v_smfmac_f32_32x32x32_bf16 v[32:47], v[140:143], v[184:191], v112
 v_exp_f32 v162, v162
 v_exp_f32 v163, v163
 v_exp_f32 v164, v164
 v_mfma_f32_32x32x16_bf16 v[176:191], v[108:111], v[148:151], 0
 v_exp_f32 v165, v165
 v_exp_f32 v166, v166
 v_exp_f32 v167, v167
 v_exp_f32 v168, v168
 v_exp_f32 v169, v169
 v_smfmac_f32_32x32x32_bf16 v[48:63], v[128:131], v[160:167], v112
 v_exp_f32 v170, v170
 v_exp_f32 v171, v171
 v_exp_f32 v172, v172
 ds_write_b128 v7, v[32:35] offset:0
 ds_write_b128 v7, v[36:39] offset:1024
 ds_write_b32 v119, v40 offset:2048
 v_exp_f32 v173, v173
 v_exp_f32 v174, v174
 v_exp_f32 v175, v175
 v_exp_f32 v176, v176
 v_exp_f32 v177, v177
 v_smfmac_f32_32x32x32_bf16 v[48:63], v[132:135], v[168:175], v112
 s_waitcnt vmcnt(9) lgkmcnt(0)
 s_barrier
 ds_read_b128 v[160:163], v8
 ds_read_b128 v[164:167], v8 offset:1024
 ds_read_b32 v168, v4 offset:2048
 v_exp_f32 v178, v178
 v_exp_f32 v179, v179
 v_exp_f32 v180, v180
 v_exp_f32 v181, v181
 v_exp_f32 v182, v182
 v_exp_f32 v183, v183
 v_exp_f32 v184, v184
 v_exp_f32 v185, v185
 v_smfmac_f32_32x32x32_bf16 v[48:63], v[136:139], v[176:183], v112
 v_exp_f32 v186, v186
 v_exp_f32 v187, v187
 v_exp_f32 v188, v188
 v_exp_f32 v189, v189
 v_exp_f32 v190, v190
 v_exp_f32 v191, v191
 s_lshl_b32 s62, s76, 5
 s_add_u32 s62, s62, s64
 v_smfmac_f32_32x32x32_bf16 v[48:63], v[140:143], v[184:191], v112
 s_lshl_b32 s68, s62, 10
 s_add_u32 s68, s68, 7340032
 ds_read_b64_tr_b16 v[88:89], v124 offset:0
 ds_read_b64_tr_b16 v[90:91], v124 offset:2048
 ds_read_b64_tr_b16 v[92:93], v124 offset:4096
 ds_read_b64_tr_b16 v[94:95], v124 offset:6144
 ds_read_b64_tr_b16 v[96:97], v1 offset:0
 ds_read_b64_tr_b16 v[98:99], v1 offset:2048
 ds_read_b64_tr_b16 v[100:101], v1 offset:4096
 ds_read_b64_tr_b16 v[102:103], v1 offset:6144
 s_waitcnt lgkmcnt(8)
 s_nop 0
 v_add_f32 v48, v48, v160
 v_add_f32 v49, v49, v161
 v_add_f32 v50, v50, v162
 v_add_f32 v51, v51, v163
 v_add_f32 v52, v52, v164
 v_add_f32 v53, v53, v165
 v_add_f32 v54, v54, v166
 v_add_f32 v55, v55, v167
 v_add_f32 v56, v56, v168
 v_fma_f32 v108, 0, v48, v56
 v_fmac_f32 v108, 0, v49
 v_fmac_f32 v108, 0, v50
 v_fmac_f32 v108, 0, v51
 v_fmac_f32 v108, 0, v52
 v_fmac_f32 v108, 0, v53
 v_fmac_f32 v108, 0, v54
 v_fmac_f32 v108, 0, v55
 v_cmp_lt_f32 vcc, 0x2b800000, v108
 s_nop 0
 s_mov_b64 s[98:99], vcc
 v_cmp_gt_f32 vcc, 0x5d800000, v108
 s_nop 0
 s_and_b64 vcc, vcc, s[98:99]
 s_cmp_eq_u64 vcc, -1
 s_cbranch_scc0 L_slow0
L_slowret0:
 v_rcp_f32 v108, v56
 s_nop 0
 v_mul_f32 v108, v108, v118
 v_mul_f32 v48, v48, v108
 v_mul_f32 v49, v49, v108
 v_mul_f32 v50, v50, v108
 v_mul_f32 v51, v51, v108
 v_mul_f32 v52, v52, v108
 v_mul_f32 v53, v53, v108
 v_mul_f32 v54, v54, v108
 v_mul_f32 v55, v55, v108
 v_cvt_pk_bf16_f32 v108, v48, v49
 v_cvt_pk_bf16_f32 v109, v50, v51
 v_cvt_pk_bf16_f32 v110, v52, v53
 v_cvt_pk_bf16_f32 v111, v54, v55
 v_min_u32 v108, -2, v108
 v_min_u32 v109, -2, v109
 v_min_u32 v110, -2, v110
 v_min_u32 v111, -2, v111
 buffer_store_dwordx4 v[108:111], v126, s[28:31], s68 offen sc1
 s_and_b32 s62, s52, 1
 s_bfe_u32 s63, s52, 0x10001
 s_sub_u32 s62, s62, s63
 s_lshl_b32 s62, s62, 13
 v_add_u32 v116, s62, v116
 s_waitcnt lgkmcnt(4)
 v_mfma_f32_16x16x32_bf16 v[224:227], v[88:91], v[192:195], v[224:227]
 s_setprio 1
 ds_read_b64_tr_b16 v[32:33], v2 offset:0
 ds_read_b64_tr_b16 v[34:35], v2 offset:2048
 v_mfma_f32_16x16x32_bf16 v[224:227], v[92:95], v[196:199], v[224:227]
 ds_read_b64_tr_b16 v[36:37], v2 offset:4096
 ds_read_b64_tr_b16 v[38:39], v2 offset:6144
 v_mfma_f32_16x16x32_bf16 v[228:231], v[88:91], v[200:203], v[228:231]
 ds_read_b64_tr_b16 v[40:41], v3 offset:0
 ds_read_b64_tr_b16 v[42:43], v3 offset:2048
 v_mfma_f32_16x16x32_bf16 v[228:231], v[92:95], v[204:207], v[228:231]
 s_setprio 0
 ds_read_b64_tr_b16 v[44:45], v3 offset:4096
 ds_read_b64_tr_b16 v[46:47], v3 offset:6144
 s_lshl_b32 s62, s71, 2
 s_add_u32 s62, s62, s72
 s_lshl_b32 s67, s62, 13
 s_lshr_b32 s68, s0, 4
 s_add_u32 s67, s67, s68
 s_add_u32 s67, s67, 7340032
 s_xor_b32 s70, s67, 4096
 v_and_b32 v13, 15, v0
 v_lshrrev_b32 v11, 4, v0
 v_xor_b32 v11, v11, v13
 s_waitcnt lgkmcnt(8)
 v_mfma_f32_16x16x32_bf16 v[232:235], v[96:99], v[192:195], v[232:235]
 s_setprio 1
 v_mfma_f32_16x16x32_bf16 v[232:235], v[100:103], v[196:199], v[232:235]
 v_mfma_f32_16x16x32_bf16 v[236:239], v[96:99], v[200:203], v[236:239]
 v_mfma_f32_16x16x32_bf16 v[236:239], v[100:103], v[204:207], v[236:239]
 s_setprio 0
 v_lshlrev_b32 v11, 4, v11
 v_lshl_add_u32 v11, v13, 8, v11
 s_lshl_b32 s68, s52, 13
 s_add_u32 s68, s68, 32768
 v_add_u32 v104, s68, v11
 v_xor_b32 v105, 64, v104
 v_xor_b32 v106, 128, v104
 s_waitcnt vmcnt(1) lgkmcnt(0)
 s_barrier
 v_mfma_f32_16x16x32_bf16 v[240:243], v[32:35], v[192:195], v[240:243]
 s_setprio 1
 ds_read_b64_tr_b16 v[144:145], v124 offset:32768
 v_mfma_f32_16x16x32_bf16 v[240:243], v[36:39], v[196:199], v[240:243]
 ds_read_b64_tr_b16 v[146:147], v124 offset:34816
 v_mfma_f32_16x16x32_bf16 v[244:247], v[32:35], v[200:203], v[244:247]
 ds_read_b64_tr_b16 v[148:149], v124 offset:36864
 v_mfma_f32_16x16x32_bf16 v[244:247], v[36:39], v[204:207], v[244:247]
 s_setprio 0
 ds_read_b64_tr_b16 v[150:151], v124 offset:38912
 s_add_u32 m0, s53, 98304
 s_xor_b32 s82, s0, 0
 buffer_load_dwordx4 v116, s[36:39], s82 offen lds
 s_add_u32 m0, s53, 106496
 s_xor_b32 s82, s0, 131072
 buffer_load_dwordx4 v116, s[36:39], s82 offen lds
 v_xor_b32 v107, 192, v104
 v_lshrrev_b32 v13, 3, v0
 s_lshl_b32 s68, s72, 3
 v_add_u32 v13, s68, v13
 v_and_b32 v11, 7, v0
 v_lshlrev_b32 v9, 1, v11
 v_and_b32 v8, 15, v13
 v_mfma_f32_16x16x32_bf16 v[248:251], v[40:43], v[192:195], v[248:251]
 s_setprio 1
 ds_read_b64_tr_b16 v[88:89], v1 offset:32768
 v_mfma_f32_16x16x32_bf16 v[248:251], v[44:47], v[196:199], v[248:251]
 ds_read_b64_tr_b16 v[90:91], v1 offset:34816
 v_mfma_f32_16x16x32_bf16 v[252:255], v[40:43], v[200:203], v[252:255]
 ds_read_b64_tr_b16 v[92:93], v1 offset:36864
 v_mfma_f32_16x16x32_bf16 v[252:255], v[44:47], v[204:207], v[252:255]
 s_setprio 0
 ds_read_b64_tr_b16 v[94:95], v1 offset:38912
 s_add_u32 m0, s53, 114688
 s_xor_b32 s82, s0, 262144
 buffer_load_dwordx4 v116, s[36:39], s82 offen lds
 s_add_u32 m0, s53, 122880
 s_xor_b32 s82, s0, 393216
 buffer_load_dwordx4 v116, s[36:39], s82 offen lds
 v_xor_b32 v9, v9, v8
 v_lshlrev_b32 v9, 4, v9
 v_lshl_add_u32 v9, v13, 8, v9
 s_and_b32 s68, s52, 1
 s_lshl_b32 s68, s68, 13
 s_add_u32 s68, s68, 32768
 v_add_u32 v10, s68, v9
 v_xor_b32 v9, 16, v10
 s_waitcnt lgkmcnt(4)
 v_mfma_f32_16x16x32_bf16 v[224:227], v[144:147], v[208:211], v[224:227]
 s_setprio 1
 ds_read_b64_tr_b16 v[96:97], v2 offset:32768
 v_mfma_f32_16x16x32_bf16 v[224:227], v[148:151], v[212:215], v[224:227]
 ds_read_b64_tr_b16 v[98:99], v2 offset:34816
 v_mfma_f32_16x16x32_bf16 v[228:231], v[144:147], v[216:219], v[228:231]
 ds_read_b64_tr_b16 v[100:101], v2 offset:36864
 v_mfma_f32_16x16x32_bf16 v[228:231], v[148:151], v[220:223], v[228:231]
 s_setprio 0
 ds_read_b64_tr_b16 v[102:103], v2 offset:38912
 s_add_u32 m0, s53, 0
 s_xor_b32 s82, s0, 65536
 buffer_load_dwordx4 v116, s[36:39], s82 offen lds
 s_add_u32 m0, s53, 8192
 s_xor_b32 s82, s0, 196608
 buffer_load_dwordx4 v116, s[36:39], s82 offen lds
 v_lshlrev_b32 v11, 4, v11
 v_lshl_add_u32 v12, v13, 10, v11
 s_lshl_b32 s62, s71, 15
 s_lshl_b32 s68, s73, 7
 s_add_u32 s77, s62, s68
 s_waitcnt lgkmcnt(4)
 v_mfma_f32_16x16x32_bf16 v[232:235], v[88:91], v[208:211], v[232:235]
 s_setprio 1
 ds_read_b64_tr_b16 v[144:145], v3 offset:32768
 v_mfma_f32_16x16x32_bf16 v[232:235], v[92:95], v[212:215], v[232:235]
 ds_read_b64_tr_b16 v[146:147], v3 offset:34816
 v_mfma_f32_16x16x32_bf16 v[236:239], v[88:91], v[216:219], v[236:239]
 ds_read_b64_tr_b16 v[148:149], v3 offset:36864
 v_mfma_f32_16x16x32_bf16 v[236:239], v[92:95], v[220:223], v[236:239]
 s_setprio 0
 ds_read_b64_tr_b16 v[150:151], v3 offset:38912
 s_add_u32 m0, s53, 16384
 s_xor_b32 s82, s0, 327680
 buffer_load_dwordx4 v116, s[36:39], s82 offen lds
 s_waitcnt lgkmcnt(4)
 v_mfma_f32_16x16x32_bf16 v[240:243], v[96:99], v[208:211], v[240:243]
 s_setprio 1
 ds_read_b64_tr_b16 v[88:89], v5 offset:32768
 v_mfma_f32_16x16x32_bf16 v[240:243], v[100:103], v[212:215], v[240:243]
 ds_read_b64_tr_b16 v[90:91], v5 offset:34816
 v_mfma_f32_16x16x32_bf16 v[244:247], v[96:99], v[216:219], v[244:247]
 ds_read_b64_tr_b16 v[92:93], v5 offset:36864
 v_mfma_f32_16x16x32_bf16 v[244:247], v[100:103], v[220:223], v[244:247]
 s_setprio 0
 ds_read_b64_tr_b16 v[94:95], v5 offset:38912
 v_add_u32 v5, 4294934528, v5
 s_add_u32 m0, s53, 24576
 s_xor_b32 s82, s0, 458752
 buffer_load_dwordx4 v116, s[36:39], s82 offen lds
 s_waitcnt lgkmcnt(4)
 v_mfma_f32_16x16x32_bf16 v[248:251], v[144:147], v[208:211], v[248:251]
 s_setprio 1
 ds_read_b64_tr_b16 v[96:97], v6 offset:32768
 v_mfma_f32_16x16x32_bf16 v[248:251], v[148:151], v[212:215], v[248:251]
 ds_read_b64_tr_b16 v[98:99], v6 offset:34816
 v_mfma_f32_16x16x32_bf16 v[252:255], v[144:147], v[216:219], v[252:255]
 ds_read_b64_tr_b16 v[100:101], v6 offset:36864
 v_mfma_f32_16x16x32_bf16 v[252:255], v[148:151], v[220:223], v[252:255]
 s_setprio 0
 ds_read_b64_tr_b16 v[102:103], v6 offset:38912
 v_add_u32 v6, 4294934528, v6
 buffer_load_dwordx4 v[160:163], v122, s[28:31], s67 offen offset:0 sc1
 s_waitcnt lgkmcnt(4)
 v_mfma_f32_16x16x32_bf16 v[224:227], v[88:91], v[16:19], v[224:227]
 s_setprio 1
 ds_read_b64_tr_b16 v[144:145], v14 offset:32768
 v_mfma_f32_16x16x32_bf16 v[224:227], v[92:95], v[20:23], v[224:227]
 ds_read_b64_tr_b16 v[146:147], v14 offset:34816
 v_mfma_f32_16x16x32_bf16 v[228:231], v[88:91], v[24:27], v[228:231]
 ds_read_b64_tr_b16 v[148:149], v14 offset:36864
 v_mfma_f32_16x16x32_bf16 v[228:231], v[92:95], v[28:31], v[228:231]
 s_setprio 0
 ds_read_b64_tr_b16 v[150:151], v14 offset:38912
 v_add_u32 v14, 4294934528, v14
 buffer_load_dwordx4 v[164:167], v122, s[28:31], s67 offen offset:2048 sc1
 s_waitcnt lgkmcnt(4)
 v_mfma_f32_16x16x32_bf16 v[232:235], v[96:99], v[16:19], v[232:235]
 s_setprio 1
 ds_read_b64_tr_b16 v[88:89], v15 offset:32768
 v_mfma_f32_16x16x32_bf16 v[232:235], v[100:103], v[20:23], v[232:235]
 ds_read_b64_tr_b16 v[90:91], v15 offset:34816
 v_mfma_f32_16x16x32_bf16 v[236:239], v[96:99], v[24:27], v[236:239]
 ds_read_b64_tr_b16 v[92:93], v15 offset:36864
 v_mfma_f32_16x16x32_bf16 v[236:239], v[100:103], v[28:31], v[236:239]
 s_setprio 0
 ds_read_b64_tr_b16 v[94:95], v15 offset:38912
 v_add_u32 v15, 4294934528, v15
 buffer_load_dwordx4 v[168:171], v122, s[28:31], s67 offen offset:256 sc1
 s_waitcnt lgkmcnt(4)
 v_mfma_f32_16x16x32_bf16 v[240:243], v[144:147], v[16:19], v[240:243]
 s_setprio 1
 ds_read_b64_tr_b16 v[96:97], v5 offset:0
 v_mfma_f32_16x16x32_bf16 v[240:243], v[148:151], v[20:23], v[240:243]
 ds_read_b64_tr_b16 v[98:99], v5 offset:2048
 v_mfma_f32_16x16x32_bf16 v[244:247], v[144:147], v[24:27], v[244:247]
 ds_read_b64_tr_b16 v[100:101], v5 offset:4096
 v_mfma_f32_16x16x32_bf16 v[244:247], v[148:151], v[28:31], v[244:247]
 s_setprio 0
 ds_read_b64_tr_b16 v[102:103], v5 offset:6144
 buffer_load_dwordx4 v[172:175], v122, s[28:31], s67 offen offset:2304 sc1
 s_waitcnt lgkmcnt(4)
 v_mfma_f32_16x16x32_bf16 v[248:251], v[88:91], v[16:19], v[248:251]
 s_setprio 1
 ds_read_b64_tr_b16 v[144:145], v6 offset:0
 v_mfma_f32_16x16x32_bf16 v[248:251], v[92:95], v[20:23], v[248:251]
 ds_read_b64_tr_b16 v[146:147], v6 offset:2048
 v_mfma_f32_16x16x32_bf16 v[252:255], v[88:91], v[24:27], v[252:255]
 ds_read_b64_tr_b16 v[148:149], v6 offset:4096
 v_mfma_f32_16x16x32_bf16 v[252:255], v[92:95], v[28:31], v[252:255]
 s_setprio 0
 ds_read_b64_tr_b16 v[150:151], v6 offset:6144
 buffer_load_dwordx4 v[176:179], v122, s[28:31], s70 offen offset:0 sc1
 s_waitcnt lgkmcnt(4)
 v_mfma_f32_16x16x32_bf16 v[224:227], v[96:99], v[64:67], v[224:227]
 s_setprio 1
 ds_read_b64_tr_b16 v[88:89], v14 offset:0
 v_mfma_f32_16x16x32_bf16 v[224:227], v[100:103], v[68:71], v[224:227]
 ds_read_b64_tr_b16 v[90:91], v14 offset:2048
 v_mfma_f32_16x16x32_bf16 v[228:231], v[96:99], v[72:75], v[228:231]
 ds_read_b64_tr_b16 v[92:93], v14 offset:4096
 v_mfma_f32_16x16x32_bf16 v[228:231], v[100:103], v[76:79], v[228:231]
 s_setprio 0
 ds_read_b64_tr_b16 v[94:95], v14 offset:6144
 buffer_load_dwordx4 v[180:183], v122, s[28:31], s70 offen offset:2048 sc1
 s_waitcnt lgkmcnt(4)
 v_mfma_f32_16x16x32_bf16 v[232:235], v[144:147], v[64:67], v[232:235]
 s_setprio 1
 ds_read_b64_tr_b16 v[96:97], v15 offset:0
 v_mfma_f32_16x16x32_bf16 v[232:235], v[148:151], v[68:71], v[232:235]
 ds_read_b64_tr_b16 v[98:99], v15 offset:2048
 v_mfma_f32_16x16x32_bf16 v[236:239], v[144:147], v[72:75], v[236:239]
 ds_read_b64_tr_b16 v[100:101], v15 offset:4096
 v_mfma_f32_16x16x32_bf16 v[236:239], v[148:151], v[76:79], v[236:239]
 s_setprio 0
 ds_read_b64_tr_b16 v[102:103], v15 offset:6144
 buffer_load_dwordx4 v[184:187], v122, s[28:31], s70 offen offset:256 sc1
 s_waitcnt vmcnt(7) lgkmcnt(0)
 s_barrier
 v_mfma_f32_16x16x32_bf16 v[240:243], v[88:91], v[64:67], v[240:243]
 s_setprio 1
 ds_read_b64_tr_b16 v[144:145], v5 offset:32768
 v_mfma_f32_16x16x32_bf16 v[240:243], v[92:95], v[68:71], v[240:243]
 ds_read_b64_tr_b16 v[146:147], v5 offset:34816
 v_mfma_f32_16x16x32_bf16 v[244:247], v[88:91], v[72:75], v[244:247]
 ds_read_b64_tr_b16 v[148:149], v5 offset:36864
 v_mfma_f32_16x16x32_bf16 v[244:247], v[92:95], v[76:79], v[244:247]
 s_setprio 0
 ds_read_b64_tr_b16 v[150:151], v5 offset:38912
 buffer_load_dwordx4 v[188:191], v122, s[28:31], s70 offen offset:2304 sc1
 v_mfma_f32_16x16x32_bf16 v[248:251], v[96:99], v[64:67], v[248:251]
 s_setprio 1
 ds_read_b64_tr_b16 v[88:89], v6 offset:32768
 v_mfma_f32_16x16x32_bf16 v[248:251], v[100:103], v[68:71], v[248:251]
 ds_read_b64_tr_b16 v[90:91], v6 offset:34816
 v_mfma_f32_16x16x32_bf16 v[252:255], v[96:99], v[72:75], v[252:255]
 ds_read_b64_tr_b16 v[92:93], v6 offset:36864
 v_mfma_f32_16x16x32_bf16 v[252:255], v[100:103], v[76:79], v[252:255]
 s_setprio 0
 ds_read_b64_tr_b16 v[94:95], v6 offset:38912
 s_waitcnt vmcnt(4)
 v_max3_u32 v13, v160, v161, v162
 v_max3_u32 v13, v13, v163, v164
 v_max3_u32 v13, v13, v165, v166
 v_max3_u32 v13, v13, v167, v168
 v_max3_u32 v13, v13, v169, v170
 v_max3_u32 v13, v13, v171, v172
 v_max3_u32 v13, v13, v173, v174
 v_max_u32 v13, v13, v175
 v_cmp_eq_u32 vcc, -1, v13
 s_nop 0
 s_cmp_lg_u64 vcc, 0
 s_cbranch_scc1 L_x_1025
L_r_1026:
 s_waitcnt lgkmcnt(4)
 v_mfma_f32_16x16x32_bf16 v[224:227], v[144:147], v[160:163], v[224:227]
 s_setprio 1
 ds_read_b64_tr_b16 v[96:97], v14 offset:32768
 v_mfma_f32_16x16x32_bf16 v[224:227], v[148:151], v[164:167], v[224:227]
 ds_read_b64_tr_b16 v[98:99], v14 offset:34816
 v_mfma_f32_16x16x32_bf16 v[228:231], v[144:147], v[168:171], v[228:231]
 ds_read_b64_tr_b16 v[100:101], v14 offset:36864
 v_mfma_f32_16x16x32_bf16 v[228:231], v[148:151], v[172:175], v[228:231]
 s_setprio 0
 ds_read_b64_tr_b16 v[102:103], v14 offset:38912
 s_waitcnt lgkmcnt(4)
 v_mfma_f32_16x16x32_bf16 v[232:235], v[88:91], v[160:163], v[232:235]
 s_setprio 1
 ds_read_b64_tr_b16 v[144:145], v15 offset:32768
 v_mfma_f32_16x16x32_bf16 v[232:235], v[92:95], v[164:167], v[232:235]
 ds_read_b64_tr_b16 v[146:147], v15 offset:34816
 v_mfma_f32_16x16x32_bf16 v[236:239], v[88:91], v[168:171], v[236:239]
 ds_read_b64_tr_b16 v[148:149], v15 offset:36864
 v_mfma_f32_16x16x32_bf16 v[236:239], v[92:95], v[172:175], v[236:239]
 s_setprio 0
 ds_read_b64_tr_b16 v[150:151], v15 offset:38912
 s_waitcnt lgkmcnt(4)
 v_mfma_f32_16x16x32_bf16 v[240:243], v[96:99], v[160:163], v[240:243]
 s_setprio 1
 ds_read_b64_tr_b16 v[88:89], v124 offset:0
 v_mfma_f32_16x16x32_bf16 v[240:243], v[100:103], v[164:167], v[240:243]
 ds_read_b64_tr_b16 v[90:91], v124 offset:2048
 v_mfma_f32_16x16x32_bf16 v[244:247], v[96:99], v[168:171], v[244:247]
 ds_read_b64_tr_b16 v[92:93], v124 offset:4096
 v_mfma_f32_16x16x32_bf16 v[244:247], v[100:103], v[172:175], v[244:247]
 s_setprio 0
 ds_read_b64_tr_b16 v[94:95], v124 offset:6144
 s_waitcnt lgkmcnt(4)
 v_mfma_f32_16x16x32_bf16 v[248:251], v[144:147], v[160:163], v[248:251]
 s_setprio 1
 ds_read_b64_tr_b16 v[96:97], v1 offset:0
 v_mfma_f32_16x16x32_bf16 v[248:251], v[148:151], v[164:167], v[248:251]
 ds_read_b64_tr_b16 v[98:99], v1 offset:2048
 v_mfma_f32_16x16x32_bf16 v[252:255], v[144:147], v[168:171], v[252:255]
 ds_read_b64_tr_b16 v[100:101], v1 offset:4096
 v_mfma_f32_16x16x32_bf16 v[252:255], v[148:151], v[172:175], v[252:255]
 s_setprio 0
 ds_read_b64_tr_b16 v[102:103], v1 offset:6144
 s_waitcnt vmcnt(0)
 v_max3_u32 v13, v176, v177, v178
 v_max3_u32 v13, v13, v179, v180
 v_max3_u32 v13, v13, v181, v182
 v_max3_u32 v13, v13, v183, v184
 v_max3_u32 v13, v13, v185, v186
 v_max3_u32 v13, v13, v187, v188
 v_max3_u32 v13, v13, v189, v190
 v_max_u32 v13, v13, v191
 v_cmp_eq_u32 vcc, -1, v13
 s_nop 0
 s_cmp_lg_u64 vcc, 0
 s_cbranch_scc1 L_x_1028
L_r_1029:
 s_waitcnt lgkmcnt(4)
 v_mfma_f32_16x16x32_bf16 v[224:227], v[88:91], v[176:179], v[224:227]
 s_setprio 1
 ds_read_b64_tr_b16 v[144:145], v2 offset:0
 v_mfma_f32_16x16x32_bf16 v[224:227], v[92:95], v[180:183], v[224:227]
 ds_read_b64_tr_b16 v[146:147], v2 offset:2048
 v_mfma_f32_16x16x32_bf16 v[228:231], v[88:91], v[184:187], v[228:231]
 ds_read_b64_tr_b16 v[148:149], v2 offset:4096
 v_mfma_f32_16x16x32_bf16 v[228:231], v[92:95], v[188:191], v[228:231]
 s_setprio 0
 ds_read_b64_tr_b16 v[150:151], v2 offset:6144
 s_waitcnt lgkmcnt(4)
 v_mfma_f32_16x16x32_bf16 v[232:235], v[96:99], v[176:179], v[232:235]
 s_setprio 1
 ds_read_b64_tr_b16 v[88:89], v3 offset:0
 v_mfma_f32_16x16x32_bf16 v[232:235], v[100:103], v[180:183], v[232:235]
 ds_read_b64_tr_b16 v[90:91], v3 offset:2048
 v_mfma_f32_16x16x32_bf16 v[236:239], v[96:99], v[184:187], v[236:239]
 ds_read_b64_tr_b16 v[92:93], v3 offset:4096
 ds_write_b128 v104, v[224:227] offset:0
 v_mfma_f32_16x16x32_bf16 v[236:239], v[100:103], v[188:191], v[236:239]
 s_setprio 0
 ds_read_b64_tr_b16 v[94:95], v3 offset:6144
 ds_write_b128 v104, v[228:231] offset:4096
 s_waitcnt lgkmcnt(6)
 v_mfma_f32_16x16x32_bf16 v[240:243], v[144:147], v[176:179], v[240:243]
 s_setprio 1
 v_mfma_f32_16x16x32_bf16 v[240:243], v[148:151], v[180:183], v[240:243]
 v_mfma_f32_16x16x32_bf16 v[244:247], v[144:147], v[184:187], v[244:247]
 ds_write_b128 v105, v[232:235] offset:0
 v_mfma_f32_16x16x32_bf16 v[244:247], v[148:151], v[188:191], v[244:247]
 s_setprio 0
 ds_write_b128 v105, v[236:239] offset:4096
 s_waitcnt lgkmcnt(3)
 v_mfma_f32_16x16x32_bf16 v[248:251], v[88:91], v[176:179], v[248:251]
 s_setprio 1
 v_mfma_f32_16x16x32_bf16 v[248:251], v[92:95], v[180:183], v[248:251]
 v_mfma_f32_16x16x32_bf16 v[252:255], v[88:91], v[184:187], v[252:255]
 ds_write_b128 v106, v[240:243] offset:0
 v_mfma_f32_16x16x32_bf16 v[252:255], v[92:95], v[188:191], v[252:255]
 s_setprio 0
 ds_write_b128 v106, v[244:247] offset:4096
 s_nop 2
 ds_write_b128 v107, v[248:251] offset:0
 s_nop 1
 ds_write_b128 v107, v[252:255] offset:4096
 s_waitcnt lgkmcnt(0)
 s_barrier
 ds_read_b128 v[128:131], v10 offset:0
 ds_read_b128 v[132:135], v9 offset:0
 ds_read_b128 v[136:139], v10 offset:16384
 ds_read_b128 v[140:143], v9 offset:16384
 ds_read_b128 v[144:147], v10 offset:32768
 ds_read_b128 v[148:151], v9 offset:32768
 ds_read_b128 v[152:155], v10 offset:49152
 ds_read_b128 v[156:159], v9 offset:49152
 s_waitcnt lgkmcnt(4)
 v_add_f32 v128, v128, v136
 v_add_f32 v129, v129, v137
 v_add_f32 v130, v130, v138
 v_add_f32 v131, v131, v139
 v_add_f32 v132, v132, v140
 v_add_f32 v133, v133, v141
 v_add_f32 v134, v134, v142
 v_add_f32 v135, v135, v143
 s_waitcnt lgkmcnt(2)
 v_add_f32 v128, v128, v144
 v_add_f32 v129, v129, v145
 v_add_f32 v130, v130, v146
 v_add_f32 v131, v131, v147
 v_add_f32 v132, v132, v148
 v_add_f32 v133, v133, v149
 v_add_f32 v134, v134, v150
 v_add_f32 v135, v135, v151
 s_waitcnt lgkmcnt(0)
 v_add_f32 v128, v128, v152
 v_add_f32 v129, v129, v153
 v_add_f32 v130, v130, v154
 v_add_f32 v131, v131, v155
 v_add_f32 v132, v132, v156
 v_add_f32 v133, v133, v157
 v_add_f32 v134, v134, v158
 v_add_f32 v135, v135, v159
 v_cvt_pk_bf16_f32 v92, v128, v129
 v_cvt_pk_bf16_f32 v93, v130, v131
 v_cvt_pk_bf16_f32 v94, v132, v133
 v_cvt_pk_bf16_f32 v95, v134, v135
 buffer_store_dwordx4 v[92:95], v12, s[40:43], s77 offen sc1
 s_endpgm
L_x_1001:
 s_mov_b64 exec, 1
 buffer_store_dword v112, v126, s[44:47], 0 offen sc1
 s_mov_b64 exec, -1
 s_branch L_r_1002
L_x_1005:
 s_mov_b32 s92, 200000
L_spin_1007:
 buffer_load_dword v121, v118, s[44:47], 0 offen sc1
 s_waitcnt vmcnt(0)
 v_cmp_eq_u32 vcc, 0, v121
 s_sub_u32 s92, s92, 1
 s_cbranch_scc1 L_r_1006
 s_cmp_lg_u64 vcc, 0
 s_cbranch_scc1 L_spin_1007
 s_branch L_r_1006
L_x_1008:
 s_mov_b32 s92, 200000
L_spin_1010:
 buffer_load_dword v14, v119, s[28:31], 0 offen sc1
 buffer_load_dword v15, v119, s[28:31], 0 offen offset:64 sc1
 s_waitcnt vmcnt(0)
 v_min_u32 v13, v14, v15
 v_cmp_eq_u32 vcc, 0, v13
 s_sub_u32 s92, s92, 1
 s_cbranch_scc1 L_r_1009
 s_cmp_lg_u64 vcc, 0
 s_cbranch_scc1 L_spin_1010
 s_branch L_r_1009
L_x_1012:
 s_mov_b32 s92, 200000
L_spin_1014:
 buffer_load_dword v121, v120, s[28:31], 0 offen sc1
 s_waitcnt vmcnt(0)
 v_cmp_eq_u32 vcc, 0, v121
 s_sub_u32 s92, s92, 1
 s_cbranch_scc1 L_r_1013
 s_cmp_lg_u64 vcc, 0
 s_cbranch_scc1 L_spin_1014
 s_branch L_r_1013
L_x_1015:
 s_mov_b32 s92, 200000
L_spin_1017:
 buffer_load_dwordx4 v[148:151], v126, s[28:31], s85 offen sc1
 buffer_load_dwordx4 v[144:147], v126, s[28:31], s3 offen sc1
 s_waitcnt vmcnt(0)
 v_max3_u32 v13, v144, v145, v146
 v_max3_u32 v13, v13, v147, v148
 v_max3_u32 v13, v13, v149, v150
 v_max_u32 v13, v13, v151
 v_cmp_eq_u32 vcc, -1, v13
 s_sub_u32 s92, s92, 1
 s_cbranch_scc1 L_r_1016
 s_cmp_lg_u64 vcc, 0
 s_cbranch_scc1 L_spin_1017
 s_branch L_r_1016
L_x_1018:
 s_mov_b32 s92, 200000
L_spin_1020:
 buffer_load_dword v121, v115, s[28:31], 0 offen sc1
 s_waitcnt vmcnt(0)
 v_cmp_eq_u32 vcc, 0, v121
 s_sub_u32 s92, s92, 1
 s_cbranch_scc1 L_r_1019
 s_cmp_lg_u64 vcc, 0
 s_cbranch_scc1 L_spin_1020
 s_branch L_r_1019
L_x_1021:
 s_mov_b32 s92, 200000
L_spin_1023:
 buffer_load_dword v118, v123, s[28:31], 0 offen sc1
 s_waitcnt vmcnt(0)
 v_cmp_eq_u32 vcc, 0, v118
 s_sub_u32 s92, s92, 1
 s_cbranch_scc1 L_r_1022
 s_cmp_lg_u64 vcc, 0
 s_cbranch_scc1 L_spin_1023
 s_branch L_r_1022
L_x_1025:
 s_mov_b32 s92, 200000
L_spin_1027:
 buffer_load_dwordx4 v[160:163], v122, s[28:31], s67 offen offset:0 sc1
 buffer_load_dwordx4 v[164:167], v122, s[28:31], s67 offen offset:2048 sc1
 buffer_load_dwordx4 v[168:171], v122, s[28:31], s67 offen offset:256 sc1
 buffer_load_dwordx4 v[172:175], v122, s[28:31], s67 offen offset:2304 sc1
 s_waitcnt vmcnt(0)
 v_max3_u32 v13, v160, v161, v162
 v_max3_u32 v13, v13, v163, v164
 v_max3_u32 v13, v13, v165, v166
 v_max3_u32 v13, v13, v167, v168
 v_max3_u32 v13, v13, v169, v170
 v_max3_u32 v13, v13, v171, v172
 v_max3_u32 v13, v13, v173, v174
 v_max_u32 v13, v13, v175
 v_cmp_eq_u32 vcc, -1, v13
 s_sub_u32 s92, s92, 1
 s_cbranch_scc1 L_r_1026
 s_cmp_lg_u64 vcc, 0
 s_cbranch_scc1 L_spin_1027
 buffer_load_dwordx4 v[176:179], v122, s[28:31], s70 offen offset:0 sc1
 buffer_load_dwordx4 v[180:183], v122, s[28:31], s70 offen offset:2048 sc1
 buffer_load_dwordx4 v[184:187], v122, s[28:31], s70 offen offset:256 sc1
 buffer_load_dwordx4 v[188:191], v122, s[28:31], s70 offen offset:2304 sc1
 s_branch L_r_1026
L_x_1028:
 s_mov_b32 s92, 200000
L_spin_1030:
 buffer_load_dwordx4 v[176:179], v122, s[28:31], s70 offen offset:0 sc1
 buffer_load_dwordx4 v[180:183], v122, s[28:31], s70 offen offset:2048 sc1
 buffer_load_dwordx4 v[184:187], v122, s[28:31], s70 offen offset:256 sc1
 buffer_load_dwordx4 v[188:191], v122, s[28:31], s70 offen offset:2304 sc1
 s_waitcnt vmcnt(0)
 v_max3_u32 v13, v176, v177, v178
 v_max3_u32 v13, v13, v179, v180
 v_max3_u32 v13, v13, v181, v182
 v_max3_u32 v13, v13, v183, v184
 v_max3_u32 v13, v13, v185, v186
 v_max3_u32 v13, v13, v187, v188
 v_max3_u32 v13, v13, v189, v190
 v_max_u32 v13, v13, v191
 v_cmp_eq_u32 vcc, -1, v13
 s_sub_u32 s92, s92, 1
 s_cbranch_scc1 L_r_1029
 s_cmp_lg_u64 vcc, 0
 s_cbranch_scc1 L_spin_1030
 s_branch L_r_1029
L_slow0:
 s_nop 11
 s_lshl_b32 s62, s94, 11
 s_add_u32 s62, s62, 0x10000
 v_subrev_u32 v108, s62, v113
 v_subrev_u32 v109, s62, v114
 s_sub_u32 s67, s66, s53
 s_mov_b32 s62, s67
 s_mov_b32 s92, 64
 v_mov_b32 v110, 0xff800000
L_slowA0:
 buffer_load_dwordx4 v[104:107], v108, s[28:31], s62 offen sc1
 s_waitcnt vmcnt(0)
 v_mfma_f32_32x32x16_bf16 v[160:175], v[104:107], v[148:151], 0
 s_add_u32 s62, s62, 2048
 s_nop 10
 v_max3_f32 v110, v110, v160, v161
 v_max3_f32 v110, v110, v162, v163
 v_max3_f32 v110, v110, v164, v165
 v_max3_f32 v110, v110, v166, v167
 v_max3_f32 v110, v110, v168, v169
 v_max3_f32 v110, v110, v170, v171
 v_max3_f32 v110, v110, v172, v173
 v_max3_f32 v110, v110, v174, v175
 s_sub_u32 s92, s92, 1
 s_cmp_lg_u32 s92, 0
 s_cbranch_scc1 L_slowA0
 v_mov_b32 v111, v110
 s_nop 1
 v_permlane32_swap_b32 v111, v110
 v_max_f32 v110, v110, v111
 v_sub_f32 v176, 0, v110
 v_mov_b32 v48, 0
 v_sub_f32 v177, 0, v110
 v_mov_b32 v49, 0
 v_sub_f32 v178, 0, v110
 v_mov_b32 v50, 0
 v_sub_f32 v179, 0, v110
 v_mov_b32 v51, 0
 v_sub_f32 v180, 0, v110
 v_mov_b32 v52, 0
 v_sub_f32 v181, 0, v110
 v_mov_b32 v53, 0
 v_sub_f32 v182, 0, v110
 v_mov_b32 v54, 0
 v_sub_f32 v183, 0, v110
 v_mov_b32 v55, 0
 v_sub_f32 v184, 0, v110
 v_mov_b32 v56, 0
 v_sub_f32 v185, 0, v110
 v_mov_b32 v57, 0
 v_sub_f32 v186, 0, v110
 v_mov_b32 v58, 0
 v_sub_f32 v187, 0, v110
 v_mov_b32 v59, 0
 v_sub_f32 v188, 0, v110
 v_mov_b32 v60, 0
 v_sub_f32 v189, 0, v110
 v_mov_b32 v61, 0
 v_sub_f32 v190, 0, v110
 v_mov_b32 v62, 0
 v_sub_f32 v191, 0, v110
 v_mov_b32 v63, 0
 s_mov_b32 s62, s67
 s_mov_b32 s92, 64
L_slowB0:
 buffer_load_dwordx4 v[104:107], v108, s[28:31], s62 offen sc1
 s_mov_b64 exec, s[96:97]
 buffer_load_dwordx4 v[128:131], v109, s[28:31], s62 offen offset:1024 sc1
 buffer_load_dwordx4 v[132:135], v109, s[28:31], s62 offen offset:1536 sc1
 s_mov_b64 exec, -1
 s_waitcnt vmcnt(0)
 v_mfma_f32_32x32x16_bf16 v[160:175], v[104:107], v[148:151], v[176:191]
 s_add_u32 s62, s62, 2048
 s_nop 10
 v_exp_f32 v160, v160
 v_exp_f32 v161, v161
 v_exp_f32 v162, v162
 v_exp_f32 v163, v163
 v_exp_f32 v164, v164
 v_exp_f32 v165, v165
 v_exp_f32 v166, v166
 v_exp_f32 v167, v167
 v_exp_f32 v168, v168
 v_exp_f32 v169, v169
 v_exp_f32 v170, v170
 v_exp_f32 v171, v171
 v_exp_f32 v172, v172
 v_exp_f32 v173, v173
 v_exp_f32 v174, v174
 v_exp_f32 v175, v175
 v_smfmac_f32_32x32x32_bf16 v[48:63], v[128:131], v[160:167], v112
 s_nop 0
 v_smfmac_f32_32x32x32_bf16 v[48:63], v[132:135], v[168:175], v112
 s_sub_u32 s92, s92, 1
 s_cmp_lg_u32 s92, 0
 s_nop 11
 s_cbranch_scc1 L_slowB0
 s_branch L_slowret0
.p2align 12
.skip 1024
L_v1:
 s_waitcnt vmcnt(5)
 s_barrier
 ds_read_b128 v[128:131], v5 offset:0
 ds_read_b128 v[132:135], v5 offset:2048
 ds_read_b128 v[136:139], v6 offset:0
 ds_read_b128 v[140:143], v6 offset:2048
 ds_read_b64_tr_b16 v[80:81], v7 offset:0
 ds_read_b64_tr_b16 v[82:83], v7 offset:512
 ds_read_b64_tr_b16 v[84:85], v7 offset:4096
 ds_read_b64_tr_b16 v[86:87], v7 offset:4608
 ds_read_b64_tr_b16 v[88:89], v8 offset:0
 ds_read_b64_tr_b16 v[90:91], v8 offset:512
 ds_read_b64_tr_b16 v[92:93], v8 offset:4096
 ds_read_b64_tr_b16 v[94:95], v8 offset:4608
 s_waitcnt lgkmcnt(4)
 v_mfma_f32_16x16x32_bf16 v[16:19], v[128:131], v[80:83], 0
 s_setprio 1
 ds_read_b64_tr_b16 v[96:97], v9 offset:0
 v_mfma_f32_16x16x32_bf16 v[16:19], v[136:139], v[84:87], v[16:19]
 ds_read_b64_tr_b16 v[98:99], v9 offset:512
 v_mfma_f32_16x16x32_bf16 v[20:23], v[132:135], v[80:83], 0
 ds_read_b64_tr_b16 v[100:101], v9 offset:4096
 v_mfma_f32_16x16x32_bf16 v[20:23], v[140:143], v[84:87], v[20:23]
 s_setprio 0
 ds_read_b64_tr_b16 v[102:103], v9 offset:4608
 s_add_u32 s91, s60, 2
 s_and_b32 s91, s91, 7
 s_add_u32 m0, s53, 32768
 s_lshl_b32 s86, s91, 7
 buffer_load_dwordx4 v1, s[4:7], s86 offen lds
 s_waitcnt lgkmcnt(4)
 v_mfma_f32_16x16x32_bf16 v[24:27], v[128:131], v[88:91], 0
 s_setprio 1
 ds_read_b64_tr_b16 v[80:81], v10 offset:0
 v_mfma_f32_16x16x32_bf16 v[24:27], v[136:139], v[92:95], v[24:27]
 ds_read_b64_tr_b16 v[82:83], v10 offset:512
 v_mfma_f32_16x16x32_bf16 v[28:31], v[132:135], v[88:91], 0
 ds_read_b64_tr_b16 v[84:85], v10 offset:4096
 v_mfma_f32_16x16x32_bf16 v[28:31], v[140:143], v[92:95], v[28:31]
 s_setprio 0
 ds_read_b64_tr_b16 v[86:87], v10 offset:4608
 s_add_u32 m0, s53, 40960
 s_add_u32 s86, s86, 65536
 buffer_load_dwordx4 v1, s[4:7], s86 offen lds
 s_waitcnt lgkmcnt(4)
 v_mfma_f32_16x16x32_bf16 v[32:35], v[96:99], v[128:131], 0
 s_setprio 1
 ds_read_b64_tr_b16 v[88:89], v9 offset:8192
 v_mfma_f32_16x16x32_bf16 v[32:35], v[100:103], v[136:139], v[32:35]
 ds_read_b64_tr_b16 v[90:91], v9 offset:8704
 v_mfma_f32_16x16x32_bf16 v[36:39], v[96:99], v[132:135], 0
 ds_read_b64_tr_b16 v[92:93], v9 offset:12288
 v_mfma_f32_16x16x32_bf16 v[36:39], v[100:103], v[140:143], v[36:39]
 s_setprio 0
 ds_read_b64_tr_b16 v[94:95], v9 offset:12800
 s_and_b32 s62, s55, 7
 s_mul_i32 s62, s62, 229376
 s_bitcmp1_b32 s54, 0
 s_cselect_b32 s62, 0x10000000, s62
 buffer_load_dword v125, v4, s[20:23], s62 offen
 buffer_load_dword v125, v4, s[24:27], s62 offen
 s_waitcnt lgkmcnt(4)
 v_mfma_f32_16x16x32_bf16 v[40:43], v[80:83], v[128:131], 0
 s_setprio 1
 ds_read_b64_tr_b16 v[96:97], v10 offset:8192
 v_mfma_f32_16x16x32_bf16 v[40:43], v[84:87], v[136:139], v[40:43]
 ds_read_b64_tr_b16 v[98:99], v10 offset:8704
 v_mfma_f32_16x16x32_bf16 v[44:47], v[80:83], v[132:135], 0
 ds_read_b64_tr_b16 v[100:101], v10 offset:12288
 v_mfma_f32_16x16x32_bf16 v[44:47], v[84:87], v[140:143], v[44:47]
 s_setprio 0
 ds_read_b64_tr_b16 v[102:103], v10 offset:12800
 s_add_u32 m0, s53, 81920
 s_mul_i32 s88, s91, 196608
 buffer_load_dwordx4 v2, s[8:11], s88 offen lds
 s_waitcnt vmcnt(7)
 s_barrier
 s_or_b32 s62, s2, s52
 s_cbranch_scc0 L_x_2001
L_r_2002:
 s_waitcnt lgkmcnt(4)
 v_mfma_f32_16x16x32_bf16 v[48:51], v[88:91], v[128:131], 0
 s_setprio 1
 ds_read_b128 v[144:147], v5 offset:16384
 ds_read_b64_tr_b16 v[80:81], v7 offset:8192
 v_mfma_f32_16x16x32_bf16 v[48:51], v[92:95], v[136:139], v[48:51]
 ds_read_b128 v[148:151], v5 offset:18432
 ds_read_b64_tr_b16 v[82:83], v7 offset:8704
 v_mfma_f32_16x16x32_bf16 v[52:55], v[88:91], v[132:135], 0
 ds_read_b128 v[152:155], v6 offset:16384
 ds_read_b64_tr_b16 v[84:85], v7 offset:12288
 v_mfma_f32_16x16x32_bf16 v[52:55], v[92:95], v[140:143], v[52:55]
 s_setprio 0
 ds_read_b128 v[156:159], v6 offset:18432
 ds_read_b64_tr_b16 v[86:87], v7 offset:12800
 s_add_u32 m0, s53, 131072
 s_mul_i32 s89, s91, s61
 buffer_load_dwordx4 v3, s[12:15], s89 offen lds
 s_add_u32 m0, s53, 139264
 s_add_u32 s89, s89, s87
 buffer_load_dwordx4 v3, s[16:19], s89 offen lds
 s_waitcnt lgkmcnt(8)
 v_mfma_f32_16x16x32_bf16 v[56:59], v[96:99], v[128:131], 0
 s_setprio 1
 ds_read_b64_tr_b16 v[88:89], v8 offset:8192
 v_mfma_f32_16x16x32_bf16 v[56:59], v[100:103], v[136:139], v[56:59]
 ds_read_b64_tr_b16 v[90:91], v8 offset:8704
 v_mfma_f32_16x16x32_bf16 v[60:63], v[96:99], v[132:135], 0
 ds_read_b64_tr_b16 v[92:93], v8 offset:12288
 v_mfma_f32_16x16x32_bf16 v[60:63], v[100:103], v[140:143], v[60:63]
 s_setprio 0
 ds_read_b64_tr_b16 v[94:95], v8 offset:12800
 s_add_u32 s91, s60, 3
 s_and_b32 s91, s91, 7
 s_add_u32 m0, s53, 49152
 s_lshl_b32 s86, s91, 7
 buffer_load_dwordx4 v1, s[4:7], s86 offen lds
 s_waitcnt vmcnt(8)
 s_barrier
 s_waitcnt lgkmcnt(4)
 v_mfma_f32_16x16x32_bf16 v[16:19], v[144:147], v[80:83], v[16:19]
 s_setprio 1
 ds_read_b64_tr_b16 v[96:97], v9 offset:16384
 v_mfma_f32_16x16x32_bf16 v[16:19], v[152:155], v[84:87], v[16:19]
 ds_read_b64_tr_b16 v[98:99], v9 offset:16896
 v_mfma_f32_16x16x32_bf16 v[20:23], v[148:151], v[80:83], v[20:23]
 ds_read_b64_tr_b16 v[100:101], v9 offset:20480
 v_mfma_f32_16x16x32_bf16 v[20:23], v[156:159], v[84:87], v[20:23]
 s_setprio 0
 ds_read_b64_tr_b16 v[102:103], v9 offset:20992
 s_add_u32 m0, s53, 57344
 s_add_u32 s86, s86, 65536
 buffer_load_dwordx4 v1, s[4:7], s86 offen lds
 buffer_load_dwordx4 v[64:67], v126, s[4:7], s80 offen
 buffer_load_dwordx4 v[68:71], v126, s[48:51], 0 offen
 s_waitcnt lgkmcnt(4)
 v_mfma_f32_16x16x32_bf16 v[24:27], v[144:147], v[88:91], v[24:27]
 s_setprio 1
 ds_read_b64_tr_b16 v[80:81], v10 offset:16384
 v_mfma_f32_16x16x32_bf16 v[24:27], v[152:155], v[92:95], v[24:27]
 ds_read_b64_tr_b16 v[82:83], v10 offset:16896
 v_mfma_f32_16x16x32_bf16 v[28:31], v[148:151], v[88:91], v[28:31]
 ds_read_b64_tr_b16 v[84:85], v10 offset:20480
 v_mfma_f32_16x16x32_bf16 v[28:31], v[156:159], v[92:95], v[28:31]
 s_setprio 0
 ds_read_b64_tr_b16 v[86:87], v10 offset:20992
 s_add_u32 m0, s53, 90112
 s_mul_i32 s88, s91, 196608
 buffer_load_dwordx4 v2, s[8:11], s88 offen lds
 s_waitcnt lgkmcnt(4)
 v_mfma_f32_16x16x32_bf16 v[32:35], v[96:99], v[144:147], v[32:35]
 s_setprio 1
 ds_read_b64_tr_b16 v[88:89], v9 offset:24576
 v_mfma_f32_16x16x32_bf16 v[32:35], v[100:103], v[152:155], v[32:35]
 ds_read_b64_tr_b16 v[90:91], v9 offset:25088
 v_mfma_f32_16x16x32_bf16 v[36:39], v[96:99], v[148:151], v[36:39]
 ds_read_b64_tr_b16 v[92:93], v9 offset:28672
 v_mfma_f32_16x16x32_bf16 v[36:39], v[100:103], v[156:159], v[36:39]
 s_setprio 0
 ds_read_b64_tr_b16 v[94:95], v9 offset:29184
 s_add_u32 m0, s53, 147456
 s_mul_i32 s89, s91, s61
 buffer_load_dwordx4 v3, s[12:15], s89 offen lds
 s_waitcnt lgkmcnt(4)
 v_mfma_f32_16x16x32_bf16 v[40:43], v[80:83], v[144:147], v[40:43]
 s_setprio 1
 ds_read_b64_tr_b16 v[96:97], v10 offset:24576
 v_mfma_f32_16x16x32_bf16 v[40:43], v[84:87], v[152:155], v[40:43]
 ds_read_b64_tr_b16 v[98:99], v10 offset:25088
 v_mfma_f32_16x16x32_bf16 v[44:47], v[80:83], v[148:151], v[44:47]
 ds_read_b64_tr_b16 v[100:101], v10 offset:28672
 v_mfma_f32_16x16x32_bf16 v[44:47], v[84:87], v[156:159], v[44:47]
 s_setprio 0
 ds_read_b64_tr_b16 v[102:103], v10 offset:29184
 s_add_u32 m0, s53, 155648
 s_add_u32 s89, s89, s87
 buffer_load_dwordx4 v3, s[16:19], s89 offen lds
 s_waitcnt vmcnt(7)
 s_barrier
 s_waitcnt lgkmcnt(4)
 v_mfma_f32_16x16x32_bf16 v[48:51], v[88:91], v[144:147], v[48:51]
 s_setprio 1
 ds_read_b128 v[160:163], v5 offset:32768
 ds_read_b64_tr_b16 v[80:81], v7 offset:16384
 v_mfma_f32_16x16x32_bf16 v[48:51], v[92:95], v[152:155], v[48:51]
 ds_read_b128 v[164:167], v5 offset:34816
 ds_read_b64_tr_b16 v[82:83], v7 offset:16896
 v_mfma_f32_16x16x32_bf16 v[52:55], v[88:91], v[148:151], v[52:55]
 ds_read_b128 v[168:171], v6 offset:32768
 ds_read_b64_tr_b16 v[84:85], v7 offset:20480
 v_mfma_f32_16x16x32_bf16 v[52:55], v[92:95], v[156:159], v[52:55]
 s_setprio 0
 ds_read_b128 v[172:175], v6 offset:34816
 ds_read_b64_tr_b16 v[86:87], v7 offset:20992
 s_add_u32 s91, s60, 4
 s_and_b32 s91, s91, 7
 s_add_u32 m0, s53, 0
 s_lshl_b32 s86, s91, 7
 buffer_load_dwordx4 v1, s[4:7], s86 offen lds
 s_waitcnt lgkmcnt(8)
 v_mfma_f32_16x16x32_bf16 v[56:59], v[96:99], v[144:147], v[56:59]
 s_setprio 1
 ds_read_b64_tr_b16 v[88:89], v8 offset:16384
 v_mfma_f32_16x16x32_bf16 v[56:59], v[100:103], v[152:155], v[56:59]
 ds_read_b64_tr_b16 v[90:91], v8 offset:16896
 v_mfma_f32_16x16x32_bf16 v[60:63], v[96:99], v[148:151], v[60:63]
 ds_read_b64_tr_b16 v[92:93], v8 offset:20480
 v_mfma_f32_16x16x32_bf16 v[60:63], v[100:103], v[156:159], v[60:63]
 s_setprio 0
 ds_read_b64_tr_b16 v[94:95], v8 offset:20992
 s_add_u32 m0, s53, 8192
 s_add_u32 s86, s86, 65536
 buffer_load_dwordx4 v1, s[4:7], s86 offen lds
 s_waitcnt lgkmcnt(4)
 v_mfma_f32_16x16x32_bf16 v[16:19], v[160:163], v[80:83], v[16:19]
 s_setprio 1
 ds_read_b64_tr_b16 v[96:97], v9 offset:32768
 v_mfma_f32_16x16x32_bf16 v[16:19], v[168:171], v[84:87], v[16:19]
 ds_read_b64_tr_b16 v[98:99], v9 offset:33280
 v_mfma_f32_16x16x32_bf16 v[20:23], v[164:167], v[80:83], v[20:23]
 ds_read_b64_tr_b16 v[100:101], v9 offset:36864
 v_mfma_f32_16x16x32_bf16 v[20:23], v[172:175], v[84:87], v[20:23]
 s_setprio 0
 ds_read_b64_tr_b16 v[102:103], v9 offset:37376
 s_add_u32 m0, s53, 65536
 s_mul_i32 s88, s91, 196608
 buffer_load_dwordx4 v2, s[8:11], s88 offen lds
 s_waitcnt lgkmcnt(4)
 v_mfma_f32_16x16x32_bf16 v[24:27], v[160:163], v[88:91], v[24:27]
 s_setprio 1
 ds_read_b64_tr_b16 v[80:81], v10 offset:32768
 v_mfma_f32_16x16x32_bf16 v[24:27], v[168:171], v[92:95], v[24:27]
 ds_read_b64_tr_b16 v[82:83], v10 offset:33280
 v_mfma_f32_16x16x32_bf16 v[28:31], v[164:167], v[88:91], v[28:31]
 ds_read_b64_tr_b16 v[84:85], v10 offset:36864
 v_mfma_f32_16x16x32_bf16 v[28:31], v[172:175], v[92:95], v[28:31]
 s_setprio 0
 ds_read_b64_tr_b16 v[86:87], v10 offset:37376
 s_add_u32 m0, s53, 98304
 s_mul_i32 s89, s91, s61
 buffer_load_dwordx4 v3, s[12:15], s89 offen lds
 s_waitcnt lgkmcnt(4)
 v_mfma_f32_16x16x32_bf16 v[32:35], v[96:99], v[160:163], v[32:35]
 s_setprio 1
 ds_read_b64_tr_b16 v[88:89], v9 offset:40960
 v_mfma_f32_16x16x32_bf16 v[32:35], v[100:103], v[168:171], v[32:35]
 ds_read_b64_tr_b16 v[90:91], v9 offset:41472
 v_mfma_f32_16x16x32_bf16 v[36:39], v[96:99], v[164:167], v[36:39]
 ds_read_b64_tr_b16 v[92:93], v9 offset:45056
 v_mfma_f32_16x16x32_bf16 v[36:39], v[100:103], v[172:175], v[36:39]
 s_setprio 0
 ds_read_b64_tr_b16 v[94:95], v9 offset:45568
 s_add_u32 m0, s53, 106496
 s_add_u32 s89, s89, s87
 buffer_load_dwordx4 v3, s[16:19], s89 offen lds
 v_mov_b32 v76, -1
 v_mov_b32 v77, -1
 v_mov_b32 v78, -1
 v_mov_b32 v79, -1
 s_lshl_b32 s67, s58, 3
 s_add_u32 s67, s67, s52
 s_waitcnt lgkmcnt(4)
 v_mfma_f32_16x16x32_bf16 v[40:43], v[80:83], v[160:163], v[40:43]
 s_setprio 1
 ds_read_b64_tr_b16 v[96:97], v10 offset:40960
 v_mfma_f32_16x16x32_bf16 v[40:43], v[84:87], v[168:171], v[40:43]
 ds_read_b64_tr_b16 v[98:99], v10 offset:41472
 v_mfma_f32_16x16x32_bf16 v[44:47], v[80:83], v[164:167], v[44:47]
 ds_read_b64_tr_b16 v[100:101], v10 offset:45056
 v_mfma_f32_16x16x32_bf16 v[44:47], v[84:87], v[172:175], v[44:47]
 s_setprio 0
 ds_read_b64_tr_b16 v[102:103], v10 offset:45568
 s_lshl_b32 s67, s67, 4
 s_add_u32 s67, s67, s56
 s_lshl_b32 s67, s67, 2
 s_add_u32 s67, s67, s59
 s_lshl_b32 s67, s67, 10
 s_add_u32 s67, s67, 1048576
 buffer_store_dwordx4 v[76:79], v126, s[28:31], s67 offen offset:0 sc1
 s_waitcnt vmcnt(2)
 s_barrier
 s_waitcnt lgkmcnt(4)
 v_mfma_f32_16x16x32_bf16 v[48:51], v[88:91], v[160:163], v[48:51]
 s_setprio 1
 ds_read_b128 v[176:179], v5 offset:49152
 ds_read_b64_tr_b16 v[80:81], v7 offset:24576
 v_mfma_f32_16x16x32_bf16 v[48:51], v[92:95], v[168:171], v[48:51]
 ds_read_b128 v[180:183], v5 offset:51200
 ds_read_b64_tr_b16 v[82:83], v7 offset:25088
 v_mfma_f32_16x16x32_bf16 v[52:55], v[88:91], v[164:167], v[52:55]
 ds_read_b128 v[184:187], v6 offset:49152
 ds_read_b64_tr_b16 v[84:85], v7 offset:28672
 v_mfma_f32_16x16x32_bf16 v[52:55], v[92:95], v[172:175], v[52:55]
 s_setprio 0
 ds_read_b128 v[188:191], v6 offset:51200
 ds_read_b64_tr_b16 v[86:87], v7 offset:29184
 s_add_u32 s91, s60, 5
 s_and_b32 s91, s91, 7
 s_add_u32 m0, s53, 16384
 s_lshl_b32 s86, s91, 7
 buffer_load_dwordx4 v1, s[4:7], s86 offen lds
 s_waitcnt lgkmcnt(8)
 v_mfma_f32_16x16x32_bf16 v[56:59], v[96:99], v[160:163], v[56:59]
 s_setprio 1
 ds_read_b64_tr_b16 v[88:89], v8 offset:24576
 v_mfma_f32_16x16x32_bf16 v[56:59], v[100:103], v[168:171], v[56:59]
 ds_read_b64_tr_b16 v[90:91], v8 offset:25088
 v_mfma_f32_16x16x32_bf16 v[60:63], v[96:99], v[164:167], v[60:63]
 ds_read_b64_tr_b16 v[92:93], v8 offset:28672
 v_mfma_f32_16x16x32_bf16 v[60:63], v[100:103], v[172:175], v[60:63]
 s_setprio 0
 ds_read_b64_tr_b16 v[94:95], v8 offset:29184
 s_add_u32 m0, s53, 24576
 s_add_u32 s86, s86, 65536
 buffer_load_dwordx4 v1, s[4:7], s86 offen lds
 v_mov_b32 v13, 0
 v_lshlrev_b32 v73, 16, v68
 v_and_b32 v75, 0xffff0000, v68
 v_lshlrev_b32 v72, 16, v64
 v_and_b32 v74, 0xffff0000, v64
 v_fmac_f32 v13, v72, v73
 v_fmac_f32 v13, v74, v75
 v_lshlrev_b32 v73, 16, v69
 v_and_b32 v75, 0xffff0000, v69
 s_waitcnt lgkmcnt(4)
 v_mfma_f32_16x16x32_bf16 v[16:19], v[176:179], v[80:83], v[16:19]
 s_setprio 1
 ds_read_b64_tr_b16 v[96:97], v9 offset:49152
 v_mfma_f32_16x16x32_bf16 v[16:19], v[184:187], v[84:87], v[16:19]
 ds_read_b64_tr_b16 v[98:99], v9 offset:49664
 v_mfma_f32_16x16x32_bf16 v[20:23], v[180:183], v[80:83], v[20:23]
 ds_read_b64_tr_b16 v[100:101], v9 offset:53248
 v_mfma_f32_16x16x32_bf16 v[20:23], v[188:191], v[84:87], v[20:23]
 s_setprio 0
 ds_read_b64_tr_b16 v[102:103], v9 offset:53760
 s_add_u32 m0, s53, 73728
 s_mul_i32 s88, s91, 196608
 buffer_load_dwordx4 v2, s[8:11], s88 offen lds
 v_lshlrev_b32 v72, 16, v65
 v_and_b32 v74, 0xffff0000, v65
 v_fmac_f32 v13, v72, v73
 v_fmac_f32 v13, v74, v75
 v_lshlrev_b32 v73, 16, v70
 v_and_b32 v75, 0xffff0000, v70
 v_lshlrev_b32 v72, 16, v66
 v_and_b32 v74, 0xffff0000, v66
 v_fmac_f32 v13, v72, v73
 s_waitcnt lgkmcnt(4)
 v_mfma_f32_16x16x32_bf16 v[24:27], v[176:179], v[88:91], v[24:27]
 s_setprio 1
 ds_read_b64_tr_b16 v[80:81], v10 offset:49152
 v_mfma_f32_16x16x32_bf16 v[24:27], v[184:187], v[92:95], v[24:27]
 ds_read_b64_tr_b16 v[82:83], v10 offset:49664
 v_mfma_f32_16x16x32_bf16 v[28:31], v[180:183], v[88:91], v[28:31]
 ds_read_b64_tr_b16 v[84:85], v10 offset:53248
 v_mfma_f32_16x16x32_bf16 v[28:31], v[188:191], v[92:95], v[28:31]
 s_setprio 0
 ds_read_b64_tr_b16 v[86:87], v10 offset:53760
 s_add_u32 m0, s53, 114688
 s_mul_i32 s89, s91, s61
 buffer_load_dwordx4 v3, s[12:15], s89 offen lds
 v_fmac_f32 v13, v74, v75
 v_lshlrev_b32 v73, 16, v71
 v_and_b32 v75, 0xffff0000, v71
 v_lshlrev_b32 v72, 16, v67
 v_and_b32 v74, 0xffff0000, v67
 v_fmac_f32 v13, v72, v73
 v_fmac_f32 v13, v74, v75
 s_nop 1
 v_add_f32_dpp v13, v13, v13 row_shr:1 row_mask:0xf bank_mask:0xf
 s_waitcnt lgkmcnt(4)
 v_mfma_f32_16x16x32_bf16 v[32:35], v[96:99], v[176:179], v[32:35]
 s_setprio 1
 ds_read_b64_tr_b16 v[88:89], v9 offset:57344
 v_mfma_f32_16x16x32_bf16 v[32:35], v[100:103], v[184:187], v[32:35]
 ds_read_b64_tr_b16 v[90:91], v9 offset:57856
 v_mfma_f32_16x16x32_bf16 v[36:39], v[96:99], v[180:183], v[36:39]
 ds_read_b64_tr_b16 v[92:93], v9 offset:61440
 v_mfma_f32_16x16x32_bf16 v[36:39], v[100:103], v[188:191], v[36:39]
 s_setprio 0
 ds_read_b64_tr_b16 v[94:95], v9 offset:61952
 s_add_u32 m0, s53, 122880
 s_add_u32 s89, s89, s87
 buffer_load_dwordx4 v3, s[16:19], s89 offen lds
 v_add_f32_dpp v13, v13, v13 row_shr:2 row_mask:0xf bank_mask:0xf
 s_waitcnt lgkmcnt(4)
 v_mfma_f32_16x16x32_bf16 v[40:43], v[80:83], v[176:179], v[40:43]
 s_setprio 1
 ds_read_b64_tr_b16 v[96:97], v10 offset:57344
 v_mfma_f32_16x16x32_bf16 v[40:43], v[84:87], v[184:187], v[40:43]
 ds_read_b64_tr_b16 v[98:99], v10 offset:57856
 v_mfma_f32_16x16x32_bf16 v[44:47], v[80:83], v[180:183], v[44:47]
 ds_read_b64_tr_b16 v[100:101], v10 offset:61440
 v_mfma_f32_16x16x32_bf16 v[44:47], v[84:87], v[188:191], v[44:47]
 s_setprio 0
 ds_read_b64_tr_b16 v[102:103], v10 offset:61952
 v_add_f32_dpp v13, v13, v13 row_shr:4 row_mask:0xf bank_mask:0xf
 s_waitcnt vmcnt(6)
 s_barrier
 s_cmp_lg_u32 s52, 0
 s_cbranch_scc1 L_s_2003
 buffer_load_dword v121, v118, s[44:47], 0 offen sc1
L_s_2003:
 s_waitcnt lgkmcnt(4)
 v_mfma_f32_16x16x32_bf16 v[48:51], v[88:91], v[176:179], v[48:51]
 s_setprio 1
 ds_read_b128 v[192:195], v5 offset:0
 ds_read_b64_tr_b16 v[80:81], v7 offset:0
 v_mfma_f32_16x16x32_bf16 v[48:51], v[92:95], v[184:187], v[48:51]
 ds_read_b128 v[196:199], v5 offset:2048
 ds_read_b64_tr_b16 v[82:83], v7 offset:512
 v_mfma_f32_16x16x32_bf16 v[52:55], v[88:91], v[180:183], v[52:55]
 ds_read_b128 v[200:203], v6 offset:0
 ds_read_b64_tr_b16 v[84:85], v7 offset:4096
 v_mfma_f32_16x16x32_bf16 v[52:55], v[92:95], v[188:191], v[52:55]
 s_setprio 0
 ds_read_b128 v[204:207], v6 offset:2048
 ds_read_b64_tr_b16 v[86:87], v7 offset:4608
 s_add_u32 s91, s60, 6
 s_and_b32 s91, s91, 7
 s_add_u32 m0, s53, 32768
 s_lshl_b32 s86, s91, 7
 buffer_load_dwordx4 v1, s[4:7], s86 offen lds
 s_waitcnt lgkmcnt(8)
 v_mfma_f32_16x16x32_bf16 v[56:59], v[96:99], v[176:179], v[56:59]
 s_setprio 1
 ds_read_b64_tr_b16 v[88:89], v8 offset:0
 v_mfma_f32_16x16x32_bf16 v[56:59], v[100:103], v[184:187], v[56:59]
 ds_read_b64_tr_b16 v[90:91], v8 offset:512
 v_mfma_f32_16x16x32_bf16 v[60:63], v[96:99], v[180:183], v[60:63]
 ds_read_b64_tr_b16 v[92:93], v8 offset:4096
 v_mfma_f32_16x16x32_bf16 v[60:63], v[100:103], v[188:191], v[60:63]
 s_setprio 0
 ds_read_b64_tr_b16 v[94:95], v8 offset:4608
 s_add_u32 m0, s53, 40960
 s_add_u32 s86, s86, 65536
 buffer_load_dwordx4 v1, s[4:7], s86 offen lds
 v_add_f32_dpp v13, v13, v13 row_shr:8 row_mask:0xf bank_mask:0xf
 s_waitcnt lgkmcnt(4)
 v_mfma_f32_16x16x32_bf16 v[16:19], v[192:195], v[80:83], v[16:19]
 s_setprio 1
 ds_read_b64_tr_b16 v[96:97], v9 offset:0
 v_mfma_f32_16x16x32_bf16 v[16:19], v[200:203], v[84:87], v[16:19]
 ds_read_b64_tr_b16 v[98:99], v9 offset:512
 v_mfma_f32_16x16x32_bf16 v[20:23], v[196:199], v[80:83], v[20:23]
 ds_read_b64_tr_b16 v[100:101], v9 offset:4096
 v_mfma_f32_16x16x32_bf16 v[20:23], v[204:207], v[84:87], v[20:23]
 s_setprio 0
 ds_read_b64_tr_b16 v[102:103], v9 offset:4608
 s_add_u32 m0, s53, 81920
 s_mul_i32 s88, s91, 196608
 buffer_load_dwordx4 v2, s[8:11], s88 offen lds
 v_add_f32_dpp v13, v13, v13 row_bcast:15 row_mask:0xa bank_mask:0xf
 s_waitcnt lgkmcnt(4)
 v_mfma_f32_16x16x32_bf16 v[24:27], v[192:195], v[88:91], v[24:27]
 s_setprio 1
 ds_read_b64_tr_b16 v[80:81], v10 offset:0
 v_mfma_f32_16x16x32_bf16 v[24:27], v[200:203], v[92:95], v[24:27]
 ds_read_b64_tr_b16 v[82:83], v10 offset:512
 v_mfma_f32_16x16x32_bf16 v[28:31], v[196:199], v[88:91], v[28:31]
 ds_read_b64_tr_b16 v[84:85], v10 offset:4096
 v_mfma_f32_16x16x32_bf16 v[28:31], v[204:207], v[92:95], v[28:31]
 s_setprio 0
 ds_read_b64_tr_b16 v[86:87], v10 offset:4608
 s_add_u32 m0, s53, 131072
 s_mul_i32 s89, s91, s61
 buffer_load_dwordx4 v3, s[12:15], s89 offen lds
 v_add_f32_dpp v13, v13, v13 row_bcast:31 row_mask:0xc bank_mask:0xf
 s_waitcnt lgkmcnt(4)
 v_mfma_f32_16x16x32_bf16 v[32:35], v[96:99], v[192:195], v[32:35]
 s_setprio 1
 ds_read_b64_tr_b16 v[88:89], v9 offset:8192
 v_mfma_f32_16x16x32_bf16 v[32:35], v[100:103], v[200:203], v[32:35]
 ds_read_b64_tr_b16 v[90:91], v9 offset:8704
 v_mfma_f32_16x16x32_bf16 v[36:39], v[96:99], v[196:199], v[36:39]
 ds_read_b64_tr_b16 v[92:93], v9 offset:12288
 v_mfma_f32_16x16x32_bf16 v[36:39], v[100:103], v[204:207], v[36:39]
 s_setprio 0
 ds_read_b64_tr_b16 v[94:95], v9 offset:12800
 s_add_u32 m0, s53, 139264
 s_add_u32 s89, s89, s87
 buffer_load_dwordx4 v3, s[16:19], s89 offen lds
 v_mul_f32 v13, 0x3fb8aa3b, v13
 v_or_b32 v13, 1, v13
 s_waitcnt lgkmcnt(4)
 v_mfma_f32_16x16x32_bf16 v[40:43], v[80:83], v[192:195], v[40:43]
 s_setprio 1
 ds_read_b64_tr_b16 v[96:97], v10 offset:8192
 v_mfma_f32_16x16x32_bf16 v[40:43], v[84:87], v[200:203], v[40:43]
 ds_read_b64_tr_b16 v[98:99], v10 offset:8704
 v_mfma_f32_16x16x32_bf16 v[44:47], v[80:83], v[196:199], v[44:47]
 ds_read_b64_tr_b16 v[100:101], v10 offset:12288
 v_mfma_f32_16x16x32_bf16 v[44:47], v[84:87], v[204:207], v[44:47]
 s_setprio 0
 ds_read_b64_tr_b16 v[102:103], v10 offset:12800
 s_cmp_lg_u32 s52, 0
 s_cbranch_scc1 L_s_2004
 s_waitcnt vmcnt(5)
 v_cmp_eq_u32 vcc, 0, v121
 s_nop 0
 s_cmp_lg_u64 vcc, 0
 s_cbranch_scc1 L_x_2005
L_r_2006:
L_s_2004:
 s_waitcnt vmcnt(5)
 s_barrier
 s_mov_b32 exec_lo, 0
 s_mov_b32 exec_hi, 0x80000000
 buffer_store_dword v13, v126, s[28:31], s65 offen sc1
 s_mov_b64 exec, -1
 s_waitcnt lgkmcnt(4)
 v_mfma_f32_16x16x32_bf16 v[48:51], v[88:91], v[192:195], v[48:51]
 s_setprio 1
 ds_read_b128 v[208:211], v5 offset:16384
 ds_read_b64_tr_b16 v[80:81], v7 offset:8192
 v_mfma_f32_16x16x32_bf16 v[48:51], v[92:95], v[200:203], v[48:51]
 ds_read_b128 v[212:215], v5 offset:18432
 ds_read_b64_tr_b16 v[82:83], v7 offset:8704
 v_mfma_f32_16x16x32_bf16 v[52:55], v[88:91], v[196:199], v[52:55]
 ds_read_b128 v[216:219], v6 offset:16384
 ds_read_b64_tr_b16 v[84:85], v7 offset:12288
 v_mfma_f32_16x16x32_bf16 v[52:55], v[92:95], v[204:207], v[52:55]
 s_setprio 0
 ds_read_b128 v[220:223], v6 offset:18432
 ds_read_b64_tr_b16 v[86:87], v7 offset:12800
 s_add_u32 s91, s60, 7
 s_and_b32 s91, s91, 7
 s_add_u32 m0, s53, 49152
 s_lshl_b32 s86, s91, 7
 buffer_load_dwordx4 v1, s[4:7], s86 offen lds
 s_waitcnt lgkmcnt(8)
 v_mfma_f32_16x16x32_bf16 v[56:59], v[96:99], v[192:195], v[56:59]
 s_setprio 1
 ds_read_b64_tr_b16 v[88:89], v8 offset:8192
 v_mfma_f32_16x16x32_bf16 v[56:59], v[100:103], v[200:203], v[56:59]
 ds_read_b64_tr_b16 v[90:91], v8 offset:8704
 v_mfma_f32_16x16x32_bf16 v[60:63], v[96:99], v[196:199], v[60:63]
 ds_read_b64_tr_b16 v[92:93], v8 offset:12288
 v_mfma_f32_16x16x32_bf16 v[60:63], v[100:103], v[204:207], v[60:63]
 s_setprio 0
 ds_read_b64_tr_b16 v[94:95], v8 offset:12800
 s_add_u32 m0, s53, 57344
 s_add_u32 s86, s86, 65536
 buffer_load_dwordx4 v1, s[4:7], s86 offen lds
 s_waitcnt lgkmcnt(4)
 v_mfma_f32_16x16x32_bf16 v[16:19], v[208:211], v[80:83], v[16:19]
 s_setprio 1
 ds_read_b64_tr_b16 v[96:97], v9 offset:16384
 v_mfma_f32_16x16x32_bf16 v[16:19], v[216:219], v[84:87], v[16:19]
 ds_read_b64_tr_b16 v[98:99], v9 offset:16896
 v_mfma_f32_16x16x32_bf16 v[20:23], v[212:215], v[80:83], v[20:23]
 ds_read_b64_tr_b16 v[100:101], v9 offset:20480
 v_mfma_f32_16x16x32_bf16 v[20:23], v[220:223], v[84:87], v[20:23]
 s_setprio 0
 ds_read_b64_tr_b16 v[102:103], v9 offset:20992
 s_add_u32 m0, s53, 90112
 s_mul_i32 s88, s91, 196608
 buffer_load_dwordx4 v2, s[8:11], s88 offen lds
 s_waitcnt lgkmcnt(4)
 v_mfma_f32_16x16x32_bf16 v[24:27], v[208:211], v[88:91], v[24:27]
 s_setprio 1
 ds_read_b64_tr_b16 v[80:81], v10 offset:16384
 v_mfma_f32_16x16x32_bf16 v[24:27], v[216:219], v[92:95], v[24:27]
 ds_read_b64_tr_b16 v[82:83], v10 offset:16896
 v_mfma_f32_16x16x32_bf16 v[28:31], v[212:215], v[88:91], v[28:31]
 ds_read_b64_tr_b16 v[84:85], v10 offset:20480
 v_mfma_f32_16x16x32_bf16 v[28:31], v[220:223], v[92:95], v[28:31]
 s_setprio 0
 ds_read_b64_tr_b16 v[86:87], v10 offset:20992
 s_add_u32 m0, s53, 147456
 s_mul_i32 s89, s91, s61
 buffer_load_dwordx4 v3, s[12:15], s89 offen lds
 s_waitcnt lgkmcnt(4)
 v_mfma_f32_16x16x32_bf16 v[32:35], v[96:99], v[208:211], v[32:35]
 s_setprio 1
 ds_read_b64_tr_b16 v[88:89], v9 offset:24576
 v_mfma_f32_16x16x32_bf16 v[32:35], v[100:103], v[216:219], v[32:35]
 ds_read_b64_tr_b16 v[90:91], v9 offset:25088
 v_mfma_f32_16x16x32_bf16 v[36:39], v[96:99], v[212:215], v[36:39]
 ds_read_b64_tr_b16 v[92:93], v9 offset:28672
 v_mfma_f32_16x16x32_bf16 v[36:39], v[100:103], v[220:223], v[36:39]
 s_setprio 0
 ds_read_b64_tr_b16 v[94:95], v9 offset:29184
 s_add_u32 m0, s53, 155648
 s_add_u32 s89, s89, s87
 buffer_load_dwordx4 v3, s[16:19], s89 offen lds
 s_waitcnt lgkmcnt(4)
 v_mfma_f32_16x16x32_bf16 v[40:43], v[80:83], v[208:211], v[40:43]
 s_setprio 1
 ds_read_b64_tr_b16 v[96:97], v10 offset:24576
 v_mfma_f32_16x16x32_bf16 v[40:43], v[84:87], v[216:219], v[40:43]
 ds_read_b64_tr_b16 v[98:99], v10 offset:25088
 v_mfma_f32_16x16x32_bf16 v[44:47], v[80:83], v[212:215], v[44:47]
 ds_read_b64_tr_b16 v[100:101], v10 offset:28672
 v_mfma_f32_16x16x32_bf16 v[44:47], v[84:87], v[220:223], v[44:47]
 s_setprio 0
 ds_read_b64_tr_b16 v[102:103], v10 offset:29184
 s_waitcnt vmcnt(6)
 s_barrier
 s_waitcnt lgkmcnt(4)
 v_mfma_f32_16x16x32_bf16 v[48:51], v[88:91], v[208:211], v[48:51]
 s_setprio 1
 ds_read_b128 v[224:227], v5 offset:32768
 ds_read_b64_tr_b16 v[80:81], v7 offset:16384
 v_mfma_f32_16x16x32_bf16 v[48:51], v[92:95], v[216:219], v[48:51]
 ds_read_b128 v[228:231], v5 offset:34816
 ds_read_b64_tr_b16 v[82:83], v7 offset:16896
 v_mfma_f32_16x16x32_bf16 v[52:55], v[88:91], v[212:215], v[52:55]
 ds_read_b128 v[232:235], v6 offset:32768
 ds_read_b64_tr_b16 v[84:85], v7 offset:20480
 v_mfma_f32_16x16x32_bf16 v[52:55], v[92:95], v[220:223], v[52:55]
 s_setprio 0
 ds_read_b128 v[236:239], v6 offset:34816
 ds_read_b64_tr_b16 v[86:87], v7 offset:20992
 s_add_u32 s91, s60, 0
 s_and_b32 s91, s91, 7
 s_add_u32 m0, s53, 98304
 s_mul_i32 s90, s91, 229376
 buffer_load_dwordx4 v4, s[20:23], s90 offen lds
 s_waitcnt lgkmcnt(8)
 v_mfma_f32_16x16x32_bf16 v[56:59], v[96:99], v[208:211], v[56:59]
 s_setprio 1
 ds_read_b64_tr_b16 v[88:89], v8 offset:16384
 v_mfma_f32_16x16x32_bf16 v[56:59], v[100:103], v[216:219], v[56:59]
 ds_read_b64_tr_b16 v[90:91], v8 offset:16896
 v_mfma_f32_16x16x32_bf16 v[60:63], v[96:99], v[212:215], v[60:63]
 ds_read_b64_tr_b16 v[92:93], v8 offset:20480
 v_mfma_f32_16x16x32_bf16 v[60:63], v[100:103], v[220:223], v[60:63]
 s_setprio 0
 ds_read_b64_tr_b16 v[94:95], v8 offset:20992
 s_add_u32 m0, s53, 106496
 s_nop 0
 buffer_load_dwordx4 v4, s[24:27], s90 offen lds
 s_waitcnt lgkmcnt(4)
 v_mfma_f32_16x16x32_bf16 v[16:19], v[224:227], v[80:83], v[16:19]
 s_setprio 1
 ds_read_b64_tr_b16 v[96:97], v9 offset:32768
 v_mfma_f32_16x16x32_bf16 v[16:19], v[232:235], v[84:87], v[16:19]
 ds_read_b64_tr_b16 v[98:99], v9 offset:33280
 v_mfma_f32_16x16x32_bf16 v[20:23], v[228:231], v[80:83], v[20:23]
 ds_read_b64_tr_b16 v[100:101], v9 offset:36864
 v_mfma_f32_16x16x32_bf16 v[20:23], v[236:239], v[84:87], v[20:23]
 s_setprio 0
 ds_read_b64_tr_b16 v[102:103], v9 offset:37376
 s_add_u32 s91, s60, 1
 s_and_b32 s91, s91, 7
 s_add_u32 m0, s53, 0
 s_mul_i32 s90, s91, 229376
 buffer_load_dwordx4 v4, s[20:23], s90 offen lds
 s_waitcnt lgkmcnt(4)
 v_mfma_f32_16x16x32_bf16 v[24:27], v[224:227], v[88:91], v[24:27]
 s_setprio 1
 ds_read_b64_tr_b16 v[80:81], v10 offset:32768
 v_mfma_f32_16x16x32_bf16 v[24:27], v[232:235], v[92:95], v[24:27]
 ds_read_b64_tr_b16 v[82:83], v10 offset:33280
 v_mfma_f32_16x16x32_bf16 v[28:31], v[228:231], v[88:91], v[28:31]
 ds_read_b64_tr_b16 v[84:85], v10 offset:36864
 v_mfma_f32_16x16x32_bf16 v[28:31], v[236:239], v[92:95], v[28:31]
 s_setprio 0
 ds_read_b64_tr_b16 v[86:87], v10 offset:37376
 s_add_u32 m0, s53, 8192
 s_nop 0
 buffer_load_dwordx4 v4, s[24:27], s90 offen lds
 s_waitcnt vmcnt(4)
 s_barrier
 s_waitcnt lgkmcnt(4)
 v_mfma_f32_16x16x32_bf16 v[32:35], v[96:99], v[224:227], v[32:35]
 s_setprio 1
 ds_read_b128 v[240:243], v5 offset:49152
 ds_read_b64_tr_b16 v[88:89], v7 offset:24576
 v_mfma_f32_16x16x32_bf16 v[32:35], v[100:103], v[232:235], v[32:35]
 ds_read_b128 v[244:247], v5 offset:51200
 ds_read_b64_tr_b16 v[90:91], v7 offset:25088
 v_mfma_f32_16x16x32_bf16 v[36:39], v[96:99], v[228:231], v[36:39]
 ds_read_b128 v[248:251], v6 offset:49152
 ds_read_b64_tr_b16 v[92:93], v7 offset:28672
 v_mfma_f32_16x16x32_bf16 v[36:39], v[100:103], v[236:239], v[36:39]
 s_setprio 0
 ds_read_b128 v[252:255], v6 offset:51200
 ds_read_b64_tr_b16 v[94:95], v7 offset:29184
 s_add_u32 s91, s60, 2
 s_and_b32 s91, s91, 7
 s_add_u32 m0, s53, 114688
 s_mul_i32 s90, s91, 229376
 buffer_load_dwordx4 v4, s[20:23], s90 offen lds
 s_waitcnt lgkmcnt(8)
 v_mfma_f32_16x16x32_bf16 v[40:43], v[80:83], v[224:227], v[40:43]
 s_setprio 1
 ds_read_b64_tr_b16 v[96:97], v8 offset:24576
 v_mfma_f32_16x16x32_bf16 v[40:43], v[84:87], v[232:235], v[40:43]
 ds_read_b64_tr_b16 v[98:99], v8 offset:25088
 v_mfma_f32_16x16x32_bf16 v[44:47], v[80:83], v[228:231], v[44:47]
 ds_read_b64_tr_b16 v[100:101], v8 offset:28672
 v_mfma_f32_16x16x32_bf16 v[44:47], v[84:87], v[236:239], v[44:47]
 s_setprio 0
 ds_read_b64_tr_b16 v[102:103], v8 offset:29184
 s_add_u32 m0, s53, 122880
 s_nop 0
 buffer_load_dwordx4 v4, s[24:27], s90 offen lds
 buffer_load_dword v14, v119, s[28:31], 0 offen sc1
 buffer_load_dword v15, v119, s[28:31], 0 offen offset:64 sc1
 s_waitcnt lgkmcnt(4)
 v_mfma_f32_16x16x32_bf16 v[16:19], v[240:243], v[88:91], v[16:19]
 s_setprio 1
 ds_read_b64_tr_b16 v[80:81], v9 offset:49152
 v_mfma_f32_16x16x32_bf16 v[16:19], v[248:251], v[92:95], v[16:19]
 ds_read_b64_tr_b16 v[82:83], v9 offset:49664
 v_mfma_f32_16x16x32_bf16 v[20:23], v[244:247], v[88:91], v[20:23]
 ds_read_b64_tr_b16 v[84:85], v9 offset:53248
 v_mfma_f32_16x16x32_bf16 v[20:23], v[252:255], v[92:95], v[20:23]
 s_setprio 0
 ds_read_b64_tr_b16 v[86:87], v9 offset:53760
 s_add_u32 s91, s60, 3
 s_and_b32 s91, s91, 7
 s_add_u32 m0, s53, 16384
 s_mul_i32 s90, s91, 229376
 buffer_load_dwordx4 v4, s[20:23], s90 offen lds
 s_waitcnt lgkmcnt(4)
 v_mfma_f32_16x16x32_bf16 v[24:27], v[240:243], v[96:99], v[24:27]
 s_setprio 1
 ds_read_b64_tr_b16 v[88:89], v10 offset:49152
 v_mfma_f32_16x16x32_bf16 v[24:27], v[248:251], v[100:103], v[24:27]
 ds_read_b64_tr_b16 v[90:91], v10 offset:49664
 v_mfma_f32_16x16x32_bf16 v[28:31], v[244:247], v[96:99], v[28:31]
 ds_read_b64_tr_b16 v[92:93], v10 offset:53248
 v_mfma_f32_16x16x32_bf16 v[28:31], v[252:255], v[100:103], v[28:31]
 s_setprio 0
 ds_read_b64_tr_b16 v[94:95], v10 offset:53760
 s_add_u32 m0, s53, 24576
 s_nop 0
 buffer_load_dwordx4 v4, s[24:27], s90 offen lds
 s_waitcnt lgkmcnt(4)
 v_mfma_f32_16x16x32_bf16 v[32:35], v[80:83], v[240:243], v[32:35]
 s_setprio 1
 ds_read_b64_tr_b16 v[96:97], v9 offset:40960
 v_mfma_f32_16x16x32_bf16 v[32:35], v[84:87], v[248:251], v[32:35]
 ds_read_b64_tr_b16 v[98:99], v9 offset:41472
 v_mfma_f32_16x16x32_bf16 v[36:39], v[80:83], v[244:247], v[36:39]
 ds_read_b64_tr_b16 v[100:101], v9 offset:45056
 v_mfma_f32_16x16x32_bf16 v[36:39], v[84:87], v[252:255], v[36:39]
 s_setprio 0
 ds_read_b64_tr_b16 v[102:103], v9 offset:45568
 s_lshl_b32 s67, s57, 1
 s_add_u32 s67, s67, s94
 s_lshl_b32 s67, s67, 18
 s_lshl_b32 s68, s95, 11
 s_add_u32 s67, s67, s68
 s_sub_u32 s67, s67, 1047552
 s_add_u32 s68, s67, 131072
 v_cvt_pk_bf16_f32 v104, v16, v17
 v_cvt_pk_bf16_f32 v105, v18, v19
 v_cvt_pk_bf16_f32 v106, v20, v21
 s_waitcnt lgkmcnt(4)
 v_mfma_f32_16x16x32_bf16 v[40:43], v[88:91], v[240:243], v[40:43]
 s_setprio 1
 ds_read_b64_tr_b16 v[80:81], v9 offset:57344
 v_mfma_f32_16x16x32_bf16 v[40:43], v[92:95], v[248:251], v[40:43]
 ds_read_b64_tr_b16 v[82:83], v9 offset:57856
 v_mfma_f32_16x16x32_bf16 v[44:47], v[88:91], v[244:247], v[44:47]
 ds_read_b64_tr_b16 v[84:85], v9 offset:61440
 v_mfma_f32_16x16x32_bf16 v[44:47], v[92:95], v[252:255], v[44:47]
 s_setprio 0
 ds_read_b64_tr_b16 v[86:87], v9 offset:61952
 v_cvt_pk_bf16_f32 v107, v22, v23
 v_cvt_pk_bf16_f32 v108, v24, v25
 v_cvt_pk_bf16_f32 v109, v26, v27
 v_cvt_pk_bf16_f32 v110, v28, v29
 v_cvt_pk_bf16_f32 v111, v30, v31
 buffer_store_dwordx4 v[104:107], v126, s[28:31], s67 offen offset:0 sc1
 s_waitcnt lgkmcnt(4)
 v_mfma_f32_16x16x32_bf16 v[48:51], v[96:99], v[224:227], v[48:51]
 s_setprio 1
 ds_read_b64_tr_b16 v[88:89], v10 offset:40960
 v_mfma_f32_16x16x32_bf16 v[48:51], v[100:103], v[232:235], v[48:51]
 ds_read_b64_tr_b16 v[90:91], v10 offset:41472
 v_mfma_f32_16x16x32_bf16 v[52:55], v[96:99], v[228:231], v[52:55]
 ds_read_b64_tr_b16 v[92:93], v10 offset:45056
 v_mfma_f32_16x16x32_bf16 v[52:55], v[100:103], v[236:239], v[52:55]
 s_setprio 0
 ds_read_b64_tr_b16 v[94:95], v10 offset:45568
 buffer_store_dwordx4 v[108:111], v126, s[28:31], s68 offen offset:0 sc1
 s_waitcnt lgkmcnt(4)
 v_mfma_f32_16x16x32_bf16 v[48:51], v[80:83], v[240:243], v[48:51]
 s_setprio 1
 ds_read_b64_tr_b16 v[96:97], v10 offset:57344
 v_mfma_f32_16x16x32_bf16 v[48:51], v[84:87], v[248:251], v[48:51]
 ds_read_b64_tr_b16 v[98:99], v10 offset:57856
 v_mfma_f32_16x16x32_bf16 v[52:55], v[80:83], v[244:247], v[52:55]
 ds_read_b64_tr_b16 v[100:101], v10 offset:61440
 v_mfma_f32_16x16x32_bf16 v[52:55], v[84:87], v[252:255], v[52:55]
 s_setprio 0
 ds_read_b64_tr_b16 v[102:103], v10 offset:61952
 s_waitcnt vmcnt(2) lgkmcnt(4)
 s_barrier
 v_mfma_f32_16x16x32_bf16 v[56:59], v[88:91], v[224:227], v[56:59]
 s_setprio 1
 ds_read_b64_tr_b16 v[80:81], v9 offset:0
 v_mfma_f32_16x16x32_bf16 v[56:59], v[92:95], v[232:235], v[56:59]
 ds_read_b64_tr_b16 v[82:83], v9 offset:512
 v_mfma_f32_16x16x32_bf16 v[60:63], v[88:91], v[228:231], v[60:63]
 ds_read_b64_tr_b16 v[84:85], v9 offset:4096
 v_mfma_f32_16x16x32_bf16 v[60:63], v[92:95], v[236:239], v[60:63]
 s_setprio 0
 ds_read_b64_tr_b16 v[86:87], v9 offset:4608
 s_add_u32 s91, s60, 4
 s_and_b32 s91, s91, 7
 s_add_u32 m0, s53, 131072
 s_mul_i32 s90, s91, 229376
 buffer_load_dwordx4 v4, s[20:23], s90 offen lds
 s_waitcnt lgkmcnt(4)
 v_mfma_f32_16x16x32_bf16 v[56:59], v[96:99], v[240:243], v[56:59]
 s_setprio 1
 ds_read_b64_tr_b16 v[88:89], v10 offset:0
 v_mfma_f32_16x16x32_bf16 v[56:59], v[100:103], v[248:251], v[56:59]
 ds_read_b64_tr_b16 v[90:91], v10 offset:512
 v_mfma_f32_16x16x32_bf16 v[60:63], v[96:99], v[244:247], v[60:63]
 ds_read_b64_tr_b16 v[92:93], v10 offset:4096
 v_mfma_f32_16x16x32_bf16 v[60:63], v[100:103], v[252:255], v[60:63]
 s_setprio 0
 ds_read_b64_tr_b16 v[94:95], v10 offset:4608
 s_add_u32 m0, s53, 139264
 s_nop 0
 buffer_load_dwordx4 v4, s[24:27], s90 offen lds
 s_waitcnt lgkmcnt(4)
 v_mfma_f32_16x16x32_bf16 v[16:19], v[80:83], v[128:131], 0
 s_setprio 1
 ds_read_b64_tr_b16 v[96:97], v9 offset:8192
 v_mfma_f32_16x16x32_bf16 v[16:19], v[84:87], v[136:139], v[16:19]
 ds_read_b64_tr_b16 v[98:99], v9 offset:8704
 v_mfma_f32_16x16x32_bf16 v[20:23], v[80:83], v[132:135], 0
 ds_read_b64_tr_b16 v[100:101], v9 offset:12288
 v_mfma_f32_16x16x32_bf16 v[20:23], v[84:87], v[140:143], v[20:23]
 s_setprio 0
 ds_read_b64_tr_b16 v[102:103], v9 offset:12800
 s_add_u32 s91, s60, 5
 s_and_b32 s91, s91, 7
 s_add_u32 m0, s53, 32768
 s_mul_i32 s90, s91, 229376
 buffer_load_dwordx4 v4, s[20:23], s90 offen lds
 s_mul_i32 s67, s95, 114688
 s_lshl_b32 s68, s74, 1
 s_add_u32 s68, s68, s94
 s_lshl_b32 s68, s68, 11
 s_add_u32 s67, s67, s68
 s_add_u32 s67, s67, 9437184
 v_mul_f32 v32, 0xbfb8aa3b, v32
 s_waitcnt lgkmcnt(4)
 v_mfma_f32_16x16x32_bf16 v[24:27], v[88:91], v[128:131], 0
 s_setprio 1
 ds_read_b64_tr_b16 v[80:81], v10 offset:8192
 v_mfma_f32_16x16x32_bf16 v[24:27], v[92:95], v[136:139], v[24:27]
 ds_read_b64_tr_b16 v[82:83], v10 offset:8704
 v_mfma_f32_16x16x32_bf16 v[28:31], v[88:91], v[132:135], 0
 ds_read_b64_tr_b16 v[84:85], v10 offset:12288
 v_mfma_f32_16x16x32_bf16 v[28:31], v[92:95], v[140:143], v[28:31]
 s_setprio 0
 ds_read_b64_tr_b16 v[86:87], v10 offset:12800
 s_add_u32 m0, s53, 40960
 s_nop 0
 buffer_load_dwordx4 v4, s[24:27], s90 offen lds
 v_mul_f32 v33, 0xbfb8aa3b, v33
 v_mul_f32 v34, 0xbfb8aa3b, v34
 v_mul_f32 v35, 0xbfb8aa3b, v35
 v_mul_f32 v40, 0xbfb8aa3b, v40
 s_waitcnt lgkmcnt(4)
 v_mfma_f32_16x16x32_bf16 v[64:67], v[96:99], v[128:131], 0
 s_setprio 1
 ds_read_b64_tr_b16 v[88:89], v11 offset:0
 v_mfma_f32_16x16x32_bf16 v[64:67], v[100:103], v[136:139], v[64:67]
 ds_read_b64_tr_b16 v[90:91], v11 offset:512
 v_mfma_f32_16x16x32_bf16 v[68:71], v[96:99], v[132:135], 0
 ds_read_b64_tr_b16 v[92:93], v11 offset:4096
 v_mfma_f32_16x16x32_bf16 v[68:71], v[100:103], v[140:143], v[68:71]
 s_setprio 0
 ds_read_b64_tr_b16 v[94:95], v11 offset:4608
 v_mul_f32 v41, 0xbfb8aa3b, v41
 v_mul_f32 v42, 0xbfb8aa3b, v42
 v_mul_f32 v43, 0xbfb8aa3b, v43
 v_exp_f32 v32, v32
 v_exp_f32 v33, v33
 v_exp_f32 v34, v34
 s_waitcnt lgkmcnt(4)
 v_mfma_f32_16x16x32_bf16 v[72:75], v[80:83], v[128:131], 0
 s_setprio 1
 ds_read_b64_tr_b16 v[96:97], v12 offset:0
 v_mfma_f32_16x16x32_bf16 v[72:75], v[84:87], v[136:139], v[72:75]
 ds_read_b64_tr_b16 v[98:99], v12 offset:512
 v_mfma_f32_16x16x32_bf16 v[76:79], v[80:83], v[132:135], 0
 ds_read_b64_tr_b16 v[100:101], v12 offset:4096
 v_mfma_f32_16x16x32_bf16 v[76:79], v[84:87], v[140:143], v[76:79]
 s_setprio 0
 ds_read_b64_tr_b16 v[102:103], v12 offset:4608
 v_exp_f32 v35, v35
 v_exp_f32 v40, v40
 v_exp_f32 v41, v41
 v_exp_f32 v42, v42
 v_exp_f32 v43, v43
 s_waitcnt lgkmcnt(4)
 v_mfma_f32_16x16x32_bf16 v[16:19], v[88:91], v[144:147], v[16:19]
 s_setprio 1
 ds_read_b64_tr_b16 v[80:81], v11 offset:8192
 v_mfma_f32_16x16x32_bf16 v[16:19], v[92:95], v[152:155], v[16:19]
 ds_read_b64_tr_b16 v[82:83], v11 offset:8704
 v_mfma_f32_16x16x32_bf16 v[20:23], v[88:91], v[148:151], v[20:23]
 ds_read_b64_tr_b16 v[84:85], v11 offset:12288
 v_mfma_f32_16x16x32_bf16 v[20:23], v[92:95], v[156:159], v[20:23]
 s_setprio 0
 ds_read_b64_tr_b16 v[86:87], v11 offset:12800
 v_min_u32 v13, v14, v15
 v_cmp_eq_u32 vcc, 0, v13
 s_nop 0
 s_cmp_lg_u64 vcc, 0
 s_cbranch_scc1 L_x_2008
L_r_2009:
 v_exp_f32 v14, v14
 v_exp_f32 v15, v15
 v_add_f32 v14, 1.0, v14
 v_add_f32 v15, 1.0, v15
 v_min_f32 v14, 0x71800000, v14
 v_min_f32 v15, 0x71800000, v15
 v_fma_f32 v32, v32, v14, v14
 v_fma_f32 v33, v33, v14, v14
 v_fma_f32 v34, v34, v14, v14
 v_fma_f32 v35, v35, v14, v14
 s_waitcnt lgkmcnt(4)
 v_mfma_f32_16x16x32_bf16 v[24:27], v[96:99], v[144:147], v[24:27]
 s_setprio 1
 ds_read_b64_tr_b16 v[88:89], v12 offset:8192
 v_mfma_f32_16x16x32_bf16 v[24:27], v[100:103], v[152:155], v[24:27]
 ds_read_b64_tr_b16 v[90:91], v12 offset:8704
 v_mfma_f32_16x16x32_bf16 v[28:31], v[96:99], v[148:151], v[28:31]
 ds_read_b64_tr_b16 v[92:93], v12 offset:12288
 v_mfma_f32_16x16x32_bf16 v[28:31], v[100:103], v[156:159], v[28:31]
 s_setprio 0
 ds_read_b64_tr_b16 v[94:95], v12 offset:12800
 v_fma_f32 v40, v40, v14, v14
 v_fma_f32 v41, v41, v14, v14
 v_fma_f32 v42, v42, v14, v14
 v_fma_f32 v43, v43, v14, v14
 v_rcp_f32 v32, v32
 v_rcp_f32 v33, v33
 v_rcp_f32 v34, v34
 s_waitcnt lgkmcnt(4)
 v_mfma_f32_16x16x32_bf16 v[64:67], v[80:83], v[144:147], v[64:67]
 s_setprio 1
 ds_read_b64_tr_b16 v[96:97], v9 offset:16384
 v_mfma_f32_16x16x32_bf16 v[64:67], v[84:87], v[152:155], v[64:67]
 ds_read_b64_tr_b16 v[98:99], v9 offset:16896
 v_mfma_f32_16x16x32_bf16 v[68:71], v[80:83], v[148:151], v[68:71]
 ds_read_b64_tr_b16 v[100:101], v9 offset:20480
 v_mfma_f32_16x16x32_bf16 v[68:71], v[84:87], v[156:159], v[68:71]
 s_setprio 0
 ds_read_b64_tr_b16 v[102:103], v9 offset:20992
 v_rcp_f32 v35, v35
 v_rcp_f32 v40, v40
 v_rcp_f32 v41, v41
 v_rcp_f32 v42, v42
 v_rcp_f32 v43, v43
 s_waitcnt lgkmcnt(4)
 v_mfma_f32_16x16x32_bf16 v[72:75], v[88:91], v[144:147], v[72:75]
 s_setprio 1
 ds_read_b64_tr_b16 v[80:81], v10 offset:16384
 v_mfma_f32_16x16x32_bf16 v[72:75], v[92:95], v[152:155], v[72:75]
 ds_read_b64_tr_b16 v[82:83], v10 offset:16896
 v_mfma_f32_16x16x32_bf16 v[76:79], v[88:91], v[148:151], v[76:79]
 ds_read_b64_tr_b16 v[84:85], v10 offset:20480
 v_mfma_f32_16x16x32_bf16 v[76:79], v[92:95], v[156:159], v[76:79]
 s_setprio 0
 ds_read_b64_tr_b16 v[86:87], v10 offset:20992
 v_mul_f32 v32, v32, v48
 v_mul_f32 v33, v33, v49
 v_mul_f32 v34, v34, v50
 v_mul_f32 v35, v35, v51
 v_mul_f32 v40, v40, v56
 v_mul_f32 v41, v41, v57
 v_mul_f32 v42, v42, v58
 v_mul_f32 v43, v43, v59
 v_cvt_pk_bf16_f32 v104, v32, v33
 s_waitcnt lgkmcnt(4)
 v_mfma_f32_16x16x32_bf16 v[16:19], v[96:99], v[160:163], v[16:19]
 s_setprio 1
 ds_read_b64_tr_b16 v[88:89], v9 offset:24576
 v_mfma_f32_16x16x32_bf16 v[16:19], v[100:103], v[168:171], v[16:19]
 ds_read_b64_tr_b16 v[90:91], v9 offset:25088
 v_mfma_f32_16x16x32_bf16 v[20:23], v[96:99], v[164:167], v[20:23]
 ds_read_b64_tr_b16 v[92:93], v9 offset:28672
 v_mfma_f32_16x16x32_bf16 v[20:23], v[100:103], v[172:175], v[20:23]
 s_setprio 0
 ds_read_b64_tr_b16 v[94:95], v9 offset:29184
 v_cvt_pk_bf16_f32 v105, v34, v35
 v_cvt_pk_bf16_f32 v106, v40, v41
 v_cvt_pk_bf16_f32 v107, v42, v43
 v_mul_f32 v36, 0xbfb8aa3b, v36
 v_mul_f32 v37, 0xbfb8aa3b, v37
 v_mul_f32 v38, 0xbfb8aa3b, v38
 v_mul_f32 v39, 0xbfb8aa3b, v39
 v_mul_f32 v44, 0xbfb8aa3b, v44
 v_mul_f32 v45, 0xbfb8aa3b, v45
 s_waitcnt vmcnt(0)
 s_barrier
 s_cmp_lg_u32 s52, 0
 s_cbranch_scc1 L_s_2011
 s_lshl_b32 s62, s57, 7
 s_lshl_b32 s63, s56, 2
 s_add_u32 s62, s62, s63
 s_mov_b64 exec, 1
 buffer_store_dword v112, v126, s[28:31], s62 offen sc1
 s_mov_b64 exec, -1
L_s_2011:
 s_waitcnt lgkmcnt(4)
 v_mfma_f32_16x16x32_bf16 v[24:27], v[80:83], v[160:163], v[24:27]
 s_setprio 1
 ds_read_b64_tr_b16 v[96:97], v10 offset:24576
 v_mfma_f32_16x16x32_bf16 v[24:27], v[84:87], v[168:171], v[24:27]
 ds_read_b64_tr_b16 v[98:99], v10 offset:25088
 v_mfma_f32_16x16x32_bf16 v[28:31], v[80:83], v[164:167], v[28:31]
 ds_read_b64_tr_b16 v[100:101], v10 offset:28672
 v_mfma_f32_16x16x32_bf16 v[28:31], v[84:87], v[172:175], v[28:31]
 s_setprio 0
 ds_read_b64_tr_b16 v[102:103], v10 offset:29184
 s_add_u32 s91, s60, 6
 s_and_b32 s91, s91, 7
 s_add_u32 m0, s53, 147456
 s_mul_i32 s90, s91, 229376
 buffer_load_dwordx4 v4, s[20:23], s90 offen lds
 v_mul_f32 v46, 0xbfb8aa3b, v46
 v_mul_f32 v47, 0xbfb8aa3b, v47
 v_exp_f32 v36, v36
 s_waitcnt lgkmcnt(4)
 v_mfma_f32_16x16x32_bf16 v[64:67], v[88:91], v[160:163], v[64:67]
 s_setprio 1
 ds_read_b64_tr_b16 v[80:81], v11 offset:16384
 v_mfma_f32_16x16x32_bf16 v[64:67], v[92:95], v[168:171], v[64:67]
 ds_read_b64_tr_b16 v[82:83], v11 offset:16896
 v_mfma_f32_16x16x32_bf16 v[68:71], v[88:91], v[164:167], v[68:71]
 ds_read_b64_tr_b16 v[84:85], v11 offset:20480
 v_mfma_f32_16x16x32_bf16 v[68:71], v[92:95], v[172:175], v[68:71]
 s_setprio 0
 ds_read_b64_tr_b16 v[86:87], v11 offset:20992
 s_add_u32 m0, s53, 155648
 s_nop 0
 buffer_load_dwordx4 v4, s[24:27], s90 offen lds
 v_exp_f32 v37, v37
 v_exp_f32 v38, v38
 s_waitcnt lgkmcnt(4)
 v_mfma_f32_16x16x32_bf16 v[72:75], v[96:99], v[160:163], v[72:75]
 s_setprio 1
 ds_read_b64_tr_b16 v[88:89], v12 offset:16384
 v_mfma_f32_16x16x32_bf16 v[72:75], v[100:103], v[168:171], v[72:75]
 ds_read_b64_tr_b16 v[90:91], v12 offset:16896
 v_mfma_f32_16x16x32_bf16 v[76:79], v[96:99], v[164:167], v[76:79]
 ds_read_b64_tr_b16 v[92:93], v12 offset:20480
 v_mfma_f32_16x16x32_bf16 v[76:79], v[100:103], v[172:175], v[76:79]
 s_setprio 0
 ds_read_b64_tr_b16 v[94:95], v12 offset:20992
 s_add_u32 s91, s60, 7
 s_and_b32 s91, s91, 7
 s_add_u32 m0, s53, 49152
 s_mul_i32 s90, s91, 229376
 buffer_load_dwordx4 v4, s[20:23], s90 offen lds
 v_exp_f32 v39, v39
 v_exp_f32 v44, v44
 s_waitcnt lgkmcnt(4)
 v_mfma_f32_16x16x32_bf16 v[16:19], v[80:83], v[176:179], v[16:19]
 s_setprio 1
 ds_read_b64_tr_b16 v[96:97], v11 offset:24576
 v_mfma_f32_16x16x32_bf16 v[16:19], v[84:87], v[184:187], v[16:19]
 ds_read_b64_tr_b16 v[98:99], v11 offset:25088
 v_mfma_f32_16x16x32_bf16 v[20:23], v[80:83], v[180:183], v[20:23]
 ds_read_b64_tr_b16 v[100:101], v11 offset:28672
 v_mfma_f32_16x16x32_bf16 v[20:23], v[84:87], v[188:191], v[20:23]
 s_setprio 0
 ds_read_b64_tr_b16 v[102:103], v11 offset:29184
 s_add_u32 m0, s53, 57344
 s_nop 0
 buffer_load_dwordx4 v4, s[24:27], s90 offen lds
 v_exp_f32 v45, v45
 v_exp_f32 v46, v46
 s_waitcnt lgkmcnt(4)
 v_mfma_f32_16x16x32_bf16 v[24:27], v[88:91], v[176:179], v[24:27]
 s_setprio 1
 ds_read_b64_tr_b16 v[80:81], v12 offset:24576
 v_mfma_f32_16x16x32_bf16 v[24:27], v[92:95], v[184:187], v[24:27]
 ds_read_b64_tr_b16 v[82:83], v12 offset:25088
 v_mfma_f32_16x16x32_bf16 v[28:31], v[88:91], v[180:183], v[28:31]
 ds_read_b64_tr_b16 v[84:85], v12 offset:28672
 v_mfma_f32_16x16x32_bf16 v[28:31], v[92:95], v[188:191], v[28:31]
 s_setprio 0
 ds_read_b64_tr_b16 v[86:87], v12 offset:29184
 v_exp_f32 v47, v47
 v_fma_f32 v36, v36, v15, v15
 v_fma_f32 v37, v37, v15, v15
 v_fma_f32 v38, v38, v15, v15
 v_fma_f32 v39, v39, v15, v15
 v_fma_f32 v44, v44, v15, v15
 v_fma_f32 v45, v45, v15, v15
 v_fma_f32 v46, v46, v15, v15
 s_waitcnt lgkmcnt(4)
 v_mfma_f32_16x16x32_bf16 v[64:67], v[96:99], v[176:179], v[64:67]
 s_setprio 1
 ds_read_b64_tr_b16 v[88:89], v9 offset:32768
 v_mfma_f32_16x16x32_bf16 v[64:67], v[100:103], v[184:187], v[64:67]
 ds_read_b64_tr_b16 v[90:91], v9 offset:33280
 v_mfma_f32_16x16x32_bf16 v[68:71], v[96:99], v[180:183], v[68:71]
 ds_read_b64_tr_b16 v[92:93], v9 offset:36864
 v_mfma_f32_16x16x32_bf16 v[68:71], v[100:103], v[188:191], v[68:71]
 s_setprio 0
 ds_read_b64_tr_b16 v[94:95], v9 offset:37376
 v_fma_f32 v47, v47, v15, v15
 buffer_store_dwordx4 v[104:107], v122, s[28:31], s67 offen offset:0 sc1
 v_rcp_f32 v36, v36
 v_rcp_f32 v37, v37
 s_waitcnt lgkmcnt(4)
 v_mfma_f32_16x16x32_bf16 v[72:75], v[80:83], v[176:179], v[72:75]
 s_setprio 1
 ds_read_b64_tr_b16 v[96:97], v10 offset:32768
 v_mfma_f32_16x16x32_bf16 v[72:75], v[84:87], v[184:187], v[72:75]
 ds_read_b64_tr_b16 v[98:99], v10 offset:33280
 v_mfma_f32_16x16x32_bf16 v[76:79], v[80:83], v[180:183], v[76:79]
 ds_read_b64_tr_b16 v[100:101], v10 offset:36864
 v_mfma_f32_16x16x32_bf16 v[76:79], v[84:87], v[188:191], v[76:79]
 s_setprio 0
 ds_read_b64_tr_b16 v[102:103], v10 offset:37376
 v_rcp_f32 v38, v38
 v_rcp_f32 v39, v39
 v_rcp_f32 v44, v44
 v_rcp_f32 v45, v45
 v_rcp_f32 v46, v46
 s_waitcnt lgkmcnt(4)
 v_mfma_f32_16x16x32_bf16 v[16:19], v[88:91], v[192:195], v[16:19]
 s_setprio 1
 ds_read_b64_tr_b16 v[80:81], v9 offset:40960
 v_mfma_f32_16x16x32_bf16 v[16:19], v[92:95], v[200:203], v[16:19]
 ds_read_b64_tr_b16 v[82:83], v9 offset:41472
 v_mfma_f32_16x16x32_bf16 v[20:23], v[88:91], v[196:199], v[20:23]
 ds_read_b64_tr_b16 v[84:85], v9 offset:45056
 v_mfma_f32_16x16x32_bf16 v[20:23], v[92:95], v[204:207], v[20:23]
 s_setprio 0
 ds_read_b64_tr_b16 v[86:87], v9 offset:45568
 v_rcp_f32 v47, v47
 v_mul_f32 v36, v36, v52
 v_mul_f32 v37, v37, v53
 v_mul_f32 v38, v38, v54
 v_mul_f32 v39, v39, v55
 v_mul_f32 v44, v44, v60
 v_mul_f32 v45, v45, v61
 v_mul_f32 v46, v46, v62
 s_waitcnt lgkmcnt(4)
 v_mfma_f32_16x16x32_bf16 v[24:27], v[96:99], v[192:195], v[24:27]
 s_setprio 1
 ds_read_b64_tr_b16 v[88:89], v10 offset:40960
 v_mfma_f32_16x16x32_bf16 v[24:27], v[100:103], v[200:203], v[24:27]
 ds_read_b64_tr_b16 v[90:91], v10 offset:41472
 v_mfma_f32_16x16x32_bf16 v[28:31], v[96:99], v[196:199], v[28:31]
 ds_read_b64_tr_b16 v[92:93], v10 offset:45056
 v_mfma_f32_16x16x32_bf16 v[28:31], v[100:103], v[204:207], v[28:31]
 s_setprio 0
 ds_read_b64_tr_b16 v[94:95], v10 offset:45568
 v_mul_f32 v47, v47, v63
 v_cvt_pk_bf16_f32 v108, v36, v37
 v_cvt_pk_bf16_f32 v109, v38, v39
 v_cvt_pk_bf16_f32 v110, v44, v45
 v_cvt_pk_bf16_f32 v111, v46, v47
 buffer_store_dwordx4 v[108:111], v122, s[28:31], s67 offen offset:256 sc1
 s_waitcnt vmcnt(2)
 s_barrier
 s_waitcnt lgkmcnt(4)
 v_mfma_f32_16x16x32_bf16 v[64:67], v[80:83], v[192:195], v[64:67]
 s_setprio 1
 ds_read_b64_tr_b16 v[96:97], v11 offset:32768
 v_mfma_f32_16x16x32_bf16 v[64:67], v[84:87], v[200:203], v[64:67]
 ds_read_b64_tr_b16 v[98:99], v11 offset:33280
 v_mfma_f32_16x16x32_bf16 v[68:71], v[80:83], v[196:199], v[68:71]
 ds_read_b64_tr_b16 v[100:101], v11 offset:36864
 v_mfma_f32_16x16x32_bf16 v[68:71], v[84:87], v[204:207], v[68:71]
 s_setprio 0
 ds_read_b64_tr_b16 v[102:103], v11 offset:37376
 v_and_b32 v129, 0x1b, v0
 v_cmp_eq_u32 vcc, 16, v129
 v_mov_b32 v129, 0x3f803f80
 s_nop 0
 v_cndmask_b32 v128, 0, v129, vcc
 v_mov_b32 v129, v128
 v_mov_b32 v130, v128
 v_mov_b32 v131, v128
 v_mov_b32 v132, v128
 s_waitcnt lgkmcnt(4)
 v_mfma_f32_16x16x32_bf16 v[72:75], v[88:91], v[192:195], v[72:75]
 s_setprio 1
 ds_read_b64_tr_b16 v[80:81], v9 offset:49152
 v_mfma_f32_16x16x32_bf16 v[72:75], v[92:95], v[200:203], v[72:75]
 ds_read_b64_tr_b16 v[82:83], v9 offset:49664
 v_mfma_f32_16x16x32_bf16 v[76:79], v[88:91], v[196:199], v[76:79]
 ds_read_b64_tr_b16 v[84:85], v9 offset:53248
 v_mfma_f32_16x16x32_bf16 v[76:79], v[92:95], v[204:207], v[76:79]
 s_setprio 0
 ds_read_b64_tr_b16 v[86:87], v9 offset:53760
 v_mov_b32 v133, v128
 v_mov_b32 v134, v128
 v_mov_b32 v135, v128
 v_mov_b32 v136, v128
 v_mov_b32 v137, v128
 v_mov_b32 v138, v128
 v_mov_b32 v139, v128
 v_mov_b32 v140, v128
 v_mov_b32 v141, v128
 s_waitcnt lgkmcnt(4)
 v_mfma_f32_16x16x32_bf16 v[16:19], v[96:99], v[208:211], v[16:19]
 s_setprio 1
 ds_read_b64_tr_b16 v[88:89], v11 offset:49152
 v_mfma_f32_16x16x32_bf16 v[16:19], v[100:103], v[216:219], v[16:19]
 ds_read_b64_tr_b16 v[90:91], v11 offset:49664
 v_mfma_f32_16x16x32_bf16 v[20:23], v[96:99], v[212:215], v[20:23]
 ds_read_b64_tr_b16 v[92:93], v11 offset:53248
 v_mfma_f32_16x16x32_bf16 v[20:23], v[100:103], v[220:223], v[20:23]
 s_setprio 0
 ds_read_b64_tr_b16 v[94:95], v11 offset:53760
 v_mov_b32 v142, v128
 v_mov_b32 v143, v128
 v_mov_b32 v152, 0
 v_mov_b32 v153, 0
 v_mov_b32 v154, 0
 v_mov_b32 v155, 0
 v_xor_b32 v1, 32, v124
 v_xor_b32 v2, 64, v124
 v_xor_b32 v3, 96, v124
 s_waitcnt lgkmcnt(4)
 v_mfma_f32_16x16x32_bf16 v[16:19], v[80:83], v[224:227], v[16:19]
 s_setprio 1
 ds_read_b64_tr_b16 v[96:97], v12 offset:32768
 v_mfma_f32_16x16x32_bf16 v[16:19], v[84:87], v[232:235], v[16:19]
 ds_read_b64_tr_b16 v[98:99], v12 offset:33280
 v_mfma_f32_16x16x32_bf16 v[20:23], v[80:83], v[228:231], v[20:23]
 ds_read_b64_tr_b16 v[100:101], v12 offset:36864
 v_mfma_f32_16x16x32_bf16 v[20:23], v[84:87], v[236:239], v[20:23]
 s_setprio 0
 ds_read_b64_tr_b16 v[102:103], v12 offset:37376
 v_add_u32 v5, 98304, v124
 v_add_u32 v6, 98304, v1
 s_xor_b32 s68, s52, 4
 s_mul_i32 s68, s68, 2304
 s_add_u32 s68, s68, 98304
 v_add_u32 v7, s68, v126
 v_lshl_add_u32 v119, v0, 2, s68
 s_mul_i32 s68, s52, 2304
 s_add_u32 s68, s68, 98304
 v_add_u32 v8, s68, v126
 v_lshl_add_u32 v4, v0, 2, s68
 s_mul_i32 s67, s95, 114688
 s_waitcnt lgkmcnt(4)
 v_mfma_f32_16x16x32_bf16 v[16:19], v[88:91], v[240:243], v[16:19]
 s_setprio 1
 ds_read_b64_tr_b16 v[80:81], v10 offset:49152
 v_mfma_f32_16x16x32_bf16 v[16:19], v[92:95], v[248:251], v[16:19]
 ds_read_b64_tr_b16 v[82:83], v10 offset:49664
 v_mfma_f32_16x16x32_bf16 v[20:23], v[88:91], v[244:247], v[20:23]
 ds_read_b64_tr_b16 v[84:85], v10 offset:53248
 v_mfma_f32_16x16x32_bf16 v[20:23], v[92:95], v[252:255], v[20:23]
 s_setprio 0
 ds_read_b64_tr_b16 v[86:87], v10 offset:53760
 s_lshl_b32 s68, s75, 1
 s_add_u32 s68, s68, s94
 s_lshl_b32 s68, s68, 11
 s_add_u32 s67, s67, s68
 s_add_u32 s67, s67, 9437184
 buffer_load_dword v121, v120, s[28:31], 0 offen sc1
 s_waitcnt lgkmcnt(4)
 v_mfma_f32_16x16x32_bf16 v[24:27], v[96:99], v[208:211], v[24:27]
 s_setprio 1
 ds_read_b64_tr_b16 v[88:89], v12 offset:49152
 v_mfma_f32_16x16x32_bf16 v[24:27], v[100:103], v[216:219], v[24:27]
 ds_read_b64_tr_b16 v[90:91], v12 offset:49664
 v_mfma_f32_16x16x32_bf16 v[28:31], v[96:99], v[212:215], v[28:31]
 ds_read_b64_tr_b16 v[92:93], v12 offset:53248
 v_mfma_f32_16x16x32_bf16 v[28:31], v[100:103], v[220:223], v[28:31]
 s_setprio 0
 ds_read_b64_tr_b16 v[94:95], v12 offset:53760
 v_mul_f32 v16, 0xbfb8aa3b, v16
 v_mul_f32 v17, 0xbfb8aa3b, v17
 v_mul_f32 v18, 0xbfb8aa3b, v18
 v_mul_f32 v19, 0xbfb8aa3b, v19
 v_mul_f32 v20, 0xbfb8aa3b, v20
 v_mul_f32 v21, 0xbfb8aa3b, v21
 v_mul_f32 v22, 0xbfb8aa3b, v22
 v_mul_f32 v23, 0xbfb8aa3b, v23
 v_exp_f32 v16, v16
 v_exp_f32 v17, v17
 s_waitcnt lgkmcnt(4)
 v_mfma_f32_16x16x32_bf16 v[24:27], v[80:83], v[224:227], v[24:27]
 s_setprio 1
 ds_read_b64_tr_b16 v[96:97], v11 offset:40960
 v_mfma_f32_16x16x32_bf16 v[24:27], v[84:87], v[232:235], v[24:27]
 ds_read_b64_tr_b16 v[98:99], v11 offset:41472
 v_mfma_f32_16x16x32_bf16 v[28:31], v[80:83], v[228:231], v[28:31]
 ds_read_b64_tr_b16 v[100:101], v11 offset:45056
 v_mfma_f32_16x16x32_bf16 v[28:31], v[84:87], v[236:239], v[28:31]
 s_setprio 0
 ds_read_b64_tr_b16 v[102:103], v11 offset:45568
 v_exp_f32 v18, v18
 v_exp_f32 v19, v19
 v_exp_f32 v20, v20
 v_exp_f32 v21, v21
 v_exp_f32 v22, v22
 v_exp_f32 v23, v23
 s_waitcnt lgkmcnt(4)
 v_mfma_f32_16x16x32_bf16 v[24:27], v[88:91], v[240:243], v[24:27]
 s_setprio 1
 ds_read_b64_tr_b16 v[80:81], v9 offset:57344
 v_mfma_f32_16x16x32_bf16 v[24:27], v[92:95], v[248:251], v[24:27]
 ds_read_b64_tr_b16 v[82:83], v9 offset:57856
 v_mfma_f32_16x16x32_bf16 v[28:31], v[88:91], v[244:247], v[28:31]
 ds_read_b64_tr_b16 v[84:85], v9 offset:61440
 v_mfma_f32_16x16x32_bf16 v[28:31], v[92:95], v[252:255], v[28:31]
 s_setprio 0
 ds_read_b64_tr_b16 v[86:87], v9 offset:61952
 v_fma_f32 v16, v16, v14, v14
 v_fma_f32 v17, v17, v14, v14
 v_fma_f32 v18, v18, v14, v14
 v_fma_f32 v19, v19, v14, v14
 v_fma_f32 v20, v20, v15, v15
 v_fma_f32 v21, v21, v15, v15
 v_fma_f32 v22, v22, v15, v15
 v_fma_f32 v23, v23, v15, v15
 v_rcp_f32 v16, v16
 v_rcp_f32 v17, v17
 s_waitcnt vmcnt(0)
 v_cmp_eq_u32 vcc, 0, v121
 s_nop 0
 s_cmp_lg_u64 vcc, 0
 s_cbranch_scc1 L_x_2012
L_r_2013:
 s_waitcnt lgkmcnt(4)
 v_mfma_f32_16x16x32_bf16 v[64:67], v[96:99], v[208:211], v[64:67]
 s_setprio 1
 ds_read_b64_tr_b16 v[88:89], v11 offset:57344
 v_mfma_f32_16x16x32_bf16 v[64:67], v[100:103], v[216:219], v[64:67]
 ds_read_b64_tr_b16 v[90:91], v11 offset:57856
 v_mfma_f32_16x16x32_bf16 v[68:71], v[96:99], v[212:215], v[68:71]
 ds_read_b64_tr_b16 v[92:93], v11 offset:61440
 v_mfma_f32_16x16x32_bf16 v[68:71], v[100:103], v[220:223], v[68:71]
 s_setprio 0
 ds_read_b64_tr_b16 v[94:95], v11 offset:61952
 s_add_u32 m0, s53, 65536
 s_add_u32 s63, s66, 0
 buffer_load_dwordx4 v126, s[28:31], s63 offen sc1 lds
 v_rcp_f32 v18, v18
 v_rcp_f32 v19, v19
 v_rcp_f32 v20, v20
 s_waitcnt lgkmcnt(4)
 v_mfma_f32_16x16x32_bf16 v[64:67], v[80:83], v[224:227], v[64:67]
 s_setprio 1
 ds_read_b64_tr_b16 v[96:97], v12 offset:40960
 v_mfma_f32_16x16x32_bf16 v[64:67], v[84:87], v[232:235], v[64:67]
 ds_read_b64_tr_b16 v[98:99], v12 offset:41472
 v_mfma_f32_16x16x32_bf16 v[68:71], v[80:83], v[228:231], v[68:71]
 ds_read_b64_tr_b16 v[100:101], v12 offset:45056
 v_mfma_f32_16x16x32_bf16 v[68:71], v[84:87], v[236:239], v[68:71]
 s_setprio 0
 ds_read_b64_tr_b16 v[102:103], v12 offset:45568
 s_add_u32 m0, s53, 73728
 s_add_u32 s63, s66, 8192
 buffer_load_dwordx4 v126, s[28:31], s63 offen sc1 lds
 v_rcp_f32 v21, v21
 v_rcp_f32 v22, v22
 v_rcp_f32 v23, v23
 s_waitcnt lgkmcnt(4)
 v_mfma_f32_16x16x32_bf16 v[64:67], v[88:91], v[240:243], v[64:67]
 s_setprio 1
 ds_read_b64_tr_b16 v[80:81], v10 offset:57344
 v_mfma_f32_16x16x32_bf16 v[64:67], v[92:95], v[248:251], v[64:67]
 ds_read_b64_tr_b16 v[82:83], v10 offset:57856
 v_mfma_f32_16x16x32_bf16 v[68:71], v[88:91], v[244:247], v[68:71]
 ds_read_b64_tr_b16 v[84:85], v10 offset:61440
 v_mfma_f32_16x16x32_bf16 v[68:71], v[92:95], v[252:255], v[68:71]
 s_setprio 0
 ds_read_b64_tr_b16 v[86:87], v10 offset:61952
 buffer_load_dwordx4 v[148:151], v126, s[28:31], s85 offen sc1
 buffer_load_dwordx4 v[144:147], v126, s[28:31], s3 offen sc1
 v_mul_f32 v24, 0xbfb8aa3b, v24
 v_mul_f32 v25, 0xbfb8aa3b, v25
 v_mul_f32 v26, 0xbfb8aa3b, v26
 v_mul_f32 v27, 0xbfb8aa3b, v27
 v_mul_f32 v28, 0xbfb8aa3b, v28
 v_mul_f32 v29, 0xbfb8aa3b, v29
 s_waitcnt lgkmcnt(4)
 v_mfma_f32_16x16x32_bf16 v[72:75], v[96:99], v[208:211], v[72:75]
 s_setprio 1
 ds_read_b64_tr_b16 v[88:89], v12 offset:57344
 v_mfma_f32_16x16x32_bf16 v[72:75], v[100:103], v[216:219], v[72:75]
 ds_read_b64_tr_b16 v[90:91], v12 offset:57856
 v_mfma_f32_16x16x32_bf16 v[76:79], v[96:99], v[212:215], v[76:79]
 ds_read_b64_tr_b16 v[92:93], v12 offset:61440
 v_mfma_f32_16x16x32_bf16 v[76:79], v[100:103], v[220:223], v[76:79]
 s_setprio 0
 ds_read_b64_tr_b16 v[94:95], v12 offset:61952
 s_add_u32 m0, s53, 81920
 s_add_u32 s63, s66, 16384
 buffer_load_dwordx4 v126, s[28:31], s63 offen sc1 lds
 v_mul_f32 v30, 0xbfb8aa3b, v30
 v_mul_f32 v31, 0xbfb8aa3b, v31
 v_exp_f32 v24, v24
 v_exp_f32 v25, v25
 s_waitcnt lgkmcnt(4)
 v_mfma_f32_16x16x32_bf16 v[72:75], v[80:83], v[224:227], v[72:75]
 s_setprio 1
 v_mfma_f32_16x16x32_bf16 v[72:75], v[84:87], v[232:235], v[72:75]
 v_mfma_f32_16x16x32_bf16 v[76:79], v[80:83], v[228:231], v[76:79]
 v_mfma_f32_16x16x32_bf16 v[76:79], v[84:87], v[236:239], v[76:79]
 s_setprio 0
 s_add_u32 m0, s53, 90112
 s_add_u32 s63, s66, 24576
 buffer_load_dwordx4 v126, s[28:31], s63 offen sc1 lds
 v_exp_f32 v26, v26
 v_exp_f32 v27, v27
 v_exp_f32 v28, v28
 s_waitcnt lgkmcnt(0)
 v_mfma_f32_16x16x32_bf16 v[72:75], v[88:91], v[240:243], v[72:75]
 s_setprio 1
 v_mfma_f32_16x16x32_bf16 v[72:75], v[92:95], v[248:251], v[72:75]
 v_mfma_f32_16x16x32_bf16 v[76:79], v[88:91], v[244:247], v[76:79]
 v_mfma_f32_16x16x32_bf16 v[76:79], v[92:95], v[252:255], v[76:79]
 s_setprio 0
 v_exp_f32 v29, v29
 v_exp_f32 v30, v30
 v_exp_f32 v31, v31
 v_fma_f32 v24, v24, v14, v14
 v_fma_f32 v25, v25, v14, v14
 v_fma_f32 v26, v26, v14, v14
 v_fma_f32 v27, v27, v14, v14
 v_fma_f32 v28, v28, v15, v15
 v_fma_f32 v29, v29, v15, v15
 v_fma_f32 v30, v30, v15, v15
 v_fma_f32 v31, v31, v15, v15
 v_rcp_f32 v24, v24
 v_rcp_f32 v25, v25
 v_rcp_f32 v26, v26
 v_rcp_f32 v27, v27
 v_rcp_f32 v28, v28
 v_rcp_f32 v29, v29
 v_rcp_f32 v30, v30
 v_rcp_f32 v31, v31
 v_mul_f32 v16, v16, v64
 v_mul_f32 v17, v17, v65
 v_mul_f32 v18, v18, v66
 v_mul_f32 v19, v19, v67
 v_mul_f32 v20, v20, v68
 v_mul_f32 v21, v21, v69
 v_mul_f32 v22, v22, v70
 v_mul_f32 v23, v23, v71
 v_cvt_pk_bf16_f32 v192, v16, v17
 v_cvt_pk_bf16_f32 v193, v18, v19
 v_cvt_pk_bf16_f32 v196, v20, v21
 v_cvt_pk_bf16_f32 v197, v22, v23
 v_mfma_f32_32x32x16_bf16 v[32:47], v[152:155], v[152:155], 0
 v_mfma_f32_32x32x16_bf16 v[48:63], v[152:155], v[152:155], 0
 s_waitcnt vmcnt(2)
 v_max3_u32 v13, v144, v145, v146
 v_max3_u32 v13, v13, v147, v148
 v_max3_u32 v13, v13, v149, v150
 v_max_u32 v13, v13, v151
 v_cmp_eq_u32 vcc, -1, v13
 s_nop 0
 s_cmp_lg_u64 vcc, 0
 s_cbranch_scc1 L_x_2015
L_r_2016:
 s_barrier
 ds_read_b128 v[104:107], v113 offset:0
 s_mov_b64 exec, s[96:97]
 ds_read_b128 v[128:131], v114 offset:1024
 ds_read_b128 v[132:135], v114 offset:1536
 s_mov_b64 exec, -1
 v_mul_f32 v24, v24, v72
 v_mul_f32 v25, v25, v73
 v_mul_f32 v26, v26, v74
 v_mul_f32 v27, v27, v75
 v_mul_f32 v28, v28, v76
 v_mul_f32 v29, v29, v77
 v_mul_f32 v30, v30, v78
 v_mul_f32 v31, v31, v79
 v_cvt_pk_bf16_f32 v194, v24, v25
 v_cvt_pk_bf16_f32 v195, v26, v27
 v_cvt_pk_bf16_f32 v198, v28, v29
 v_cvt_pk_bf16_f32 v199, v30, v31
 s_waitcnt lgkmcnt(2)
 v_mfma_f32_32x32x16_bf16 v[160:175], v[104:107], v[144:147], 0
 v_add_u32 v14, 98304, v2
 v_add_u32 v15, 98304, v3
 v_mov_b32 v152, -1
 v_mov_b32 v153, -1
 v_mov_b32 v154, -1
 v_mov_b32 v155, -1
 s_lshl_b32 s70, s95, 4
 s_add_u32 s70, s70, s57
 s_lshl_b32 s70, s70, 1
 s_add_u32 s70, s70, s94
 s_lshl_b32 s68, s70, 10
 s_add_u32 s68, s68, 7340032
 s_waitcnt lgkmcnt(0)
 v_exp_f32 v160, v160
 v_exp_f32 v161, v161
 ds_read_b128 v[108:111], v113 offset:4096
 s_setprio 3
 v_exp_f32 v162, v162
 v_exp_f32 v163, v163
 v_exp_f32 v164, v164
 v_mfma_f32_32x32x16_bf16 v[176:191], v[104:107], v[148:151], 0
 v_exp_f32 v165, v165
 v_exp_f32 v166, v166
 v_exp_f32 v167, v167
 v_exp_f32 v168, v168
 v_exp_f32 v169, v169
 v_smfmac_f32_32x32x32_bf16 v[32:47], v[128:131], v[160:167], v112
 s_mov_b64 exec, s[96:97]
 ds_read_b128 v[136:139], v114 offset:5120
 ds_read_b128 v[140:143], v114 offset:5632
 s_mov_b64 exec, -1
 v_exp_f32 v170, v170
 v_exp_f32 v171, v171
 v_exp_f32 v172, v172
 v_exp_f32 v173, v173
 buffer_store_dwordx4 v[192:195], v122, s[28:31], s67 offen offset:0 sc1
 v_exp_f32 v174, v174
 v_exp_f32 v175, v175
 v_exp_f32 v176, v176
 v_exp_f32 v177, v177
 v_smfmac_f32_32x32x32_bf16 v[32:47], v[132:135], v[168:175], v112
 s_waitcnt lgkmcnt(0)
 v_exp_f32 v178, v178
 v_exp_f32 v179, v179
 v_exp_f32 v180, v180
 v_mfma_f32_32x32x16_bf16 v[160:175], v[108:111], v[144:147], 0
 buffer_store_dwordx4 v[196:199], v122, s[28:31], s67 offen offset:256 sc1
 v_exp_f32 v181, v181
 v_exp_f32 v182, v182
 v_exp_f32 v183, v183
 v_exp_f32 v184, v184
 v_exp_f32 v185, v185
 v_smfmac_f32_32x32x32_bf16 v[48:63], v[128:131], v[176:183], v112
 buffer_store_dwordx4 v[152:155], v126, s[28:31], s68 offen offset:0 sc1
 v_exp_f32 v186, v186
 v_exp_f32 v187, v187
 v_exp_f32 v188, v188
 v_exp_f32 v189, v189
 v_exp_f32 v190, v190
 v_exp_f32 v191, v191
 v_exp_f32 v160, v160
 v_exp_f32 v161, v161
 v_smfmac_f32_32x32x32_bf16 v[48:63], v[132:135], v[184:191], v112
 ds_read_b128 v[104:107], v113 offset:8192
 s_setprio 2
 v_exp_f32 v162, v162
 v_exp_f32 v163, v163
 v_exp_f32 v164, v164
 v_mfma_f32_32x32x16_bf16 v[176:191], v[108:111], v[148:151], 0
 v_exp_f32 v165, v165
 v_exp_f32 v166, v166
 v_exp_f32 v167, v167
 v_exp_f32 v168, v168
 v_exp_f32 v169, v169
 v_smfmac_f32_32x32x32_bf16 v[32:47], v[136:139], v[160:167], v112
 s_mov_b64 exec, s[96:97]
 ds_read_b128 v[128:131], v114 offset:9216
 ds_read_b128 v[132:135], v114 offset:9728
 s_mov_b64 exec, -1
 v_exp_f32 v170, v170
 v_exp_f32 v171, v171
 v_exp_f32 v172, v172
 v_exp_f32 v173, v173
 s_add_u32 m0, s53, 98304
 s_add_u32 s63, s66, 32768
 buffer_load_dwordx4 v126, s[28:31], s63 offen sc1 lds
 v_exp_f32 v174, v174
 v_exp_f32 v175, v175
 v_exp_f32 v176, v176
 v_exp_f32 v177, v177
 v_smfmac_f32_32x32x32_bf16 v[32:47], v[140:143], v[168:175], v112
 s_waitcnt lgkmcnt(0)
 v_exp_f32 v178, v178
 v_exp_f32 v179, v179
 v_exp_f32 v180, v180
 v_mfma_f32_32x32x16_bf16 v[160:175], v[104:107], v[144:147], 0
 s_add_u32 m0, s53, 106496
 s_add_u32 s63, s66, 40960
 buffer_load_dwordx4 v126, s[28:31], s63 offen sc1 lds
 v_exp_f32 v181, v181
 v_exp_f32 v182, v182
 v_exp_f32 v183, v183
 v_exp_f32 v184, v184
 v_exp_f32 v185, v185
 v_smfmac_f32_32x32x32_bf16 v[48:63], v[136:139], v[176:183], v112
 s_add_u32 m0, s53, 114688
 s_add_u32 s63, s66, 49152
 buffer_load_dwordx4 v126, s[28:31], s63 offen sc1 lds
 v_exp_f32 v186, v186
 v_exp_f32 v187, v187
 v_exp_f32 v188, v188
 v_exp_f32 v189, v189
 v_exp_f32 v190, v190
 v_exp_f32 v191, v191
 v_exp_f32 v160, v160
 v_exp_f32 v161, v161
 v_smfmac_f32_32x32x32_bf16 v[48:63], v[140:143], v[184:191], v112
 ds_read_b128 v[108:111], v113 offset:12288
 s_setprio 1
 v_exp_f32 v162, v162
 v_exp_f32 v163, v163
 v_exp_f32 v164, v164
 v_mfma_f32_32x32x16_bf16 v[176:191], v[104:107], v[148:151], 0
 v_exp_f32 v165, v165
 v_exp_f32 v166, v166
 v_exp_f32 v167, v167
 v_exp_f32 v168, v168
 v_exp_f32 v169, v169
 v_smfmac_f32_32x32x32_bf16 v[32:47], v[128:131], v[160:167], v112
 s_mov_b64 exec, s[96:97]
 ds_read_b128 v[136:139], v114 offset:13312
 ds_read_b128 v[140:143], v114 offset:13824
 s_mov_b64 exec, -1
 v_exp_f32 v170, v170
 v_exp_f32 v171, v171
 v_exp_f32 v172, v172
 v_exp_f32 v173, v173
 v_exp_f32 v174, v174
 v_exp_f32 v175, v175
 v_exp_f32 v176, v176
 v_exp_f32 v177, v177
 v_smfmac_f32_32x32x32_bf16 v[32:47], v[132:135], v[168:175], v112
 s_waitcnt lgkmcnt(0)
 v_exp_f32 v178, v178
 v_exp_f32 v179, v179
 v_exp_f32 v180, v180
 v_mfma_f32_32x32x16_bf16 v[160:175], v[108:111], v[144:147], 0
 s_add_u32 m0, s53, 122880
 s_add_u32 s63, s66, 57344
 buffer_load_dwordx4 v126, s[28:31], s63 offen sc1 lds
 v_exp_f32 v181, v181
 v_exp_f32 v182, v182
 v_exp_f32 v183, v183
 v_exp_f32 v184, v184
 v_exp_f32 v185, v185
 v_smfmac_f32_32x32x32_bf16 v[48:63], v[128:131], v[176:183], v112
 s_setprio 0
 s_add_u32 s82, s81, 0
 s_cmp_ge_u32 s82, 7
 s_cselect_b32 s63, 7, 0
 s_sub_u32 s82, s82, s63
 s_add_u32 m0, s53, 0
 s_lshl_b32 s82, s82, 16
 buffer_load_dwordx4 v116, s[32:35], s82 offen lds
 v_exp_f32 v186, v186
 v_exp_f32 v187, v187
 v_exp_f32 v188, v188
 v_exp_f32 v189, v189
 v_exp_f32 v190, v190
 v_exp_f32 v191, v191
 s_waitcnt vmcnt(8)
 s_barrier
 v_exp_f32 v160, v160
 v_exp_f32 v161, v161
 v_smfmac_f32_32x32x32_bf16 v[48:63], v[132:135], v[184:191], v112
 ds_read_b128 v[104:107], v113 offset:16384
 s_setprio 3
 v_exp_f32 v162, v162
 v_exp_f32 v163, v163
 v_exp_f32 v164, v164
 v_mfma_f32_32x32x16_bf16 v[176:191], v[108:111], v[148:151], 0
 v_exp_f32 v165, v165
 v_exp_f32 v166, v166
 v_exp_f32 v167, v167
 v_exp_f32 v168, v168
 v_exp_f32 v169, v169
 v_smfmac_f32_32x32x32_bf16 v[32:47], v[136:139], v[160:167], v112
 s_mov_b64 exec, s[96:97]
 ds_read_b128 v[128:131], v114 offset:17408
 ds_read_b128 v[132:135], v114 offset:17920
 s_mov_b64 exec, -1
 v_exp_f32 v170, v170
 v_exp_f32 v171, v171
 v_exp_f32 v172, v172
 v_exp_f32 v173, v173
 v_exp_f32 v174, v174
 v_exp_f32 v175, v175
 v_exp_f32 v176, v176
 v_exp_f32 v177, v177
 v_smfmac_f32_32x32x32_bf16 v[32:47], v[140:143], v[168:175], v112
 s_waitcnt lgkmcnt(0)
 v_exp_f32 v178, v178
 v_exp_f32 v179, v179
 v_exp_f32 v180, v180
 v_mfma_f32_32x32x16_bf16 v[160:175], v[104:107], v[144:147], 0
 v_exp_f32 v181, v181
 v_exp_f32 v182, v182
 v_exp_f32 v183, v183
 v_exp_f32 v184, v184
 v_exp_f32 v185, v185
 v_smfmac_f32_32x32x32_bf16 v[48:63], v[136:139], v[176:183], v112
 s_add_u32 m0, s53, 8192
 s_add_u32 s82, s82, 458752
 buffer_load_dwordx4 v116, s[32:35], s82 offen lds
 v_exp_f32 v186, v186
 v_exp_f32 v187, v187
 v_exp_f32 v188, v188
 v_exp_f32 v189, v189
 v_exp_f32 v190, v190
 v_exp_f32 v191, v191
 v_exp_f32 v160, v160
 v_exp_f32 v161, v161
 v_smfmac_f32_32x32x32_bf16 v[48:63], v[140:143], v[184:191], v112
 ds_read_b128 v[108:111], v113 offset:20480
 v_exp_f32 v162, v162
 v_exp_f32 v163, v163
 v_exp_f32 v164, v164
 v_mfma_f32_32x32x16_bf16 v[176:191], v[104:107], v[148:151], 0
 v_exp_f32 v165, v165
 v_exp_f32 v166, v166
 v_exp_f32 v167, v167
 v_exp_f32 v168, v168
 v_exp_f32 v169, v169
 v_smfmac_f32_32x32x32_bf16 v[32:47], v[128:131], v[160:167], v112
 s_mov_b64 exec, s[96:97]
 ds_read_b128 v[136:139], v114 offset:21504
 ds_read_b128 v[140:143], v114 offset:22016
 s_mov_b64 exec, -1
 v_exp_f32 v170, v170
 v_exp_f32 v171, v171
 v_exp_f32 v172, v172
 v_exp_f32 v173, v173
 v_exp_f32 v174, v174
 v_exp_f32 v175, v175
 v_exp_f32 v176, v176
 v_exp_f32 v177, v177
 v_smfmac_f32_32x32x32_bf16 v[32:47], v[132:135], v[168:175], v112
 s_waitcnt lgkmcnt(0)
 v_exp_f32 v178, v178
 v_exp_f32 v179, v179
 v_exp_f32 v180, v180
 v_mfma_f32_32x32x16_bf16 v[160:175], v[108:111], v[144:147], 0
 v_exp_f32 v181, v181
 v_exp_f32 v182, v182
 v_exp_f32 v183, v183
 v_exp_f32 v184, v184
 v_exp_f32 v185, v185
 v_smfmac_f32_32x32x32_bf16 v[48:63], v[128:131], v[176:183], v112
 s_add_u32 m0, s53, 16384
 s_add_u32 s82, s82, 458752
 buffer_load_dwordx4 v116, s[32:35], s82 offen lds
 v_exp_f32 v186, v186
 v_exp_f32 v187, v187
 v_exp_f32 v188, v188
 v_exp_f32 v189, v189
 v_exp_f32 v190, v190
 v_exp_f32 v191, v191
 v_exp_f32 v160, v160
 v_exp_f32 v161, v161
 v_smfmac_f32_32x32x32_bf16 v[48:63], v[132:135], v[184:191], v112
 ds_read_b128 v[104:107], v113 offset:24576
 s_setprio 2
 v_exp_f32 v162, v162
 v_exp_f32 v163, v163
 v_exp_f32 v164, v164
 v_mfma_f32_32x32x16_bf16 v[176:191], v[108:111], v[148:151], 0
 v_exp_f32 v165, v165
 v_exp_f32 v166, v166
 v_exp_f32 v167, v167
 v_exp_f32 v168, v168
 v_exp_f32 v169, v169
 v_smfmac_f32_32x32x32_bf16 v[32:47], v[136:139], v[160:167], v112
 s_mov_b64 exec, s[96:97]
 ds_read_b128 v[128:131], v114 offset:25600
 ds_read_b128 v[132:135], v114 offset:26112
 s_mov_b64 exec, -1
 v_exp_f32 v170, v170
 v_exp_f32 v171, v171
 v_exp_f32 v172, v172
 v_exp_f32 v173, v173
 v_exp_f32 v174, v174
 v_exp_f32 v175, v175
 v_exp_f32 v176, v176
 v_exp_f32 v177, v177
 v_smfmac_f32_32x32x32_bf16 v[32:47], v[140:143], v[168:175], v112
 s_waitcnt lgkmcnt(0)
 v_exp_f32 v178, v178
 v_exp_f32 v179, v179
 v_exp_f32 v180, v180
 v_mfma_f32_32x32x16_bf16 v[160:175], v[104:107], v[144:147], 0
 s_lshl_b32 s62, s70, 2
 s_add_u32 s62, s62, 4096
 s_waitcnt vmcnt(7)
 s_mov_b64 exec, 1
 buffer_store_dword v112, v126, s[28:31], s62 offen sc1
 s_mov_b64 exec, -1
 v_exp_f32 v181, v181
 v_exp_f32 v182, v182
 v_exp_f32 v183, v183
 v_exp_f32 v184, v184
 v_exp_f32 v185, v185
 v_smfmac_f32_32x32x32_bf16 v[48:63], v[136:139], v[176:183], v112
 s_add_u32 m0, s53, 24576
 s_add_u32 s82, s82, 458752
 buffer_load_dwordx4 v116, s[32:35], s82 offen lds
 v_exp_f32 v186, v186
 v_exp_f32 v187, v187
 v_exp_f32 v188, v188
 v_exp_f32 v189, v189
 v_exp_f32 v190, v190
 v_exp_f32 v191, v191
 v_exp_f32 v160, v160
 v_exp_f32 v161, v161
 v_smfmac_f32_32x32x32_bf16 v[48:63], v[140:143], v[184:191], v112
 ds_read_b128 v[108:111], v113 offset:28672
 s_setprio 1
 v_exp_f32 v162, v162
 v_exp_f32 v163, v163
 v_exp_f32 v164, v164
 v_mfma_f32_32x32x16_bf16 v[176:191], v[104:107], v[148:151], 0
 v_exp_f32 v165, v165
 v_exp_f32 v166, v166
 v_exp_f32 v167, v167
 v_exp_f32 v168, v168
 v_exp_f32 v169, v169
 v_smfmac_f32_32x32x32_bf16 v[32:47], v[128:131], v[160:167], v112
 s_mov_b64 exec, s[96:97]
 ds_read_b128 v[136:139], v114 offset:29696
 ds_read_b128 v[140:143], v114 offset:30208
 s_mov_b64 exec, -1
 v_exp_f32 v170, v170
 v_exp_f32 v171, v171
 v_exp_f32 v172, v172
 v_exp_f32 v173, v173
 v_exp_f32 v174, v174
 v_exp_f32 v175, v175
 v_exp_f32 v176, v176
 v_exp_f32 v177, v177
 v_smfmac_f32_32x32x32_bf16 v[32:47], v[132:135], v[168:175], v112
 s_waitcnt lgkmcnt(0)
 v_exp_f32 v178, v178
 v_exp_f32 v179, v179
 v_exp_f32 v180, v180
 v_mfma_f32_32x32x16_bf16 v[160:175], v[108:111], v[144:147], 0
 v_exp_f32 v181, v181
 v_exp_f32 v182, v182
 v_exp_f32 v183, v183
 v_exp_f32 v184, v184
 v_exp_f32 v185, v185
 v_smfmac_f32_32x32x32_bf16 v[48:63], v[128:131], v[176:183], v112
 s_setprio 0
 s_add_u32 s82, s81, 1
 s_cmp_ge_u32 s82, 7
 s_cselect_b32 s63, 7, 0
 s_sub_u32 s82, s82, s63
 s_add_u32 m0, s53, 32768
 s_lshl_b32 s82, s82, 16
 buffer_load_dwordx4 v116, s[32:35], s82 offen lds
 v_exp_f32 v186, v186
 v_exp_f32 v187, v187
 v_exp_f32 v188, v188
 v_exp_f32 v189, v189
 v_exp_f32 v190, v190
 v_exp_f32 v191, v191
 s_waitcnt vmcnt(6)
 s_barrier
 v_exp_f32 v160, v160
 v_exp_f32 v161, v161
 v_smfmac_f32_32x32x32_bf16 v[48:63], v[132:135], v[184:191], v112
 ds_read_b128 v[104:107], v113 offset:32768
 s_setprio 3
 v_exp_f32 v162, v162
 v_exp_f32 v163, v163
 v_exp_f32 v164, v164
 v_mfma_f32_32x32x16_bf16 v[176:191], v[108:111], v[148:151], 0
 v_exp_f32 v165, v165
 v_exp_f32 v166, v166
 v_exp_f32 v167, v167
 v_exp_f32 v168, v168
 v_exp_f32 v169, v169
 v_smfmac_f32_32x32x32_bf16 v[32:47], v[136:139], v[160:167], v112
 s_mov_b64 exec, s[96:97]
 ds_read_b128 v[128:131], v114 offset:33792
 ds_read_b128 v[132:135], v114 offset:34304
 s_mov_b64 exec, -1
 v_exp_f32 v170, v170
 v_exp_f32 v171, v171
 v_exp_f32 v172, v172
 v_exp_f32 v173, v173
 v_exp_f32 v174, v174
 v_exp_f32 v175, v175
 v_exp_f32 v176, v176
 v_exp_f32 v177, v177
 v_smfmac_f32_32x32x32_bf16 v[32:47], v[140:143], v[168:175], v112
 s_waitcnt lgkmcnt(0)
 v_exp_f32 v178, v178
 v_exp_f32 v179, v179
 v_exp_f32 v180, v180
 v_mfma_f32_32x32x16_bf16 v[160:175], v[104:107], v[144:147], 0
 s_add_u32 m0, s53, 65536
 s_add_u32 s63, s66, 65536
 buffer_load_dwordx4 v126, s[28:31], s63 offen sc1 lds
 v_exp_f32 v181, v181
 v_exp_f32 v182, v182
 v_exp_f32 v183, v183
 v_exp_f32 v184, v184
 v_exp_f32 v185, v185
 v_smfmac_f32_32x32x32_bf16 v[48:63], v[136:139], v[176:183], v112
 s_add_u32 m0, s53, 73728
 s_add_u32 s63, s66, 73728
 buffer_load_dwordx4 v126, s[28:31], s63 offen sc1 lds
 v_exp_f32 v186, v186
 v_exp_f32 v187, v187
 v_exp_f32 v188, v188
 v_exp_f32 v189, v189
 v_exp_f32 v190, v190
 v_exp_f32 v191, v191
 v_exp_f32 v160, v160
 v_exp_f32 v161, v161
 v_smfmac_f32_32x32x32_bf16 v[48:63], v[140:143], v[184:191], v112
 ds_read_b128 v[108:111], v113 offset:36864
 v_exp_f32 v162, v162
 v_exp_f32 v163, v163
 v_exp_f32 v164, v164
 v_mfma_f32_32x32x16_bf16 v[176:191], v[104:107], v[148:151], 0
 v_exp_f32 v165, v165
 v_exp_f32 v166, v166
 v_exp_f32 v167, v167
 v_exp_f32 v168, v168
 v_exp_f32 v169, v169
 v_smfmac_f32_32x32x32_bf16 v[32:47], v[128:131], v[160:167], v112
 s_mov_b64 exec, s[96:97]
 ds_read_b128 v[136:139], v114 offset:37888
 ds_read_b128 v[140:143], v114 offset:38400
 s_mov_b64 exec, -1
 v_exp_f32 v170, v170
 v_exp_f32 v171, v171
 v_exp_f32 v172, v172
 v_exp_f32 v173, v173
 v_exp_f32 v174, v174
 v_exp_f32 v175, v175
 v_exp_f32 v176, v176
 v_exp_f32 v177, v177
 v_smfmac_f32_32x32x32_bf16 v[32:47], v[132:135], v[168:175], v112
 s_waitcnt lgkmcnt(0)
 v_exp_f32 v178, v178
 v_exp_f32 v179, v179
 v_exp_f32 v180, v180
 v_mfma_f32_32x32x16_bf16 v[160:175], v[108:111], v[144:147], 0
 s_add_u32 m0, s53, 81920
 s_add_u32 s63, s66, 81920
 buffer_load_dwordx4 v126, s[28:31], s63 offen sc1 lds
 v_exp_f32 v181, v181
 v_exp_f32 v182, v182
 v_exp_f32 v183, v183
 v_exp_f32 v184, v184
 v_exp_f32 v185, v185
 v_smfmac_f32_32x32x32_bf16 v[48:63], v[128:131], v[176:183], v112
 s_add_u32 m0, s53, 90112
 s_add_u32 s63, s66, 90112
 buffer_load_dwordx4 v126, s[28:31], s63 offen sc1 lds
 v_exp_f32 v186, v186
 v_exp_f32 v187, v187
 v_exp_f32 v188, v188
 v_exp_f32 v189, v189
 v_exp_f32 v190, v190
 v_exp_f32 v191, v191
 v_exp_f32 v160, v160
 v_exp_f32 v161, v161
 v_smfmac_f32_32x32x32_bf16 v[48:63], v[132:135], v[184:191], v112
 ds_read_b128 v[104:107], v113 offset:40960
 v_exp_f32 v162, v162
 v_exp_f32 v163, v163
 v_exp_f32 v164, v164
 v_mfma_f32_32x32x16_bf16 v[176:191], v[108:111], v[148:151], 0
 v_exp_f32 v165, v165
 v_exp_f32 v166, v166
 v_exp_f32 v167, v167
 v_exp_f32 v168, v168
 v_exp_f32 v169, v169
 v_smfmac_f32_32x32x32_bf16 v[32:47], v[136:139], v[160:167], v112
 s_mov_b64 exec, s[96:97]
 ds_read_b128 v[128:131], v114 offset:41984
 ds_read_b128 v[132:135], v114 offset:42496
 s_mov_b64 exec, -1
 v_exp_f32 v170, v170
 v_exp_f32 v171, v171
 v_exp_f32 v172, v172
 v_exp_f32 v173, v173
 v_exp_f32 v174, v174
 v_exp_f32 v175, v175
 v_exp_f32 v176, v176
 v_exp_f32 v177, v177
 v_smfmac_f32_32x32x32_bf16 v[32:47], v[140:143], v[168:175], v112
 s_waitcnt lgkmcnt(0)
 v_exp_f32 v178, v178
 v_exp_f32 v179, v179
 v_exp_f32 v180, v180
 v_mfma_f32_32x32x16_bf16 v[160:175], v[104:107], v[144:147], 0
 s_add_u32 m0, s53, 40960
 s_add_u32 s82, s82, 458752
 buffer_load_dwordx4 v116, s[32:35], s82 offen lds
 v_exp_f32 v181, v181
 v_exp_f32 v182, v182
 v_exp_f32 v183, v183
 v_exp_f32 v184, v184
 v_exp_f32 v185, v185
 v_smfmac_f32_32x32x32_bf16 v[48:63], v[136:139], v[176:183], v112
 s_add_u32 m0, s53, 49152
 s_add_u32 s82, s82, 458752
 buffer_load_dwordx4 v116, s[32:35], s82 offen lds
 v_exp_f32 v186, v186
 v_exp_f32 v187, v187
 v_exp_f32 v188, v188
 v_exp_f32 v189, v189
 v_exp_f32 v190, v190
 v_exp_f32 v191, v191
 v_exp_f32 v160, v160
 v_exp_f32 v161, v161
 v_smfmac_f32_32x32x32_bf16 v[48:63], v[140:143], v[184:191], v112
 ds_read_b128 v[108:111], v113 offset:45056
 v_exp_f32 v162, v162
 v_exp_f32 v163, v163
 v_exp_f32 v164, v164
 v_mfma_f32_32x32x16_bf16 v[176:191], v[104:107], v[148:151], 0
 v_exp_f32 v165, v165
 v_exp_f32 v166, v166
 v_exp_f32 v167, v167
 v_exp_f32 v168, v168
 v_exp_f32 v169, v169
 v_smfmac_f32_32x32x32_bf16 v[32:47], v[128:131], v[160:167], v112
 s_mov_b64 exec, s[96:97]
 ds_read_b128 v[136:139], v114 offset:46080
 ds_read_b128 v[140:143], v114 offset:46592
 s_mov_b64 exec, -1
 v_exp_f32 v170, v170
 v_exp_f32 v171, v171
 v_exp_f32 v172, v172
 v_exp_f32 v173, v173
 v_exp_f32 v174, v174
 v_exp_f32 v175, v175
 v_exp_f32 v176, v176
 v_exp_f32 v177, v177
 v_smfmac_f32_32x32x32_bf16 v[32:47], v[132:135], v[168:175], v112
 s_waitcnt lgkmcnt(0)
 v_exp_f32 v178, v178
 v_exp_f32 v179, v179
 v_exp_f32 v180, v180
 v_mfma_f32_32x32x16_bf16 v[160:175], v[108:111], v[144:147], 0
 buffer_load_dword v118, v123, s[28:31], 0 offen sc1
 buffer_load_dword v121, v115, s[28:31], 0 offen sc1
 s_add_u32 m0, s53, 57344
 s_add_u32 s82, s82, 458752
 buffer_load_dwordx4 v116, s[32:35], s82 offen lds
 v_exp_f32 v181, v181
 v_exp_f32 v182, v182
 v_exp_f32 v183, v183
 v_exp_f32 v184, v184
 v_exp_f32 v185, v185
 v_smfmac_f32_32x32x32_bf16 v[48:63], v[128:131], v[176:183], v112
 s_add_u32 s82, s81, 2
 s_cmp_ge_u32 s82, 7
 s_cselect_b32 s63, 7, 0
 s_sub_u32 s82, s82, s63
 s_add_u32 m0, s53, 131072
 s_lshl_b32 s82, s82, 16
 buffer_load_dwordx4 v116, s[32:35], s82 offen lds
 v_exp_f32 v186, v186
 v_exp_f32 v187, v187
 v_exp_f32 v188, v188
 v_exp_f32 v189, v189
 v_exp_f32 v190, v190
 v_exp_f32 v191, v191
 v_exp_f32 v160, v160
 v_exp_f32 v161, v161
 v_smfmac_f32_32x32x32_bf16 v[48:63], v[132:135], v[184:191], v112
 ds_read_b128 v[104:107], v113 offset:49152
 s_setprio 2
 v_exp_f32 v162, v162
 v_exp_f32 v163, v163
 v_exp_f32 v164, v164
 v_mfma_f32_32x32x16_bf16 v[176:191], v[108:111], v[148:151], 0
 v_exp_f32 v165, v165
 v_exp_f32 v166, v166
 v_exp_f32 v167, v167
 v_exp_f32 v168, v168
 v_exp_f32 v169, v169
 v_smfmac_f32_32x32x32_bf16 v[32:47], v[136:139], v[160:167], v112
 s_mov_b64 exec, s[96:97]
 ds_read_b128 v[128:131], v114 offset:50176
 ds_read_b128 v[132:135], v114 offset:50688
 s_mov_b64 exec, -1
 v_exp_f32 v170, v170
 v_exp_f32 v171, v171
 v_exp_f32 v172, v172
 v_exp_f32 v173, v173
 v_exp_f32 v174, v174
 v_exp_f32 v175, v175
 v_exp_f32 v176, v176
 v_exp_f32 v177, v177
 v_smfmac_f32_32x32x32_bf16 v[32:47], v[140:143], v[168:175], v112
 s_waitcnt lgkmcnt(0)
 v_exp_f32 v178, v178
 v_exp_f32 v179, v179
 v_exp_f32 v180, v180
 v_mfma_f32_32x32x16_bf16 v[160:175], v[104:107], v[144:147], 0
 s_add_u32 m0, s53, 139264
 s_add_u32 s82, s82, 458752
 buffer_load_dwordx4 v116, s[32:35], s82 offen lds
 v_exp_f32 v181, v181
 v_exp_f32 v182, v182
 v_exp_f32 v183, v183
 v_exp_f32 v184, v184
 v_exp_f32 v185, v185
 v_smfmac_f32_32x32x32_bf16 v[48:63], v[136:139], v[176:183], v112
 s_add_u32 m0, s53, 147456
 s_add_u32 s82, s82, 458752
 buffer_load_dwordx4 v116, s[32:35], s82 offen lds
 v_exp_f32 v186, v186
 v_exp_f32 v187, v187
 v_exp_f32 v188, v188
 v_exp_f32 v189, v189
 v_exp_f32 v190, v190
 v_exp_f32 v191, v191
 s_waitcnt vmcnt(4)
 v_cmp_eq_u32 vcc, 0, v121
 s_nop 0
 s_cmp_lg_u64 vcc, 0
 s_cbranch_scc1 L_x_2018
L_r_2019:
 v_cmp_eq_u32 vcc, 0, v118
 s_nop 0
 s_cmp_lg_u64 vcc, 0
 s_cbranch_scc1 L_x_2021
L_r_2022:
 v_exp_f32 v160, v160
 v_exp_f32 v161, v161
 v_smfmac_f32_32x32x32_bf16 v[48:63], v[140:143], v[184:191], v112
 ds_read_b128 v[108:111], v113 offset:53248
 v_exp_f32 v162, v162
 v_exp_f32 v163, v163
 v_exp_f32 v164, v164
 v_mfma_f32_32x32x16_bf16 v[176:191], v[104:107], v[148:151], 0
 v_exp_f32 v165, v165
 v_exp_f32 v166, v166
 v_exp_f32 v167, v167
 v_exp_f32 v168, v168
 v_exp_f32 v169, v169
 v_smfmac_f32_32x32x32_bf16 v[32:47], v[128:131], v[160:167], v112
 s_mov_b64 exec, s[96:97]
 ds_read_b128 v[136:139], v114 offset:54272
 ds_read_b128 v[140:143], v114 offset:54784
 s_mov_b64 exec, -1
 v_exp_f32 v170, v170
 v_exp_f32 v171, v171
 v_exp_f32 v172, v172
 v_exp_f32 v173, v173
 v_exp_f32 v174, v174
 v_exp_f32 v175, v175
 v_exp_f32 v118, -v118
 v_exp_f32 v176, v176
 v_exp_f32 v177, v177
 v_smfmac_f32_32x32x32_bf16 v[32:47], v[132:135], v[168:175], v112
 s_waitcnt lgkmcnt(0)
 v_exp_f32 v178, v178
 v_exp_f32 v179, v179
 v_exp_f32 v180, v180
 v_mfma_f32_32x32x16_bf16 v[160:175], v[108:111], v[144:147], 0
 s_add_u32 s83, s81, 0
 s_cmp_ge_u32 s83, 7
 s_cselect_b32 s63, 7, 0
 s_sub_u32 s83, s83, s63
 s_lshl_b32 s83, s83, 12
 s_add_u32 s83, s83, s69
 buffer_load_dwordx4 v[16:19], v122, s[28:31], s83 offen offset:0 sc1
 v_exp_f32 v181, v181
 v_exp_f32 v182, v182
 v_exp_f32 v183, v183
 v_exp_f32 v184, v184
 v_exp_f32 v185, v185
 v_smfmac_f32_32x32x32_bf16 v[48:63], v[128:131], v[176:183], v112
 buffer_load_dwordx4 v[20:23], v122, s[28:31], s83 offen offset:2048 sc1
 v_add_f32 v118, 1.0, v118
 v_rcp_f32 v118, v118
 v_exp_f32 v186, v186
 v_exp_f32 v187, v187
 v_exp_f32 v188, v188
 v_exp_f32 v189, v189
 v_exp_f32 v190, v190
 v_exp_f32 v191, v191
 v_exp_f32 v160, v160
 v_exp_f32 v161, v161
 v_smfmac_f32_32x32x32_bf16 v[48:63], v[132:135], v[184:191], v112
 ds_read_b128 v[104:107], v113 offset:57344
 v_exp_f32 v162, v162
 v_exp_f32 v163, v163
 v_exp_f32 v164, v164
 v_mfma_f32_32x32x16_bf16 v[176:191], v[108:111], v[148:151], 0
 v_exp_f32 v165, v165
 v_exp_f32 v166, v166
 v_exp_f32 v167, v167
 v_exp_f32 v168, v168
 v_exp_f32 v169, v169
 v_smfmac_f32_32x32x32_bf16 v[32:47], v[136:139], v[160:167], v112
 s_mov_b64 exec, s[96:97]
 ds_read_b128 v[128:131], v114 offset:58368
 ds_read_b128 v[132:135], v114 offset:58880
 s_mov_b64 exec, -1
 v_exp_f32 v170, v170
 v_exp_f32 v171, v171
 v_exp_f32 v172, v172
 v_exp_f32 v173, v173
 v_exp_f32 v174, v174
 v_exp_f32 v175, v175
 v_exp_f32 v176, v176
 v_exp_f32 v177, v177
 v_smfmac_f32_32x32x32_bf16 v[32:47], v[140:143], v[168:175], v112
 s_waitcnt lgkmcnt(0)
 s_setprio 1
 v_exp_f32 v178, v178
 v_exp_f32 v179, v179
 v_exp_f32 v180, v180
 v_mfma_f32_32x32x16_bf16 v[160:175], v[104:107], v[144:147], 0
 s_cmp_lg_u32 s72, 1
 s_cbranch_scc1 L_s_2024
 s_and_b32 s62, s71, 7
 s_lshl_b32 s62, s62, 16
 buffer_load_dword v125, v117, s[36:39], s62 offen
L_s_2024:
 buffer_load_dwordx4 v[24:27], v122, s[28:31], s83 offen offset:256 sc1
 v_exp_f32 v181, v181
 v_exp_f32 v182, v182
 v_exp_f32 v183, v183
 v_exp_f32 v184, v184
 v_exp_f32 v185, v185
 v_smfmac_f32_32x32x32_bf16 v[48:63], v[136:139], v[176:183], v112
 buffer_load_dwordx4 v[28:31], v122, s[28:31], s83 offen offset:2304 sc1
 v_exp_f32 v186, v186
 v_exp_f32 v187, v187
 v_exp_f32 v188, v188
 v_exp_f32 v189, v189
 v_exp_f32 v190, v190
 v_exp_f32 v191, v191
 v_exp_f32 v160, v160
 v_exp_f32 v161, v161
 v_smfmac_f32_32x32x32_bf16 v[48:63], v[140:143], v[184:191], v112
 ds_read_b128 v[108:111], v113 offset:61440
 v_exp_f32 v162, v162
 v_exp_f32 v163, v163
 v_exp_f32 v164, v164
 v_mfma_f32_32x32x16_bf16 v[176:191], v[104:107], v[148:151], 0
 v_exp_f32 v165, v165
 v_exp_f32 v166, v166
 v_exp_f32 v167, v167
 v_exp_f32 v168, v168
 v_exp_f32 v169, v169
 v_smfmac_f32_32x32x32_bf16 v[32:47], v[128:131], v[160:167], v112
 s_mov_b64 exec, s[96:97]
 ds_read_b128 v[136:139], v114 offset:62464
 ds_read_b128 v[140:143], v114 offset:62976
 s_mov_b64 exec, -1
 v_exp_f32 v170, v170
 v_exp_f32 v171, v171
 v_exp_f32 v172, v172
 v_exp_f32 v173, v173
 s_add_u32 s83, s81, 1
 s_cmp_ge_u32 s83, 7
 s_cselect_b32 s63, 7, 0
 s_sub_u32 s83, s83, s63
 s_lshl_b32 s83, s83, 12
 s_add_u32 s83, s83, s69
 buffer_load_dwordx4 v[64:67], v122, s[28:31], s83 offen offset:0 sc1
 v_exp_f32 v174, v174
 v_exp_f32 v175, v175
 v_exp_f32 v176, v176
 v_exp_f32 v177, v177
 v_smfmac_f32_32x32x32_bf16 v[32:47], v[132:135], v[168:175], v112
 s_waitcnt lgkmcnt(0)
 v_exp_f32 v178, v178
 v_exp_f32 v179, v179
 v_exp_f32 v180, v180
 v_mfma_f32_32x32x16_bf16 v[160:175], v[108:111], v[144:147], 0
 buffer_load_dwordx4 v[68:71], v122, s[28:31], s83 offen offset:2048 sc1
 v_exp_f32 v181, v181
 v_exp_f32 v182, v182
 v_exp_f32 v183, v183
 v_exp_f32 v184, v184
 v_exp_f32 v185, v185
 v_smfmac_f32_32x32x32_bf16 v[48:63], v[128:131], v[176:183], v112
 s_setprio 0
 s_add_u32 m0, s53, 155648
 s_add_u32 s82, s82, 458752
 buffer_load_dwordx4 v116, s[32:35], s82 offen lds
 v_exp_f32 v186, v186
 v_exp_f32 v187, v187
 v_exp_f32 v188, v188
 v_exp_f32 v189, v189
 v_exp_f32 v190, v190
 v_exp_f32 v191, v191
 s_waitcnt vmcnt(10)
 s_barrier
 v_exp_f32 v160, v160
 v_exp_f32 v161, v161
 v_smfmac_f32_32x32x32_bf16 v[48:63], v[132:135], v[184:191], v112
 ds_read_b128 v[104:107], v113 offset:0
 s_setprio 3
 v_exp_f32 v162, v162
 v_exp_f32 v163, v163
 v_exp_f32 v164, v164
 v_mfma_f32_32x32x16_bf16 v[176:191], v[108:111], v[148:151], 0
 ds_read_b64_tr_b16 v[88:89], v124 offset:0
 ds_read_b64_tr_b16 v[90:91], v124 offset:2048
 v_exp_f32 v165, v165
 v_exp_f32 v166, v166
 v_exp_f32 v167, v167
 v_exp_f32 v168, v168
 v_exp_f32 v169, v169
 v_smfmac_f32_32x32x32_bf16 v[32:47], v[136:139], v[160:167], v112
 ds_read_b64_tr_b16 v[92:93], v124 offset:4096
 ds_read_b64_tr_b16 v[94:95], v124 offset:6144
 s_mov_b64 exec, s[96:97]
 ds_read_b128 v[128:131], v114 offset:1024
 ds_read_b128 v[132:135], v114 offset:1536
 s_mov_b64 exec, -1
 v_exp_f32 v170, v170
 v_exp_f32 v171, v171
 v_exp_f32 v172, v172
 v_exp_f32 v173, v173
 buffer_load_dwordx4 v[72:75], v122, s[28:31], s83 offen offset:256 sc1
 v_exp_f32 v174, v174
 v_exp_f32 v175, v175
 v_exp_f32 v176, v176
 v_exp_f32 v177, v177
 v_smfmac_f32_32x32x32_bf16 v[32:47], v[140:143], v[168:175], v112
 s_waitcnt lgkmcnt(0)
 v_exp_f32 v178, v178
 v_exp_f32 v179, v179
 v_exp_f32 v180, v180
 v_mfma_f32_32x32x16_bf16 v[160:175], v[104:107], v[144:147], 0
 buffer_load_dwordx4 v[76:79], v122, s[28:31], s83 offen offset:2304 sc1
 v_exp_f32 v181, v181
 v_exp_f32 v182, v182
 v_exp_f32 v183, v183
 v_exp_f32 v184, v184
 v_exp_f32 v185, v185
 v_smfmac_f32_32x32x32_bf16 v[48:63], v[136:139], v[176:183], v112
 s_add_u32 m0, s53, 98304
 s_add_u32 s63, s66, 98304
 buffer_load_dwordx4 v126, s[28:31], s63 offen sc1 lds
 v_exp_f32 v186, v186
 v_exp_f32 v187, v187
 v_exp_f32 v188, v188
 v_exp_f32 v189, v189
 s_waitcnt vmcnt(8)
 v_mfma_f32_16x16x32_bf16 v[224:227], v[88:91], v[16:19], 0
 v_mfma_f32_16x16x32_bf16 v[224:227], v[92:95], v[20:23], v[224:227]
 v_exp_f32 v190, v190
 v_exp_f32 v191, v191
 v_exp_f32 v160, v160
 v_exp_f32 v161, v161
 v_smfmac_f32_32x32x32_bf16 v[48:63], v[140:143], v[184:191], v112
 ds_read_b128 v[108:111], v113 offset:4096
 v_exp_f32 v162, v162
 v_exp_f32 v163, v163
 v_exp_f32 v164, v164
 v_mfma_f32_32x32x16_bf16 v[176:191], v[104:107], v[148:151], 0
 ds_read_b64_tr_b16 v[96:97], v1 offset:0
 ds_read_b64_tr_b16 v[98:99], v1 offset:2048
 v_exp_f32 v165, v165
 v_exp_f32 v166, v166
 v_exp_f32 v167, v167
 v_exp_f32 v168, v168
 v_exp_f32 v169, v169
 v_smfmac_f32_32x32x32_bf16 v[32:47], v[128:131], v[160:167], v112
 ds_read_b64_tr_b16 v[100:101], v1 offset:4096
 ds_read_b64_tr_b16 v[102:103], v1 offset:6144
 s_mov_b64 exec, s[96:97]
 ds_read_b128 v[136:139], v114 offset:5120
 ds_read_b128 v[140:143], v114 offset:5632
 s_mov_b64 exec, -1
 v_exp_f32 v170, v170
 v_exp_f32 v171, v171
 v_exp_f32 v172, v172
 v_exp_f32 v173, v173
 s_waitcnt vmcnt(6)
 v_mfma_f32_16x16x32_bf16 v[228:231], v[88:91], v[24:27], 0
 v_mfma_f32_16x16x32_bf16 v[228:231], v[92:95], v[28:31], v[228:231]
 s_add_u32 s83, s81, 2
 s_cmp_ge_u32 s83, 7
 s_cselect_b32 s63, 7, 0
 s_sub_u32 s83, s83, s63
 s_lshl_b32 s83, s83, 12
 s_add_u32 s83, s83, s69
 buffer_load_dwordx4 v[80:83], v122, s[28:31], s83 offen offset:0 sc1
 v_exp_f32 v174, v174
 v_exp_f32 v175, v175
 v_exp_f32 v176, v176
 v_exp_f32 v177, v177
 v_smfmac_f32_32x32x32_bf16 v[32:47], v[132:135], v[168:175], v112
 s_waitcnt lgkmcnt(0)
 v_exp_f32 v178, v178
 v_exp_f32 v179, v179
 v_exp_f32 v180, v180
 v_mfma_f32_32x32x16_bf16 v[160:175], v[108:111], v[144:147], 0
 buffer_load_dwordx4 v[84:87], v122, s[28:31], s83 offen offset:2048 sc1
 v_exp_f32 v181, v181
 v_exp_f32 v182, v182
 v_exp_f32 v183, v183
 v_exp_f32 v184, v184
 v_exp_f32 v185, v185
 v_smfmac_f32_32x32x32_bf16 v[48:63], v[128:131], v[176:183], v112
 s_add_u32 m0, s53, 106496
 s_add_u32 s63, s66, 106496
 buffer_load_dwordx4 v126, s[28:31], s63 offen sc1 lds
 v_exp_f32 v186, v186
 v_exp_f32 v187, v187
 v_exp_f32 v188, v188
 v_exp_f32 v189, v189
 v_mfma_f32_16x16x32_bf16 v[232:235], v[96:99], v[16:19], 0
 v_mfma_f32_16x16x32_bf16 v[232:235], v[100:103], v[20:23], v[232:235]
 v_exp_f32 v190, v190
 v_exp_f32 v191, v191
 v_exp_f32 v160, v160
 v_exp_f32 v161, v161
 v_smfmac_f32_32x32x32_bf16 v[48:63], v[132:135], v[184:191], v112
 ds_read_b128 v[104:107], v113 offset:8192
 v_exp_f32 v162, v162
 v_exp_f32 v163, v163
 v_exp_f32 v164, v164
 v_mfma_f32_32x32x16_bf16 v[176:191], v[108:111], v[148:151], 0
 ds_read_b64_tr_b16 v[88:89], v2 offset:0
 ds_read_b64_tr_b16 v[90:91], v2 offset:2048
 v_exp_f32 v165, v165
 v_exp_f32 v166, v166
 v_exp_f32 v167, v167
 v_exp_f32 v168, v168
 v_exp_f32 v169, v169
 v_smfmac_f32_32x32x32_bf16 v[32:47], v[136:139], v[160:167], v112
 ds_read_b64_tr_b16 v[92:93], v2 offset:4096
 ds_read_b64_tr_b16 v[94:95], v2 offset:6144
 s_mov_b64 exec, s[96:97]
 ds_read_b128 v[128:131], v114 offset:9216
 ds_read_b128 v[132:135], v114 offset:9728
 s_mov_b64 exec, -1
 v_exp_f32 v170, v170
 v_exp_f32 v171, v171
 v_exp_f32 v172, v172
 v_exp_f32 v173, v173
 v_mfma_f32_16x16x32_bf16 v[236:239], v[96:99], v[24:27], 0
 v_mfma_f32_16x16x32_bf16 v[236:239], v[100:103], v[28:31], v[236:239]
 buffer_load_dwordx4 v[152:155], v122, s[28:31], s83 offen offset:256 sc1
 v_exp_f32 v174, v174
 v_exp_f32 v175, v175
 v_exp_f32 v176, v176
 v_exp_f32 v177, v177
 v_smfmac_f32_32x32x32_bf16 v[32:47], v[140:143], v[168:175], v112
 s_waitcnt lgkmcnt(0)
 v_exp_f32 v178, v178
 v_exp_f32 v179, v179
 v_exp_f32 v180, v180
 v_mfma_f32_32x32x16_bf16 v[160:175], v[104:107], v[144:147], 0
 buffer_load_dwordx4 v[156:159], v122, s[28:31], s83 offen offset:2304 sc1
 v_exp_f32 v181, v181
 v_exp_f32 v182, v182
 v_exp_f32 v183, v183
 v_exp_f32 v184, v184
 v_exp_f32 v185, v185
 v_smfmac_f32_32x32x32_bf16 v[48:63], v[136:139], v[176:183], v112
 s_add_u32 m0, s53, 114688
 s_add_u32 s63, s66, 114688
 buffer_load_dwordx4 v126, s[28:31], s63 offen sc1 lds
 v_exp_f32 v186, v186
 v_exp_f32 v187, v187
 v_exp_f32 v188, v188
 v_exp_f32 v189, v189
 v_mfma_f32_16x16x32_bf16 v[240:243], v[88:91], v[16:19], 0
 v_mfma_f32_16x16x32_bf16 v[240:243], v[92:95], v[20:23], v[240:243]
 v_exp_f32 v190, v190
 v_exp_f32 v191, v191
 v_exp_f32 v160, v160
 v_exp_f32 v161, v161
 v_smfmac_f32_32x32x32_bf16 v[48:63], v[140:143], v[184:191], v112
 ds_read_b128 v[108:111], v113 offset:12288
 v_exp_f32 v162, v162
 v_exp_f32 v163, v163
 v_exp_f32 v164, v164
 v_mfma_f32_32x32x16_bf16 v[176:191], v[104:107], v[148:151], 0
 ds_read_b64_tr_b16 v[96:97], v3 offset:0
 ds_read_b64_tr_b16 v[98:99], v3 offset:2048
 v_exp_f32 v165, v165
 v_exp_f32 v166, v166
 v_exp_f32 v167, v167
 v_exp_f32 v168, v168
 v_exp_f32 v169, v169
 v_smfmac_f32_32x32x32_bf16 v[32:47], v[128:131], v[160:167], v112
 ds_read_b64_tr_b16 v[100:101], v3 offset:4096
 ds_read_b64_tr_b16 v[102:103], v3 offset:6144
 s_mov_b64 exec, s[96:97]
 ds_read_b128 v[136:139], v114 offset:13312
 ds_read_b128 v[140:143], v114 offset:13824
 s_mov_b64 exec, -1
 v_exp_f32 v170, v170
 v_exp_f32 v171, v171
 v_exp_f32 v172, v172
 v_exp_f32 v173, v173
 v_mfma_f32_16x16x32_bf16 v[244:247], v[88:91], v[24:27], 0
 v_mfma_f32_16x16x32_bf16 v[244:247], v[92:95], v[28:31], v[244:247]
 s_add_u32 s83, s81, 3
 s_cmp_ge_u32 s83, 7
 s_cselect_b32 s63, 7, 0
 s_sub_u32 s83, s83, s63
 s_lshl_b32 s83, s83, 12
 s_add_u32 s83, s83, s69
 buffer_load_dwordx4 v[192:195], v122, s[28:31], s83 offen offset:0 sc1
 v_exp_f32 v174, v174
 v_exp_f32 v175, v175
 v_exp_f32 v176, v176
 v_exp_f32 v177, v177
 v_smfmac_f32_32x32x32_bf16 v[32:47], v[132:135], v[168:175], v112
 s_waitcnt lgkmcnt(0)
 v_exp_f32 v178, v178
 v_exp_f32 v179, v179
 v_exp_f32 v180, v180
 v_mfma_f32_32x32x16_bf16 v[160:175], v[108:111], v[144:147], 0
 buffer_load_dwordx4 v[196:199], v122, s[28:31], s83 offen offset:2048 sc1
 v_exp_f32 v181, v181
 v_exp_f32 v182, v182
 v_exp_f32 v183, v183
 v_exp_f32 v184, v184
 v_exp_f32 v185, v185
 v_smfmac_f32_32x32x32_bf16 v[48:63], v[128:131], v[176:183], v112
 s_add_u32 m0, s53, 122880
 s_add_u32 s63, s66, 122880
 buffer_load_dwordx4 v126, s[28:31], s63 offen sc1 lds
 v_exp_f32 v186, v186
 v_exp_f32 v187, v187
 v_exp_f32 v188, v188
 v_exp_f32 v189, v189
 v_mfma_f32_16x16x32_bf16 v[248:251], v[96:99], v[16:19], 0
 v_mfma_f32_16x16x32_bf16 v[248:251], v[100:103], v[20:23], v[248:251]
 v_exp_f32 v190, v190
 v_exp_f32 v191, v191
 v_exp_f32 v160, v160
 v_exp_f32 v161, v161
 v_smfmac_f32_32x32x32_bf16 v[48:63], v[132:135], v[184:191], v112
 ds_read_b128 v[104:107], v113 offset:16384
 s_setprio 2
 v_exp_f32 v162, v162
 v_exp_f32 v163, v163
 v_exp_f32 v164, v164
 v_mfma_f32_32x32x16_bf16 v[176:191], v[108:111], v[148:151], 0
 ds_read_b64_tr_b16 v[88:89], v124 offset:32768
 ds_read_b64_tr_b16 v[90:91], v124 offset:34816
 v_exp_f32 v165, v165
 v_exp_f32 v166, v166
 v_exp_f32 v167, v167
 v_exp_f32 v168, v168
 v_exp_f32 v169, v169
 v_smfmac_f32_32x32x32_bf16 v[32:47], v[136:139], v[160:167], v112
 ds_read_b64_tr_b16 v[92:93], v124 offset:36864
 ds_read_b64_tr_b16 v[94:95], v124 offset:38912
 s_mov_b64 exec, s[96:97]
 ds_read_b128 v[128:131], v114 offset:17408
 ds_read_b128 v[132:135], v114 offset:17920
 s_mov_b64 exec, -1
 v_exp_f32 v170, v170
 v_exp_f32 v171, v171
 v_exp_f32 v172, v172
 v_exp_f32 v173, v173
 v_mfma_f32_16x16x32_bf16 v[252:255], v[96:99], v[24:27], 0
 v_mfma_f32_16x16x32_bf16 v[252:255], v[100:103], v[28:31], v[252:255]
 buffer_load_dwordx4 v[200:203], v122, s[28:31], s83 offen offset:256 sc1
 v_exp_f32 v174, v174
 v_exp_f32 v175, v175
 v_exp_f32 v176, v176
 v_exp_f32 v177, v177
 v_smfmac_f32_32x32x32_bf16 v[32:47], v[140:143], v[168:175], v112
 s_waitcnt lgkmcnt(0)
 v_exp_f32 v178, v178
 v_exp_f32 v179, v179
 v_exp_f32 v180, v180
 v_mfma_f32_32x32x16_bf16 v[160:175], v[104:107], v[144:147], 0
 buffer_load_dwordx4 v[204:207], v122, s[28:31], s83 offen offset:2304 sc1
 v_exp_f32 v181, v181
 v_exp_f32 v182, v182
 v_exp_f32 v183, v183
 v_exp_f32 v184, v184
 v_exp_f32 v185, v185
 v_smfmac_f32_32x32x32_bf16 v[48:63], v[136:139], v[176:183], v112
 s_add_u32 s83, s81, 4
 s_cmp_ge_u32 s83, 7
 s_cselect_b32 s63, 7, 0
 s_sub_u32 s83, s83, s63
 s_lshl_b32 s83, s83, 12
 s_add_u32 s83, s83, s69
 buffer_load_dwordx4 v[208:211], v122, s[28:31], s83 offen offset:0 sc1
 v_exp_f32 v186, v186
 v_exp_f32 v187, v187
 v_exp_f32 v188, v188
 v_exp_f32 v189, v189
 s_waitcnt vmcnt(16)
 v_mfma_f32_16x16x32_bf16 v[224:227], v[88:91], v[64:67], v[224:227]
 v_mfma_f32_16x16x32_bf16 v[224:227], v[92:95], v[68:71], v[224:227]
 v_exp_f32 v190, v190
 v_exp_f32 v191, v191
 v_exp_f32 v160, v160
 v_exp_f32 v161, v161
 v_smfmac_f32_32x32x32_bf16 v[48:63], v[140:143], v[184:191], v112
 ds_read_b128 v[108:111], v113 offset:20480
 v_exp_f32 v162, v162
 v_exp_f32 v163, v163
 v_exp_f32 v164, v164
 v_mfma_f32_32x32x16_bf16 v[176:191], v[104:107], v[148:151], 0
 ds_read_b64_tr_b16 v[96:97], v1 offset:32768
 ds_read_b64_tr_b16 v[98:99], v1 offset:34816
 v_exp_f32 v165, v165
 v_exp_f32 v166, v166
 v_exp_f32 v167, v167
 v_exp_f32 v168, v168
 v_exp_f32 v169, v169
 v_smfmac_f32_32x32x32_bf16 v[32:47], v[128:131], v[160:167], v112
 ds_read_b64_tr_b16 v[100:101], v1 offset:36864
 ds_read_b64_tr_b16 v[102:103], v1 offset:38912
 s_mov_b64 exec, s[96:97]
 ds_read_b128 v[136:139], v114 offset:21504
 ds_read_b128 v[140:143], v114 offset:22016
 s_mov_b64 exec, -1
 v_exp_f32 v170, v170
 v_exp_f32 v171, v171
 v_exp_f32 v172, v172
 v_exp_f32 v173, v173
 s_waitcnt vmcnt(13)
 v_mfma_f32_16x16x32_bf16 v[228:231], v[88:91], v[72:75], v[228:231]
 v_mfma_f32_16x16x32_bf16 v[228:231], v[92:95], v[76:79], v[228:231]
 buffer_load_dwordx4 v[212:215], v122, s[28:31], s83 offen offset:2048 sc1
 v_exp_f32 v174, v174
 v_exp_f32 v175, v175
 v_exp_f32 v176, v176
 v_exp_f32 v177, v177
 v_smfmac_f32_32x32x32_bf16 v[32:47], v[132:135], v[168:175], v112
 s_waitcnt lgkmcnt(0)
 v_exp_f32 v178, v178
 v_exp_f32 v179, v179
 v_exp_f32 v180, v180
 v_mfma_f32_32x32x16_bf16 v[160:175], v[108:111], v[144:147], 0
 buffer_load_dwordx4 v[216:219], v122, s[28:31], s83 offen offset:256 sc1
 v_exp_f32 v181, v181
 v_exp_f32 v182, v182
 v_exp_f32 v183, v183
 v_exp_f32 v184, v184
 v_exp_f32 v185, v185
 v_smfmac_f32_32x32x32_bf16 v[48:63], v[128:131], v[176:183], v112
 buffer_load_dwordx4 v[220:223], v122, s[28:31], s83 offen offset:2304 sc1
 v_exp_f32 v186, v186
 v_exp_f32 v187, v187
 v_exp_f32 v188, v188
 v_exp_f32 v189, v189
 v_mfma_f32_16x16x32_bf16 v[232:235], v[96:99], v[64:67], v[232:235]
 v_mfma_f32_16x16x32_bf16 v[232:235], v[100:103], v[68:71], v[232:235]
 v_exp_f32 v190, v190
 v_exp_f32 v191, v191
 v_exp_f32 v160, v160
 v_exp_f32 v161, v161
 v_smfmac_f32_32x32x32_bf16 v[48:63], v[132:135], v[184:191], v112
 ds_read_b128 v[104:107], v113 offset:24576
 v_exp_f32 v162, v162
 v_exp_f32 v163, v163
 v_exp_f32 v164, v164
 v_mfma_f32_32x32x16_bf16 v[176:191], v[108:111], v[148:151], 0
 ds_read_b64_tr_b16 v[88:89], v2 offset:32768
 ds_read_b64_tr_b16 v[90:91], v2 offset:34816
 v_exp_f32 v165, v165
 v_exp_f32 v166, v166
 v_exp_f32 v167, v167
 v_exp_f32 v168, v168
 v_exp_f32 v169, v169
 v_smfmac_f32_32x32x32_bf16 v[32:47], v[136:139], v[160:167], v112
 ds_read_b64_tr_b16 v[92:93], v2 offset:36864
 ds_read_b64_tr_b16 v[94:95], v2 offset:38912
 s_mov_b64 exec, s[96:97]
 ds_read_b128 v[128:131], v114 offset:25600
 ds_read_b128 v[132:135], v114 offset:26112
 s_mov_b64 exec, -1
 v_exp_f32 v170, v170
 v_exp_f32 v171, v171
 v_exp_f32 v172, v172
 v_exp_f32 v173, v173
 v_mfma_f32_16x16x32_bf16 v[236:239], v[96:99], v[72:75], v[236:239]
 v_mfma_f32_16x16x32_bf16 v[236:239], v[100:103], v[76:79], v[236:239]
 s_add_u32 s83, s81, 5
 s_cmp_ge_u32 s83, 7
 s_cselect_b32 s63, 7, 0
 s_sub_u32 s83, s83, s63
 s_lshl_b32 s83, s83, 12
 s_add_u32 s83, s83, s69
 buffer_load_dwordx4 v[16:19], v122, s[28:31], s83 offen offset:0 sc1
 v_exp_f32 v174, v174
 v_exp_f32 v175, v175
 v_exp_f32 v176, v176
 v_exp_f32 v177, v177
 v_smfmac_f32_32x32x32_bf16 v[32:47], v[140:143], v[168:175], v112
 s_waitcnt lgkmcnt(0)
 s_setprio 1
 v_exp_f32 v178, v178
 v_exp_f32 v179, v179
 v_exp_f32 v180, v180
 v_mfma_f32_32x32x16_bf16 v[160:175], v[104:107], v[144:147], 0
 buffer_load_dwordx4 v[20:23], v122, s[28:31], s83 offen offset:2048 sc1
 v_exp_f32 v181, v181
 v_exp_f32 v182, v182
 v_exp_f32 v183, v183
 v_exp_f32 v184, v184
 v_exp_f32 v185, v185
 v_smfmac_f32_32x32x32_bf16 v[48:63], v[136:139], v[176:183], v112
 buffer_load_dwordx4 v[24:27], v122, s[28:31], s83 offen offset:256 sc1
 v_exp_f32 v186, v186
 v_exp_f32 v187, v187
 v_exp_f32 v188, v188
 v_exp_f32 v189, v189
 v_mfma_f32_16x16x32_bf16 v[240:243], v[88:91], v[64:67], v[240:243]
 v_mfma_f32_16x16x32_bf16 v[240:243], v[92:95], v[68:71], v[240:243]
 v_exp_f32 v190, v190
 v_exp_f32 v191, v191
 v_exp_f32 v160, v160
 v_exp_f32 v161, v161
 v_smfmac_f32_32x32x32_bf16 v[48:63], v[140:143], v[184:191], v112
 ds_read_b128 v[108:111], v113 offset:28672
 v_exp_f32 v162, v162
 v_exp_f32 v163, v163
 v_exp_f32 v164, v164
 v_mfma_f32_32x32x16_bf16 v[176:191], v[104:107], v[148:151], 0
 ds_read_b64_tr_b16 v[96:97], v3 offset:32768
 ds_read_b64_tr_b16 v[98:99], v3 offset:34816
 v_exp_f32 v165, v165
 v_exp_f32 v166, v166
 v_exp_f32 v167, v167
 v_exp_f32 v168, v168
 v_exp_f32 v169, v169
 v_smfmac_f32_32x32x32_bf16 v[32:47], v[128:131], v[160:167], v112
 ds_read_b64_tr_b16 v[100:101], v3 offset:36864
 ds_read_b64_tr_b16 v[102:103], v3 offset:38912
 s_mov_b64 exec, s[96:97]
 ds_read_b128 v[136:139], v114 offset:29696
 ds_read_b128 v[140:143], v114 offset:30208
 s_mov_b64 exec, -1
 v_exp_f32 v170, v170
 v_exp_f32 v171, v171
 v_exp_f32 v172, v172
 v_exp_f32 v173, v173
 v_mfma_f32_16x16x32_bf16 v[244:247], v[88:91], v[72:75], v[244:247]
 v_mfma_f32_16x16x32_bf16 v[244:247], v[92:95], v[76:79], v[244:247]
 buffer_load_dwordx4 v[28:31], v122, s[28:31], s83 offen offset:2304 sc1
 v_exp_f32 v174, v174
 v_exp_f32 v175, v175
 v_exp_f32 v176, v176
 v_exp_f32 v177, v177
 v_smfmac_f32_32x32x32_bf16 v[32:47], v[132:135], v[168:175], v112
 s_waitcnt lgkmcnt(0)
 v_exp_f32 v178, v178
 v_exp_f32 v179, v179
 v_exp_f32 v180, v180
 v_mfma_f32_32x32x16_bf16 v[160:175], v[108:111], v[144:147], 0
 v_exp_f32 v181, v181
 v_exp_f32 v182, v182
 v_exp_f32 v183, v183
 v_exp_f32 v184, v184
 v_exp_f32 v185, v185
 v_smfmac_f32_32x32x32_bf16 v[48:63], v[128:131], v[176:183], v112
 s_setprio 0
 v_exp_f32 v186, v186
 v_exp_f32 v187, v187
 v_exp_f32 v188, v188
 v_exp_f32 v189, v189
 v_mfma_f32_16x16x32_bf16 v[248:251], v[96:99], v[64:67], v[248:251]
 v_mfma_f32_16x16x32_bf16 v[248:251], v[100:103], v[68:71], v[248:251]
 v_exp_f32 v190, v190
 v_exp_f32 v191, v191
 s_waitcnt vmcnt(10)
 s_barrier
 v_exp_f32 v160, v160
 v_exp_f32 v161, v161
 v_smfmac_f32_32x32x32_bf16 v[48:63], v[132:135], v[184:191], v112
 ds_read_b128 v[104:107], v113 offset:32768
 s_setprio 3
 v_exp_f32 v162, v162
 v_exp_f32 v163, v163
 v_exp_f32 v164, v164
 v_mfma_f32_32x32x16_bf16 v[176:191], v[108:111], v[148:151], 0
 ds_read_b64_tr_b16 v[88:89], v5 offset:32768
 ds_read_b64_tr_b16 v[90:91], v5 offset:34816
 v_exp_f32 v165, v165
 v_exp_f32 v166, v166
 v_exp_f32 v167, v167
 v_exp_f32 v168, v168
 v_exp_f32 v169, v169
 v_smfmac_f32_32x32x32_bf16 v[32:47], v[136:139], v[160:167], v112
 ds_read_b64_tr_b16 v[92:93], v5 offset:36864
 ds_read_b64_tr_b16 v[94:95], v5 offset:38912
 s_mov_b64 exec, s[96:97]
 ds_read_b128 v[128:131], v114 offset:33792
 ds_read_b128 v[132:135], v114 offset:34304
 s_mov_b64 exec, -1
 v_exp_f32 v170, v170
 v_exp_f32 v171, v171
 v_exp_f32 v172, v172
 v_exp_f32 v173, v173
 v_mfma_f32_16x16x32_bf16 v[252:255], v[96:99], v[72:75], v[252:255]
 v_mfma_f32_16x16x32_bf16 v[252:255], v[100:103], v[76:79], v[252:255]
 v_exp_f32 v174, v174
 v_exp_f32 v175, v175
 v_exp_f32 v176, v176
 v_exp_f32 v177, v177
 v_smfmac_f32_32x32x32_bf16 v[32:47], v[140:143], v[168:175], v112
 s_waitcnt lgkmcnt(0)
 v_exp_f32 v178, v178
 v_exp_f32 v179, v179
 v_exp_f32 v180, v180
 v_mfma_f32_32x32x16_bf16 v[160:175], v[104:107], v[144:147], 0
 s_add_u32 s82, s81, 3
 s_cmp_ge_u32 s82, 7
 s_cselect_b32 s63, 7, 0
 s_sub_u32 s82, s82, s63
 s_add_u32 m0, s53, 0
 s_lshl_b32 s82, s82, 16
 buffer_load_dwordx4 v116, s[32:35], s82 offen lds
 v_exp_f32 v181, v181
 v_exp_f32 v182, v182
 v_exp_f32 v183, v183
 v_exp_f32 v184, v184
 v_exp_f32 v185, v185
 v_smfmac_f32_32x32x32_bf16 v[48:63], v[136:139], v[176:183], v112
 s_add_u32 m0, s53, 8192
 s_add_u32 s82, s82, 458752
 buffer_load_dwordx4 v116, s[32:35], s82 offen lds
 v_exp_f32 v186, v186
 v_exp_f32 v187, v187
 v_exp_f32 v188, v188
 v_exp_f32 v189, v189
 v_mfma_f32_16x16x32_bf16 v[224:227], v[88:91], v[80:83], v[224:227]
 v_mfma_f32_16x16x32_bf16 v[224:227], v[92:95], v[84:87], v[224:227]
 v_exp_f32 v190, v190
 v_exp_f32 v191, v191
 v_exp_f32 v160, v160
 v_exp_f32 v161, v161
 v_smfmac_f32_32x32x32_bf16 v[48:63], v[140:143], v[184:191], v112
 ds_read_b128 v[108:111], v113 offset:36864
 v_exp_f32 v162, v162
 v_exp_f32 v163, v163
 v_exp_f32 v164, v164
 v_mfma_f32_32x32x16_bf16 v[176:191], v[104:107], v[148:151], 0
 ds_read_b64_tr_b16 v[96:97], v6 offset:32768
 ds_read_b64_tr_b16 v[98:99], v6 offset:34816
 v_exp_f32 v165, v165
 v_exp_f32 v166, v166
 v_exp_f32 v167, v167
 v_exp_f32 v168, v168
 v_exp_f32 v169, v169
 v_smfmac_f32_32x32x32_bf16 v[32:47], v[128:131], v[160:167], v112
 ds_read_b64_tr_b16 v[100:101], v6 offset:36864
 ds_read_b64_tr_b16 v[102:103], v6 offset:38912
 s_mov_b64 exec, s[96:97]
 ds_read_b128 v[136:139], v114 offset:37888
 ds_read_b128 v[140:143], v114 offset:38400
 s_mov_b64 exec, -1
 v_exp_f32 v170, v170
 v_exp_f32 v171, v171
 v_exp_f32 v172, v172
 v_exp_f32 v173, v173
 v_mfma_f32_16x16x32_bf16 v[228:231], v[88:91], v[152:155], v[228:231]
 v_mfma_f32_16x16x32_bf16 v[228:231], v[92:95], v[156:159], v[228:231]
 s_add_u32 s83, s81, 6
 s_cmp_ge_u32 s83, 7
 s_cselect_b32 s63, 7, 0
 s_sub_u32 s83, s83, s63
 s_lshl_b32 s83, s83, 12
 s_add_u32 s83, s83, s69
 buffer_load_dwordx4 v[64:67], v122, s[28:31], s83 offen offset:0 sc1
 v_exp_f32 v174, v174
 v_exp_f32 v175, v175
 v_exp_f32 v176, v176
 v_exp_f32 v177, v177
 v_smfmac_f32_32x32x32_bf16 v[32:47], v[132:135], v[168:175], v112
 s_waitcnt lgkmcnt(0)
 v_exp_f32 v178, v178
 v_exp_f32 v179, v179
 v_exp_f32 v180, v180
 v_mfma_f32_32x32x16_bf16 v[160:175], v[108:111], v[144:147], 0
 s_add_u32 m0, s53, 16384
 s_add_u32 s82, s82, 458752
 buffer_load_dwordx4 v116, s[32:35], s82 offen lds
 v_exp_f32 v181, v181
 v_exp_f32 v182, v182
 v_exp_f32 v183, v183
 v_exp_f32 v184, v184
 v_exp_f32 v185, v185
 v_smfmac_f32_32x32x32_bf16 v[48:63], v[128:131], v[176:183], v112
 s_add_u32 m0, s53, 24576
 s_add_u32 s82, s82, 458752
 buffer_load_dwordx4 v116, s[32:35], s82 offen lds
 v_exp_f32 v186, v186
 v_exp_f32 v187, v187
 v_exp_f32 v188, v188
 v_exp_f32 v189, v189
 v_mfma_f32_16x16x32_bf16 v[232:235], v[96:99], v[80:83], v[232:235]
 v_mfma_f32_16x16x32_bf16 v[232:235], v[100:103], v[84:87], v[232:235]
 v_exp_f32 v190, v190
 v_exp_f32 v191, v191
 v_exp_f32 v160, v160
 v_exp_f32 v161, v161
 v_smfmac_f32_32x32x32_bf16 v[48:63], v[132:135], v[184:191], v112
 ds_read_b128 v[104:107], v113 offset:40960
 s_setprio 2
 v_exp_f32 v162, v162
 v_exp_f32 v163, v163
 v_exp_f32 v164, v164
 v_mfma_f32_32x32x16_bf16 v[176:191], v[108:111], v[148:151], 0
 ds_read_b64_tr_b16 v[88:89], v14 offset:32768
 ds_read_b64_tr_b16 v[90:91], v14 offset:34816
 v_exp_f32 v165, v165
 v_exp_f32 v166, v166
 v_exp_f32 v167, v167
 v_exp_f32 v168, v168
 v_exp_f32 v169, v169
 v_smfmac_f32_32x32x32_bf16 v[32:47], v[136:139], v[160:167], v112
 ds_read_b64_tr_b16 v[92:93], v14 offset:36864
 ds_read_b64_tr_b16 v[94:95], v14 offset:38912
 s_mov_b64 exec, s[96:97]
 ds_read_b128 v[128:131], v114 offset:41984
 ds_read_b128 v[132:135], v114 offset:42496
 s_mov_b64 exec, -1
 v_exp_f32 v170, v170
 v_exp_f32 v171, v171
 v_exp_f32 v172, v172
 v_exp_f32 v173, v173
 v_mfma_f32_16x16x32_bf16 v[236:239], v[96:99], v[152:155], v[236:239]
 v_mfma_f32_16x16x32_bf16 v[236:239], v[100:103], v[156:159], v[236:239]
 buffer_load_dwordx4 v[68:71], v122, s[28:31], s83 offen offset:2048 sc1
 v_exp_f32 v174, v174
 v_exp_f32 v175, v175
 v_exp_f32 v176, v176
 v_exp_f32 v177, v177
 v_smfmac_f32_32x32x32_bf16 v[32:47], v[140:143], v[168:175], v112
 s_waitcnt lgkmcnt(0)
 v_exp_f32 v178, v178
 v_exp_f32 v179, v179
 v_exp_f32 v180, v180
 v_mfma_f32_32x32x16_bf16 v[160:175], v[104:107], v[144:147], 0
 s_add_u32 s82, s81, 4
 s_cmp_ge_u32 s82, 7
 s_cselect_b32 s63, 7, 0
 s_sub_u32 s82, s82, s63
 s_add_u32 m0, s53, 32768
 s_lshl_b32 s82, s82, 16
 buffer_load_dwordx4 v116, s[32:35], s82 offen lds
 v_exp_f32 v181, v181
 v_exp_f32 v182, v182
 v_exp_f32 v183, v183
 v_exp_f32 v184, v184
 v_exp_f32 v185, v185
 v_smfmac_f32_32x32x32_bf16 v[48:63], v[136:139], v[176:183], v112
 s_add_u32 m0, s53, 40960
 s_add_u32 s82, s82, 458752
 buffer_load_dwordx4 v116, s[32:35], s82 offen lds
 v_exp_f32 v186, v186
 v_exp_f32 v187, v187
 v_exp_f32 v188, v188
 v_exp_f32 v189, v189
 v_mfma_f32_16x16x32_bf16 v[240:243], v[88:91], v[80:83], v[240:243]
 v_mfma_f32_16x16x32_bf16 v[240:243], v[92:95], v[84:87], v[240:243]
 v_exp_f32 v190, v190
 v_exp_f32 v191, v191
 v_exp_f32 v160, v160
 v_exp_f32 v161, v161
 v_smfmac_f32_32x32x32_bf16 v[48:63], v[140:143], v[184:191], v112
 ds_read_b128 v[108:111], v113 offset:45056
 v_exp_f32 v162, v162
 v_exp_f32 v163, v163
 v_exp_f32 v164, v164
 v_mfma_f32_32x32x16_bf16 v[176:191], v[104:107], v[148:151], 0
 ds_read_b64_tr_b16 v[96:97], v15 offset:32768
 ds_read_b64_tr_b16 v[98:99], v15 offset:34816
 v_exp_f32 v165, v165
 v_exp_f32 v166, v166
 v_exp_f32 v167, v167
 v_exp_f32 v168, v168
 v_exp_f32 v169, v169
 v_smfmac_f32_32x32x32_bf16 v[32:47], v[128:131], v[160:167], v112
 ds_read_b64_tr_b16 v[100:101], v15 offset:36864
 ds_read_b64_tr_b16 v[102:103], v15 offset:38912
 s_mov_b64 exec, s[96:97]
 ds_read_b128 v[136:139], v114 offset:46080
 ds_read_b128 v[140:143], v114 offset:46592
 s_mov_b64 exec, -1
 v_exp_f32 v170, v170
 v_exp_f32 v171, v171
 v_exp_f32 v172, v172
 v_exp_f32 v173, v173
 v_mfma_f32_16x16x32_bf16 v[244:247], v[88:91], v[152:155], v[244:247]
 v_mfma_f32_16x16x32_bf16 v[244:247], v[92:95], v[156:159], v[244:247]
 buffer_load_dwordx4 v[72:75], v122, s[28:31], s83 offen offset:256 sc1
 v_exp_f32 v174, v174
 v_exp_f32 v175, v175
 v_exp_f32 v176, v176
 v_exp_f32 v177, v177
 v_smfmac_f32_32x32x32_bf16 v[32:47], v[132:135], v[168:175], v112
 s_waitcnt lgkmcnt(0)
 s_setprio 1
 v_exp_f32 v178, v178
 v_exp_f32 v179, v179
 v_exp_f32 v180, v180
 v_mfma_f32_32x32x16_bf16 v[160:175], v[108:111], v[144:147], 0
 s_add_u32 m0, s53, 49152
 s_add_u32 s82, s82, 458752
 buffer_load_dwordx4 v116, s[32:35], s82 offen lds
 v_exp_f32 v181, v181
 v_exp_f32 v182, v182
 v_exp_f32 v183, v183
 v_exp_f32 v184, v184
 v_exp_f32 v185, v185
 v_smfmac_f32_32x32x32_bf16 v[48:63], v[128:131], v[176:183], v112
 s_add_u32 m0, s53, 57344
 s_add_u32 s82, s82, 458752
 buffer_load_dwordx4 v116, s[32:35], s82 offen lds
 v_exp_f32 v186, v186
 v_exp_f32 v187, v187
 v_exp_f32 v188, v188
 v_exp_f32 v189, v189
 v_mfma_f32_16x16x32_bf16 v[248:251], v[96:99], v[80:83], v[248:251]
 v_mfma_f32_16x16x32_bf16 v[248:251], v[100:103], v[84:87], v[248:251]
 v_exp_f32 v190, v190
 v_exp_f32 v191, v191
 v_exp_f32 v160, v160
 v_exp_f32 v161, v161
 v_smfmac_f32_32x32x32_bf16 v[48:63], v[132:135], v[184:191], v112
 ds_read_b128 v[104:107], v113 offset:49152
 v_exp_f32 v162, v162
 v_exp_f32 v163, v163
 v_exp_f32 v164, v164
 v_mfma_f32_32x32x16_bf16 v[176:191], v[108:111], v[148:151], 0
 v_exp_f32 v165, v165
 v_exp_f32 v166, v166
 v_exp_f32 v167, v167
 v_exp_f32 v168, v168
 v_exp_f32 v169, v169
 v_smfmac_f32_32x32x32_bf16 v[32:47], v[136:139], v[160:167], v112
 s_mov_b64 exec, s[96:97]
 ds_read_b128 v[128:131], v114 offset:50176
 ds_read_b128 v[132:135], v114 offset:50688
 s_mov_b64 exec, -1
 v_exp_f32 v170, v170
 v_exp_f32 v171, v171
 v_exp_f32 v172, v172
 v_exp_f32 v173, v173
 v_mfma_f32_16x16x32_bf16 v[252:255], v[96:99], v[152:155], v[252:255]
 v_mfma_f32_16x16x32_bf16 v[252:255], v[100:103], v[156:159], v[252:255]
 buffer_load_dwordx4 v[76:79], v122, s[28:31], s83 offen offset:2304 sc1
 v_exp_f32 v174, v174
 v_exp_f32 v175, v175
 v_exp_f32 v176, v176
 v_exp_f32 v177, v177
 v_smfmac_f32_32x32x32_bf16 v[32:47], v[140:143], v[168:175], v112
 s_waitcnt lgkmcnt(0)
 v_exp_f32 v178, v178
 v_exp_f32 v179, v179
 v_exp_f32 v180, v180
 v_mfma_f32_32x32x16_bf16 v[160:175], v[104:107], v[144:147], 0
 s_add_u32 s82, s81, 6
 s_cmp_ge_u32 s82, 7
 s_cselect_b32 s63, 7, 0
 s_sub_u32 s82, s82, s63
 s_add_u32 m0, s53, 65536
 s_lshl_b32 s82, s82, 16
 buffer_load_dwordx4 v116, s[32:35], s82 offen lds
 v_exp_f32 v181, v181
 v_exp_f32 v182, v182
 v_exp_f32 v183, v183
 v_exp_f32 v184, v184
 v_exp_f32 v185, v185
 v_smfmac_f32_32x32x32_bf16 v[48:63], v[136:139], v[176:183], v112
 s_setprio 0
 s_add_u32 m0, s53, 73728
 s_add_u32 s82, s82, 458752
 buffer_load_dwordx4 v116, s[32:35], s82 offen lds
 v_exp_f32 v186, v186
 v_exp_f32 v187, v187
 v_exp_f32 v188, v188
 v_exp_f32 v189, v189
 v_exp_f32 v190, v190
 v_exp_f32 v191, v191
 s_barrier
 v_exp_f32 v160, v160
 v_exp_f32 v161, v161
 v_smfmac_f32_32x32x32_bf16 v[48:63], v[140:143], v[184:191], v112
 ds_read_b128 v[108:111], v113 offset:53248
 s_setprio 3
 v_exp_f32 v162, v162
 v_exp_f32 v163, v163
 v_exp_f32 v164, v164
 v_mfma_f32_32x32x16_bf16 v[176:191], v[104:107], v[148:151], 0
 v_exp_f32 v165, v165
 v_exp_f32 v166, v166
 v_exp_f32 v167, v167
 v_exp_f32 v168, v168
 v_exp_f32 v169, v169
 v_smfmac_f32_32x32x32_bf16 v[32:47], v[128:131], v[160:167], v112
 s_mov_b64 exec, s[96:97]
 ds_read_b128 v[136:139], v114 offset:54272
 ds_read_b128 v[140:143], v114 offset:54784
 s_mov_b64 exec, -1
 v_exp_f32 v170, v170
 v_exp_f32 v171, v171
 v_exp_f32 v172, v172
 v_exp_f32 v173, v173
 v_exp_f32 v174, v174
 v_exp_f32 v175, v175
 v_exp_f32 v176, v176
 v_exp_f32 v177, v177
 v_smfmac_f32_32x32x32_bf16 v[32:47], v[132:135], v[168:175], v112
 s_waitcnt lgkmcnt(0)
 v_exp_f32 v178, v178
 v_exp_f32 v179, v179
 v_exp_f32 v180, v180
 v_mfma_f32_32x32x16_bf16 v[160:175], v[108:111], v[144:147], 0
 s_add_u32 m0, s53, 81920
 s_add_u32 s82, s82, 458752
 buffer_load_dwordx4 v116, s[32:35], s82 offen lds
 v_exp_f32 v181, v181
 v_exp_f32 v182, v182
 v_exp_f32 v183, v183
 v_exp_f32 v184, v184
 v_exp_f32 v185, v185
 v_smfmac_f32_32x32x32_bf16 v[48:63], v[128:131], v[176:183], v112
 s_add_u32 m0, s53, 90112
 s_add_u32 s82, s82, 458752
 buffer_load_dwordx4 v116, s[32:35], s82 offen lds
 v_exp_f32 v186, v186
 v_exp_f32 v187, v187
 v_exp_f32 v188, v188
 v_exp_f32 v189, v189
 v_exp_f32 v190, v190
 v_exp_f32 v191, v191
 v_exp_f32 v160, v160
 v_exp_f32 v161, v161
 v_smfmac_f32_32x32x32_bf16 v[48:63], v[132:135], v[184:191], v112
 ds_read_b128 v[104:107], v113 offset:57344
 s_setprio 2
 v_exp_f32 v162, v162
 v_exp_f32 v163, v163
 v_exp_f32 v164, v164
 v_mfma_f32_32x32x16_bf16 v[176:191], v[108:111], v[148:151], 0
 v_exp_f32 v165, v165
 v_exp_f32 v166, v166
 v_exp_f32 v167, v167
 v_exp_f32 v168, v168
 v_exp_f32 v169, v169
 v_smfmac_f32_32x32x32_bf16 v[32:47], v[136:139], v[160:167], v112
 s_mov_b64 exec, s[96:97]
 ds_read_b128 v[128:131], v114 offset:58368
 ds_read_b128 v[132:135], v114 offset:58880
 s_mov_b64 exec, -1
 v_exp_f32 v170, v170
 v_exp_f32 v171, v171
 v_exp_f32 v172, v172
 v_exp_f32 v173, v173
 v_exp_f32 v174, v174
 v_exp_f32 v175, v175
 v_exp_f32 v176, v176
 v_exp_f32 v177, v177
 v_smfmac_f32_32x32x32_bf16 v[32:47], v[140:143], v[168:175], v112
 s_waitcnt lgkmcnt(0)
 v_exp_f32 v178, v178
 v_exp_f32 v179, v179
 v_exp_f32 v180, v180
 v_mfma_f32_32x32x16_bf16 v[160:175], v[104:107], v[144:147], 0
 ds_read_b128 v[108:111], v113 offset:61440
 s_add_u32 s82, s81, 5
 s_cmp_ge_u32 s82, 7
 s_cselect_b32 s63, 7, 0
 s_sub_u32 s82, s82, s63
 s_add_u32 m0, s53, 131072
 s_lshl_b32 s82, s82, 16
 buffer_load_dwordx4 v116, s[32:35], s82 offen lds
 v_exp_f32 v181, v181
 v_exp_f32 v182, v182
 v_exp_f32 v183, v183
 v_exp_f32 v184, v184
 v_exp_f32 v185, v185
 v_smfmac_f32_32x32x32_bf16 v[48:63], v[136:139], v[176:183], v112
 s_add_u32 m0, s53, 139264
 s_add_u32 s82, s82, 458752
 buffer_load_dwordx4 v116, s[32:35], s82 offen lds
 v_exp_f32 v186, v186
 v_exp_f32 v187, v187
 v_exp_f32 v188, v188
 v_exp_f32 v189, v189
 v_exp_f32 v190, v190
 v_exp_f32 v191, v191
 v_exp_f32 v160, v160
 v_exp_f32 v161, v161
 v_smfmac_f32_32x32x32_bf16 v[48:63], v[140:143], v[184:191], v112
 s_waitcnt lgkmcnt(0)
 s_setprio 1
 v_exp_f32 v162, v162
 v_exp_f32 v163, v163
 v_exp_f32 v164, v164
 v_mfma_f32_32x32x16_bf16 v[176:191], v[108:111], v[144:147], 0
 v_exp_f32 v165, v165
 v_exp_f32 v166, v166
 v_exp_f32 v167, v167
 v_exp_f32 v168, v168
 v_exp_f32 v169, v169
 v_smfmac_f32_32x32x32_bf16 v[32:47], v[128:131], v[160:167], v112
 s_mov_b64 exec, s[96:97]
 ds_read_b128 v[136:139], v114 offset:62464
 ds_read_b128 v[140:143], v114 offset:62976
 s_mov_b64 exec, -1
 v_exp_f32 v170, v170
 v_exp_f32 v171, v171
 v_exp_f32 v172, v172
 v_exp_f32 v173, v173
 v_exp_f32 v174, v174
 v_exp_f32 v175, v175
 v_exp_f32 v176, v176
 v_exp_f32 v177, v177
 v_smfmac_f32_32x32x32_bf16 v[32:47], v[132:135], v[168:175], v112
 s_waitcnt lgkmcnt(0)
 v_exp_f32 v178, v178
 v_exp_f32 v179, v179
 v_exp_f32 v180, v180
 v_mfma_f32_32x32x16_bf16 v[160:175], v[104:107], v[148:151], 0
 s_add_u32 m0, s53, 147456
 s_add_u32 s82, s82, 458752
 buffer_load_dwordx4 v116, s[32:35], s82 offen lds
 v_exp_f32 v181, v181
 v_exp_f32 v182, v182
 v_exp_f32 v183, v183
 v_exp_f32 v184, v184
 v_exp_f32 v185, v185
 v_smfmac_f32_32x32x32_bf16 v[32:47], v[136:139], v[176:183], v112
 s_setprio 0
 s_add_u32 m0, s53, 155648
 s_add_u32 s82, s82, 458752
 buffer_load_dwordx4 v116, s[32:35], s82 offen lds
 v_exp_f32 v186, v186
 v_exp_f32 v187, v187
 v_exp_f32 v188, v188
 v_exp_f32 v189, v189
 v_exp_f32 v190, v190
 v_exp_f32 v191, v191
 v_exp_f32 v160, v160
 v_exp_f32 v161, v161
 v_smfmac_f32_32x32x32_bf16 v[32:47], v[140:143], v[184:191], v112
 v_exp_f32 v162, v162
 v_exp_f32 v163, v163
 v_exp_f32 v164, v164
 v_mfma_f32_32x32x16_bf16 v[176:191], v[108:111], v[148:151], 0
 v_exp_f32 v165, v165
 v_exp_f32 v166, v166
 v_exp_f32 v167, v167
 v_exp_f32 v168, v168
 v_exp_f32 v169, v169
 v_smfmac_f32_32x32x32_bf16 v[48:63], v[128:131], v[160:167], v112
 v_exp_f32 v170, v170
 v_exp_f32 v171, v171
 v_exp_f32 v172, v172
 ds_write_b128 v7, v[32:35] offset:0
 ds_write_b128 v7, v[36:39] offset:1024
 ds_write_b32 v119, v40 offset:2048
 v_exp_f32 v173, v173
 v_exp_f32 v174, v174
 v_exp_f32 v175, v175
 v_exp_f32 v176, v176
 v_exp_f32 v177, v177
 v_smfmac_f32_32x32x32_bf16 v[48:63], v[132:135], v[168:175], v112
 s_waitcnt vmcnt(9) lgkmcnt(0)
 s_barrier
 ds_read_b128 v[160:163], v8
 ds_read_b128 v[164:167], v8 offset:1024
 ds_read_b32 v168, v4 offset:2048
 v_exp_f32 v178, v178
 v_exp_f32 v179, v179
 v_exp_f32 v180, v180
 v_exp_f32 v181, v181
 v_exp_f32 v182, v182
 v_exp_f32 v183, v183
 v_exp_f32 v184, v184
 v_exp_f32 v185, v185
 v_smfmac_f32_32x32x32_bf16 v[48:63], v[136:139], v[176:183], v112
 v_exp_f32 v186, v186
 v_exp_f32 v187, v187
 v_exp_f32 v188, v188
 v_exp_f32 v189, v189
 v_exp_f32 v190, v190
 v_exp_f32 v191, v191
 s_lshl_b32 s62, s76, 5
 s_add_u32 s62, s62, s64
 v_smfmac_f32_32x32x32_bf16 v[48:63], v[140:143], v[184:191], v112
 s_lshl_b32 s68, s62, 10
 s_add_u32 s68, s68, 7340032
 ds_read_b64_tr_b16 v[88:89], v124 offset:0
 ds_read_b64_tr_b16 v[90:91], v124 offset:2048
 ds_read_b64_tr_b16 v[92:93], v124 offset:4096
 ds_read_b64_tr_b16 v[94:95], v124 offset:6144
 ds_read_b64_tr_b16 v[96:97], v1 offset:0
 ds_read_b64_tr_b16 v[98:99], v1 offset:2048
 ds_read_b64_tr_b16 v[100:101], v1 offset:4096
 ds_read_b64_tr_b16 v[102:103], v1 offset:6144
 s_waitcnt lgkmcnt(8)
 s_nop 0
 v_add_f32 v48, v48, v160
 v_add_f32 v49, v49, v161
 v_add_f32 v50, v50, v162
 v_add_f32 v51, v51, v163
 v_add_f32 v52, v52, v164
 v_add_f32 v53, v53, v165
 v_add_f32 v54, v54, v166
 v_add_f32 v55, v55, v167
 v_add_f32 v56, v56, v168
 v_fma_f32 v108, 0, v48, v56
 v_fmac_f32 v108, 0, v49
 v_fmac_f32 v108, 0, v50
 v_fmac_f32 v108, 0, v51
 v_fmac_f32 v108, 0, v52
 v_fmac_f32 v108, 0, v53
 v_fmac_f32 v108, 0, v54
 v_fmac_f32 v108, 0, v55
 v_cmp_lt_f32 vcc, 0x2b800000, v108
 s_nop 0
 s_mov_b64 s[98:99], vcc
 v_cmp_gt_f32 vcc, 0x5d800000, v108
 s_nop 0
 s_and_b64 vcc, vcc, s[98:99]
 s_cmp_eq_u64 vcc, -1
 s_cbranch_scc0 L_slow1
L_slowret1:
 v_rcp_f32 v108, v56
 s_nop 0
 v_mul_f32 v108, v108, v118
 v_mul_f32 v48, v48, v108
 v_mul_f32 v49, v49, v108
 v_mul_f32 v50, v50, v108
 v_mul_f32 v51, v51, v108
 v_mul_f32 v52, v52, v108
 v_mul_f32 v53, v53, v108
 v_mul_f32 v54, v54, v108
 v_mul_f32 v55, v55, v108
 v_cvt_pk_bf16_f32 v108, v48, v49
 v_cvt_pk_bf16_f32 v109, v50, v51
 v_cvt_pk_bf16_f32 v110, v52, v53
 v_cvt_pk_bf16_f32 v111, v54, v55
 v_min_u32 v108, -2, v108
 v_min_u32 v109, -2, v109
 v_min_u32 v110, -2, v110
 v_min_u32 v111, -2, v111
 buffer_store_dwordx4 v[108:111], v126, s[28:31], s68 offen sc1
 s_and_b32 s62, s52, 1
 s_bfe_u32 s63, s52, 0x10001
 s_sub_u32 s62, s62, s63
 s_lshl_b32 s62, s62, 13
 v_add_u32 v116, s62, v116
 s_waitcnt lgkmcnt(4)
 v_mfma_f32_16x16x32_bf16 v[224:227], v[88:91], v[192:195], v[224:227]
 s_setprio 1
 ds_read_b64_tr_b16 v[32:33], v2 offset:0
 ds_read_b64_tr_b16 v[34:35], v2 offset:2048
 v_mfma_f32_16x16x32_bf16 v[224:227], v[92:95], v[196:199], v[224:227]
 ds_read_b64_tr_b16 v[36:37], v2 offset:4096
 ds_read_b64_tr_b16 v[38:39], v2 offset:6144
 v_mfma_f32_16x16x32_bf16 v[228:231], v[88:91], v[200:203], v[228:231]
 ds_read_b64_tr_b16 v[40:41], v3 offset:0
 ds_read_b64_tr_b16 v[42:43], v3 offset:2048
 v_mfma_f32_16x16x32_bf16 v[228:231], v[92:95], v[204:207], v[228:231]
 s_setprio 0
 ds_read_b64_tr_b16 v[44:45], v3 offset:4096
 ds_read_b64_tr_b16 v[46:47], v3 offset:6144
 s_lshl_b32 s62, s71, 2
 s_add_u32 s62, s62, s72
 s_lshl_b32 s67, s62, 13
 s_lshr_b32 s68, s0, 4
 s_add_u32 s67, s67, s68
 s_add_u32 s67, s67, 7340032
 s_xor_b32 s70, s67, 4096
 v_and_b32 v13, 15, v0
 v_lshrrev_b32 v11, 4, v0
 v_xor_b32 v11, v11, v13
 s_waitcnt lgkmcnt(8)
 v_mfma_f32_16x16x32_bf16 v[232:235], v[96:99], v[192:195], v[232:235]
 s_setprio 1
 v_mfma_f32_16x16x32_bf16 v[232:235], v[100:103], v[196:199], v[232:235]
 v_mfma_f32_16x16x32_bf16 v[236:239], v[96:99], v[200:203], v[236:239]
 v_mfma_f32_16x16x32_bf16 v[236:239], v[100:103], v[204:207], v[236:239]
 s_setprio 0
 v_lshlrev_b32 v11, 4, v11
 v_lshl_add_u32 v11, v13, 8, v11
 s_lshl_b32 s68, s52, 13
 s_add_u32 s68, s68, 32768
 v_add_u32 v104, s68, v11
 v_xor_b32 v105, 64, v104
 v_xor_b32 v106, 128, v104
 s_waitcnt vmcnt(1) lgkmcnt(0)
 s_barrier
 v_mfma_f32_16x16x32_bf16 v[240:243], v[32:35], v[192:195], v[240:243]
 s_setprio 1
 ds_read_b64_tr_b16 v[144:145], v124 offset:32768
 v_mfma_f32_16x16x32_bf16 v[240:243], v[36:39], v[196:199], v[240:243]
 ds_read_b64_tr_b16 v[146:147], v124 offset:34816
 v_mfma_f32_16x16x32_bf16 v[244:247], v[32:35], v[200:203], v[244:247]
 ds_read_b64_tr_b16 v[148:149], v124 offset:36864
 v_mfma_f32_16x16x32_bf16 v[244:247], v[36:39], v[204:207], v[244:247]
 s_setprio 0
 ds_read_b64_tr_b16 v[150:151], v124 offset:38912
 s_add_u32 m0, s53, 98304
 s_xor_b32 s82, s0, 0
 buffer_load_dwordx4 v116, s[36:39], s82 offen lds
 s_add_u32 m0, s53, 106496
 s_xor_b32 s82, s0, 131072
 buffer_load_dwordx4 v116, s[36:39], s82 offen lds
 v_xor_b32 v107, 192, v104
 v_lshrrev_b32 v13, 3, v0
 s_lshl_b32 s68, s72, 3
 v_add_u32 v13, s68, v13
 v_and_b32 v11, 7, v0
 v_lshlrev_b32 v9, 1, v11
 v_and_b32 v8, 15, v13
 v_mfma_f32_16x16x32_bf16 v[248:251], v[40:43], v[192:195], v[248:251]
 s_setprio 1
 ds_read_b64_tr_b16 v[88:89], v1 offset:32768
 v_mfma_f32_16x16x32_bf16 v[248:251], v[44:47], v[196:199], v[248:251]
 ds_read_b64_tr_b16 v[90:91], v1 offset:34816
 v_mfma_f32_16x16x32_bf16 v[252:255], v[40:43], v[200:203], v[252:255]
 ds_read_b64_tr_b16 v[92:93], v1 offset:36864
 v_mfma_f32_16x16x32_bf16 v[252:255], v[44:47], v[204:207], v[252:255]
 s_setprio 0
 ds_read_b64_tr_b16 v[94:95], v1 offset:38912
 s_add_u32 m0, s53, 114688
 s_xor_b32 s82, s0, 262144
 buffer_load_dwordx4 v116, s[36:39], s82 offen lds
 s_add_u32 m0, s53, 122880
 s_xor_b32 s82, s0, 393216
 buffer_load_dwordx4 v116, s[36:39], s82 offen lds
 v_xor_b32 v9, v9, v8
 v_lshlrev_b32 v9, 4, v9
 v_lshl_add_u32 v9, v13, 8, v9
 s_and_b32 s68, s52, 1
 s_lshl_b32 s68, s68, 13
 s_add_u32 s68, s68, 32768
 v_add_u32 v10, s68, v9
 v_xor_b32 v9, 16, v10
 s_waitcnt lgkmcnt(4)
 v_mfma_f32_16x16x32_bf16 v[224:227], v[144:147], v[208:211], v[224:227]
 s_setprio 1
 ds_read_b64_tr_b16 v[96:97], v2 offset:32768
 v_mfma_f32_16x16x32_bf16 v[224:227], v[148:151], v[212:215], v[224:227]
 ds_read_b64_tr_b16 v[98:99], v2 offset:34816
 v_mfma_f32_16x16x32_bf16 v[228:231], v[144:147], v[216:219], v[228:231]
 ds_read_b64_tr_b16 v[100:101], v2 offset:36864
 v_mfma_f32_16x16x32_bf16 v[228:231], v[148:151], v[220:223], v[228:231]
 s_setprio 0
 ds_read_b64_tr_b16 v[102:103], v2 offset:38912
 s_add_u32 m0, s53, 0
 s_xor_b32 s82, s0, 65536
 buffer_load_dwordx4 v116, s[36:39], s82 offen lds
 s_add_u32 m0, s53, 8192
 s_xor_b32 s82, s0, 196608
 buffer_load_dwordx4 v116, s[36:39], s82 offen lds
 v_lshlrev_b32 v11, 4, v11
 v_lshl_add_u32 v12, v13, 10, v11
 s_lshl_b32 s62, s71, 15
 s_lshl_b32 s68, s73, 7
 s_add_u32 s77, s62, s68
 s_waitcnt lgkmcnt(4)
 v_mfma_f32_16x16x32_bf16 v[232:235], v[88:91], v[208:211], v[232:235]
 s_setprio 1
 ds_read_b64_tr_b16 v[144:145], v3 offset:32768
 v_mfma_f32_16x16x32_bf16 v[232:235], v[92:95], v[212:215], v[232:235]
 ds_read_b64_tr_b16 v[146:147], v3 offset:34816
 v_mfma_f32_16x16x32_bf16 v[236:239], v[88:91], v[216:219], v[236:239]
 ds_read_b64_tr_b16 v[148:149], v3 offset:36864
 v_mfma_f32_16x16x32_bf16 v[236:239], v[92:95], v[220:223], v[236:239]
 s_setprio 0
 ds_read_b64_tr_b16 v[150:151], v3 offset:38912
 s_add_u32 m0, s53, 16384
 s_xor_b32 s82, s0, 327680
 buffer_load_dwordx4 v116, s[36:39], s82 offen lds
 s_waitcnt lgkmcnt(4)
 v_mfma_f32_16x16x32_bf16 v[240:243], v[96:99], v[208:211], v[240:243]
 s_setprio 1
 ds_read_b64_tr_b16 v[88:89], v5 offset:32768
 v_mfma_f32_16x16x32_bf16 v[240:243], v[100:103], v[212:215], v[240:243]
 ds_read_b64_tr_b16 v[90:91], v5 offset:34816
 v_mfma_f32_16x16x32_bf16 v[244:247], v[96:99], v[216:219], v[244:247]
 ds_read_b64_tr_b16 v[92:93], v5 offset:36864
 v_mfma_f32_16x16x32_bf16 v[244:247], v[100:103], v[220:223], v[244:247]
 s_setprio 0
 ds_read_b64_tr_b16 v[94:95], v5 offset:38912
 v_add_u32 v5, 4294934528, v5
 s_add_u32 m0, s53, 24576
 s_xor_b32 s82, s0, 458752
 buffer_load_dwordx4 v116, s[36:39], s82 offen lds
 s_waitcnt lgkmcnt(4)
 v_mfma_f32_16x16x32_bf16 v[248:251], v[144:147], v[208:211], v[248:251]
 s_setprio 1
 ds_read_b64_tr_b16 v[96:97], v6 offset:32768
 v_mfma_f32_16x16x32_bf16 v[248:251], v[148:151], v[212:215], v[248:251]
 ds_read_b64_tr_b16 v[98:99], v6 offset:34816
 v_mfma_f32_16x16x32_bf16 v[252:255], v[144:147], v[216:219], v[252:255]
 ds_read_b64_tr_b16 v[100:101], v6 offset:36864
 v_mfma_f32_16x16x32_bf16 v[252:255], v[148:151], v[220:223], v[252:255]
 s_setprio 0
 ds_read_b64_tr_b16 v[102:103], v6 offset:38912
 v_add_u32 v6, 4294934528, v6
 buffer_load_dwordx4 v[160:163], v122, s[28:31], s67 offen offset:0 sc1
 s_waitcnt lgkmcnt(4)
 v_mfma_f32_16x16x32_bf16 v[224:227], v[88:91], v[16:19], v[224:227]
 s_setprio 1
 ds_read_b64_tr_b16 v[144:145], v14 offset:32768
 v_mfma_f32_16x16x32_bf16 v[224:227], v[92:95], v[20:23], v[224:227]
 ds_read_b64_tr_b16 v[146:147], v14 offset:34816
 v_mfma_f32_16x16x32_bf16 v[228:231], v[88:91], v[24:27], v[228:231]
 ds_read_b64_tr_b16 v[148:149], v14 offset:36864
 v_mfma_f32_16x16x32_bf16 v[228:231], v[92:95], v[28:31], v[228:231]
 s_setprio 0
 ds_read_b64_tr_b16 v[150:151], v14 offset:38912
 v_add_u32 v14, 4294934528, v14
 buffer_load_dwordx4 v[164:167], v122, s[28:31], s67 offen offset:2048 sc1
 s_waitcnt lgkmcnt(4)
 v_mfma_f32_16x16x32_bf16 v[232:235], v[96:99], v[16:19], v[232:235]
 s_setprio 1
 ds_read_b64_tr_b16 v[88:89], v15 offset:32768
 v_mfma_f32_16x16x32_bf16 v[232:235], v[100:103], v[20:23], v[232:235]
 ds_read_b64_tr_b16 v[90:91], v15 offset:34816
 v_mfma_f32_16x16x32_bf16 v[236:239], v[96:99], v[24:27], v[236:239]
 ds_read_b64_tr_b16 v[92:93], v15 offset:36864
 v_mfma_f32_16x16x32_bf16 v[236:239], v[100:103], v[28:31], v[236:239]
 s_setprio 0
 ds_read_b64_tr_b16 v[94:95], v15 offset:38912
 v_add_u32 v15, 4294934528, v15
 buffer_load_dwordx4 v[168:171], v122, s[28:31], s67 offen offset:256 sc1
 s_waitcnt lgkmcnt(4)
 v_mfma_f32_16x16x32_bf16 v[240:243], v[144:147], v[16:19], v[240:243]
 s_setprio 1
 ds_read_b64_tr_b16 v[96:97], v5 offset:0
 v_mfma_f32_16x16x32_bf16 v[240:243], v[148:151], v[20:23], v[240:243]
 ds_read_b64_tr_b16 v[98:99], v5 offset:2048
 v_mfma_f32_16x16x32_bf16 v[244:247], v[144:147], v[24:27], v[244:247]
 ds_read_b64_tr_b16 v[100:101], v5 offset:4096
 v_mfma_f32_16x16x32_bf16 v[244:247], v[148:151], v[28:31], v[244:247]
 s_setprio 0
 ds_read_b64_tr_b16 v[102:103], v5 offset:6144
 buffer_load_dwordx4 v[172:175], v122, s[28:31], s67 offen offset:2304 sc1
 s_waitcnt lgkmcnt(4)
 v_mfma_f32_16x16x32_bf16 v[248:251], v[88:91], v[16:19], v[248:251]
 s_setprio 1
 ds_read_b64_tr_b16 v[144:145], v6 offset:0
 v_mfma_f32_16x16x32_bf16 v[248:251], v[92:95], v[20:23], v[248:251]
 ds_read_b64_tr_b16 v[146:147], v6 offset:2048
 v_mfma_f32_16x16x32_bf16 v[252:255], v[88:91], v[24:27], v[252:255]
 ds_read_b64_tr_b16 v[148:149], v6 offset:4096
 v_mfma_f32_16x16x32_bf16 v[252:255], v[92:95], v[28:31], v[252:255]
 s_setprio 0
 ds_read_b64_tr_b16 v[150:151], v6 offset:6144
 buffer_load_dwordx4 v[176:179], v122, s[28:31], s70 offen offset:0 sc1
 s_waitcnt lgkmcnt(4)
 v_mfma_f32_16x16x32_bf16 v[224:227], v[96:99], v[64:67], v[224:227]
 s_setprio 1
 ds_read_b64_tr_b16 v[88:89], v14 offset:0
 v_mfma_f32_16x16x32_bf16 v[224:227], v[100:103], v[68:71], v[224:227]
 ds_read_b64_tr_b16 v[90:91], v14 offset:2048
 v_mfma_f32_16x16x32_bf16 v[228:231], v[96:99], v[72:75], v[228:231]
 ds_read_b64_tr_b16 v[92:93], v14 offset:4096
 v_mfma_f32_16x16x32_bf16 v[228:231], v[100:103], v[76:79], v[228:231]
 s_setprio 0
 ds_read_b64_tr_b16 v[94:95], v14 offset:6144
 buffer_load_dwordx4 v[180:183], v122, s[28:31], s70 offen offset:2048 sc1
 s_waitcnt lgkmcnt(4)
 v_mfma_f32_16x16x32_bf16 v[232:235], v[144:147], v[64:67], v[232:235]
 s_setprio 1
 ds_read_b64_tr_b16 v[96:97], v15 offset:0
 v_mfma_f32_16x16x32_bf16 v[232:235], v[148:151], v[68:71], v[232:235]
 ds_read_b64_tr_b16 v[98:99], v15 offset:2048
 v_mfma_f32_16x16x32_bf16 v[236:239], v[144:147], v[72:75], v[236:239]
 ds_read_b64_tr_b16 v[100:101], v15 offset:4096
 v_mfma_f32_16x16x32_bf16 v[236:239], v[148:151], v[76:79], v[236:239]
 s_setprio 0
 ds_read_b64_tr_b16 v[102:103], v15 offset:6144
 buffer_load_dwordx4 v[184:187], v122, s[28:31], s70 offen offset:256 sc1
 s_waitcnt vmcnt(7) lgkmcnt(0)
 s_barrier
 v_mfma_f32_16x16x32_bf16 v[240:243], v[88:91], v[64:67], v[240:243]
 s_setprio 1
 ds_read_b64_tr_b16 v[144:145], v5 offset:32768
 v_mfma_f32_16x16x32_bf16 v[240:243], v[92:95], v[68:71], v[240:243]
 ds_read_b64_tr_b16 v[146:147], v5 offset:34816
 v_mfma_f32_16x16x32_bf16 v[244:247], v[88:91], v[72:75], v[244:247]
 ds_read_b64_tr_b16 v[148:149], v5 offset:36864
 v_mfma_f32_16x16x32_bf16 v[244:247], v[92:95], v[76:79], v[244:247]
 s_setprio 0
 ds_read_b64_tr_b16 v[150:151], v5 offset:38912
 buffer_load_dwordx4 v[188:191], v122, s[28:31], s70 offen offset:2304 sc1
 v_mfma_f32_16x16x32_bf16 v[248:251], v[96:99], v[64:67], v[248:251]
 s_setprio 1
 ds_read_b64_tr_b16 v[88:89], v6 offset:32768
 v_mfma_f32_16x16x32_bf16 v[248:251], v[100:103], v[68:71], v[248:251]
 ds_read_b64_tr_b16 v[90:91], v6 offset:34816
 v_mfma_f32_16x16x32_bf16 v[252:255], v[96:99], v[72:75], v[252:255]
 ds_read_b64_tr_b16 v[92:93], v6 offset:36864
 v_mfma_f32_16x16x32_bf16 v[252:255], v[100:103], v[76:79], v[252:255]
 s_setprio 0
 ds_read_b64_tr_b16 v[94:95], v6 offset:38912
 s_waitcnt vmcnt(4)
 v_max3_u32 v13, v160, v161, v162
 v_max3_u32 v13, v13, v163, v164
 v_max3_u32 v13, v13, v165, v166
 v_max3_u32 v13, v13, v167, v168
 v_max3_u32 v13, v13, v169, v170
 v_max3_u32 v13, v13, v171, v172
 v_max3_u32 v13, v13, v173, v174
 v_max_u32 v13, v13, v175
 v_cmp_eq_u32 vcc, -1, v13
 s_nop 0
 s_cmp_lg_u64 vcc, 0
 s_cbranch_scc1 L_x_2025
L_r_2026:
 s_waitcnt lgkmcnt(4)
 v_mfma_f32_16x16x32_bf16 v[224:227], v[144:147], v[160:163], v[224:227]
 s_setprio 1
 ds_read_b64_tr_b16 v[96:97], v14 offset:32768
 v_mfma_f32_16x16x32_bf16 v[224:227], v[148:151], v[164:167], v[224:227]
 ds_read_b64_tr_b16 v[98:99], v14 offset:34816
 v_mfma_f32_16x16x32_bf16 v[228:231], v[144:147], v[168:171], v[228:231]
 ds_read_b64_tr_b16 v[100:101], v14 offset:36864
 v_mfma_f32_16x16x32_bf16 v[228:231], v[148:151], v[172:175], v[228:231]
 s_setprio 0
 ds_read_b64_tr_b16 v[102:103], v14 offset:38912
 s_waitcnt lgkmcnt(4)
 v_mfma_f32_16x16x32_bf16 v[232:235], v[88:91], v[160:163], v[232:235]
 s_setprio 1
 ds_read_b64_tr_b16 v[144:145], v15 offset:32768
 v_mfma_f32_16x16x32_bf16 v[232:235], v[92:95], v[164:167], v[232:235]
 ds_read_b64_tr_b16 v[146:147], v15 offset:34816
 v_mfma_f32_16x16x32_bf16 v[236:239], v[88:91], v[168:171], v[236:239]
 ds_read_b64_tr_b16 v[148:149], v15 offset:36864
 v_mfma_f32_16x16x32_bf16 v[236:239], v[92:95], v[172:175], v[236:239]
 s_setprio 0
 ds_read_b64_tr_b16 v[150:151], v15 offset:38912
 s_waitcnt lgkmcnt(4)
 v_mfma_f32_16x16x32_bf16 v[240:243], v[96:99], v[160:163], v[240:243]
 s_setprio 1
 ds_read_b64_tr_b16 v[88:89], v124 offset:0
 v_mfma_f32_16x16x32_bf16 v[240:243], v[100:103], v[164:167], v[240:243]
 ds_read_b64_tr_b16 v[90:91], v124 offset:2048
 v_mfma_f32_16x16x32_bf16 v[244:247], v[96:99], v[168:171], v[244:247]
 ds_read_b64_tr_b16 v[92:93], v124 offset:4096
 v_mfma_f32_16x16x32_bf16 v[244:247], v[100:103], v[172:175], v[244:247]
 s_setprio 0
 ds_read_b64_tr_b16 v[94:95], v124 offset:6144
 s_waitcnt lgkmcnt(4)
 v_mfma_f32_16x16x32_bf16 v[248:251], v[144:147], v[160:163], v[248:251]
 s_setprio 1
 ds_read_b64_tr_b16 v[96:97], v1 offset:0
 v_mfma_f32_16x16x32_bf16 v[248:251], v[148:151], v[164:167], v[248:251]
 ds_read_b64_tr_b16 v[98:99], v1 offset:2048
 v_mfma_f32_16x16x32_bf16 v[252:255], v[144:147], v[168:171], v[252:255]
 ds_read_b64_tr_b16 v[100:101], v1 offset:4096
 v_mfma_f32_16x16x32_bf16 v[252:255], v[148:151], v[172:175], v[252:255]
 s_setprio 0
 ds_read_b64_tr_b16 v[102:103], v1 offset:6144
 s_waitcnt vmcnt(0)
 v_max3_u32 v13, v176, v177, v178
 v_max3_u32 v13, v13, v179, v180
 v_max3_u32 v13, v13, v181, v182
 v_max3_u32 v13, v13, v183, v184
 v_max3_u32 v13, v13, v185, v186
 v_max3_u32 v13, v13, v187, v188
 v_max3_u32 v13, v13, v189, v190
 v_max_u32 v13, v13, v191
 v_cmp_eq_u32 vcc, -1, v13
 s_nop 0
 s_cmp_lg_u64 vcc, 0
 s_cbranch_scc1 L_x_2028
L_r_2029:
 s_waitcnt lgkmcnt(4)
 v_mfma_f32_16x16x32_bf16 v[224:227], v[88:91], v[176:179], v[224:227]
 s_setprio 1
 ds_read_b64_tr_b16 v[144:145], v2 offset:0
 v_mfma_f32_16x16x32_bf16 v[224:227], v[92:95], v[180:183], v[224:227]
 ds_read_b64_tr_b16 v[146:147], v2 offset:2048
 v_mfma_f32_16x16x32_bf16 v[228:231], v[88:91], v[184:187], v[228:231]
 ds_read_b64_tr_b16 v[148:149], v2 offset:4096
 v_mfma_f32_16x16x32_bf16 v[228:231], v[92:95], v[188:191], v[228:231]
 s_setprio 0
 ds_read_b64_tr_b16 v[150:151], v2 offset:6144
 s_waitcnt lgkmcnt(4)
 v_mfma_f32_16x16x32_bf16 v[232:235], v[96:99], v[176:179], v[232:235]
 s_setprio 1
 ds_read_b64_tr_b16 v[88:89], v3 offset:0
 v_mfma_f32_16x16x32_bf16 v[232:235], v[100:103], v[180:183], v[232:235]
 ds_read_b64_tr_b16 v[90:91], v3 offset:2048
 v_mfma_f32_16x16x32_bf16 v[236:239], v[96:99], v[184:187], v[236:239]
 ds_read_b64_tr_b16 v[92:93], v3 offset:4096
 ds_write_b128 v104, v[224:227] offset:0
 v_mfma_f32_16x16x32_bf16 v[236:239], v[100:103], v[188:191], v[236:239]
 s_setprio 0
 ds_read_b64_tr_b16 v[94:95], v3 offset:6144
 ds_write_b128 v104, v[228:231] offset:4096
 s_waitcnt lgkmcnt(6)
 v_mfma_f32_16x16x32_bf16 v[240:243], v[144:147], v[176:179], v[240:243]
 s_setprio 1
 v_mfma_f32_16x16x32_bf16 v[240:243], v[148:151], v[180:183], v[240:243]
 v_mfma_f32_16x16x32_bf16 v[244:247], v[144:147], v[184:187], v[244:247]
 ds_write_b128 v105, v[232:235] offset:0
 v_mfma_f32_16x16x32_bf16 v[244:247], v[148:151], v[188:191], v[244:247]
 s_setprio 0
 ds_write_b128 v105, v[236:239] offset:4096
 s_waitcnt lgkmcnt(3)
 v_mfma_f32_16x16x32_bf16 v[248:251], v[88:91], v[176:179], v[248:251]
 s_setprio 1
 v_mfma_f32_16x16x32_bf16 v[248:251], v[92:95], v[180:183], v[248:251]
 v_mfma_f32_16x16x32_bf16 v[252:255], v[88:91], v[184:187], v[252:255]
 ds_write_b128 v106, v[240:243] offset:0
 v_mfma_f32_16x16x32_bf16 v[252:255], v[92:95], v[188:191], v[252:255]
 s_setprio 0
 ds_write_b128 v106, v[244:247] offset:4096
 s_nop 2
 ds_write_b128 v107, v[248:251] offset:0
 s_nop 1
 ds_write_b128 v107, v[252:255] offset:4096
 s_waitcnt lgkmcnt(0)
 s_barrier
 ds_read_b128 v[128:131], v10 offset:0
 ds_read_b128 v[132:135], v9 offset:0
 ds_read_b128 v[136:139], v10 offset:16384
 ds_read_b128 v[140:143], v9 offset:16384
 ds_read_b128 v[144:147], v10 offset:32768
 ds_read_b128 v[148:151], v9 offset:32768
 ds_read_b128 v[152:155], v10 offset:49152
 ds_read_b128 v[156:159], v9 offset:49152
 s_waitcnt lgkmcnt(4)
 v_add_f32 v128, v128, v136
 v_add_f32 v129, v129, v137
 v_add_f32 v130, v130, v138
 v_add_f32 v131, v131, v139
 v_add_f32 v132, v132, v140
 v_add_f32 v133, v133, v141
 v_add_f32 v134, v134, v142
 v_add_f32 v135, v135, v143
 s_waitcnt lgkmcnt(2)
 v_add_f32 v128, v128, v144
 v_add_f32 v129, v129, v145
 v_add_f32 v130, v130, v146
 v_add_f32 v131, v131, v147
 v_add_f32 v132, v132, v148
 v_add_f32 v133, v133, v149
 v_add_f32 v134, v134, v150
 v_add_f32 v135, v135, v151
 s_waitcnt lgkmcnt(0)
 v_add_f32 v128, v128, v152
 v_add_f32 v129, v129, v153
 v_add_f32 v130, v130, v154
 v_add_f32 v131, v131, v155
 v_add_f32 v132, v132, v156
 v_add_f32 v133, v133, v157
 v_add_f32 v134, v134, v158
 v_add_f32 v135, v135, v159
 v_cvt_pk_bf16_f32 v92, v128, v129
 v_cvt_pk_bf16_f32 v93, v130, v131
 v_cvt_pk_bf16_f32 v94, v132, v133
 v_cvt_pk_bf16_f32 v95, v134, v135
 buffer_store_dwordx4 v[92:95], v12, s[40:43], s77 offen sc1
 s_endpgm
L_x_2001:
 s_mov_b64 exec, 1
 buffer_store_dword v112, v126, s[44:47], 0 offen sc1
 s_mov_b64 exec, -1
 s_branch L_r_2002
L_x_2005:
 s_mov_b32 s92, 200000
L_spin_2007:
 buffer_load_dword v121, v118, s[44:47], 0 offen sc1
 s_waitcnt vmcnt(0)
 v_cmp_eq_u32 vcc, 0, v121
 s_sub_u32 s92, s92, 1
 s_cbranch_scc1 L_r_2006
 s_cmp_lg_u64 vcc, 0
 s_cbranch_scc1 L_spin_2007
 s_branch L_r_2006
L_x_2008:
 s_mov_b32 s92, 200000
L_spin_2010:
 buffer_load_dword v14, v119, s[28:31], 0 offen sc1
 buffer_load_dword v15, v119, s[28:31], 0 offen offset:64 sc1
 s_waitcnt vmcnt(0)
 v_min_u32 v13, v14, v15
 v_cmp_eq_u32 vcc, 0, v13
 s_sub_u32 s92, s92, 1
 s_cbranch_scc1 L_r_2009
 s_cmp_lg_u64 vcc, 0
 s_cbranch_scc1 L_spin_2010
 s_branch L_r_2009
L_x_2012:
 s_mov_b32 s92, 200000
L_spin_2014:
 buffer_load_dword v121, v120, s[28:31], 0 offen sc1
 s_waitcnt vmcnt(0)
 v_cmp_eq_u32 vcc, 0, v121
 s_sub_u32 s92, s92, 1
 s_cbranch_scc1 L_r_2013
 s_cmp_lg_u64 vcc, 0
 s_cbranch_scc1 L_spin_2014
 s_branch L_r_2013
L_x_2015:
 s_mov_b32 s92, 200000
L_spin_2017:
 buffer_load_dwordx4 v[148:151], v126, s[28:31], s85 offen sc1
 buffer_load_dwordx4 v[144:147], v126, s[28:31], s3 offen sc1
 s_waitcnt vmcnt(0)
 v_max3_u32 v13, v144, v145, v146
 v_max3_u32 v13, v13, v147, v148
 v_max3_u32 v13, v13, v149, v150
 v_max_u32 v13, v13, v151
 v_cmp_eq_u32 vcc, -1, v13
 s_sub_u32 s92, s92, 1
 s_cbranch_scc1 L_r_2016
 s_cmp_lg_u64 vcc, 0
 s_cbranch_scc1 L_spin_2017
 s_branch L_r_2016
L_x_2018:
 s_mov_b32 s92, 200000
L_spin_2020:
 buffer_load_dword v121, v115, s[28:31], 0 offen sc1
 s_waitcnt vmcnt(0)
 v_cmp_eq_u32 vcc, 0, v121
 s_sub_u32 s92, s92, 1
 s_cbranch_scc1 L_r_2019
 s_cmp_lg_u64 vcc, 0
 s_cbranch_scc1 L_spin_2020
 s_branch L_r_2019
L_x_2021:
 s_mov_b32 s92, 200000
L_spin_2023:
 buffer_load_dword v118, v123, s[28:31], 0 offen sc1
 s_waitcnt vmcnt(0)
 v_cmp_eq_u32 vcc, 0, v118
 s_sub_u32 s92, s92, 1
 s_cbranch_scc1 L_r_2022
 s_cmp_lg_u64 vcc, 0
 s_cbranch_scc1 L_spin_2023
 s_branch L_r_2022
L_x_2025:
 s_mov_b32 s92, 200000
L_spin_2027:
 buffer_load_dwordx4 v[160:163], v122, s[28:31], s67 offen offset:0 sc1
 buffer_load_dwordx4 v[164:167], v122, s[28:31], s67 offen offset:2048 sc1
 buffer_load_dwordx4 v[168:171], v122, s[28:31], s67 offen offset:256 sc1
 buffer_load_dwordx4 v[172:175], v122, s[28:31], s67 offen offset:2304 sc1
 s_waitcnt vmcnt(0)
 v_max3_u32 v13, v160, v161, v162
 v_max3_u32 v13, v13, v163, v164
 v_max3_u32 v13, v13, v165, v166
 v_max3_u32 v13, v13, v167, v168
 v_max3_u32 v13, v13, v169, v170
 v_max3_u32 v13, v13, v171, v172
 v_max3_u32 v13, v13, v173, v174
 v_max_u32 v13, v13, v175
 v_cmp_eq_u32 vcc, -1, v13
 s_sub_u32 s92, s92, 1
 s_cbranch_scc1 L_r_2026
 s_cmp_lg_u64 vcc, 0
 s_cbranch_scc1 L_spin_2027
 buffer_load_dwordx4 v[176:179], v122, s[28:31], s70 offen offset:0 sc1
 buffer_load_dwordx4 v[180:183], v122, s[28:31], s70 offen offset:2048 sc1
 buffer_load_dwordx4 v[184:187], v122, s[28:31], s70 offen offset:256 sc1
 buffer_load_dwordx4 v[188:191], v122, s[28:31], s70 offen offset:2304 sc1
 s_branch L_r_2026
L_x_2028:
 s_mov_b32 s92, 200000
L_spin_2030:
 buffer_load_dwordx4 v[176:179], v122, s[28:31], s70 offen offset:0 sc1
 buffer_load_dwordx4 v[180:183], v122, s[28:31], s70 offen offset:2048 sc1
 buffer_load_dwordx4 v[184:187], v122, s[28:31], s70 offen offset:256 sc1
 buffer_load_dwordx4 v[188:191], v122, s[28:31], s70 offen offset:2304 sc1
 s_waitcnt vmcnt(0)
 v_max3_u32 v13, v176, v177, v178
 v_max3_u32 v13, v13, v179, v180
 v_max3_u32 v13, v13, v181, v182
 v_max3_u32 v13, v13, v183, v184
 v_max3_u32 v13, v13, v185, v186
 v_max3_u32 v13, v13, v187, v188
 v_max3_u32 v13, v13, v189, v190
 v_max_u32 v13, v13, v191
 v_cmp_eq_u32 vcc, -1, v13
 s_sub_u32 s92, s92, 1
 s_cbranch_scc1 L_r_2029
 s_cmp_lg_u64 vcc, 0
 s_cbranch_scc1 L_spin_2030
 s_branch L_r_2029
L_slow1:
 s_nop 11
 s_lshl_b32 s62, s94, 11
 s_add_u32 s62, s62, 0x10000
 v_subrev_u32 v108, s62, v113
 v_subrev_u32 v109, s62, v114
 s_sub_u32 s67, s66, s53
 s_mov_b32 s62, s67
 s_mov_b32 s92, 64
 v_mov_b32 v110, 0xff800000
L_slowA1:
 buffer_load_dwordx4 v[104:107], v108, s[28:31], s62 offen sc1
 s_waitcnt vmcnt(0)
 v_mfma_f32_32x32x16_bf16 v[160:175], v[104:107], v[148:151], 0
 s_add_u32 s62, s62, 2048
 s_nop 10
 v_max3_f32 v110, v110, v160, v161
 v_max3_f32 v110, v110, v162, v163
 v_max3_f32 v110, v110, v164, v165
 v_max3_f32 v110, v110, v166, v167
 v_max3_f32 v110, v110, v168, v169
 v_max3_f32 v110, v110, v170, v171
 v_max3_f32 v110, v110, v172, v173
 v_max3_f32 v110, v110, v174, v175
 s_sub_u32 s92, s92, 1
 s_cmp_lg_u32 s92, 0
 s_cbranch_scc1 L_slowA1
 v_mov_b32 v111, v110
 s_nop 1
 v_permlane32_swap_b32 v111, v110
 v_max_f32 v110, v110, v111
 v_sub_f32 v176, 0, v110
 v_mov_b32 v48, 0
 v_sub_f32 v177, 0, v110
 v_mov_b32 v49, 0
 v_sub_f32 v178, 0, v110
 v_mov_b32 v50, 0
 v_sub_f32 v179, 0, v110
 v_mov_b32 v51, 0
 v_sub_f32 v180, 0, v110
 v_mov_b32 v52, 0
 v_sub_f32 v181, 0, v110
 v_mov_b32 v53, 0
 v_sub_f32 v182, 0, v110
 v_mov_b32 v54, 0
 v_sub_f32 v183, 0, v110
 v_mov_b32 v55, 0
 v_sub_f32 v184, 0, v110
 v_mov_b32 v56, 0
 v_sub_f32 v185, 0, v110
 v_mov_b32 v57, 0
 v_sub_f32 v186, 0, v110
 v_mov_b32 v58, 0
 v_sub_f32 v187, 0, v110
 v_mov_b32 v59, 0
 v_sub_f32 v188, 0, v110
 v_mov_b32 v60, 0
 v_sub_f32 v189, 0, v110
 v_mov_b32 v61, 0
 v_sub_f32 v190, 0, v110
 v_mov_b32 v62, 0
 v_sub_f32 v191, 0, v110
 v_mov_b32 v63, 0
 s_mov_b32 s62, s67
 s_mov_b32 s92, 64
L_slowB1:
 buffer_load_dwordx4 v[104:107], v108, s[28:31], s62 offen sc1
 s_mov_b64 exec, s[96:97]
 buffer_load_dwordx4 v[128:131], v109, s[28:31], s62 offen offset:1024 sc1
 buffer_load_dwordx4 v[132:135], v109, s[28:31], s62 offen offset:1536 sc1
 s_mov_b64 exec, -1
 s_waitcnt vmcnt(0)
 v_mfma_f32_32x32x16_bf16 v[160:175], v[104:107], v[148:151], v[176:191]
 s_add_u32 s62, s62, 2048
 s_nop 10
 v_exp_f32 v160, v160
 v_exp_f32 v161, v161
 v_exp_f32 v162, v162
 v_exp_f32 v163, v163
 v_exp_f32 v164, v164
 v_exp_f32 v165, v165
 v_exp_f32 v166, v166
 v_exp_f32 v167, v167
 v_exp_f32 v168, v168
 v_exp_f32 v169, v169
 v_exp_f32 v170, v170
 v_exp_f32 v171, v171
 v_exp_f32 v172, v172
 v_exp_f32 v173, v173
 v_exp_f32 v174, v174
 v_exp_f32 v175, v175
 v_smfmac_f32_32x32x32_bf16 v[48:63], v[128:131], v[160:167], v112
 s_nop 0
 v_smfmac_f32_32x32x32_bf16 v[48:63], v[132:135], v[168:175], v112
 s_sub_u32 s92, s92, 1
 s_cmp_lg_u32 s92, 0
 s_nop 11
 s_cbranch_scc1 L_slowB1
 s_branch L_slowret1
.p2align 12
.skip 1024
L_v2:
 s_waitcnt vmcnt(5)
 s_barrier
 ds_read_b128 v[128:131], v5 offset:0
 ds_read_b128 v[132:135], v5 offset:2048
 ds_read_b128 v[136:139], v6 offset:0
 ds_read_b128 v[140:143], v6 offset:2048
 ds_read_b64_tr_b16 v[80:81], v7 offset:0
 ds_read_b64_tr_b16 v[82:83], v7 offset:512
 ds_read_b64_tr_b16 v[84:85], v7 offset:4096
 ds_read_b64_tr_b16 v[86:87], v7 offset:4608
 ds_read_b64_tr_b16 v[88:89], v8 offset:0
 ds_read_b64_tr_b16 v[90:91], v8 offset:512
 ds_read_b64_tr_b16 v[92:93], v8 offset:4096
 ds_read_b64_tr_b16 v[94:95], v8 offset:4608
 s_waitcnt lgkmcnt(4)
 v_mfma_f32_16x16x32_bf16 v[16:19], v[80:83], v[128:131], 0
 s_setprio 1
 ds_read_b64_tr_b16 v[96:97], v9 offset:0
 v_mfma_f32_16x16x32_bf16 v[16:19], v[84:87], v[136:139], v[16:19]
 ds_read_b64_tr_b16 v[98:99], v9 offset:512
 v_mfma_f32_16x16x32_bf16 v[20:23], v[80:83], v[132:135], 0
 ds_read_b64_tr_b16 v[100:101], v9 offset:4096
 v_mfma_f32_16x16x32_bf16 v[20:23], v[84:87], v[140:143], v[20:23]
 s_setprio 0
 ds_read_b64_tr_b16 v[102:103], v9 offset:4608
 s_add_u32 s91, s60, 2
 s_and_b32 s91, s91, 7
 s_add_u32 m0, s53, 32768
 s_lshl_b32 s86, s91, 7
 buffer_load_dwordx4 v1, s[4:7], s86 offen lds
 s_waitcnt lgkmcnt(4)
 v_mfma_f32_16x16x32_bf16 v[24:27], v[88:91], v[128:131], 0
 s_setprio 1
 ds_read_b64_tr_b16 v[80:81], v10 offset:0
 v_mfma_f32_16x16x32_bf16 v[24:27], v[92:95], v[136:139], v[24:27]
 ds_read_b64_tr_b16 v[82:83], v10 offset:512
 v_mfma_f32_16x16x32_bf16 v[28:31], v[88:91], v[132:135], 0
 ds_read_b64_tr_b16 v[84:85], v10 offset:4096
 v_mfma_f32_16x16x32_bf16 v[28:31], v[92:95], v[140:143], v[28:31]
 s_setprio 0
 ds_read_b64_tr_b16 v[86:87], v10 offset:4608
 s_add_u32 m0, s53, 40960
 s_add_u32 s86, s86, 65536
 buffer_load_dwordx4 v1, s[4:7], s86 offen lds
 s_waitcnt lgkmcnt(4)
 v_mfma_f32_16x16x32_bf16 v[32:35], v[96:99], v[128:131], 0
 s_setprio 1
 ds_read_b64_tr_b16 v[88:89], v9 offset:8192
 v_mfma_f32_16x16x32_bf16 v[32:35], v[100:103], v[136:139], v[32:35]
 ds_read_b64_tr_b16 v[90:91], v9 offset:8704
 v_mfma_f32_16x16x32_bf16 v[36:39], v[96:99], v[132:135], 0
 ds_read_b64_tr_b16 v[92:93], v9 offset:12288
 v_mfma_f32_16x16x32_bf16 v[36:39], v[100:103], v[140:143], v[36:39]
 s_setprio 0
 ds_read_b64_tr_b16 v[94:95], v9 offset:12800
 s_and_b32 s62, s55, 7
 s_mul_i32 s62, s62, 229376
 s_bitcmp1_b32 s54, 0
 s_cselect_b32 s62, 0x10000000, s62
 buffer_load_dword v125, v4, s[20:23], s62 offen
 buffer_load_dword v125, v4, s[24:27], s62 offen
 s_waitcnt lgkmcnt(4)
 v_mfma_f32_16x16x32_bf16 v[40:43], v[80:83], v[128:131], 0
 s_setprio 1
 ds_read_b64_tr_b16 v[96:97], v10 offset:8192
 v_mfma_f32_16x16x32_bf16 v[40:43], v[84:87], v[136:139], v[40:43]
 ds_read_b64_tr_b16 v[98:99], v10 offset:8704
 v_mfma_f32_16x16x32_bf16 v[44:47], v[80:83], v[132:135], 0
 ds_read_b64_tr_b16 v[100:101], v10 offset:12288
 v_mfma_f32_16x16x32_bf16 v[44:47], v[84:87], v[140:143], v[44:47]
 s_setprio 0
 ds_read_b64_tr_b16 v[102:103], v10 offset:12800
 s_add_u32 m0, s53, 81920
 s_mul_i32 s88, s91, 196608
 buffer_load_dwordx4 v2, s[8:11], s88 offen lds
 s_waitcnt vmcnt(7)
 s_barrier
 s_or_b32 s62, s2, s52
 s_cbranch_scc0 L_x_3001
L_r_3002:
 s_waitcnt lgkmcnt(4)
 v_mfma_f32_16x16x32_bf16 v[48:51], v[88:91], v[128:131], 0
 s_setprio 1
 ds_read_b128 v[144:147], v5 offset:16384
 ds_read_b64_tr_b16 v[80:81], v7 offset:8192
 v_mfma_f32_16x16x32_bf16 v[48:51], v[92:95], v[136:139], v[48:51]
 ds_read_b128 v[148:151], v5 offset:18432
 ds_read_b64_tr_b16 v[82:83], v7 offset:8704
 v_mfma_f32_16x16x32_bf16 v[52:55], v[88:91], v[132:135], 0
 ds_read_b128 v[152:155], v6 offset:16384
 ds_read_b64_tr_b16 v[84:85], v7 offset:12288
 v_mfma_f32_16x16x32_bf16 v[52:55], v[92:95], v[140:143], v[52:55]
 s_setprio 0
 ds_read_b128 v[156:159], v6 offset:18432
 ds_read_b64_tr_b16 v[86:87], v7 offset:12800
 s_add_u32 m0, s53, 131072
 s_mul_i32 s89, s91, s61
 buffer_load_dwordx4 v3, s[12:15], s89 offen lds
 s_add_u32 m0, s53, 139264
 s_add_u32 s89, s89, s87
 buffer_load_dwordx4 v3, s[16:19], s89 offen lds
 s_waitcnt lgkmcnt(8)
 v_mfma_f32_16x16x32_bf16 v[56:59], v[96:99], v[128:131], 0
 s_setprio 1
 ds_read_b64_tr_b16 v[88:89], v8 offset:8192
 v_mfma_f32_16x16x32_bf16 v[56:59], v[100:103], v[136:139], v[56:59]
 ds_read_b64_tr_b16 v[90:91], v8 offset:8704
 v_mfma_f32_16x16x32_bf16 v[60:63], v[96:99], v[132:135], 0
 ds_read_b64_tr_b16 v[92:93], v8 offset:12288
 v_mfma_f32_16x16x32_bf16 v[60:63], v[100:103], v[140:143], v[60:63]
 s_setprio 0
 ds_read_b64_tr_b16 v[94:95], v8 offset:12800
 s_add_u32 s91, s60, 3
 s_and_b32 s91, s91, 7
 s_add_u32 m0, s53, 49152
 s_lshl_b32 s86, s91, 7
 buffer_load_dwordx4 v1, s[4:7], s86 offen lds
 s_waitcnt vmcnt(8)
 s_barrier
 s_waitcnt lgkmcnt(4)
 v_mfma_f32_16x16x32_bf16 v[16:19], v[80:83], v[144:147], v[16:19]
 s_setprio 1
 ds_read_b64_tr_b16 v[96:97], v9 offset:16384
 v_mfma_f32_16x16x32_bf16 v[16:19], v[84:87], v[152:155], v[16:19]
 ds_read_b64_tr_b16 v[98:99], v9 offset:16896
 v_mfma_f32_16x16x32_bf16 v[20:23], v[80:83], v[148:151], v[20:23]
 ds_read_b64_tr_b16 v[100:101], v9 offset:20480
 v_mfma_f32_16x16x32_bf16 v[20:23], v[84:87], v[156:159], v[20:23]
 s_setprio 0
 ds_read_b64_tr_b16 v[102:103], v9 offset:20992
 s_add_u32 m0, s53, 57344
 s_add_u32 s86, s86, 65536
 buffer_load_dwordx4 v1, s[4:7], s86 offen lds
 buffer_load_dwordx4 v[64:67], v126, s[4:7], s80 offen
 buffer_load_dwordx4 v[68:71], v126, s[48:51], 0 offen
 s_waitcnt lgkmcnt(4)
 v_mfma_f32_16x16x32_bf16 v[24:27], v[88:91], v[144:147], v[24:27]
 s_setprio 1
 ds_read_b64_tr_b16 v[80:81], v10 offset:16384
 v_mfma_f32_16x16x32_bf16 v[24:27], v[92:95], v[152:155], v[24:27]
 ds_read_b64_tr_b16 v[82:83], v10 offset:16896
 v_mfma_f32_16x16x32_bf16 v[28:31], v[88:91], v[148:151], v[28:31]
 ds_read_b64_tr_b16 v[84:85], v10 offset:20480
 v_mfma_f32_16x16x32_bf16 v[28:31], v[92:95], v[156:159], v[28:31]
 s_setprio 0
 ds_read_b64_tr_b16 v[86:87], v10 offset:20992
 s_add_u32 m0, s53, 90112
 s_mul_i32 s88, s91, 196608
 buffer_load_dwordx4 v2, s[8:11], s88 offen lds
 s_waitcnt lgkmcnt(4)
 v_mfma_f32_16x16x32_bf16 v[32:35], v[96:99], v[144:147], v[32:35]
 s_setprio 1
 ds_read_b64_tr_b16 v[88:89], v9 offset:24576
 v_mfma_f32_16x16x32_bf16 v[32:35], v[100:103], v[152:155], v[32:35]
 ds_read_b64_tr_b16 v[90:91], v9 offset:25088
 v_mfma_f32_16x16x32_bf16 v[36:39], v[96:99], v[148:151], v[36:39]
 ds_read_b64_tr_b16 v[92:93], v9 offset:28672
 v_mfma_f32_16x16x32_bf16 v[36:39], v[100:103], v[156:159], v[36:39]
 s_setprio 0
 ds_read_b64_tr_b16 v[94:95], v9 offset:29184
 s_add_u32 m0, s53, 147456
 s_mul_i32 s89, s91, s61
 buffer_load_dwordx4 v3, s[12:15], s89 offen lds
 s_waitcnt lgkmcnt(4)
 v_mfma_f32_16x16x32_bf16 v[40:43], v[80:83], v[144:147], v[40:43]
 s_setprio 1
 ds_read_b64_tr_b16 v[96:97], v10 offset:24576
 v_mfma_f32_16x16x32_bf16 v[40:43], v[84:87], v[152:155], v[40:43]
 ds_read_b64_tr_b16 v[98:99], v10 offset:25088
 v_mfma_f32_16x16x32_bf16 v[44:47], v[80:83], v[148:151], v[44:47]
 ds_read_b64_tr_b16 v[100:101], v10 offset:28672
 v_mfma_f32_16x16x32_bf16 v[44:47], v[84:87], v[156:159], v[44:47]
 s_setprio 0
 ds_read_b64_tr_b16 v[102:103], v10 offset:29184
 s_add_u32 m0, s53, 155648
 s_add_u32 s89, s89, s87
 buffer_load_dwordx4 v3, s[16:19], s89 offen lds
 s_waitcnt vmcnt(7)
 s_barrier
 s_waitcnt lgkmcnt(4)
 v_mfma_f32_16x16x32_bf16 v[48:51], v[88:91], v[144:147], v[48:51]
 s_setprio 1
 ds_read_b128 v[160:163], v5 offset:32768
 ds_read_b64_tr_b16 v[80:81], v7 offset:16384
 v_mfma_f32_16x16x32_bf16 v[48:51], v[92:95], v[152:155], v[48:51]
 ds_read_b128 v[164:167], v5 offset:34816
 ds_read_b64_tr_b16 v[82:83], v7 offset:16896
 v_mfma_f32_16x16x32_bf16 v[52:55], v[88:91], v[148:151], v[52:55]
 ds_read_b128 v[168:171], v6 offset:32768
 ds_read_b64_tr_b16 v[84:85], v7 offset:20480
 v_mfma_f32_16x16x32_bf16 v[52:55], v[92:95], v[156:159], v[52:55]
 s_setprio 0
 ds_read_b128 v[172:175], v6 offset:34816
 ds_read_b64_tr_b16 v[86:87], v7 offset:20992
 s_add_u32 s91, s60, 4
 s_and_b32 s91, s91, 7
 s_add_u32 m0, s53, 0
 s_lshl_b32 s86, s91, 7
 buffer_load_dwordx4 v1, s[4:7], s86 offen lds
 s_waitcnt lgkmcnt(8)
 v_mfma_f32_16x16x32_bf16 v[56:59], v[96:99], v[144:147], v[56:59]
 s_setprio 1
 ds_read_b64_tr_b16 v[88:89], v8 offset:16384
 v_mfma_f32_16x16x32_bf16 v[56:59], v[100:103], v[152:155], v[56:59]
 ds_read_b64_tr_b16 v[90:91], v8 offset:16896
 v_mfma_f32_16x16x32_bf16 v[60:63], v[96:99], v[148:151], v[60:63]
 ds_read_b64_tr_b16 v[92:93], v8 offset:20480
 v_mfma_f32_16x16x32_bf16 v[60:63], v[100:103], v[156:159], v[60:63]
 s_setprio 0
 ds_read_b64_tr_b16 v[94:95], v8 offset:20992
 s_add_u32 m0, s53, 8192
 s_add_u32 s86, s86, 65536
 buffer_load_dwordx4 v1, s[4:7], s86 offen lds
 s_waitcnt lgkmcnt(4)
 v_mfma_f32_16x16x32_bf16 v[16:19], v[80:83], v[160:163], v[16:19]
 s_setprio 1
 ds_read_b64_tr_b16 v[96:97], v9 offset:32768
 v_mfma_f32_16x16x32_bf16 v[16:19], v[84:87], v[168:171], v[16:19]
 ds_read_b64_tr_b16 v[98:99], v9 offset:33280
 v_mfma_f32_16x16x32_bf16 v[20:23], v[80:83], v[164:167], v[20:23]
 ds_read_b64_tr_b16 v[100:101], v9 offset:36864
 v_mfma_f32_16x16x32_bf16 v[20:23], v[84:87], v[172:175], v[20:23]
 s_setprio 0
 ds_read_b64_tr_b16 v[102:103], v9 offset:37376
 s_add_u32 m0, s53, 65536
 s_mul_i32 s88, s91, 196608
 buffer_load_dwordx4 v2, s[8:11], s88 offen lds
 s_waitcnt lgkmcnt(4)
 v_mfma_f32_16x16x32_bf16 v[24:27], v[88:91], v[160:163], v[24:27]
 s_setprio 1
 ds_read_b64_tr_b16 v[80:81], v10 offset:32768
 v_mfma_f32_16x16x32_bf16 v[24:27], v[92:95], v[168:171], v[24:27]
 ds_read_b64_tr_b16 v[82:83], v10 offset:33280
 v_mfma_f32_16x16x32_bf16 v[28:31], v[88:91], v[164:167], v[28:31]
 ds_read_b64_tr_b16 v[84:85], v10 offset:36864
 v_mfma_f32_16x16x32_bf16 v[28:31], v[92:95], v[172:175], v[28:31]
 s_setprio 0
 ds_read_b64_tr_b16 v[86:87], v10 offset:37376
 s_add_u32 m0, s53, 98304
 s_mul_i32 s89, s91, s61
 buffer_load_dwordx4 v3, s[12:15], s89 offen lds
 s_waitcnt lgkmcnt(4)
 v_mfma_f32_16x16x32_bf16 v[32:35], v[96:99], v[160:163], v[32:35]
 s_setprio 1
 ds_read_b64_tr_b16 v[88:89], v9 offset:40960
 v_mfma_f32_16x16x32_bf16 v[32:35], v[100:103], v[168:171], v[32:35]
 ds_read_b64_tr_b16 v[90:91], v9 offset:41472
 v_mfma_f32_16x16x32_bf16 v[36:39], v[96:99], v[164:167], v[36:39]
 ds_read_b64_tr_b16 v[92:93], v9 offset:45056
 v_mfma_f32_16x16x32_bf16 v[36:39], v[100:103], v[172:175], v[36:39]
 s_setprio 0
 ds_read_b64_tr_b16 v[94:95], v9 offset:45568
 s_add_u32 m0, s53, 106496
 s_add_u32 s89, s89, s87
 buffer_load_dwordx4 v3, s[16:19], s89 offen lds
 v_mov_b32 v76, -1
 v_mov_b32 v77, -1
 v_mov_b32 v78, -1
 v_mov_b32 v79, -1
 s_lshl_b32 s67, s58, 3
 s_add_u32 s67, s67, s52
 s_waitcnt lgkmcnt(4)
 v_mfma_f32_16x16x32_bf16 v[40:43], v[80:83], v[160:163], v[40:43]
 s_setprio 1
 ds_read_b64_tr_b16 v[96:97], v10 offset:40960
 v_mfma_f32_16x16x32_bf16 v[40:43], v[84:87], v[168:171], v[40:43]
 ds_read_b64_tr_b16 v[98:99], v10 offset:41472
 v_mfma_f32_16x16x32_bf16 v[44:47], v[80:83], v[164:167], v[44:47]
 ds_read_b64_tr_b16 v[100:101], v10 offset:45056
 v_mfma_f32_16x16x32_bf16 v[44:47], v[84:87], v[172:175], v[44:47]
 s_setprio 0
 ds_read_b64_tr_b16 v[102:103], v10 offset:45568
 s_lshl_b32 s67, s67, 4
 s_add_u32 s67, s67, s56
 s_lshl_b32 s67, s67, 2
 s_add_u32 s67, s67, s59
 s_lshl_b32 s67, s67, 10
 s_add_u32 s67, s67, 1048576
 buffer_store_dwordx4 v[76:79], v126, s[28:31], s67 offen offset:0 sc1
 s_waitcnt vmcnt(2)
 s_barrier
 s_waitcnt lgkmcnt(4)
 v_mfma_f32_16x16x32_bf16 v[48:51], v[88:91], v[160:163], v[48:51]
 s_setprio 1
 ds_read_b128 v[176:179], v5 offset:49152
 ds_read_b64_tr_b16 v[80:81], v7 offset:24576
 v_mfma_f32_16x16x32_bf16 v[48:51], v[92:95], v[168:171], v[48:51]
 ds_read_b128 v[180:183], v5 offset:51200
 ds_read_b64_tr_b16 v[82:83], v7 offset:25088
 v_mfma_f32_16x16x32_bf16 v[52:55], v[88:91], v[164:167], v[52:55]
 ds_read_b128 v[184:187], v6 offset:49152
 ds_read_b64_tr_b16 v[84:85], v7 offset:28672
 v_mfma_f32_16x16x32_bf16 v[52:55], v[92:95], v[172:175], v[52:55]
 s_setprio 0
 ds_read_b128 v[188:191], v6 offset:51200
 ds_read_b64_tr_b16 v[86:87], v7 offset:29184
 s_add_u32 s91, s60, 5
 s_and_b32 s91, s91, 7
 s_add_u32 m0, s53, 16384
 s_lshl_b32 s86, s91, 7
 buffer_load_dwordx4 v1, s[4:7], s86 offen lds
 s_waitcnt lgkmcnt(8)
 v_mfma_f32_16x16x32_bf16 v[56:59], v[96:99], v[160:163], v[56:59]
 s_setprio 1
 ds_read_b64_tr_b16 v[88:89], v8 offset:24576
 v_mfma_f32_16x16x32_bf16 v[56:59], v[100:103], v[168:171], v[56:59]
 ds_read_b64_tr_b16 v[90:91], v8 offset:25088
 v_mfma_f32_16x16x32_bf16 v[60:63], v[96:99], v[164:167], v[60:63]
 ds_read_b64_tr_b16 v[92:93], v8 offset:28672
 v_mfma_f32_16x16x32_bf16 v[60:63], v[100:103], v[172:175], v[60:63]
 s_setprio 0
 ds_read_b64_tr_b16 v[94:95], v8 offset:29184
 s_add_u32 m0, s53, 24576
 s_add_u32 s86, s86, 65536
 buffer_load_dwordx4 v1, s[4:7], s86 offen lds
 v_mov_b32 v13, 0
 v_lshlrev_b32 v73, 16, v68
 v_and_b32 v75, 0xffff0000, v68
 v_lshlrev_b32 v72, 16, v64
 v_and_b32 v74, 0xffff0000, v64
 v_fmac_f32 v13, v72, v73
 v_fmac_f32 v13, v74, v75
 v_lshlrev_b32 v73, 16, v69
 v_and_b32 v75, 0xffff0000, v69
 s_waitcnt lgkmcnt(4)
 v_mfma_f32_16x16x32_bf16 v[16:19], v[80:83], v[176:179], v[16:19]
 s_setprio 1
 ds_read_b64_tr_b16 v[96:97], v9 offset:49152
 v_mfma_f32_16x16x32_bf16 v[16:19], v[84:87], v[184:187], v[16:19]
 ds_read_b64_tr_b16 v[98:99], v9 offset:49664
 v_mfma_f32_16x16x32_bf16 v[20:23], v[80:83], v[180:183], v[20:23]
 ds_read_b64_tr_b16 v[100:101], v9 offset:53248
 v_mfma_f32_16x16x32_bf16 v[20:23], v[84:87], v[188:191], v[20:23]
 s_setprio 0
 ds_read_b64_tr_b16 v[102:103], v9 offset:53760
 s_add_u32 m0, s53, 73728
 s_mul_i32 s88, s91, 196608
 buffer_load_dwordx4 v2, s[8:11], s88 offen lds
 v_lshlrev_b32 v72, 16, v65
 v_and_b32 v74, 0xffff0000, v65
 v_fmac_f32 v13, v72, v73
 v_fmac_f32 v13, v74, v75
 v_lshlrev_b32 v73, 16, v70
 v_and_b32 v75, 0xffff0000, v70
 v_lshlrev_b32 v72, 16, v66
 v_and_b32 v74, 0xffff0000, v66
 v_fmac_f32 v13, v72, v73
 s_waitcnt lgkmcnt(4)
 v_mfma_f32_16x16x32_bf16 v[24:27], v[88:91], v[176:179], v[24:27]
 s_setprio 1
 ds_read_b64_tr_b16 v[80:81], v10 offset:49152
 v_mfma_f32_16x16x32_bf16 v[24:27], v[92:95], v[184:187], v[24:27]
 ds_read_b64_tr_b16 v[82:83], v10 offset:49664
 v_mfma_f32_16x16x32_bf16 v[28:31], v[88:91], v[180:183], v[28:31]
 ds_read_b64_tr_b16 v[84:85], v10 offset:53248
 v_mfma_f32_16x16x32_bf16 v[28:31], v[92:95], v[188:191], v[28:31]
 s_setprio 0
 ds_read_b64_tr_b16 v[86:87], v10 offset:53760
 s_add_u32 m0, s53, 114688
 s_mul_i32 s89, s91, s61
 buffer_load_dwordx4 v3, s[12:15], s89 offen lds
 v_fmac_f32 v13, v74, v75
 v_lshlrev_b32 v73, 16, v71
 v_and_b32 v75, 0xffff0000, v71
 v_lshlrev_b32 v72, 16, v67
 v_and_b32 v74, 0xffff0000, v67
 v_fmac_f32 v13, v72, v73
 v_fmac_f32 v13, v74, v75
 s_nop 1
 v_add_f32_dpp v13, v13, v13 row_shr:1 row_mask:0xf bank_mask:0xf
 s_waitcnt lgkmcnt(4)
 v_mfma_f32_16x16x32_bf16 v[32:35], v[96:99], v[176:179], v[32:35]
 s_setprio 1
 ds_read_b64_tr_b16 v[88:89], v9 offset:57344
 v_mfma_f32_16x16x32_bf16 v[32:35], v[100:103], v[184:187], v[32:35]
 ds_read_b64_tr_b16 v[90:91], v9 offset:57856
 v_mfma_f32_16x16x32_bf16 v[36:39], v[96:99], v[180:183], v[36:39]
 ds_read_b64_tr_b16 v[92:93], v9 offset:61440
 v_mfma_f32_16x16x32_bf16 v[36:39], v[100:103], v[188:191], v[36:39]
 s_setprio 0
 ds_read_b64_tr_b16 v[94:95], v9 offset:61952
 s_add_u32 m0, s53, 122880
 s_add_u32 s89, s89, s87
 buffer_load_dwordx4 v3, s[16:19], s89 offen lds
 v_add_f32_dpp v13, v13, v13 row_shr:2 row_mask:0xf bank_mask:0xf
 s_waitcnt lgkmcnt(4)
 v_mfma_f32_16x16x32_bf16 v[40:43], v[80:83], v[176:179], v[40:43]
 s_setprio 1
 ds_read_b64_tr_b16 v[96:97], v10 offset:57344
 v_mfma_f32_16x16x32_bf16 v[40:43], v[84:87], v[184:187], v[40:43]
 ds_read_b64_tr_b16 v[98:99], v10 offset:57856
 v_mfma_f32_16x16x32_bf16 v[44:47], v[80:83], v[180:183], v[44:47]
 ds_read_b64_tr_b16 v[100:101], v10 offset:61440
 v_mfma_f32_16x16x32_bf16 v[44:47], v[84:87], v[188:191], v[44:47]
 s_setprio 0
 ds_read_b64_tr_b16 v[102:103], v10 offset:61952
 v_add_f32_dpp v13, v13, v13 row_shr:4 row_mask:0xf bank_mask:0xf
 s_waitcnt vmcnt(6)
 s_barrier
 s_cmp_lg_u32 s52, 0
 s_cbranch_scc1 L_s_3003
 buffer_load_dword v121, v118, s[44:47], 0 offen sc1
L_s_3003:
 s_waitcnt lgkmcnt(4)
 v_mfma_f32_16x16x32_bf16 v[48:51], v[88:91], v[176:179], v[48:51]
 s_setprio 1
 ds_read_b128 v[192:195], v5 offset:0
 ds_read_b64_tr_b16 v[80:81], v7 offset:0
 v_mfma_f32_16x16x32_bf16 v[48:51], v[92:95], v[184:187], v[48:51]
 ds_read_b128 v[196:199], v5 offset:2048
 ds_read_b64_tr_b16 v[82:83], v7 offset:512
 v_mfma_f32_16x16x32_bf16 v[52:55], v[88:91], v[180:183], v[52:55]
 ds_read_b128 v[200:203], v6 offset:0
 ds_read_b64_tr_b16 v[84:85], v7 offset:4096
 v_mfma_f32_16x16x32_bf16 v[52:55], v[92:95], v[188:191], v[52:55]
 s_setprio 0
 ds_read_b128 v[204:207], v6 offset:2048
 ds_read_b64_tr_b16 v[86:87], v7 offset:4608
 s_add_u32 s91, s60, 6
 s_and_b32 s91, s91, 7
 s_add_u32 m0, s53, 32768
 s_lshl_b32 s86, s91, 7
 buffer_load_dwordx4 v1, s[4:7], s86 offen lds
 s_waitcnt lgkmcnt(8)
 v_mfma_f32_16x16x32_bf16 v[56:59], v[96:99], v[176:179], v[56:59]
 s_setprio 1
 ds_read_b64_tr_b16 v[88:89], v8 offset:0
 v_mfma_f32_16x16x32_bf16 v[56:59], v[100:103], v[184:187], v[56:59]
 ds_read_b64_tr_b16 v[90:91], v8 offset:512
 v_mfma_f32_16x16x32_bf16 v[60:63], v[96:99], v[180:183], v[60:63]
 ds_read_b64_tr_b16 v[92:93], v8 offset:4096
 v_mfma_f32_16x16x32_bf16 v[60:63], v[100:103], v[188:191], v[60:63]
 s_setprio 0
 ds_read_b64_tr_b16 v[94:95], v8 offset:4608
 s_add_u32 m0, s53, 40960
 s_add_u32 s86, s86, 65536
 buffer_load_dwordx4 v1, s[4:7], s86 offen lds
 v_add_f32_dpp v13, v13, v13 row_shr:8 row_mask:0xf bank_mask:0xf
 s_waitcnt lgkmcnt(4)
 v_mfma_f32_16x16x32_bf16 v[16:19], v[80:83], v[192:195], v[16:19]
 s_setprio 1
 ds_read_b64_tr_b16 v[96:97], v9 offset:0
 v_mfma_f32_16x16x32_bf16 v[16:19], v[84:87], v[200:203], v[16:19]
 ds_read_b64_tr_b16 v[98:99], v9 offset:512
 v_mfma_f32_16x16x32_bf16 v[20:23], v[80:83], v[196:199], v[20:23]
 ds_read_b64_tr_b16 v[100:101], v9 offset:4096
 v_mfma_f32_16x16x32_bf16 v[20:23], v[84:87], v[204:207], v[20:23]
 s_setprio 0
 ds_read_b64_tr_b16 v[102:103], v9 offset:4608
 s_add_u32 m0, s53, 81920
 s_mul_i32 s88, s91, 196608
 buffer_load_dwordx4 v2, s[8:11], s88 offen lds
 v_add_f32_dpp v13, v13, v13 row_bcast:15 row_mask:0xa bank_mask:0xf
 s_waitcnt lgkmcnt(4)
 v_mfma_f32_16x16x32_bf16 v[24:27], v[88:91], v[192:195], v[24:27]
 s_setprio 1
 ds_read_b64_tr_b16 v[80:81], v10 offset:0
 v_mfma_f32_16x16x32_bf16 v[24:27], v[92:95], v[200:203], v[24:27]
 ds_read_b64_tr_b16 v[82:83], v10 offset:512
 v_mfma_f32_16x16x32_bf16 v[28:31], v[88:91], v[196:199], v[28:31]
 ds_read_b64_tr_b16 v[84:85], v10 offset:4096
 v_mfma_f32_16x16x32_bf16 v[28:31], v[92:95], v[204:207], v[28:31]
 s_setprio 0
 ds_read_b64_tr_b16 v[86:87], v10 offset:4608
 s_add_u32 m0, s53, 131072
 s_mul_i32 s89, s91, s61
 buffer_load_dwordx4 v3, s[12:15], s89 offen lds
 v_add_f32_dpp v13, v13, v13 row_bcast:31 row_mask:0xc bank_mask:0xf
 s_waitcnt lgkmcnt(4)
 v_mfma_f32_16x16x32_bf16 v[32:35], v[96:99], v[192:195], v[32:35]
 s_setprio 1
 ds_read_b64_tr_b16 v[88:89], v9 offset:8192
 v_mfma_f32_16x16x32_bf16 v[32:35], v[100:103], v[200:203], v[32:35]
 ds_read_b64_tr_b16 v[90:91], v9 offset:8704
 v_mfma_f32_16x16x32_bf16 v[36:39], v[96:99], v[196:199], v[36:39]
 ds_read_b64_tr_b16 v[92:93], v9 offset:12288
 v_mfma_f32_16x16x32_bf16 v[36:39], v[100:103], v[204:207], v[36:39]
 s_setprio 0
 ds_read_b64_tr_b16 v[94:95], v9 offset:12800
 s_add_u32 m0, s53, 139264
 s_add_u32 s89, s89, s87
 buffer_load_dwordx4 v3, s[16:19], s89 offen lds
 v_mul_f32 v13, 0x3fb8aa3b, v13
 v_or_b32 v13, 1, v13
 s_waitcnt lgkmcnt(4)
 v_mfma_f32_16x16x32_bf16 v[40:43], v[80:83], v[192:195], v[40:43]
 s_setprio 1
 ds_read_b64_tr_b16 v[96:97], v10 offset:8192
 v_mfma_f32_16x16x32_bf16 v[40:43], v[84:87], v[200:203], v[40:43]
 ds_read_b64_tr_b16 v[98:99], v10 offset:8704
 v_mfma_f32_16x16x32_bf16 v[44:47], v[80:83], v[196:199], v[44:47]
 ds_read_b64_tr_b16 v[100:101], v10 offset:12288
 v_mfma_f32_16x16x32_bf16 v[44:47], v[84:87], v[204:207], v[44:47]
 s_setprio 0
 ds_read_b64_tr_b16 v[102:103], v10 offset:12800
 s_cmp_lg_u32 s52, 0
 s_cbranch_scc1 L_s_3004
 s_waitcnt vmcnt(5)
 v_cmp_eq_u32 vcc, 0, v121
 s_nop 0
 s_cmp_lg_u64 vcc, 0
 s_cbranch_scc1 L_x_3005
L_r_3006:
L_s_3004:
 s_waitcnt vmcnt(5)
 s_barrier
 s_mov_b32 exec_lo, 0
 s_mov_b32 exec_hi, 0x80000000
 buffer_store_dword v13, v126, s[28:31], s65 offen sc1
 s_mov_b64 exec, -1
 s_waitcnt lgkmcnt(4)
 v_mfma_f32_16x16x32_bf16 v[48:51], v[88:91], v[192:195], v[48:51]
 s_setprio 1
 ds_read_b128 v[208:211], v5 offset:16384
 ds_read_b64_tr_b16 v[80:81], v7 offset:8192
 v_mfma_f32_16x16x32_bf16 v[48:51], v[92:95], v[200:203], v[48:51]
 ds_read_b128 v[212:215], v5 offset:18432
 ds_read_b64_tr_b16 v[82:83], v7 offset:8704
 v_mfma_f32_16x16x32_bf16 v[52:55], v[88:91], v[196:199], v[52:55]
 ds_read_b128 v[216:219], v6 offset:16384
 ds_read_b64_tr_b16 v[84:85], v7 offset:12288
 v_mfma_f32_16x16x32_bf16 v[52:55], v[92:95], v[204:207], v[52:55]
 s_setprio 0
 ds_read_b128 v[220:223], v6 offset:18432
 ds_read_b64_tr_b16 v[86:87], v7 offset:12800
 s_add_u32 s91, s60, 7
 s_and_b32 s91, s91, 7
 s_add_u32 m0, s53, 49152
 s_lshl_b32 s86, s91, 7
 buffer_load_dwordx4 v1, s[4:7], s86 offen lds
 s_waitcnt lgkmcnt(8)
 v_mfma_f32_16x16x32_bf16 v[56:59], v[96:99], v[192:195], v[56:59]
 s_setprio 1
 ds_read_b64_tr_b16 v[88:89], v8 offset:8192
 v_mfma_f32_16x16x32_bf16 v[56:59], v[100:103], v[200:203], v[56:59]
 ds_read_b64_tr_b16 v[90:91], v8 offset:8704
 v_mfma_f32_16x16x32_bf16 v[60:63], v[96:99], v[196:199], v[60:63]
 ds_read_b64_tr_b16 v[92:93], v8 offset:12288
 v_mfma_f32_16x16x32_bf16 v[60:63], v[100:103], v[204:207], v[60:63]
 s_setprio 0
 ds_read_b64_tr_b16 v[94:95], v8 offset:12800
 s_add_u32 m0, s53, 57344
 s_add_u32 s86, s86, 65536
 buffer_load_dwordx4 v1, s[4:7], s86 offen lds
 s_waitcnt lgkmcnt(4)
 v_mfma_f32_16x16x32_bf16 v[16:19], v[80:83], v[208:211], v[16:19]
 s_setprio 1
 ds_read_b64_tr_b16 v[96:97], v9 offset:16384
 v_mfma_f32_16x16x32_bf16 v[16:19], v[84:87], v[216:219], v[16:19]
 ds_read_b64_tr_b16 v[98:99], v9 offset:16896
 v_mfma_f32_16x16x32_bf16 v[20:23], v[80:83], v[212:215], v[20:23]
 ds_read_b64_tr_b16 v[100:101], v9 offset:20480
 v_mfma_f32_16x16x32_bf16 v[20:23], v[84:87], v[220:223], v[20:23]
 s_setprio 0
 ds_read_b64_tr_b16 v[102:103], v9 offset:20992
 s_add_u32 m0, s53, 90112
 s_mul_i32 s88, s91, 196608
 buffer_load_dwordx4 v2, s[8:11], s88 offen lds
 s_waitcnt lgkmcnt(4)
 v_mfma_f32_16x16x32_bf16 v[24:27], v[88:91], v[208:211], v[24:27]
 s_setprio 1
 ds_read_b64_tr_b16 v[80:81], v10 offset:16384
 v_mfma_f32_16x16x32_bf16 v[24:27], v[92:95], v[216:219], v[24:27]
 ds_read_b64_tr_b16 v[82:83], v10 offset:16896
 v_mfma_f32_16x16x32_bf16 v[28:31], v[88:91], v[212:215], v[28:31]
 ds_read_b64_tr_b16 v[84:85], v10 offset:20480
 v_mfma_f32_16x16x32_bf16 v[28:31], v[92:95], v[220:223], v[28:31]
 s_setprio 0
 ds_read_b64_tr_b16 v[86:87], v10 offset:20992
 s_add_u32 m0, s53, 147456
 s_mul_i32 s89, s91, s61
 buffer_load_dwordx4 v3, s[12:15], s89 offen lds
 s_waitcnt lgkmcnt(4)
 v_mfma_f32_16x16x32_bf16 v[32:35], v[96:99], v[208:211], v[32:35]
 s_setprio 1
 ds_read_b64_tr_b16 v[88:89], v9 offset:24576
 v_mfma_f32_16x16x32_bf16 v[32:35], v[100:103], v[216:219], v[32:35]
 ds_read_b64_tr_b16 v[90:91], v9 offset:25088
 v_mfma_f32_16x16x32_bf16 v[36:39], v[96:99], v[212:215], v[36:39]
 ds_read_b64_tr_b16 v[92:93], v9 offset:28672
 v_mfma_f32_16x16x32_bf16 v[36:39], v[100:103], v[220:223], v[36:39]
 s_setprio 0
 ds_read_b64_tr_b16 v[94:95], v9 offset:29184
 s_add_u32 m0, s53, 155648
 s_add_u32 s89, s89, s87
 buffer_load_dwordx4 v3, s[16:19], s89 offen lds
 s_waitcnt lgkmcnt(4)
 v_mfma_f32_16x16x32_bf16 v[40:43], v[80:83], v[208:211], v[40:43]
 s_setprio 1
 ds_read_b64_tr_b16 v[96:97], v10 offset:24576
 v_mfma_f32_16x16x32_bf16 v[40:43], v[84:87], v[216:219], v[40:43]
 ds_read_b64_tr_b16 v[98:99], v10 offset:25088
 v_mfma_f32_16x16x32_bf16 v[44:47], v[80:83], v[212:215], v[44:47]
 ds_read_b64_tr_b16 v[100:101], v10 offset:28672
 v_mfma_f32_16x16x32_bf16 v[44:47], v[84:87], v[220:223], v[44:47]
 s_setprio 0
 ds_read_b64_tr_b16 v[102:103], v10 offset:29184
 s_waitcnt vmcnt(6)
 s_barrier
 s_waitcnt lgkmcnt(4)
 v_mfma_f32_16x16x32_bf16 v[48:51], v[88:91], v[208:211], v[48:51]
 s_setprio 1
 ds_read_b128 v[224:227], v5 offset:32768
 ds_read_b64_tr_b16 v[80:81], v7 offset:16384
 v_mfma_f32_16x16x32_bf16 v[48:51], v[92:95], v[216:219], v[48:51]
 ds_read_b128 v[228:231], v5 offset:34816
 ds_read_b64_tr_b16 v[82:83], v7 offset:16896
 v_mfma_f32_16x16x32_bf16 v[52:55], v[88:91], v[212:215], v[52:55]
 ds_read_b128 v[232:235], v6 offset:32768
 ds_read_b64_tr_b16 v[84:85], v7 offset:20480
 v_mfma_f32_16x16x32_bf16 v[52:55], v[92:95], v[220:223], v[52:55]
 s_setprio 0
 ds_read_b128 v[236:239], v6 offset:34816
 ds_read_b64_tr_b16 v[86:87], v7 offset:20992
 s_add_u32 s91, s60, 0
 s_and_b32 s91, s91, 7
 s_add_u32 m0, s53, 98304
 s_mul_i32 s90, s91, 229376
 buffer_load_dwordx4 v4, s[20:23], s90 offen lds
 s_waitcnt lgkmcnt(8)
 v_mfma_f32_16x16x32_bf16 v[56:59], v[96:99], v[208:211], v[56:59]
 s_setprio 1
 ds_read_b64_tr_b16 v[88:89], v8 offset:16384
 v_mfma_f32_16x16x32_bf16 v[56:59], v[100:103], v[216:219], v[56:59]
 ds_read_b64_tr_b16 v[90:91], v8 offset:16896
 v_mfma_f32_16x16x32_bf16 v[60:63], v[96:99], v[212:215], v[60:63]
 ds_read_b64_tr_b16 v[92:93], v8 offset:20480
 v_mfma_f32_16x16x32_bf16 v[60:63], v[100:103], v[220:223], v[60:63]
 s_setprio 0
 ds_read_b64_tr_b16 v[94:95], v8 offset:20992
 s_add_u32 m0, s53, 106496
 s_nop 0
 buffer_load_dwordx4 v4, s[24:27], s90 offen lds
 s_waitcnt lgkmcnt(4)
 v_mfma_f32_16x16x32_bf16 v[16:19], v[80:83], v[224:227], v[16:19]
 s_setprio 1
 ds_read_b64_tr_b16 v[96:97], v9 offset:32768
 v_mfma_f32_16x16x32_bf16 v[16:19], v[84:87], v[232:235], v[16:19]
 ds_read_b64_tr_b16 v[98:99], v9 offset:33280
 v_mfma_f32_16x16x32_bf16 v[20:23], v[80:83], v[228:231], v[20:23]
 ds_read_b64_tr_b16 v[100:101], v9 offset:36864
 v_mfma_f32_16x16x32_bf16 v[20:23], v[84:87], v[236:239], v[20:23]
 s_setprio 0
 ds_read_b64_tr_b16 v[102:103], v9 offset:37376
 s_add_u32 s91, s60, 1
 s_and_b32 s91, s91, 7
 s_add_u32 m0, s53, 0
 s_mul_i32 s90, s91, 229376
 buffer_load_dwordx4 v4, s[20:23], s90 offen lds
 s_waitcnt lgkmcnt(4)
 v_mfma_f32_16x16x32_bf16 v[24:27], v[88:91], v[224:227], v[24:27]
 s_setprio 1
 ds_read_b64_tr_b16 v[80:81], v10 offset:32768
 v_mfma_f32_16x16x32_bf16 v[24:27], v[92:95], v[232:235], v[24:27]
 ds_read_b64_tr_b16 v[82:83], v10 offset:33280
 v_mfma_f32_16x16x32_bf16 v[28:31], v[88:91], v[228:231], v[28:31]
 ds_read_b64_tr_b16 v[84:85], v10 offset:36864
 v_mfma_f32_16x16x32_bf16 v[28:31], v[92:95], v[236:239], v[28:31]
 s_setprio 0
 ds_read_b64_tr_b16 v[86:87], v10 offset:37376
 s_add_u32 m0, s53, 8192
 s_nop 0
 buffer_load_dwordx4 v4, s[24:27], s90 offen lds
 s_waitcnt vmcnt(4)
 s_barrier
 s_waitcnt lgkmcnt(4)
 v_mfma_f32_16x16x32_bf16 v[32:35], v[96:99], v[224:227], v[32:35]
 s_setprio 1
 ds_read_b128 v[240:243], v5 offset:49152
 ds_read_b64_tr_b16 v[88:89], v7 offset:24576
 v_mfma_f32_16x16x32_bf16 v[32:35], v[100:103], v[232:235], v[32:35]
 ds_read_b128 v[244:247], v5 offset:51200
 ds_read_b64_tr_b16 v[90:91], v7 offset:25088
 v_mfma_f32_16x16x32_bf16 v[36:39], v[96:99], v[228:231], v[36:39]
 ds_read_b128 v[248:251], v6 offset:49152
 ds_read_b64_tr_b16 v[92:93], v7 offset:28672
 v_mfma_f32_16x16x32_bf16 v[36:39], v[100:103], v[236:239], v[36:39]
 s_setprio 0
 ds_read_b128 v[252:255], v6 offset:51200
 ds_read_b64_tr_b16 v[94:95], v7 offset:29184
 s_add_u32 s91, s60, 2
 s_and_b32 s91, s91, 7
 s_add_u32 m0, s53, 114688
 s_mul_i32 s90, s91, 229376
 buffer_load_dwordx4 v4, s[20:23], s90 offen lds
 s_waitcnt lgkmcnt(8)
 v_mfma_f32_16x16x32_bf16 v[40:43], v[80:83], v[224:227], v[40:43]
 s_setprio 1
 ds_read_b64_tr_b16 v[96:97], v8 offset:24576
 v_mfma_f32_16x16x32_bf16 v[40:43], v[84:87], v[232:235], v[40:43]
 ds_read_b64_tr_b16 v[98:99], v8 offset:25088
 v_mfma_f32_16x16x32_bf16 v[44:47], v[80:83], v[228:231], v[44:47]
 ds_read_b64_tr_b16 v[100:101], v8 offset:28672
 v_mfma_f32_16x16x32_bf16 v[44:47], v[84:87], v[236:239], v[44:47]
 s_setprio 0
 ds_read_b64_tr_b16 v[102:103], v8 offset:29184
 s_add_u32 m0, s53, 122880
 s_nop 0
 buffer_load_dwordx4 v4, s[24:27], s90 offen lds
 buffer_load_dword v14, v119, s[28:31], 0 offen sc1
 buffer_load_dword v15, v119, s[28:31], 0 offen offset:64 sc1
 s_waitcnt lgkmcnt(4)
 v_mfma_f32_16x16x32_bf16 v[16:19], v[88:91], v[240:243], v[16:19]
 s_setprio 1
 ds_read_b64_tr_b16 v[80:81], v9 offset:49152
 v_mfma_f32_16x16x32_bf16 v[16:19], v[92:95], v[248:251], v[16:19]
 ds_read_b64_tr_b16 v[82:83], v9 offset:49664
 v_mfma_f32_16x16x32_bf16 v[20:23], v[88:91], v[244:247], v[20:23]
 ds_read_b64_tr_b16 v[84:85], v9 offset:53248
 v_mfma_f32_16x16x32_bf16 v[20:23], v[92:95], v[252:255], v[20:23]
 s_setprio 0
 ds_read_b64_tr_b16 v[86:87], v9 offset:53760
 s_add_u32 s91, s60, 3
 s_and_b32 s91, s91, 7
 s_add_u32 m0, s53, 16384
 s_mul_i32 s90, s91, 229376
 buffer_load_dwordx4 v4, s[20:23], s90 offen lds
 s_waitcnt lgkmcnt(4)
 v_mfma_f32_16x16x32_bf16 v[24:27], v[96:99], v[240:243], v[24:27]
 s_setprio 1
 ds_read_b64_tr_b16 v[88:89], v10 offset:49152
 v_mfma_f32_16x16x32_bf16 v[24:27], v[100:103], v[248:251], v[24:27]
 ds_read_b64_tr_b16 v[90:91], v10 offset:49664
 v_mfma_f32_16x16x32_bf16 v[28:31], v[96:99], v[244:247], v[28:31]
 ds_read_b64_tr_b16 v[92:93], v10 offset:53248
 v_mfma_f32_16x16x32_bf16 v[28:31], v[100:103], v[252:255], v[28:31]
 s_setprio 0
 ds_read_b64_tr_b16 v[94:95], v10 offset:53760
 s_add_u32 m0, s53, 24576
 s_nop 0
 buffer_load_dwordx4 v4, s[24:27], s90 offen lds
 s_waitcnt lgkmcnt(4)
 v_mfma_f32_16x16x32_bf16 v[32:35], v[80:83], v[240:243], v[32:35]
 s_setprio 1
 ds_read_b64_tr_b16 v[96:97], v9 offset:40960
 v_mfma_f32_16x16x32_bf16 v[32:35], v[84:87], v[248:251], v[32:35]
 ds_read_b64_tr_b16 v[98:99], v9 offset:41472
 v_mfma_f32_16x16x32_bf16 v[36:39], v[80:83], v[244:247], v[36:39]
 ds_read_b64_tr_b16 v[100:101], v9 offset:45056
 v_mfma_f32_16x16x32_bf16 v[36:39], v[84:87], v[252:255], v[36:39]
 s_setprio 0
 ds_read_b64_tr_b16 v[102:103], v9 offset:45568
 s_lshl_b32 s67, s57, 1
 s_add_u32 s67, s67, s94
 s_lshl_b32 s67, s67, 18
 s_lshl_b32 s68, s95, 11
 s_add_u32 s67, s67, s68
 s_add_u32 s67, s67, 3145728
 s_add_u32 s68, s67, 131072
 v_mul_f32 v16, 0x3eb8aa3b, v16
 v_mul_f32 v17, 0x3eb8aa3b, v17
 v_mul_f32 v18, 0x3eb8aa3b, v18
 v_mul_f32 v19, 0x3eb8aa3b, v19
 v_mul_f32 v20, 0x3eb8aa3b, v20
 v_mul_f32 v21, 0x3eb8aa3b, v21
 v_mul_f32 v22, 0x3eb8aa3b, v22
 s_waitcnt lgkmcnt(4)
 v_mfma_f32_16x16x32_bf16 v[40:43], v[88:91], v[240:243], v[40:43]
 s_setprio 1
 ds_read_b64_tr_b16 v[80:81], v9 offset:57344
 v_mfma_f32_16x16x32_bf16 v[40:43], v[92:95], v[248:251], v[40:43]
 ds_read_b64_tr_b16 v[82:83], v9 offset:57856
 v_mfma_f32_16x16x32_bf16 v[44:47], v[88:91], v[244:247], v[44:47]
 ds_read_b64_tr_b16 v[84:85], v9 offset:61440
 v_mfma_f32_16x16x32_bf16 v[44:47], v[92:95], v[252:255], v[44:47]
 s_setprio 0
 ds_read_b64_tr_b16 v[86:87], v9 offset:61952
 v_mul_f32 v23, 0x3eb8aa3b, v23
 v_mul_f32 v24, 0x3eb8aa3b, v24
 v_mul_f32 v25, 0x3eb8aa3b, v25
 v_mul_f32 v26, 0x3eb8aa3b, v26
 v_mul_f32 v27, 0x3eb8aa3b, v27
 v_mul_f32 v28, 0x3eb8aa3b, v28
 v_mul_f32 v29, 0x3eb8aa3b, v29
 v_mul_f32 v30, 0x3eb8aa3b, v30
 v_mul_f32 v31, 0x3eb8aa3b, v31
 v_cvt_pk_bf16_f32 v104, v16, v17
 s_waitcnt lgkmcnt(4)
 v_mfma_f32_16x16x32_bf16 v[48:51], v[96:99], v[224:227], v[48:51]
 s_setprio 1
 ds_read_b64_tr_b16 v[88:89], v10 offset:40960
 v_mfma_f32_16x16x32_bf16 v[48:51], v[100:103], v[232:235], v[48:51]
 ds_read_b64_tr_b16 v[90:91], v10 offset:41472
 v_mfma_f32_16x16x32_bf16 v[52:55], v[96:99], v[228:231], v[52:55]
 ds_read_b64_tr_b16 v[92:93], v10 offset:45056
 v_mfma_f32_16x16x32_bf16 v[52:55], v[100:103], v[236:239], v[52:55]
 s_setprio 0
 ds_read_b64_tr_b16 v[94:95], v10 offset:45568
 v_cvt_pk_bf16_f32 v105, v18, v19
 v_cvt_pk_bf16_f32 v106, v20, v21
 v_cvt_pk_bf16_f32 v107, v22, v23
 v_cvt_pk_bf16_f32 v108, v24, v25
 v_cvt_pk_bf16_f32 v109, v26, v27
 v_cvt_pk_bf16_f32 v110, v28, v29
 v_cvt_pk_bf16_f32 v111, v30, v31
 v_permlane16_swap_b32 v104, v106
 v_permlane16_swap_b32 v105, v107
 s_waitcnt lgkmcnt(4)
 v_mfma_f32_16x16x32_bf16 v[48:51], v[80:83], v[240:243], v[48:51]
 s_setprio 1
 ds_read_b64_tr_b16 v[96:97], v10 offset:57344
 v_mfma_f32_16x16x32_bf16 v[48:51], v[84:87], v[248:251], v[48:51]
 ds_read_b64_tr_b16 v[98:99], v10 offset:57856
 v_mfma_f32_16x16x32_bf16 v[52:55], v[80:83], v[244:247], v[52:55]
 ds_read_b64_tr_b16 v[100:101], v10 offset:61440
 v_mfma_f32_16x16x32_bf16 v[52:55], v[84:87], v[252:255], v[52:55]
 s_setprio 0
 ds_read_b64_tr_b16 v[102:103], v10 offset:61952
 v_permlane16_swap_b32 v108, v110
 v_permlane16_swap_b32 v109, v111
 buffer_store_dwordx4 v[104:107], v126, s[28:31], s67 offen offset:0 sc1
 buffer_store_dwordx4 v[108:111], v126, s[28:31], s68 offen offset:0 sc1
 s_waitcnt vmcnt(2) lgkmcnt(4)
 s_barrier
 v_mfma_f32_16x16x32_bf16 v[56:59], v[88:91], v[224:227], v[56:59]
 s_setprio 1
 ds_read_b64_tr_b16 v[80:81], v9 offset:0
 v_mfma_f32_16x16x32_bf16 v[56:59], v[92:95], v[232:235], v[56:59]
 ds_read_b64_tr_b16 v[82:83], v9 offset:512
 v_mfma_f32_16x16x32_bf16 v[60:63], v[88:91], v[228:231], v[60:63]
 ds_read_b64_tr_b16 v[84:85], v9 offset:4096
 v_mfma_f32_16x16x32_bf16 v[60:63], v[92:95], v[236:239], v[60:63]
 s_setprio 0
 ds_read_b64_tr_b16 v[86:87], v9 offset:4608
 s_add_u32 s91, s60, 4
 s_and_b32 s91, s91, 7
 s_add_u32 m0, s53, 131072
 s_mul_i32 s90, s91, 229376
 buffer_load_dwordx4 v4, s[20:23], s90 offen lds
 s_waitcnt lgkmcnt(4)
 v_mfma_f32_16x16x32_bf16 v[56:59], v[96:99], v[240:243], v[56:59]
 s_setprio 1
 ds_read_b64_tr_b16 v[88:89], v10 offset:0
 v_mfma_f32_16x16x32_bf16 v[56:59], v[100:103], v[248:251], v[56:59]
 ds_read_b64_tr_b16 v[90:91], v10 offset:512
 v_mfma_f32_16x16x32_bf16 v[60:63], v[96:99], v[244:247], v[60:63]
 ds_read_b64_tr_b16 v[92:93], v10 offset:4096
 v_mfma_f32_16x16x32_bf16 v[60:63], v[100:103], v[252:255], v[60:63]
 s_setprio 0
 ds_read_b64_tr_b16 v[94:95], v10 offset:4608
 s_add_u32 m0, s53, 139264
 s_nop 0
 buffer_load_dwordx4 v4, s[24:27], s90 offen lds
 s_waitcnt lgkmcnt(4)
 v_mfma_f32_16x16x32_bf16 v[16:19], v[80:83], v[128:131], 0
 s_setprio 1
 ds_read_b64_tr_b16 v[96:97], v9 offset:8192
 v_mfma_f32_16x16x32_bf16 v[16:19], v[84:87], v[136:139], v[16:19]
 ds_read_b64_tr_b16 v[98:99], v9 offset:8704
 v_mfma_f32_16x16x32_bf16 v[20:23], v[80:83], v[132:135], 0
 ds_read_b64_tr_b16 v[100:101], v9 offset:12288
 v_mfma_f32_16x16x32_bf16 v[20:23], v[84:87], v[140:143], v[20:23]
 s_setprio 0
 ds_read_b64_tr_b16 v[102:103], v9 offset:12800
 s_add_u32 s91, s60, 5
 s_and_b32 s91, s91, 7
 s_add_u32 m0, s53, 32768
 s_mul_i32 s90, s91, 229376
 buffer_load_dwordx4 v4, s[20:23], s90 offen lds
 v_min_u32 v13, v14, v15
 v_cmp_eq_u32 vcc, 0, v13
 s_nop 0
 s_cmp_lg_u64 vcc, 0
 s_cbranch_scc1 L_x_3008
L_r_3009:
 v_exp_f32 v14, v14
 v_exp_f32 v15, v15
 v_add_f32 v14, 1.0, v14
 v_add_f32 v15, 1.0, v15
 v_min_f32 v14, 0x71800000, v14
 v_min_f32 v15, 0x71800000, v15
 s_waitcnt lgkmcnt(4)
 v_mfma_f32_16x16x32_bf16 v[24:27], v[88:91], v[128:131], 0
 s_setprio 1
 ds_read_b64_tr_b16 v[80:81], v10 offset:8192
 v_mfma_f32_16x16x32_bf16 v[24:27], v[92:95], v[136:139], v[24:27]
 ds_read_b64_tr_b16 v[82:83], v10 offset:8704
 v_mfma_f32_16x16x32_bf16 v[28:31], v[88:91], v[132:135], 0
 ds_read_b64_tr_b16 v[84:85], v10 offset:12288
 v_mfma_f32_16x16x32_bf16 v[28:31], v[92:95], v[140:143], v[28:31]
 s_setprio 0
 ds_read_b64_tr_b16 v[86:87], v10 offset:12800
 s_add_u32 m0, s53, 40960
 s_nop 0
 buffer_load_dwordx4 v4, s[24:27], s90 offen lds
 s_lshl_b32 s67, s59, 2
 s_add_u32 s67, s67, s94
 s_lshl_b32 s67, s67, 17
 s_lshl_b32 s68, s95, 10
 s_add_u32 s67, s67, s68
 s_add_u32 s67, s67, 1048576
 v_cvt_pk_bf16_f32 v104, v32, v33
 s_waitcnt lgkmcnt(4)
 v_mfma_f32_16x16x32_bf16 v[64:67], v[96:99], v[128:131], 0
 s_setprio 1
 ds_read_b64_tr_b16 v[88:89], v11 offset:0
 v_mfma_f32_16x16x32_bf16 v[64:67], v[100:103], v[136:139], v[64:67]
 ds_read_b64_tr_b16 v[90:91], v11 offset:512
 v_mfma_f32_16x16x32_bf16 v[68:71], v[96:99], v[132:135], 0
 ds_read_b64_tr_b16 v[92:93], v11 offset:4096
 v_mfma_f32_16x16x32_bf16 v[68:71], v[100:103], v[140:143], v[68:71]
 s_setprio 0
 ds_read_b64_tr_b16 v[94:95], v11 offset:4608
 v_cvt_pk_bf16_f32 v105, v34, v35
 v_cvt_pk_bf16_f32 v106, v36, v37
 v_cvt_pk_bf16_f32 v107, v38, v39
 s_add_u32 s68, s67, 0
 v_permlane16_swap_b32 v104, v106
 v_permlane16_swap_b32 v105, v107
 v_min_u32 v104, -2, v104
 v_min_u32 v105, -2, v105
 s_waitcnt lgkmcnt(4)
 v_mfma_f32_16x16x32_bf16 v[72:75], v[80:83], v[128:131], 0
 s_setprio 1
 ds_read_b64_tr_b16 v[96:97], v12 offset:0
 v_mfma_f32_16x16x32_bf16 v[72:75], v[84:87], v[136:139], v[72:75]
 ds_read_b64_tr_b16 v[98:99], v12 offset:512
 v_mfma_f32_16x16x32_bf16 v[76:79], v[80:83], v[132:135], 0
 ds_read_b64_tr_b16 v[100:101], v12 offset:4096
 v_mfma_f32_16x16x32_bf16 v[76:79], v[84:87], v[140:143], v[76:79]
 s_setprio 0
 ds_read_b64_tr_b16 v[102:103], v12 offset:4608
 v_min_u32 v106, -2, v106
 v_min_u32 v107, -2, v107
 buffer_store_dwordx4 v[104:107], v126, s[28:31], s68 offen offset:0 sc1
 v_cvt_pk_bf16_f32 v108, v40, v41
 v_cvt_pk_bf16_f32 v109, v42, v43
 s_waitcnt lgkmcnt(4)
 v_mfma_f32_16x16x32_bf16 v[16:19], v[88:91], v[144:147], v[16:19]
 s_setprio 1
 ds_read_b64_tr_b16 v[80:81], v11 offset:8192
 v_mfma_f32_16x16x32_bf16 v[16:19], v[92:95], v[152:155], v[16:19]
 ds_read_b64_tr_b16 v[82:83], v11 offset:8704
 v_mfma_f32_16x16x32_bf16 v[20:23], v[88:91], v[148:151], v[20:23]
 ds_read_b64_tr_b16 v[84:85], v11 offset:12288
 v_mfma_f32_16x16x32_bf16 v[20:23], v[92:95], v[156:159], v[20:23]
 s_setprio 0
 ds_read_b64_tr_b16 v[86:87], v11 offset:12800
 v_cvt_pk_bf16_f32 v110, v44, v45
 v_cvt_pk_bf16_f32 v111, v46, v47
 s_add_u32 s68, s67, 65536
 v_permlane16_swap_b32 v108, v110
 v_permlane16_swap_b32 v109, v111
 v_min_u32 v108, -2, v108
 v_min_u32 v109, -2, v109
 v_min_u32 v110, -2, v110
 s_waitcnt lgkmcnt(4)
 v_mfma_f32_16x16x32_bf16 v[24:27], v[96:99], v[144:147], v[24:27]
 s_setprio 1
 ds_read_b64_tr_b16 v[88:89], v12 offset:8192
 v_mfma_f32_16x16x32_bf16 v[24:27], v[100:103], v[152:155], v[24:27]
 ds_read_b64_tr_b16 v[90:91], v12 offset:8704
 v_mfma_f32_16x16x32_bf16 v[28:31], v[96:99], v[148:151], v[28:31]
 ds_read_b64_tr_b16 v[92:93], v12 offset:12288
 v_mfma_f32_16x16x32_bf16 v[28:31], v[100:103], v[156:159], v[28:31]
 s_setprio 0
 ds_read_b64_tr_b16 v[94:95], v12 offset:12800
 v_min_u32 v111, -2, v111
 buffer_store_dwordx4 v[108:111], v126, s[28:31], s68 offen offset:0 sc1
 v_cvt_pk_bf16_f32 v104, v48, v49
 v_cvt_pk_bf16_f32 v105, v50, v51
 v_cvt_pk_bf16_f32 v106, v52, v53
 s_waitcnt lgkmcnt(4)
 v_mfma_f32_16x16x32_bf16 v[64:67], v[80:83], v[144:147], v[64:67]
 s_setprio 1
 ds_read_b64_tr_b16 v[96:97], v9 offset:16384
 v_mfma_f32_16x16x32_bf16 v[64:67], v[84:87], v[152:155], v[64:67]
 ds_read_b64_tr_b16 v[98:99], v9 offset:16896
 v_mfma_f32_16x16x32_bf16 v[68:71], v[80:83], v[148:151], v[68:71]
 ds_read_b64_tr_b16 v[100:101], v9 offset:20480
 v_mfma_f32_16x16x32_bf16 v[68:71], v[84:87], v[156:159], v[68:71]
 s_setprio 0
 ds_read_b64_tr_b16 v[102:103], v9 offset:20992
 v_cvt_pk_bf16_f32 v107, v54, v55
 s_add_u32 s68, s67, 262144
 v_permlane16_swap_b32 v104, v106
 v_permlane16_swap_b32 v105, v107
 v_min_u32 v104, -2, v104
 v_min_u32 v105, -2, v105
 v_min_u32 v106, -2, v106
 v_min_u32 v107, -2, v107
 s_waitcnt lgkmcnt(4)
 v_mfma_f32_16x16x32_bf16 v[72:75], v[88:91], v[144:147], v[72:75]
 s_setprio 1
 ds_read_b64_tr_b16 v[80:81], v10 offset:16384
 v_mfma_f32_16x16x32_bf16 v[72:75], v[92:95], v[152:155], v[72:75]
 ds_read_b64_tr_b16 v[82:83], v10 offset:16896
 v_mfma_f32_16x16x32_bf16 v[76:79], v[88:91], v[148:151], v[76:79]
 ds_read_b64_tr_b16 v[84:85], v10 offset:20480
 v_mfma_f32_16x16x32_bf16 v[76:79], v[92:95], v[156:159], v[76:79]
 s_setprio 0
 ds_read_b64_tr_b16 v[86:87], v10 offset:20992
 buffer_store_dwordx4 v[104:107], v126, s[28:31], s68 offen offset:0 sc1
 v_cvt_pk_bf16_f32 v108, v56, v57
 v_cvt_pk_bf16_f32 v109, v58, v59
 v_cvt_pk_bf16_f32 v110, v60, v61
 v_cvt_pk_bf16_f32 v111, v62, v63
 s_waitcnt lgkmcnt(4)
 v_mfma_f32_16x16x32_bf16 v[16:19], v[96:99], v[160:163], v[16:19]
 s_setprio 1
 ds_read_b64_tr_b16 v[88:89], v9 offset:24576
 v_mfma_f32_16x16x32_bf16 v[16:19], v[100:103], v[168:171], v[16:19]
 ds_read_b64_tr_b16 v[90:91], v9 offset:25088
 v_mfma_f32_16x16x32_bf16 v[20:23], v[96:99], v[164:167], v[20:23]
 ds_read_b64_tr_b16 v[92:93], v9 offset:28672
 v_mfma_f32_16x16x32_bf16 v[20:23], v[100:103], v[172:175], v[20:23]
 s_setprio 0
 ds_read_b64_tr_b16 v[94:95], v9 offset:29184
 s_add_u32 s68, s67, 327680
 v_permlane16_swap_b32 v108, v110
 v_permlane16_swap_b32 v109, v111
 v_min_u32 v108, -2, v108
 v_min_u32 v109, -2, v109
 v_min_u32 v110, -2, v110
 v_min_u32 v111, -2, v111
 buffer_store_dwordx4 v[108:111], v126, s[28:31], s68 offen offset:0 sc1
 s_waitcnt vmcnt(4)
 s_barrier
 s_cmp_lg_u32 s52, 0
 s_cbranch_scc1 L_s_3011
 s_lshl_b32 s62, s57, 7
 s_lshl_b32 s63, s56, 2
 s_add_u32 s62, s62, s63
 s_mov_b64 exec, 1
 buffer_store_dword v112, v126, s[28:31], s62 offen sc1
 s_mov_b64 exec, -1
L_s_3011:
 s_waitcnt lgkmcnt(4)
 v_mfma_f32_16x16x32_bf16 v[24:27], v[80:83], v[160:163], v[24:27]
 s_setprio 1
 ds_read_b64_tr_b16 v[96:97], v10 offset:24576
 v_mfma_f32_16x16x32_bf16 v[24:27], v[84:87], v[168:171], v[24:27]
 ds_read_b64_tr_b16 v[98:99], v10 offset:25088
 v_mfma_f32_16x16x32_bf16 v[28:31], v[80:83], v[164:167], v[28:31]
 ds_read_b64_tr_b16 v[100:101], v10 offset:28672
 v_mfma_f32_16x16x32_bf16 v[28:31], v[84:87], v[172:175], v[28:31]
 s_setprio 0
 ds_read_b64_tr_b16 v[102:103], v10 offset:29184
 s_add_u32 s91, s60, 6
 s_and_b32 s91, s91, 7
 s_add_u32 m0, s53, 147456
 s_mul_i32 s90, s91, 229376
 buffer_load_dwordx4 v4, s[20:23], s90 offen lds
 s_waitcnt lgkmcnt(4)
 v_mfma_f32_16x16x32_bf16 v[64:67], v[88:91], v[160:163], v[64:67]
 s_setprio 1
 ds_read_b64_tr_b16 v[80:81], v11 offset:16384
 v_mfma_f32_16x16x32_bf16 v[64:67], v[92:95], v[168:171], v[64:67]
 ds_read_b64_tr_b16 v[82:83], v11 offset:16896
 v_mfma_f32_16x16x32_bf16 v[68:71], v[88:91], v[164:167], v[68:71]
 ds_read_b64_tr_b16 v[84:85], v11 offset:20480
 v_mfma_f32_16x16x32_bf16 v[68:71], v[92:95], v[172:175], v[68:71]
 s_setprio 0
 ds_read_b64_tr_b16 v[86:87], v11 offset:20992
 s_add_u32 m0, s53, 155648
 s_nop 0
 buffer_load_dwordx4 v4, s[24:27], s90 offen lds
 s_waitcnt lgkmcnt(4)
 v_mfma_f32_16x16x32_bf16 v[72:75], v[96:99], v[160:163], v[72:75]
 s_setprio 1
 ds_read_b64_tr_b16 v[88:89], v12 offset:16384
 v_mfma_f32_16x16x32_bf16 v[72:75], v[100:103], v[168:171], v[72:75]
 ds_read_b64_tr_b16 v[90:91], v12 offset:16896
 v_mfma_f32_16x16x32_bf16 v[76:79], v[96:99], v[164:167], v[76:79]
 ds_read_b64_tr_b16 v[92:93], v12 offset:20480
 v_mfma_f32_16x16x32_bf16 v[76:79], v[100:103], v[172:175], v[76:79]
 s_setprio 0
 ds_read_b64_tr_b16 v[94:95], v12 offset:20992
 s_add_u32 s91, s60, 7
 s_and_b32 s91, s91, 7
 s_add_u32 m0, s53, 49152
 s_mul_i32 s90, s91, 229376
 buffer_load_dwordx4 v4, s[20:23], s90 offen lds
 s_waitcnt lgkmcnt(4)
 v_mfma_f32_16x16x32_bf16 v[16:19], v[80:83], v[176:179], v[16:19]
 s_setprio 1
 ds_read_b64_tr_b16 v[96:97], v11 offset:24576
 v_mfma_f32_16x16x32_bf16 v[16:19], v[84:87], v[184:187], v[16:19]
 ds_read_b64_tr_b16 v[98:99], v11 offset:25088
 v_mfma_f32_16x16x32_bf16 v[20:23], v[80:83], v[180:183], v[20:23]
 ds_read_b64_tr_b16 v[100:101], v11 offset:28672
 v_mfma_f32_16x16x32_bf16 v[20:23], v[84:87], v[188:191], v[20:23]
 s_setprio 0
 ds_read_b64_tr_b16 v[102:103], v11 offset:29184
 s_add_u32 m0, s53, 57344
 s_nop 0
 buffer_load_dwordx4 v4, s[24:27], s90 offen lds
 v_and_b32 v129, 0x1b, v0
 v_cmp_eq_u32 vcc, 16, v129
 v_mov_b32 v129, 0x3f803f80
 s_nop 0
 v_cndmask_b32 v128, 0, v129, vcc
 s_waitcnt lgkmcnt(4)
 v_mfma_f32_16x16x32_bf16 v[24:27], v[88:91], v[176:179], v[24:27]
 s_setprio 1
 ds_read_b64_tr_b16 v[80:81], v12 offset:24576
 v_mfma_f32_16x16x32_bf16 v[24:27], v[92:95], v[184:187], v[24:27]
 ds_read_b64_tr_b16 v[82:83], v12 offset:25088
 v_mfma_f32_16x16x32_bf16 v[28:31], v[88:91], v[180:183], v[28:31]
 ds_read_b64_tr_b16 v[84:85], v12 offset:28672
 v_mfma_f32_16x16x32_bf16 v[28:31], v[92:95], v[188:191], v[28:31]
 s_setprio 0
 ds_read_b64_tr_b16 v[86:87], v12 offset:29184
 v_mov_b32 v129, v128
 v_mov_b32 v130, v128
 v_mov_b32 v131, v128
 v_mov_b32 v132, v128
 v_mov_b32 v133, v128
 v_mov_b32 v134, v128
 v_mov_b32 v135, v128
 v_mov_b32 v136, v128
 v_mov_b32 v137, v128
 s_waitcnt lgkmcnt(4)
 v_mfma_f32_16x16x32_bf16 v[64:67], v[96:99], v[176:179], v[64:67]
 s_setprio 1
 ds_read_b64_tr_b16 v[88:89], v9 offset:32768
 v_mfma_f32_16x16x32_bf16 v[64:67], v[100:103], v[184:187], v[64:67]
 ds_read_b64_tr_b16 v[90:91], v9 offset:33280
 v_mfma_f32_16x16x32_bf16 v[68:71], v[96:99], v[180:183], v[68:71]
 ds_read_b64_tr_b16 v[92:93], v9 offset:36864
 v_mfma_f32_16x16x32_bf16 v[68:71], v[100:103], v[188:191], v[68:71]
 s_setprio 0
 ds_read_b64_tr_b16 v[94:95], v9 offset:37376
 v_mov_b32 v138, v128
 v_mov_b32 v139, v128
 v_mov_b32 v140, v128
 v_mov_b32 v141, v128
 v_mov_b32 v142, v128
 v_mov_b32 v143, v128
 v_mov_b32 v152, 0
 v_mov_b32 v153, 0
 v_mov_b32 v154, 0
 s_waitcnt lgkmcnt(4)
 v_mfma_f32_16x16x32_bf16 v[72:75], v[80:83], v[176:179], v[72:75]
 s_setprio 1
 ds_read_b64_tr_b16 v[96:97], v10 offset:32768
 v_mfma_f32_16x16x32_bf16 v[72:75], v[84:87], v[184:187], v[72:75]
 ds_read_b64_tr_b16 v[98:99], v10 offset:33280
 v_mfma_f32_16x16x32_bf16 v[76:79], v[80:83], v[180:183], v[76:79]
 ds_read_b64_tr_b16 v[100:101], v10 offset:36864
 v_mfma_f32_16x16x32_bf16 v[76:79], v[84:87], v[188:191], v[76:79]
 s_setprio 0
 ds_read_b64_tr_b16 v[102:103], v10 offset:37376
 v_mov_b32 v155, 0
 v_xor_b32 v1, 32, v124
 v_xor_b32 v2, 64, v124
 v_xor_b32 v3, 96, v124
 v_add_u32 v5, 98304, v124
 v_add_u32 v6, 98304, v1
 s_xor_b32 s68, s52, 4
 s_mul_i32 s68, s68, 2304
 s_add_u32 s68, s68, 98304
 v_add_u32 v7, s68, v126
 v_lshl_add_u32 v119, v0, 2, s68
 s_waitcnt lgkmcnt(4)
 v_mfma_f32_16x16x32_bf16 v[16:19], v[88:91], v[192:195], v[16:19]
 s_setprio 1
 ds_read_b64_tr_b16 v[80:81], v9 offset:40960
 v_mfma_f32_16x16x32_bf16 v[16:19], v[92:95], v[200:203], v[16:19]
 ds_read_b64_tr_b16 v[82:83], v9 offset:41472
 v_mfma_f32_16x16x32_bf16 v[20:23], v[88:91], v[196:199], v[20:23]
 ds_read_b64_tr_b16 v[84:85], v9 offset:45056
 v_mfma_f32_16x16x32_bf16 v[20:23], v[92:95], v[204:207], v[20:23]
 s_setprio 0
 ds_read_b64_tr_b16 v[86:87], v9 offset:45568
 s_mul_i32 s68, s52, 2304
 s_add_u32 s68, s68, 98304
 v_add_u32 v8, s68, v126
 v_lshl_add_u32 v4, v0, 2, s68
 s_mul_i32 s67, s95, 114688
 s_lshl_b32 s68, s75, 1
 s_add_u32 s68, s68, s94
 s_lshl_b32 s68, s68, 11
 s_add_u32 s67, s67, s68
 s_add_u32 s67, s67, 9437184
 s_waitcnt lgkmcnt(4)
 v_mfma_f32_16x16x32_bf16 v[24:27], v[96:99], v[192:195], v[24:27]
 s_setprio 1
 ds_read_b64_tr_b16 v[88:89], v10 offset:40960
 v_mfma_f32_16x16x32_bf16 v[24:27], v[100:103], v[200:203], v[24:27]
 ds_read_b64_tr_b16 v[90:91], v10 offset:41472
 v_mfma_f32_16x16x32_bf16 v[28:31], v[96:99], v[196:199], v[28:31]
 ds_read_b64_tr_b16 v[92:93], v10 offset:45056
 v_mfma_f32_16x16x32_bf16 v[28:31], v[100:103], v[204:207], v[28:31]
 s_setprio 0
 ds_read_b64_tr_b16 v[94:95], v10 offset:45568
 s_waitcnt vmcnt(0)
 s_barrier
 s_waitcnt lgkmcnt(4)
 v_mfma_f32_16x16x32_bf16 v[64:67], v[80:83], v[192:195], v[64:67]
 s_setprio 1
 ds_read_b64_tr_b16 v[96:97], v11 offset:32768
 v_mfma_f32_16x16x32_bf16 v[64:67], v[84:87], v[200:203], v[64:67]
 ds_read_b64_tr_b16 v[98:99], v11 offset:33280
 v_mfma_f32_16x16x32_bf16 v[68:71], v[80:83], v[196:199], v[68:71]
 ds_read_b64_tr_b16 v[100:101], v11 offset:36864
 v_mfma_f32_16x16x32_bf16 v[68:71], v[84:87], v[204:207], v[68:71]
 s_setprio 0
 ds_read_b64_tr_b16 v[102:103], v11 offset:37376
 s_waitcnt lgkmcnt(4)
 v_mfma_f32_16x16x32_bf16 v[72:75], v[88:91], v[192:195], v[72:75]
 s_setprio 1
 ds_read_b64_tr_b16 v[80:81], v9 offset:49152
 v_mfma_f32_16x16x32_bf16 v[72:75], v[92:95], v[200:203], v[72:75]
 ds_read_b64_tr_b16 v[82:83], v9 offset:49664
 v_mfma_f32_16x16x32_bf16 v[76:79], v[88:91], v[196:199], v[76:79]
 ds_read_b64_tr_b16 v[84:85], v9 offset:53248
 v_mfma_f32_16x16x32_bf16 v[76:79], v[92:95], v[204:207], v[76:79]
 s_setprio 0
 ds_read_b64_tr_b16 v[86:87], v9 offset:53760
 s_waitcnt lgkmcnt(4)
 v_mfma_f32_16x16x32_bf16 v[16:19], v[96:99], v[208:211], v[16:19]
 s_setprio 1
 ds_read_b64_tr_b16 v[88:89], v11 offset:49152
 v_mfma_f32_16x16x32_bf16 v[16:19], v[100:103], v[216:219], v[16:19]
 ds_read_b64_tr_b16 v[90:91], v11 offset:49664
 v_mfma_f32_16x16x32_bf16 v[20:23], v[96:99], v[212:215], v[20:23]
 ds_read_b64_tr_b16 v[92:93], v11 offset:53248
 v_mfma_f32_16x16x32_bf16 v[20:23], v[100:103], v[220:223], v[20:23]
 s_setprio 0
 ds_read_b64_tr_b16 v[94:95], v11 offset:53760
 s_waitcnt lgkmcnt(4)
 v_mfma_f32_16x16x32_bf16 v[16:19], v[80:83], v[224:227], v[16:19]
 s_setprio 1
 ds_read_b64_tr_b16 v[96:97], v12 offset:32768
 v_mfma_f32_16x16x32_bf16 v[16:19], v[84:87], v[232:235], v[16:19]
 ds_read_b64_tr_b16 v[98:99], v12 offset:33280
 v_mfma_f32_16x16x32_bf16 v[20:23], v[80:83], v[228:231], v[20:23]
 ds_read_b64_tr_b16 v[100:101], v12 offset:36864
 v_mfma_f32_16x16x32_bf16 v[20:23], v[84:87], v[236:239], v[20:23]
 s_setprio 0
 ds_read_b64_tr_b16 v[102:103], v12 offset:37376
 s_waitcnt lgkmcnt(4)
 v_mfma_f32_16x16x32_bf16 v[16:19], v[88:91], v[240:243], v[16:19]
 s_setprio 1
 ds_read_b64_tr_b16 v[80:81], v10 offset:49152
 v_mfma_f32_16x16x32_bf16 v[16:19], v[92:95], v[248:251], v[16:19]
 ds_read_b64_tr_b16 v[82:83], v10 offset:49664
 v_mfma_f32_16x16x32_bf16 v[20:23], v[88:91], v[244:247], v[20:23]
 ds_read_b64_tr_b16 v[84:85], v10 offset:53248
 v_mfma_f32_16x16x32_bf16 v[20:23], v[92:95], v[252:255], v[20:23]
 s_setprio 0
 ds_read_b64_tr_b16 v[86:87], v10 offset:53760
 buffer_load_dword v121, v120, s[28:31], 0 offen sc1
 s_waitcnt lgkmcnt(4)
 v_mfma_f32_16x16x32_bf16 v[24:27], v[96:99], v[208:211], v[24:27]
 s_setprio 1
 ds_read_b64_tr_b16 v[88:89], v12 offset:49152
 v_mfma_f32_16x16x32_bf16 v[24:27], v[100:103], v[216:219], v[24:27]
 ds_read_b64_tr_b16 v[90:91], v12 offset:49664
 v_mfma_f32_16x16x32_bf16 v[28:31], v[96:99], v[212:215], v[28:31]
 ds_read_b64_tr_b16 v[92:93], v12 offset:53248
 v_mfma_f32_16x16x32_bf16 v[28:31], v[100:103], v[220:223], v[28:31]
 s_setprio 0
 ds_read_b64_tr_b16 v[94:95], v12 offset:53760
 v_mul_f32 v16, 0xbfb8aa3b, v16
 v_mul_f32 v17, 0xbfb8aa3b, v17
 v_mul_f32 v18, 0xbfb8aa3b, v18
 v_mul_f32 v19, 0xbfb8aa3b, v19
 v_mul_f32 v20, 0xbfb8aa3b, v20
 v_mul_f32 v21, 0xbfb8aa3b, v21
 v_mul_f32 v22, 0xbfb8aa3b, v22
 v_mul_f32 v23, 0xbfb8aa3b, v23
 v_exp_f32 v16, v16
 v_exp_f32 v17, v17
 s_waitcnt lgkmcnt(4)
 v_mfma_f32_16x16x32_bf16 v[24:27], v[80:83], v[224:227], v[24:27]
 s_setprio 1
 ds_read_b64_tr_b16 v[96:97], v11 offset:40960
 v_mfma_f32_16x16x32_bf16 v[24:27], v[84:87], v[232:235], v[24:27]
 ds_read_b64_tr_b16 v[98:99], v11 offset:41472
 v_mfma_f32_16x16x32_bf16 v[28:31], v[80:83], v[228:231], v[28:31]
 ds_read_b64_tr_b16 v[100:101], v11 offset:45056
 v_mfma_f32_16x16x32_bf16 v[28:31], v[84:87], v[236:239], v[28:31]
 s_setprio 0
 ds_read_b64_tr_b16 v[102:103], v11 offset:45568
 v_exp_f32 v18, v18
 v_exp_f32 v19, v19
 v_exp_f32 v20, v20
 v_exp_f32 v21, v21
 v_exp_f32 v22, v22
 v_exp_f32 v23, v23
 s_waitcnt lgkmcnt(4)
 v_mfma_f32_16x16x32_bf16 v[24:27], v[88:91], v[240:243], v[24:27]
 s_setprio 1
 ds_read_b64_tr_b16 v[80:81], v9 offset:57344
 v_mfma_f32_16x16x32_bf16 v[24:27], v[92:95], v[248:251], v[24:27]
 ds_read_b64_tr_b16 v[82:83], v9 offset:57856
 v_mfma_f32_16x16x32_bf16 v[28:31], v[88:91], v[244:247], v[28:31]
 ds_read_b64_tr_b16 v[84:85], v9 offset:61440
 v_mfma_f32_16x16x32_bf16 v[28:31], v[92:95], v[252:255], v[28:31]
 s_setprio 0
 ds_read_b64_tr_b16 v[86:87], v9 offset:61952
 v_fma_f32 v16, v16, v14, v14
 v_fma_f32 v17, v17, v14, v14
 v_fma_f32 v18, v18, v14, v14
 v_fma_f32 v19, v19, v14, v14
 v_fma_f32 v20, v20, v15, v15
 v_fma_f32 v21, v21, v15, v15
 v_fma_f32 v22, v22, v15, v15
 v_fma_f32 v23, v23, v15, v15
 v_rcp_f32 v16, v16
 v_rcp_f32 v17, v17
 s_waitcnt vmcnt(0)
 v_cmp_eq_u32 vcc, 0, v121
 s_nop 0
 s_cmp_lg_u64 vcc, 0
 s_cbranch_scc1 L_x_3012
L_r_3013:
 s_waitcnt lgkmcnt(4)
 v_mfma_f32_16x16x32_bf16 v[64:67], v[96:99], v[208:211], v[64:67]
 s_setprio 1
 ds_read_b64_tr_b16 v[88:89], v11 offset:57344
 v_mfma_f32_16x16x32_bf16 v[64:67], v[100:103], v[216:219], v[64:67]
 ds_read_b64_tr_b16 v[90:91], v11 offset:57856
 v_mfma_f32_16x16x32_bf16 v[68:71], v[96:99], v[212:215], v[68:71]
 ds_read_b64_tr_b16 v[92:93], v11 offset:61440
 v_mfma_f32_16x16x32_bf16 v[68:71], v[100:103], v[220:223], v[68:71]
 s_setprio 0
 ds_read_b64_tr_b16 v[94:95], v11 offset:61952
 s_add_u32 m0, s53, 65536
 s_add_u32 s63, s66, 0
 buffer_load_dwordx4 v126, s[28:31], s63 offen sc1 lds
 v_rcp_f32 v18, v18
 v_rcp_f32 v19, v19
 v_rcp_f32 v20, v20
 s_waitcnt lgkmcnt(4)
 v_mfma_f32_16x16x32_bf16 v[64:67], v[80:83], v[224:227], v[64:67]
 s_setprio 1
 ds_read_b64_tr_b16 v[96:97], v12 offset:40960
 v_mfma_f32_16x16x32_bf16 v[64:67], v[84:87], v[232:235], v[64:67]
 ds_read_b64_tr_b16 v[98:99], v12 offset:41472
 v_mfma_f32_16x16x32_bf16 v[68:71], v[80:83], v[228:231], v[68:71]
 ds_read_b64_tr_b16 v[100:101], v12 offset:45056
 v_mfma_f32_16x16x32_bf16 v[68:71], v[84:87], v[236:239], v[68:71]
 s_setprio 0
 ds_read_b64_tr_b16 v[102:103], v12 offset:45568
 s_add_u32 m0, s53, 73728
 s_add_u32 s63, s66, 8192
 buffer_load_dwordx4 v126, s[28:31], s63 offen sc1 lds
 v_rcp_f32 v21, v21
 v_rcp_f32 v22, v22
 v_rcp_f32 v23, v23
 s_waitcnt lgkmcnt(4)
 v_mfma_f32_16x16x32_bf16 v[64:67], v[88:91], v[240:243], v[64:67]
 s_setprio 1
 ds_read_b64_tr_b16 v[80:81], v10 offset:57344
 v_mfma_f32_16x16x32_bf16 v[64:67], v[92:95], v[248:251], v[64:67]
 ds_read_b64_tr_b16 v[82:83], v10 offset:57856
 v_mfma_f32_16x16x32_bf16 v[68:71], v[88:91], v[244:247], v[68:71]
 ds_read_b64_tr_b16 v[84:85], v10 offset:61440
 v_mfma_f32_16x16x32_bf16 v[68:71], v[92:95], v[252:255], v[68:71]
 s_setprio 0
 ds_read_b64_tr_b16 v[86:87], v10 offset:61952
 buffer_load_dwordx4 v[148:151], v126, s[28:31], s85 offen sc1
 buffer_load_dwordx4 v[144:147], v126, s[28:31], s3 offen sc1
 v_mul_f32 v24, 0xbfb8aa3b, v24
 v_mul_f32 v25, 0xbfb8aa3b, v25
 v_mul_f32 v26, 0xbfb8aa3b, v26
 v_mul_f32 v27, 0xbfb8aa3b, v27
 v_mul_f32 v28, 0xbfb8aa3b, v28
 v_mul_f32 v29, 0xbfb8aa3b, v29
 s_waitcnt lgkmcnt(4)
 v_mfma_f32_16x16x32_bf16 v[72:75], v[96:99], v[208:211], v[72:75]
 s_setprio 1
 ds_read_b64_tr_b16 v[88:89], v12 offset:57344
 v_mfma_f32_16x16x32_bf16 v[72:75], v[100:103], v[216:219], v[72:75]
 ds_read_b64_tr_b16 v[90:91], v12 offset:57856
 v_mfma_f32_16x16x32_bf16 v[76:79], v[96:99], v[212:215], v[76:79]
 ds_read_b64_tr_b16 v[92:93], v12 offset:61440
 v_mfma_f32_16x16x32_bf16 v[76:79], v[100:103], v[220:223], v[76:79]
 s_setprio 0
 ds_read_b64_tr_b16 v[94:95], v12 offset:61952
 s_add_u32 m0, s53, 81920
 s_add_u32 s63, s66, 16384
 buffer_load_dwordx4 v126, s[28:31], s63 offen sc1 lds
 v_mul_f32 v30, 0xbfb8aa3b, v30
 v_mul_f32 v31, 0xbfb8aa3b, v31
 v_exp_f32 v24, v24
 v_exp_f32 v25, v25
 s_waitcnt lgkmcnt(4)
 v_mfma_f32_16x16x32_bf16 v[72:75], v[80:83], v[224:227], v[72:75]
 s_setprio 1
 v_mfma_f32_16x16x32_bf16 v[72:75], v[84:87], v[232:235], v[72:75]
 v_mfma_f32_16x16x32_bf16 v[76:79], v[80:83], v[228:231], v[76:79]
 v_mfma_f32_16x16x32_bf16 v[76:79], v[84:87], v[236:239], v[76:79]
 s_setprio 0
 s_add_u32 m0, s53, 90112
 s_add_u32 s63, s66, 24576
 buffer_load_dwordx4 v126, s[28:31], s63 offen sc1 lds
 v_exp_f32 v26, v26
 v_exp_f32 v27, v27
 v_exp_f32 v28, v28
 s_waitcnt lgkmcnt(0)
 v_mfma_f32_16x16x32_bf16 v[72:75], v[88:91], v[240:243], v[72:75]
 s_setprio 1
 v_mfma_f32_16x16x32_bf16 v[72:75], v[92:95], v[248:251], v[72:75]
 v_mfma_f32_16x16x32_bf16 v[76:79], v[88:91], v[244:247], v[76:79]
 v_mfma_f32_16x16x32_bf16 v[76:79], v[92:95], v[252:255], v[76:79]
 s_setprio 0
 v_exp_f32 v29, v29
 v_exp_f32 v30, v30
 v_exp_f32 v31, v31
 v_fma_f32 v24, v24, v14, v14
 v_fma_f32 v25, v25, v14, v14
 v_fma_f32 v26, v26, v14, v14
 v_fma_f32 v27, v27, v14, v14
 v_fma_f32 v28, v28, v15, v15
 v_fma_f32 v29, v29, v15, v15
 v_fma_f32 v30, v30, v15, v15
 v_fma_f32 v31, v31, v15, v15
 v_rcp_f32 v24, v24
 v_rcp_f32 v25, v25
 v_rcp_f32 v26, v26
 v_rcp_f32 v27, v27
 v_rcp_f32 v28, v28
 v_rcp_f32 v29, v29
 v_rcp_f32 v30, v30
 v_rcp_f32 v31, v31
 v_mul_f32 v16, v16, v64
 v_mul_f32 v17, v17, v65
 v_mul_f32 v18, v18, v66
 v_mul_f32 v19, v19, v67
 v_mul_f32 v20, v20, v68
 v_mul_f32 v21, v21, v69
 v_mul_f32 v22, v22, v70
 v_mul_f32 v23, v23, v71
 v_cvt_pk_bf16_f32 v192, v16, v17
 v_cvt_pk_bf16_f32 v193, v18, v19
 v_cvt_pk_bf16_f32 v196, v20, v21
 v_cvt_pk_bf16_f32 v197, v22, v23
 v_mfma_f32_32x32x16_bf16 v[32:47], v[152:155], v[152:155], 0
 v_mfma_f32_32x32x16_bf16 v[48:63], v[152:155], v[152:155], 0
 s_waitcnt vmcnt(2)
 v_max3_u32 v13, v144, v145, v146
 v_max3_u32 v13, v13, v147, v148
 v_max3_u32 v13, v13, v149, v150
 v_max_u32 v13, v13, v151
 v_cmp_eq_u32 vcc, -1, v13
 s_nop 0
 s_cmp_lg_u64 vcc, 0
 s_cbranch_scc1 L_x_3015
L_r_3016:
 s_barrier
 ds_read_b128 v[104:107], v113 offset:0
 s_mov_b64 exec, s[96:97]
 ds_read_b128 v[128:131], v114 offset:1024
 ds_read_b128 v[132:135], v114 offset:1536
 s_mov_b64 exec, -1
 v_mul_f32 v24, v24, v72
 v_mul_f32 v25, v25, v73
 v_mul_f32 v26, v26, v74
 v_mul_f32 v27, v27, v75
 v_mul_f32 v28, v28, v76
 v_mul_f32 v29, v29, v77
 v_mul_f32 v30, v30, v78
 v_mul_f32 v31, v31, v79
 v_cvt_pk_bf16_f32 v194, v24, v25
 v_cvt_pk_bf16_f32 v195, v26, v27
 v_cvt_pk_bf16_f32 v198, v28, v29
 v_cvt_pk_bf16_f32 v199, v30, v31
 s_waitcnt lgkmcnt(2)
 v_mfma_f32_32x32x16_bf16 v[160:175], v[104:107], v[144:147], 0
 v_add_u32 v14, 98304, v2
 v_add_u32 v15, 98304, v3
 v_mov_b32 v152, -1
 v_mov_b32 v153, -1
 v_mov_b32 v154, -1
 v_mov_b32 v155, -1
 s_lshl_b32 s70, s95, 4
 s_add_u32 s70, s70, s57
 s_lshl_b32 s70, s70, 1
 s_add_u32 s70, s70, s94
 s_lshl_b32 s68, s70, 10
 s_add_u32 s68, s68, 7340032
 s_waitcnt lgkmcnt(0)
 v_exp_f32 v160, v160
 v_exp_f32 v161, v161
 ds_read_b128 v[108:111], v113 offset:4096
 s_setprio 3
 v_exp_f32 v162, v162
 v_exp_f32 v163, v163
 v_exp_f32 v164, v164
 v_mfma_f32_32x32x16_bf16 v[176:191], v[104:107], v[148:151], 0
 v_exp_f32 v165, v165
 v_exp_f32 v166, v166
 v_exp_f32 v167, v167
 v_exp_f32 v168, v168
 v_exp_f32 v169, v169
 v_smfmac_f32_32x32x32_bf16 v[32:47], v[128:131], v[160:167], v112
 s_mov_b64 exec, s[96:97]
 ds_read_b128 v[136:139], v114 offset:5120
 ds_read_b128 v[140:143], v114 offset:5632
 s_mov_b64 exec, -1
 v_exp_f32 v170, v170
 v_exp_f32 v171, v171
 v_exp_f32 v172, v172
 v_exp_f32 v173, v173
 buffer_store_dwordx4 v[192:195], v122, s[28:31], s67 offen offset:0 sc1
 v_exp_f32 v174, v174
 v_exp_f32 v175, v175
 v_exp_f32 v176, v176
 v_exp_f32 v177, v177
 v_smfmac_f32_32x32x32_bf16 v[32:47], v[132:135], v[168:175], v112
 s_waitcnt lgkmcnt(0)
 v_exp_f32 v178, v178
 v_exp_f32 v179, v179
 v_exp_f32 v180, v180
 v_mfma_f32_32x32x16_bf16 v[160:175], v[108:111], v[144:147], 0
 buffer_store_dwordx4 v[196:199], v122, s[28:31], s67 offen offset:256 sc1
 v_exp_f32 v181, v181
 v_exp_f32 v182, v182
 v_exp_f32 v183, v183
 v_exp_f32 v184, v184
 v_exp_f32 v185, v185
 v_smfmac_f32_32x32x32_bf16 v[48:63], v[128:131], v[176:183], v112
 buffer_store_dwordx4 v[152:155], v126, s[28:31], s68 offen offset:0 sc1
 v_exp_f32 v186, v186
 v_exp_f32 v187, v187
 v_exp_f32 v188, v188
 v_exp_f32 v189, v189
 v_exp_f32 v190, v190
 v_exp_f32 v191, v191
 v_exp_f32 v160, v160
 v_exp_f32 v161, v161
 v_smfmac_f32_32x32x32_bf16 v[48:63], v[132:135], v[184:191], v112
 ds_read_b128 v[104:107], v113 offset:8192
 s_setprio 2
 v_exp_f32 v162, v162
 v_exp_f32 v163, v163
 v_exp_f32 v164, v164
 v_mfma_f32_32x32x16_bf16 v[176:191], v[108:111], v[148:151], 0
 v_exp_f32 v165, v165
 v_exp_f32 v166, v166
 v_exp_f32 v167, v167
 v_exp_f32 v168, v168
 v_exp_f32 v169, v169
 v_smfmac_f32_32x32x32_bf16 v[32:47], v[136:139], v[160:167], v112
 s_mov_b64 exec, s[96:97]
 ds_read_b128 v[128:131], v114 offset:9216
 ds_read_b128 v[132:135], v114 offset:9728
 s_mov_b64 exec, -1
 v_exp_f32 v170, v170
 v_exp_f32 v171, v171
 v_exp_f32 v172, v172
 v_exp_f32 v173, v173
 s_add_u32 m0, s53, 98304
 s_add_u32 s63, s66, 32768
 buffer_load_dwordx4 v126, s[28:31], s63 offen sc1 lds
 v_exp_f32 v174, v174
 v_exp_f32 v175, v175
 v_exp_f32 v176, v176
 v_exp_f32 v177, v177
 v_smfmac_f32_32x32x32_bf16 v[32:47], v[140:143], v[168:175], v112
 s_waitcnt lgkmcnt(0)
 v_exp_f32 v178, v178
 v_exp_f32 v179, v179
 v_exp_f32 v180, v180
 v_mfma_f32_32x32x16_bf16 v[160:175], v[104:107], v[144:147], 0
 s_add_u32 m0, s53, 106496
 s_add_u32 s63, s66, 40960
 buffer_load_dwordx4 v126, s[28:31], s63 offen sc1 lds
 v_exp_f32 v181, v181
 v_exp_f32 v182, v182
 v_exp_f32 v183, v183
 v_exp_f32 v184, v184
 v_exp_f32 v185, v185
 v_smfmac_f32_32x32x32_bf16 v[48:63], v[136:139], v[176:183], v112
 s_add_u32 m0, s53, 114688
 s_add_u32 s63, s66, 49152
 buffer_load_dwordx4 v126, s[28:31], s63 offen sc1 lds
 v_exp_f32 v186, v186
 v_exp_f32 v187, v187
 v_exp_f32 v188, v188
 v_exp_f32 v189, v189
 v_exp_f32 v190, v190
 v_exp_f32 v191, v191
 v_exp_f32 v160, v160
 v_exp_f32 v161, v161
 v_smfmac_f32_32x32x32_bf16 v[48:63], v[140:143], v[184:191], v112
 ds_read_b128 v[108:111], v113 offset:12288
 s_setprio 1
 v_exp_f32 v162, v162
 v_exp_f32 v163, v163
 v_exp_f32 v164, v164
 v_mfma_f32_32x32x16_bf16 v[176:191], v[104:107], v[148:151], 0
 v_exp_f32 v165, v165
 v_exp_f32 v166, v166
 v_exp_f32 v167, v167
 v_exp_f32 v168, v168
 v_exp_f32 v169, v169
 v_smfmac_f32_32x32x32_bf16 v[32:47], v[128:131], v[160:167], v112
 s_mov_b64 exec, s[96:97]
 ds_read_b128 v[136:139], v114 offset:13312
 ds_read_b128 v[140:143], v114 offset:13824
 s_mov_b64 exec, -1
 v_exp_f32 v170, v170
 v_exp_f32 v171, v171
 v_exp_f32 v172, v172
 v_exp_f32 v173, v173
 v_exp_f32 v174, v174
 v_exp_f32 v175, v175
 v_exp_f32 v176, v176
 v_exp_f32 v177, v177
 v_smfmac_f32_32x32x32_bf16 v[32:47], v[132:135], v[168:175], v112
 s_waitcnt lgkmcnt(0)
 v_exp_f32 v178, v178
 v_exp_f32 v179, v179
 v_exp_f32 v180, v180
 v_mfma_f32_32x32x16_bf16 v[160:175], v[108:111], v[144:147], 0
 s_add_u32 m0, s53, 122880
 s_add_u32 s63, s66, 57344
 buffer_load_dwordx4 v126, s[28:31], s63 offen sc1 lds
 v_exp_f32 v181, v181
 v_exp_f32 v182, v182
 v_exp_f32 v183, v183
 v_exp_f32 v184, v184
 v_exp_f32 v185, v185
 v_smfmac_f32_32x32x32_bf16 v[48:63], v[128:131], v[176:183], v112
 s_setprio 0
 s_add_u32 s82, s81, 0
 s_cmp_ge_u32 s82, 7
 s_cselect_b32 s63, 7, 0
 s_sub_u32 s82, s82, s63
 s_add_u32 m0, s53, 0
 s_lshl_b32 s82, s82, 16
 buffer_load_dwordx4 v116, s[32:35], s82 offen lds
 v_exp_f32 v186, v186
 v_exp_f32 v187, v187
 v_exp_f32 v188, v188
 v_exp_f32 v189, v189
 v_exp_f32 v190, v190
 v_exp_f32 v191, v191
 s_waitcnt vmcnt(8)
 s_barrier
 v_exp_f32 v160, v160
 v_exp_f32 v161, v161
 v_smfmac_f32_32x32x32_bf16 v[48:63], v[132:135], v[184:191], v112
 ds_read_b128 v[104:107], v113 offset:16384
 s_setprio 3
 v_exp_f32 v162, v162
 v_exp_f32 v163, v163
 v_exp_f32 v164, v164
 v_mfma_f32_32x32x16_bf16 v[176:191], v[108:111], v[148:151], 0
 v_exp_f32 v165, v165
 v_exp_f32 v166, v166
 v_exp_f32 v167, v167
 v_exp_f32 v168, v168
 v_exp_f32 v169, v169
 v_smfmac_f32_32x32x32_bf16 v[32:47], v[136:139], v[160:167], v112
 s_mov_b64 exec, s[96:97]
 ds_read_b128 v[128:131], v114 offset:17408
 ds_read_b128 v[132:135], v114 offset:17920
 s_mov_b64 exec, -1
 v_exp_f32 v170, v170
 v_exp_f32 v171, v171
 v_exp_f32 v172, v172
 v_exp_f32 v173, v173
 v_exp_f32 v174, v174
 v_exp_f32 v175, v175
 v_exp_f32 v176, v176
 v_exp_f32 v177, v177
 v_smfmac_f32_32x32x32_bf16 v[32:47], v[140:143], v[168:175], v112
 s_waitcnt lgkmcnt(0)
 v_exp_f32 v178, v178
 v_exp_f32 v179, v179
 v_exp_f32 v180, v180
 v_mfma_f32_32x32x16_bf16 v[160:175], v[104:107], v[144:147], 0
 v_exp_f32 v181, v181
 v_exp_f32 v182, v182
 v_exp_f32 v183, v183
 v_exp_f32 v184, v184
 v_exp_f32 v185, v185
 v_smfmac_f32_32x32x32_bf16 v[48:63], v[136:139], v[176:183], v112
 s_add_u32 m0, s53, 8192
 s_add_u32 s82, s82, 458752
 buffer_load_dwordx4 v116, s[32:35], s82 offen lds
 v_exp_f32 v186, v186
 v_exp_f32 v187, v187
 v_exp_f32 v188, v188
 v_exp_f32 v189, v189
 v_exp_f32 v190, v190
 v_exp_f32 v191, v191
 v_exp_f32 v160, v160
 v_exp_f32 v161, v161
 v_smfmac_f32_32x32x32_bf16 v[48:63], v[140:143], v[184:191], v112
 ds_read_b128 v[108:111], v113 offset:20480
 v_exp_f32 v162, v162
 v_exp_f32 v163, v163
 v_exp_f32 v164, v164
 v_mfma_f32_32x32x16_bf16 v[176:191], v[104:107], v[148:151], 0
 v_exp_f32 v165, v165
 v_exp_f32 v166, v166
 v_exp_f32 v167, v167
 v_exp_f32 v168, v168
 v_exp_f32 v169, v169
 v_smfmac_f32_32x32x32_bf16 v[32:47], v[128:131], v[160:167], v112
 s_mov_b64 exec, s[96:97]
 ds_read_b128 v[136:139], v114 offset:21504
 ds_read_b128 v[140:143], v114 offset:22016
 s_mov_b64 exec, -1
 v_exp_f32 v170, v170
 v_exp_f32 v171, v171
 v_exp_f32 v172, v172
 v_exp_f32 v173, v173
 v_exp_f32 v174, v174
 v_exp_f32 v175, v175
 v_exp_f32 v176, v176
 v_exp_f32 v177, v177
 v_smfmac_f32_32x32x32_bf16 v[32:47], v[132:135], v[168:175], v112
 s_waitcnt lgkmcnt(0)
 v_exp_f32 v178, v178
 v_exp_f32 v179, v179
 v_exp_f32 v180, v180
 v_mfma_f32_32x32x16_bf16 v[160:175], v[108:111], v[144:147], 0
 v_exp_f32 v181, v181
 v_exp_f32 v182, v182
 v_exp_f32 v183, v183
 v_exp_f32 v184, v184
 v_exp_f32 v185, v185
 v_smfmac_f32_32x32x32_bf16 v[48:63], v[128:131], v[176:183], v112
 s_add_u32 m0, s53, 16384
 s_add_u32 s82, s82, 458752
 buffer_load_dwordx4 v116, s[32:35], s82 offen lds
 v_exp_f32 v186, v186
 v_exp_f32 v187, v187
 v_exp_f32 v188, v188
 v_exp_f32 v189, v189
 v_exp_f32 v190, v190
 v_exp_f32 v191, v191
 v_exp_f32 v160, v160
 v_exp_f32 v161, v161
 v_smfmac_f32_32x32x32_bf16 v[48:63], v[132:135], v[184:191], v112
 ds_read_b128 v[104:107], v113 offset:24576
 s_setprio 2
 v_exp_f32 v162, v162
 v_exp_f32 v163, v163
 v_exp_f32 v164, v164
 v_mfma_f32_32x32x16_bf16 v[176:191], v[108:111], v[148:151], 0
 v_exp_f32 v165, v165
 v_exp_f32 v166, v166
 v_exp_f32 v167, v167
 v_exp_f32 v168, v168
 v_exp_f32 v169, v169
 v_smfmac_f32_32x32x32_bf16 v[32:47], v[136:139], v[160:167], v112
 s_mov_b64 exec, s[96:97]
 ds_read_b128 v[128:131], v114 offset:25600
 ds_read_b128 v[132:135], v114 offset:26112
 s_mov_b64 exec, -1
 v_exp_f32 v170, v170
 v_exp_f32 v171, v171
 v_exp_f32 v172, v172
 v_exp_f32 v173, v173
 v_exp_f32 v174, v174
 v_exp_f32 v175, v175
 v_exp_f32 v176, v176
 v_exp_f32 v177, v177
 v_smfmac_f32_32x32x32_bf16 v[32:47], v[140:143], v[168:175], v112
 s_waitcnt lgkmcnt(0)
 v_exp_f32 v178, v178
 v_exp_f32 v179, v179
 v_exp_f32 v180, v180
 v_mfma_f32_32x32x16_bf16 v[160:175], v[104:107], v[144:147], 0
 s_lshl_b32 s62, s70, 2
 s_add_u32 s62, s62, 4096
 s_waitcnt vmcnt(7)
 s_mov_b64 exec, 1
 buffer_store_dword v112, v126, s[28:31], s62 offen sc1
 s_mov_b64 exec, -1
 v_exp_f32 v181, v181
 v_exp_f32 v182, v182
 v_exp_f32 v183, v183
 v_exp_f32 v184, v184
 v_exp_f32 v185, v185
 v_smfmac_f32_32x32x32_bf16 v[48:63], v[136:139], v[176:183], v112
 s_add_u32 m0, s53, 24576
 s_add_u32 s82, s82, 458752
 buffer_load_dwordx4 v116, s[32:35], s82 offen lds
 v_exp_f32 v186, v186
 v_exp_f32 v187, v187
 v_exp_f32 v188, v188
 v_exp_f32 v189, v189
 v_exp_f32 v190, v190
 v_exp_f32 v191, v191
 v_exp_f32 v160, v160
 v_exp_f32 v161, v161
 v_smfmac_f32_32x32x32_bf16 v[48:63], v[140:143], v[184:191], v112
 ds_read_b128 v[108:111], v113 offset:28672
 s_setprio 1
 v_exp_f32 v162, v162
 v_exp_f32 v163, v163
 v_exp_f32 v164, v164
 v_mfma_f32_32x32x16_bf16 v[176:191], v[104:107], v[148:151], 0
 v_exp_f32 v165, v165
 v_exp_f32 v166, v166
 v_exp_f32 v167, v167
 v_exp_f32 v168, v168
 v_exp_f32 v169, v169
 v_smfmac_f32_32x32x32_bf16 v[32:47], v[128:131], v[160:167], v112
 s_mov_b64 exec, s[96:97]
 ds_read_b128 v[136:139], v114 offset:29696
 ds_read_b128 v[140:143], v114 offset:30208
 s_mov_b64 exec, -1
 v_exp_f32 v170, v170
 v_exp_f32 v171, v171
 v_exp_f32 v172, v172
 v_exp_f32 v173, v173
 v_exp_f32 v174, v174
 v_exp_f32 v175, v175
 v_exp_f32 v176, v176
 v_exp_f32 v177, v177
 v_smfmac_f32_32x32x32_bf16 v[32:47], v[132:135], v[168:175], v112
 s_waitcnt lgkmcnt(0)
 v_exp_f32 v178, v178
 v_exp_f32 v179, v179
 v_exp_f32 v180, v180
 v_mfma_f32_32x32x16_bf16 v[160:175], v[108:111], v[144:147], 0
 v_exp_f32 v181, v181
 v_exp_f32 v182, v182
 v_exp_f32 v183, v183
 v_exp_f32 v184, v184
 v_exp_f32 v185, v185
 v_smfmac_f32_32x32x32_bf16 v[48:63], v[128:131], v[176:183], v112
 s_setprio 0
 s_add_u32 s82, s81, 1
 s_cmp_ge_u32 s82, 7
 s_cselect_b32 s63, 7, 0
 s_sub_u32 s82, s82, s63
 s_add_u32 m0, s53, 32768
 s_lshl_b32 s82, s82, 16
 buffer_load_dwordx4 v116, s[32:35], s82 offen lds
 v_exp_f32 v186, v186
 v_exp_f32 v187, v187
 v_exp_f32 v188, v188
 v_exp_f32 v189, v189
 v_exp_f32 v190, v190
 v_exp_f32 v191, v191
 s_waitcnt vmcnt(6)
 s_barrier
 v_exp_f32 v160, v160
 v_exp_f32 v161, v161
 v_smfmac_f32_32x32x32_bf16 v[48:63], v[132:135], v[184:191], v112
 ds_read_b128 v[104:107], v113 offset:32768
 s_setprio 3
 v_exp_f32 v162, v162
 v_exp_f32 v163, v163
 v_exp_f32 v164, v164
 v_mfma_f32_32x32x16_bf16 v[176:191], v[108:111], v[148:151], 0
 v_exp_f32 v165, v165
 v_exp_f32 v166, v166
 v_exp_f32 v167, v167
 v_exp_f32 v168, v168
 v_exp_f32 v169, v169
 v_smfmac_f32_32x32x32_bf16 v[32:47], v[136:139], v[160:167], v112
 s_mov_b64 exec, s[96:97]
 ds_read_b128 v[128:131], v114 offset:33792
 ds_read_b128 v[132:135], v114 offset:34304
 s_mov_b64 exec, -1
 v_exp_f32 v170, v170
 v_exp_f32 v171, v171
 v_exp_f32 v172, v172
 v_exp_f32 v173, v173
 v_exp_f32 v174, v174
 v_exp_f32 v175, v175
 v_exp_f32 v176, v176
 v_exp_f32 v177, v177
 v_smfmac_f32_32x32x32_bf16 v[32:47], v[140:143], v[168:175], v112
 s_waitcnt lgkmcnt(0)
 v_exp_f32 v178, v178
 v_exp_f32 v179, v179
 v_exp_f32 v180, v180
 v_mfma_f32_32x32x16_bf16 v[160:175], v[104:107], v[144:147], 0
 s_add_u32 m0, s53, 65536
 s_add_u32 s63, s66, 65536
 buffer_load_dwordx4 v126, s[28:31], s63 offen sc1 lds
 v_exp_f32 v181, v181
 v_exp_f32 v182, v182
 v_exp_f32 v183, v183
 v_exp_f32 v184, v184
 v_exp_f32 v185, v185
 v_smfmac_f32_32x32x32_bf16 v[48:63], v[136:139], v[176:183], v112
 s_add_u32 m0, s53, 73728
 s_add_u32 s63, s66, 73728
 buffer_load_dwordx4 v126, s[28:31], s63 offen sc1 lds
 v_exp_f32 v186, v186
 v_exp_f32 v187, v187
 v_exp_f32 v188, v188
 v_exp_f32 v189, v189
 v_exp_f32 v190, v190
 v_exp_f32 v191, v191
 v_exp_f32 v160, v160
 v_exp_f32 v161, v161
 v_smfmac_f32_32x32x32_bf16 v[48:63], v[140:143], v[184:191], v112
 ds_read_b128 v[108:111], v113 offset:36864
 v_exp_f32 v162, v162
 v_exp_f32 v163, v163
 v_exp_f32 v164, v164
 v_mfma_f32_32x32x16_bf16 v[176:191], v[104:107], v[148:151], 0
 v_exp_f32 v165, v165
 v_exp_f32 v166, v166
 v_exp_f32 v167, v167
 v_exp_f32 v168, v168
 v_exp_f32 v169, v169
 v_smfmac_f32_32x32x32_bf16 v[32:47], v[128:131], v[160:167], v112
 s_mov_b64 exec, s[96:97]
 ds_read_b128 v[136:139], v114 offset:37888
 ds_read_b128 v[140:143], v114 offset:38400
 s_mov_b64 exec, -1
 v_exp_f32 v170, v170
 v_exp_f32 v171, v171
 v_exp_f32 v172, v172
 v_exp_f32 v173, v173
 v_exp_f32 v174, v174
 v_exp_f32 v175, v175
 v_exp_f32 v176, v176
 v_exp_f32 v177, v177
 v_smfmac_f32_32x32x32_bf16 v[32:47], v[132:135], v[168:175], v112
 s_waitcnt lgkmcnt(0)
 v_exp_f32 v178, v178
 v_exp_f32 v179, v179
 v_exp_f32 v180, v180
 v_mfma_f32_32x32x16_bf16 v[160:175], v[108:111], v[144:147], 0
 s_add_u32 m0, s53, 81920
 s_add_u32 s63, s66, 81920
 buffer_load_dwordx4 v126, s[28:31], s63 offen sc1 lds
 v_exp_f32 v181, v181
 v_exp_f32 v182, v182
 v_exp_f32 v183, v183
 v_exp_f32 v184, v184
 v_exp_f32 v185, v185
 v_smfmac_f32_32x32x32_bf16 v[48:63], v[128:131], v[176:183], v112
 s_add_u32 m0, s53, 90112
 s_add_u32 s63, s66, 90112
 buffer_load_dwordx4 v126, s[28:31], s63 offen sc1 lds
 v_exp_f32 v186, v186
 v_exp_f32 v187, v187
 v_exp_f32 v188, v188
 v_exp_f32 v189, v189
 v_exp_f32 v190, v190
 v_exp_f32 v191, v191
 v_exp_f32 v160, v160
 v_exp_f32 v161, v161
 v_smfmac_f32_32x32x32_bf16 v[48:63], v[132:135], v[184:191], v112
 ds_read_b128 v[104:107], v113 offset:40960
 v_exp_f32 v162, v162
 v_exp_f32 v163, v163
 v_exp_f32 v164, v164
 v_mfma_f32_32x32x16_bf16 v[176:191], v[108:111], v[148:151], 0
 v_exp_f32 v165, v165
 v_exp_f32 v166, v166
 v_exp_f32 v167, v167
 v_exp_f32 v168, v168
 v_exp_f32 v169, v169
 v_smfmac_f32_32x32x32_bf16 v[32:47], v[136:139], v[160:167], v112
 s_mov_b64 exec, s[96:97]
 ds_read_b128 v[128:131], v114 offset:41984
 ds_read_b128 v[132:135], v114 offset:42496
 s_mov_b64 exec, -1
 v_exp_f32 v170, v170
 v_exp_f32 v171, v171
 v_exp_f32 v172, v172
 v_exp_f32 v173, v173
 v_exp_f32 v174, v174
 v_exp_f32 v175, v175
 v_exp_f32 v176, v176
 v_exp_f32 v177, v177
 v_smfmac_f32_32x32x32_bf16 v[32:47], v[140:143], v[168:175], v112
 s_waitcnt lgkmcnt(0)
 v_exp_f32 v178, v178
 v_exp_f32 v179, v179
 v_exp_f32 v180, v180
 v_mfma_f32_32x32x16_bf16 v[160:175], v[104:107], v[144:147], 0
 s_add_u32 m0, s53, 40960
 s_add_u32 s82, s82, 458752
 buffer_load_dwordx4 v116, s[32:35], s82 offen lds
 v_exp_f32 v181, v181
 v_exp_f32 v182, v182
 v_exp_f32 v183, v183
 v_exp_f32 v184, v184
 v_exp_f32 v185, v185
 v_smfmac_f32_32x32x32_bf16 v[48:63], v[136:139], v[176:183], v112
 s_add_u32 m0, s53, 49152
 s_add_u32 s82, s82, 458752
 buffer_load_dwordx4 v116, s[32:35], s82 offen lds
 v_exp_f32 v186, v186
 v_exp_f32 v187, v187
 v_exp_f32 v188, v188
 v_exp_f32 v189, v189
 v_exp_f32 v190, v190
 v_exp_f32 v191, v191
 v_exp_f32 v160, v160
 v_exp_f32 v161, v161
 v_smfmac_f32_32x32x32_bf16 v[48:63], v[140:143], v[184:191], v112
 ds_read_b128 v[108:111], v113 offset:45056
 v_exp_f32 v162, v162
 v_exp_f32 v163, v163
 v_exp_f32 v164, v164
 v_mfma_f32_32x32x16_bf16 v[176:191], v[104:107], v[148:151], 0
 v_exp_f32 v165, v165
 v_exp_f32 v166, v166
 v_exp_f32 v167, v167
 v_exp_f32 v168, v168
 v_exp_f32 v169, v169
 v_smfmac_f32_32x32x32_bf16 v[32:47], v[128:131], v[160:167], v112
 s_mov_b64 exec, s[96:97]
 ds_read_b128 v[136:139], v114 offset:46080
 ds_read_b128 v[140:143], v114 offset:46592
 s_mov_b64 exec, -1
 v_exp_f32 v170, v170
 v_exp_f32 v171, v171
 v_exp_f32 v172, v172
 v_exp_f32 v173, v173
 v_exp_f32 v174, v174
 v_exp_f32 v175, v175
 v_exp_f32 v176, v176
 v_exp_f32 v177, v177
 v_smfmac_f32_32x32x32_bf16 v[32:47], v[132:135], v[168:175], v112
 s_waitcnt lgkmcnt(0)
 v_exp_f32 v178, v178
 v_exp_f32 v179, v179
 v_exp_f32 v180, v180
 v_mfma_f32_32x32x16_bf16 v[160:175], v[108:111], v[144:147], 0
 buffer_load_dword v118, v123, s[28:31], 0 offen sc1
 buffer_load_dword v121, v115, s[28:31], 0 offen sc1
 s_add_u32 m0, s53, 57344
 s_add_u32 s82, s82, 458752
 buffer_load_dwordx4 v116, s[32:35], s82 offen lds
 v_exp_f32 v181, v181
 v_exp_f32 v182, v182
 v_exp_f32 v183, v183
 v_exp_f32 v184, v184
 v_exp_f32 v185, v185
 v_smfmac_f32_32x32x32_bf16 v[48:63], v[128:131], v[176:183], v112
 s_add_u32 s82, s81, 2
 s_cmp_ge_u32 s82, 7
 s_cselect_b32 s63, 7, 0
 s_sub_u32 s82, s82, s63
 s_add_u32 m0, s53, 131072
 s_lshl_b32 s82, s82, 16
 buffer_load_dwordx4 v116, s[32:35], s82 offen lds
 v_exp_f32 v186, v186
 v_exp_f32 v187, v187
 v_exp_f32 v188, v188
 v_exp_f32 v189, v189
 v_exp_f32 v190, v190
 v_exp_f32 v191, v191
 v_exp_f32 v160, v160
 v_exp_f32 v161, v161
 v_smfmac_f32_32x32x32_bf16 v[48:63], v[132:135], v[184:191], v112
 ds_read_b128 v[104:107], v113 offset:49152
 s_setprio 2
 v_exp_f32 v162, v162
 v_exp_f32 v163, v163
 v_exp_f32 v164, v164
 v_mfma_f32_32x32x16_bf16 v[176:191], v[108:111], v[148:151], 0
 v_exp_f32 v165, v165
 v_exp_f32 v166, v166
 v_exp_f32 v167, v167
 v_exp_f32 v168, v168
 v_exp_f32 v169, v169
 v_smfmac_f32_32x32x32_bf16 v[32:47], v[136:139], v[160:167], v112
 s_mov_b64 exec, s[96:97]
 ds_read_b128 v[128:131], v114 offset:50176
 ds_read_b128 v[132:135], v114 offset:50688
 s_mov_b64 exec, -1
 v_exp_f32 v170, v170
 v_exp_f32 v171, v171
 v_exp_f32 v172, v172
 v_exp_f32 v173, v173
 v_exp_f32 v174, v174
 v_exp_f32 v175, v175
 v_exp_f32 v176, v176
 v_exp_f32 v177, v177
 v_smfmac_f32_32x32x32_bf16 v[32:47], v[140:143], v[168:175], v112
 s_waitcnt lgkmcnt(0)
 v_exp_f32 v178, v178
 v_exp_f32 v179, v179
 v_exp_f32 v180, v180
 v_mfma_f32_32x32x16_bf16 v[160:175], v[104:107], v[144:147], 0
 s_add_u32 m0, s53, 139264
 s_add_u32 s82, s82, 458752
 buffer_load_dwordx4 v116, s[32:35], s82 offen lds
 v_exp_f32 v181, v181
 v_exp_f32 v182, v182
 v_exp_f32 v183, v183
 v_exp_f32 v184, v184
 v_exp_f32 v185, v185
 v_smfmac_f32_32x32x32_bf16 v[48:63], v[136:139], v[176:183], v112
 s_add_u32 m0, s53, 147456
 s_add_u32 s82, s82, 458752
 buffer_load_dwordx4 v116, s[32:35], s82 offen lds
 v_exp_f32 v186, v186
 v_exp_f32 v187, v187
 v_exp_f32 v188, v188
 v_exp_f32 v189, v189
 v_exp_f32 v190, v190
 v_exp_f32 v191, v191
 s_waitcnt vmcnt(4)
 v_cmp_eq_u32 vcc, 0, v121
 s_nop 0
 s_cmp_lg_u64 vcc, 0
 s_cbranch_scc1 L_x_3018
L_r_3019:
 v_cmp_eq_u32 vcc, 0, v118
 s_nop 0
 s_cmp_lg_u64 vcc, 0
 s_cbranch_scc1 L_x_3021
L_r_3022:
 v_exp_f32 v160, v160
 v_exp_f32 v161, v161
 v_smfmac_f32_32x32x32_bf16 v[48:63], v[140:143], v[184:191], v112
 ds_read_b128 v[108:111], v113 offset:53248
 v_exp_f32 v162, v162
 v_exp_f32 v163, v163
 v_exp_f32 v164, v164
 v_mfma_f32_32x32x16_bf16 v[176:191], v[104:107], v[148:151], 0
 v_exp_f32 v165, v165
 v_exp_f32 v166, v166
 v_exp_f32 v167, v167
 v_exp_f32 v168, v168
 v_exp_f32 v169, v169
 v_smfmac_f32_32x32x32_bf16 v[32:47], v[128:131], v[160:167], v112
 s_mov_b64 exec, s[96:97]
 ds_read_b128 v[136:139], v114 offset:54272
 ds_read_b128 v[140:143], v114 offset:54784
 s_mov_b64 exec, -1
 v_exp_f32 v170, v170
 v_exp_f32 v171, v171
 v_exp_f32 v172, v172
 v_exp_f32 v173, v173
 v_exp_f32 v174, v174
 v_exp_f32 v175, v175
 v_exp_f32 v118, -v118
 v_exp_f32 v176, v176
 v_exp_f32 v177, v177
 v_smfmac_f32_32x32x32_bf16 v[32:47], v[132:135], v[168:175], v112
 s_waitcnt lgkmcnt(0)
 v_exp_f32 v178, v178
 v_exp_f32 v179, v179
 v_exp_f32 v180, v180
 v_mfma_f32_32x32x16_bf16 v[160:175], v[108:111], v[144:147], 0
 s_add_u32 s83, s81, 0
 s_cmp_ge_u32 s83, 7
 s_cselect_b32 s63, 7, 0
 s_sub_u32 s83, s83, s63
 s_lshl_b32 s83, s83, 12
 s_add_u32 s83, s83, s69
 buffer_load_dwordx4 v[16:19], v122, s[28:31], s83 offen offset:0 sc1
 v_exp_f32 v181, v181
 v_exp_f32 v182, v182
 v_exp_f32 v183, v183
 v_exp_f32 v184, v184
 v_exp_f32 v185, v185
 v_smfmac_f32_32x32x32_bf16 v[48:63], v[128:131], v[176:183], v112
 buffer_load_dwordx4 v[20:23], v122, s[28:31], s83 offen offset:2048 sc1
 v_add_f32 v118, 1.0, v118
 v_rcp_f32 v118, v118
 v_exp_f32 v186, v186
 v_exp_f32 v187, v187
 v_exp_f32 v188, v188
 v_exp_f32 v189, v189
 v_exp_f32 v190, v190
 v_exp_f32 v191, v191
 v_exp_f32 v160, v160
 v_exp_f32 v161, v161
 v_smfmac_f32_32x32x32_bf16 v[48:63], v[132:135], v[184:191], v112
 ds_read_b128 v[104:107], v113 offset:57344
 v_exp_f32 v162, v162
 v_exp_f32 v163, v163
 v_exp_f32 v164, v164
 v_mfma_f32_32x32x16_bf16 v[176:191], v[108:111], v[148:151], 0
 v_exp_f32 v165, v165
 v_exp_f32 v166, v166
 v_exp_f32 v167, v167
 v_exp_f32 v168, v168
 v_exp_f32 v169, v169
 v_smfmac_f32_32x32x32_bf16 v[32:47], v[136:139], v[160:167], v112
 s_mov_b64 exec, s[96:97]
 ds_read_b128 v[128:131], v114 offset:58368
 ds_read_b128 v[132:135], v114 offset:58880
 s_mov_b64 exec, -1
 v_exp_f32 v170, v170
 v_exp_f32 v171, v171
 v_exp_f32 v172, v172
 v_exp_f32 v173, v173
 v_exp_f32 v174, v174
 v_exp_f32 v175, v175
 v_exp_f32 v176, v176
 v_exp_f32 v177, v177
 v_smfmac_f32_32x32x32_bf16 v[32:47], v[140:143], v[168:175], v112
 s_waitcnt lgkmcnt(0)
 s_setprio 1
 v_exp_f32 v178, v178
 v_exp_f32 v179, v179
 v_exp_f32 v180, v180
 v_mfma_f32_32x32x16_bf16 v[160:175], v[104:107], v[144:147], 0
 s_cmp_lg_u32 s72, 1
 s_cbranch_scc1 L_s_3024
 s_and_b32 s62, s71, 7
 s_lshl_b32 s62, s62, 16
 buffer_load_dword v125, v117, s[36:39], s62 offen
L_s_3024:
 buffer_load_dwordx4 v[24:27], v122, s[28:31], s83 offen offset:256 sc1
 v_exp_f32 v181, v181
 v_exp_f32 v182, v182
 v_exp_f32 v183, v183
 v_exp_f32 v184, v184
 v_exp_f32 v185, v185
 v_smfmac_f32_32x32x32_bf16 v[48:63], v[136:139], v[176:183], v112
 buffer_load_dwordx4 v[28:31], v122, s[28:31], s83 offen offset:2304 sc1
 v_exp_f32 v186, v186
 v_exp_f32 v187, v187
 v_exp_f32 v188, v188
 v_exp_f32 v189, v189
 v_exp_f32 v190, v190
 v_exp_f32 v191, v191
 v_exp_f32 v160, v160
 v_exp_f32 v161, v161
 v_smfmac_f32_32x32x32_bf16 v[48:63], v[140:143], v[184:191], v112
 ds_read_b128 v[108:111], v113 offset:61440
 v_exp_f32 v162, v162
 v_exp_f32 v163, v163
 v_exp_f32 v164, v164
 v_mfma_f32_32x32x16_bf16 v[176:191], v[104:107], v[148:151], 0
 v_exp_f32 v165, v165
 v_exp_f32 v166, v166
 v_exp_f32 v167, v167
 v_exp_f32 v168, v168
 v_exp_f32 v169, v169
 v_smfmac_f32_32x32x32_bf16 v[32:47], v[128:131], v[160:167], v112
 s_mov_b64 exec, s[96:97]
 ds_read_b128 v[136:139], v114 offset:62464
 ds_read_b128 v[140:143], v114 offset:62976
 s_mov_b64 exec, -1
 v_exp_f32 v170, v170
 v_exp_f32 v171, v171
 v_exp_f32 v172, v172
 v_exp_f32 v173, v173
 s_add_u32 s83, s81, 1
 s_cmp_ge_u32 s83, 7
 s_cselect_b32 s63, 7, 0
 s_sub_u32 s83, s83, s63
 s_lshl_b32 s83, s83, 12
 s_add_u32 s83, s83, s69
 buffer_load_dwordx4 v[64:67], v122, s[28:31], s83 offen offset:0 sc1
 v_exp_f32 v174, v174
 v_exp_f32 v175, v175
 v_exp_f32 v176, v176
 v_exp_f32 v177, v177
 v_smfmac_f32_32x32x32_bf16 v[32:47], v[132:135], v[168:175], v112
 s_waitcnt lgkmcnt(0)
 v_exp_f32 v178, v178
 v_exp_f32 v179, v179
 v_exp_f32 v180, v180
 v_mfma_f32_32x32x16_bf16 v[160:175], v[108:111], v[144:147], 0
 buffer_load_dwordx4 v[68:71], v122, s[28:31], s83 offen offset:2048 sc1
 v_exp_f32 v181, v181
 v_exp_f32 v182, v182
 v_exp_f32 v183, v183
 v_exp_f32 v184, v184
 v_exp_f32 v185, v185
 v_smfmac_f32_32x32x32_bf16 v[48:63], v[128:131], v[176:183], v112
 s_setprio 0
 s_add_u32 m0, s53, 155648
 s_add_u32 s82, s82, 458752
 buffer_load_dwordx4 v116, s[32:35], s82 offen lds
 v_exp_f32 v186, v186
 v_exp_f32 v187, v187
 v_exp_f32 v188, v188
 v_exp_f32 v189, v189
 v_exp_f32 v190, v190
 v_exp_f32 v191, v191
 s_waitcnt vmcnt(10)
 s_barrier
 v_exp_f32 v160, v160
 v_exp_f32 v161, v161
 v_smfmac_f32_32x32x32_bf16 v[48:63], v[132:135], v[184:191], v112
 ds_read_b128 v[104:107], v113 offset:0
 s_setprio 3
 v_exp_f32 v162, v162
 v_exp_f32 v163, v163
 v_exp_f32 v164, v164
 v_mfma_f32_32x32x16_bf16 v[176:191], v[108:111], v[148:151], 0
 ds_read_b64_tr_b16 v[88:89], v124 offset:0
 ds_read_b64_tr_b16 v[90:91], v124 offset:2048
 v_exp_f32 v165, v165
 v_exp_f32 v166, v166
 v_exp_f32 v167, v167
 v_exp_f32 v168, v168
 v_exp_f32 v169, v169
 v_smfmac_f32_32x32x32_bf16 v[32:47], v[136:139], v[160:167], v112
 ds_read_b64_tr_b16 v[92:93], v124 offset:4096
 ds_read_b64_tr_b16 v[94:95], v124 offset:6144
 s_mov_b64 exec, s[96:97]
 ds_read_b128 v[128:131], v114 offset:1024
 ds_read_b128 v[132:135], v114 offset:1536
 s_mov_b64 exec, -1
 v_exp_f32 v170, v170
 v_exp_f32 v171, v171
 v_exp_f32 v172, v172
 v_exp_f32 v173, v173
 buffer_load_dwordx4 v[72:75], v122, s[28:31], s83 offen offset:256 sc1
 v_exp_f32 v174, v174
 v_exp_f32 v175, v175
 v_exp_f32 v176, v176
 v_exp_f32 v177, v177
 v_smfmac_f32_32x32x32_bf16 v[32:47], v[140:143], v[168:175], v112
 s_waitcnt lgkmcnt(0)
 v_exp_f32 v178, v178
 v_exp_f32 v179, v179
 v_exp_f32 v180, v180
 v_mfma_f32_32x32x16_bf16 v[160:175], v[104:107], v[144:147], 0
 buffer_load_dwordx4 v[76:79], v122, s[28:31], s83 offen offset:2304 sc1
 v_exp_f32 v181, v181
 v_exp_f32 v182, v182
 v_exp_f32 v183, v183
 v_exp_f32 v184, v184
 v_exp_f32 v185, v185
 v_smfmac_f32_32x32x32_bf16 v[48:63], v[136:139], v[176:183], v112
 s_add_u32 m0, s53, 98304
 s_add_u32 s63, s66, 98304
 buffer_load_dwordx4 v126, s[28:31], s63 offen sc1 lds
 v_exp_f32 v186, v186
 v_exp_f32 v187, v187
 v_exp_f32 v188, v188
 v_exp_f32 v189, v189
 s_waitcnt vmcnt(8)
 v_mfma_f32_16x16x32_bf16 v[224:227], v[88:91], v[16:19], 0
 v_mfma_f32_16x16x32_bf16 v[224:227], v[92:95], v[20:23], v[224:227]
 v_exp_f32 v190, v190
 v_exp_f32 v191, v191
 v_exp_f32 v160, v160
 v_exp_f32 v161, v161
 v_smfmac_f32_32x32x32_bf16 v[48:63], v[140:143], v[184:191], v112
 ds_read_b128 v[108:111], v113 offset:4096
 v_exp_f32 v162, v162
 v_exp_f32 v163, v163
 v_exp_f32 v164, v164
 v_mfma_f32_32x32x16_bf16 v[176:191], v[104:107], v[148:151], 0
 ds_read_b64_tr_b16 v[96:97], v1 offset:0
 ds_read_b64_tr_b16 v[98:99], v1 offset:2048
 v_exp_f32 v165, v165
 v_exp_f32 v166, v166
 v_exp_f32 v167, v167
 v_exp_f32 v168, v168
 v_exp_f32 v169, v169
 v_smfmac_f32_32x32x32_bf16 v[32:47], v[128:131], v[160:167], v112
 ds_read_b64_tr_b16 v[100:101], v1 offset:4096
 ds_read_b64_tr_b16 v[102:103], v1 offset:6144
 s_mov_b64 exec, s[96:97]
 ds_read_b128 v[136:139], v114 offset:5120
 ds_read_b128 v[140:143], v114 offset:5632
 s_mov_b64 exec, -1
 v_exp_f32 v170, v170
 v_exp_f32 v171, v171
 v_exp_f32 v172, v172
 v_exp_f32 v173, v173
 s_waitcnt vmcnt(6)
 v_mfma_f32_16x16x32_bf16 v[228:231], v[88:91], v[24:27], 0
 v_mfma_f32_16x16x32_bf16 v[228:231], v[92:95], v[28:31], v[228:231]
 s_add_u32 s83, s81, 2
 s_cmp_ge_u32 s83, 7
 s_cselect_b32 s63, 7, 0
 s_sub_u32 s83, s83, s63
 s_lshl_b32 s83, s83, 12
 s_add_u32 s83, s83, s69
 buffer_load_dwordx4 v[80:83], v122, s[28:31], s83 offen offset:0 sc1
 v_exp_f32 v174, v174
 v_exp_f32 v175, v175
 v_exp_f32 v176, v176
 v_exp_f32 v177, v177
 v_smfmac_f32_32x32x32_bf16 v[32:47], v[132:135], v[168:175], v112
 s_waitcnt lgkmcnt(0)
 v_exp_f32 v178, v178
 v_exp_f32 v179, v179
 v_exp_f32 v180, v180
 v_mfma_f32_32x32x16_bf16 v[160:175], v[108:111], v[144:147], 0
 buffer_load_dwordx4 v[84:87], v122, s[28:31], s83 offen offset:2048 sc1
 v_exp_f32 v181, v181
 v_exp_f32 v182, v182
 v_exp_f32 v183, v183
 v_exp_f32 v184, v184
 v_exp_f32 v185, v185
 v_smfmac_f32_32x32x32_bf16 v[48:63], v[128:131], v[176:183], v112
 s_add_u32 m0, s53, 106496
 s_add_u32 s63, s66, 106496
 buffer_load_dwordx4 v126, s[28:31], s63 offen sc1 lds
 v_exp_f32 v186, v186
 v_exp_f32 v187, v187
 v_exp_f32 v188, v188
 v_exp_f32 v189, v189
 v_mfma_f32_16x16x32_bf16 v[232:235], v[96:99], v[16:19], 0
 v_mfma_f32_16x16x32_bf16 v[232:235], v[100:103], v[20:23], v[232:235]
 v_exp_f32 v190, v190
 v_exp_f32 v191, v191
 v_exp_f32 v160, v160
 v_exp_f32 v161, v161
 v_smfmac_f32_32x32x32_bf16 v[48:63], v[132:135], v[184:191], v112
 ds_read_b128 v[104:107], v113 offset:8192
 v_exp_f32 v162, v162
 v_exp_f32 v163, v163
 v_exp_f32 v164, v164
 v_mfma_f32_32x32x16_bf16 v[176:191], v[108:111], v[148:151], 0
 ds_read_b64_tr_b16 v[88:89], v2 offset:0
 ds_read_b64_tr_b16 v[90:91], v2 offset:2048
 v_exp_f32 v165, v165
 v_exp_f32 v166, v166
 v_exp_f32 v167, v167
 v_exp_f32 v168, v168
 v_exp_f32 v169, v169
 v_smfmac_f32_32x32x32_bf16 v[32:47], v[136:139], v[160:167], v112
 ds_read_b64_tr_b16 v[92:93], v2 offset:4096
 ds_read_b64_tr_b16 v[94:95], v2 offset:6144
 s_mov_b64 exec, s[96:97]
 ds_read_b128 v[128:131], v114 offset:9216
 ds_read_b128 v[132:135], v114 offset:9728
 s_mov_b64 exec, -1
 v_exp_f32 v170, v170
 v_exp_f32 v171, v171
 v_exp_f32 v172, v172
 v_exp_f32 v173, v173
 v_mfma_f32_16x16x32_bf16 v[236:239], v[96:99], v[24:27], 0
 v_mfma_f32_16x16x32_bf16 v[236:239], v[100:103], v[28:31], v[236:239]
 buffer_load_dwordx4 v[152:155], v122, s[28:31], s83 offen offset:256 sc1
 v_exp_f32 v174, v174
 v_exp_f32 v175, v175
 v_exp_f32 v176, v176
 v_exp_f32 v177, v177
 v_smfmac_f32_32x32x32_bf16 v[32:47], v[140:143], v[168:175], v112
 s_waitcnt lgkmcnt(0)
 v_exp_f32 v178, v178
 v_exp_f32 v179, v179
 v_exp_f32 v180, v180
 v_mfma_f32_32x32x16_bf16 v[160:175], v[104:107], v[144:147], 0
 buffer_load_dwordx4 v[156:159], v122, s[28:31], s83 offen offset:2304 sc1
 v_exp_f32 v181, v181
 v_exp_f32 v182, v182
 v_exp_f32 v183, v183
 v_exp_f32 v184, v184
 v_exp_f32 v185, v185
 v_smfmac_f32_32x32x32_bf16 v[48:63], v[136:139], v[176:183], v112
 s_add_u32 m0, s53, 114688
 s_add_u32 s63, s66, 114688
 buffer_load_dwordx4 v126, s[28:31], s63 offen sc1 lds
 v_exp_f32 v186, v186
 v_exp_f32 v187, v187
 v_exp_f32 v188, v188
 v_exp_f32 v189, v189
 v_mfma_f32_16x16x32_bf16 v[240:243], v[88:91], v[16:19], 0
 v_mfma_f32_16x16x32_bf16 v[240:243], v[92:95], v[20:23], v[240:243]
 v_exp_f32 v190, v190
 v_exp_f32 v191, v191
 v_exp_f32 v160, v160
 v_exp_f32 v161, v161
 v_smfmac_f32_32x32x32_bf16 v[48:63], v[140:143], v[184:191], v112
 ds_read_b128 v[108:111], v113 offset:12288
 v_exp_f32 v162, v162
 v_exp_f32 v163, v163
 v_exp_f32 v164, v164
 v_mfma_f32_32x32x16_bf16 v[176:191], v[104:107], v[148:151], 0
 ds_read_b64_tr_b16 v[96:97], v3 offset:0
 ds_read_b64_tr_b16 v[98:99], v3 offset:2048
 v_exp_f32 v165, v165
 v_exp_f32 v166, v166
 v_exp_f32 v167, v167
 v_exp_f32 v168, v168
 v_exp_f32 v169, v169
 v_smfmac_f32_32x32x32_bf16 v[32:47], v[128:131], v[160:167], v112
 ds_read_b64_tr_b16 v[100:101], v3 offset:4096
 ds_read_b64_tr_b16 v[102:103], v3 offset:6144
 s_mov_b64 exec, s[96:97]
 ds_read_b128 v[136:139], v114 offset:13312
 ds_read_b128 v[140:143], v114 offset:13824
 s_mov_b64 exec, -1
 v_exp_f32 v170, v170
 v_exp_f32 v171, v171
 v_exp_f32 v172, v172
 v_exp_f32 v173, v173
 v_mfma_f32_16x16x32_bf16 v[244:247], v[88:91], v[24:27], 0
 v_mfma_f32_16x16x32_bf16 v[244:247], v[92:95], v[28:31], v[244:247]
 s_add_u32 s83, s81, 3
 s_cmp_ge_u32 s83, 7
 s_cselect_b32 s63, 7, 0
 s_sub_u32 s83, s83, s63
 s_lshl_b32 s83, s83, 12
 s_add_u32 s83, s83, s69
 buffer_load_dwordx4 v[192:195], v122, s[28:31], s83 offen offset:0 sc1
 v_exp_f32 v174, v174
 v_exp_f32 v175, v175
 v_exp_f32 v176, v176
 v_exp_f32 v177, v177
 v_smfmac_f32_32x32x32_bf16 v[32:47], v[132:135], v[168:175], v112
 s_waitcnt lgkmcnt(0)
 v_exp_f32 v178, v178
 v_exp_f32 v179, v179
 v_exp_f32 v180, v180
 v_mfma_f32_32x32x16_bf16 v[160:175], v[108:111], v[144:147], 0
 buffer_load_dwordx4 v[196:199], v122, s[28:31], s83 offen offset:2048 sc1
 v_exp_f32 v181, v181
 v_exp_f32 v182, v182
 v_exp_f32 v183, v183
 v_exp_f32 v184, v184
 v_exp_f32 v185, v185
 v_smfmac_f32_32x32x32_bf16 v[48:63], v[128:131], v[176:183], v112
 s_add_u32 m0, s53, 122880
 s_add_u32 s63, s66, 122880
 buffer_load_dwordx4 v126, s[28:31], s63 offen sc1 lds
 v_exp_f32 v186, v186
 v_exp_f32 v187, v187
 v_exp_f32 v188, v188
 v_exp_f32 v189, v189
 v_mfma_f32_16x16x32_bf16 v[248:251], v[96:99], v[16:19], 0
 v_mfma_f32_16x16x32_bf16 v[248:251], v[100:103], v[20:23], v[248:251]
 v_exp_f32 v190, v190
 v_exp_f32 v191, v191
 v_exp_f32 v160, v160
 v_exp_f32 v161, v161
 v_smfmac_f32_32x32x32_bf16 v[48:63], v[132:135], v[184:191], v112
 ds_read_b128 v[104:107], v113 offset:16384
 s_setprio 2
 v_exp_f32 v162, v162
 v_exp_f32 v163, v163
 v_exp_f32 v164, v164
 v_mfma_f32_32x32x16_bf16 v[176:191], v[108:111], v[148:151], 0
 ds_read_b64_tr_b16 v[88:89], v124 offset:32768
 ds_read_b64_tr_b16 v[90:91], v124 offset:34816
 v_exp_f32 v165, v165
 v_exp_f32 v166, v166
 v_exp_f32 v167, v167
 v_exp_f32 v168, v168
 v_exp_f32 v169, v169
 v_smfmac_f32_32x32x32_bf16 v[32:47], v[136:139], v[160:167], v112
 ds_read_b64_tr_b16 v[92:93], v124 offset:36864
 ds_read_b64_tr_b16 v[94:95], v124 offset:38912
 s_mov_b64 exec, s[96:97]
 ds_read_b128 v[128:131], v114 offset:17408
 ds_read_b128 v[132:135], v114 offset:17920
 s_mov_b64 exec, -1
 v_exp_f32 v170, v170
 v_exp_f32 v171, v171
 v_exp_f32 v172, v172
 v_exp_f32 v173, v173
 v_mfma_f32_16x16x32_bf16 v[252:255], v[96:99], v[24:27], 0
 v_mfma_f32_16x16x32_bf16 v[252:255], v[100:103], v[28:31], v[252:255]
 buffer_load_dwordx4 v[200:203], v122, s[28:31], s83 offen offset:256 sc1
 v_exp_f32 v174, v174
 v_exp_f32 v175, v175
 v_exp_f32 v176, v176
 v_exp_f32 v177, v177
 v_smfmac_f32_32x32x32_bf16 v[32:47], v[140:143], v[168:175], v112
 s_waitcnt lgkmcnt(0)
 v_exp_f32 v178, v178
 v_exp_f32 v179, v179
 v_exp_f32 v180, v180
 v_mfma_f32_32x32x16_bf16 v[160:175], v[104:107], v[144:147], 0
 buffer_load_dwordx4 v[204:207], v122, s[28:31], s83 offen offset:2304 sc1
 v_exp_f32 v181, v181
 v_exp_f32 v182, v182
 v_exp_f32 v183, v183
 v_exp_f32 v184, v184
 v_exp_f32 v185, v185
 v_smfmac_f32_32x32x32_bf16 v[48:63], v[136:139], v[176:183], v112
 s_add_u32 s83, s81, 4
 s_cmp_ge_u32 s83, 7
 s_cselect_b32 s63, 7, 0
 s_sub_u32 s83, s83, s63
 s_lshl_b32 s83, s83, 12
 s_add_u32 s83, s83, s69
 buffer_load_dwordx4 v[208:211], v122, s[28:31], s83 offen offset:0 sc1
 v_exp_f32 v186, v186
 v_exp_f32 v187, v187
 v_exp_f32 v188, v188
 v_exp_f32 v189, v189
 s_waitcnt vmcnt(16)
 v_mfma_f32_16x16x32_bf16 v[224:227], v[88:91], v[64:67], v[224:227]
 v_mfma_f32_16x16x32_bf16 v[224:227], v[92:95], v[68:71], v[224:227]
 v_exp_f32 v190, v190
 v_exp_f32 v191, v191
 v_exp_f32 v160, v160
 v_exp_f32 v161, v161
 v_smfmac_f32_32x32x32_bf16 v[48:63], v[140:143], v[184:191], v112
 ds_read_b128 v[108:111], v113 offset:20480
 v_exp_f32 v162, v162
 v_exp_f32 v163, v163
 v_exp_f32 v164, v164
 v_mfma_f32_32x32x16_bf16 v[176:191], v[104:107], v[148:151], 0
 ds_read_b64_tr_b16 v[96:97], v1 offset:32768
 ds_read_b64_tr_b16 v[98:99], v1 offset:34816
 v_exp_f32 v165, v165
 v_exp_f32 v166, v166
 v_exp_f32 v167, v167
 v_exp_f32 v168, v168
 v_exp_f32 v169, v169
 v_smfmac_f32_32x32x32_bf16 v[32:47], v[128:131], v[160:167], v112
 ds_read_b64_tr_b16 v[100:101], v1 offset:36864
 ds_read_b64_tr_b16 v[102:103], v1 offset:38912
 s_mov_b64 exec, s[96:97]
 ds_read_b128 v[136:139], v114 offset:21504
 ds_read_b128 v[140:143], v114 offset:22016
 s_mov_b64 exec, -1
 v_exp_f32 v170, v170
 v_exp_f32 v171, v171
 v_exp_f32 v172, v172
 v_exp_f32 v173, v173
 s_waitcnt vmcnt(13)
 v_mfma_f32_16x16x32_bf16 v[228:231], v[88:91], v[72:75], v[228:231]
 v_mfma_f32_16x16x32_bf16 v[228:231], v[92:95], v[76:79], v[228:231]
 buffer_load_dwordx4 v[212:215], v122, s[28:31], s83 offen offset:2048 sc1
 v_exp_f32 v174, v174
 v_exp_f32 v175, v175
 v_exp_f32 v176, v176
 v_exp_f32 v177, v177
 v_smfmac_f32_32x32x32_bf16 v[32:47], v[132:135], v[168:175], v112
 s_waitcnt lgkmcnt(0)
 v_exp_f32 v178, v178
 v_exp_f32 v179, v179
 v_exp_f32 v180, v180
 v_mfma_f32_32x32x16_bf16 v[160:175], v[108:111], v[144:147], 0
 buffer_load_dwordx4 v[216:219], v122, s[28:31], s83 offen offset:256 sc1
 v_exp_f32 v181, v181
 v_exp_f32 v182, v182
 v_exp_f32 v183, v183
 v_exp_f32 v184, v184
 v_exp_f32 v185, v185
 v_smfmac_f32_32x32x32_bf16 v[48:63], v[128:131], v[176:183], v112
 buffer_load_dwordx4 v[220:223], v122, s[28:31], s83 offen offset:2304 sc1
 v_exp_f32 v186, v186
 v_exp_f32 v187, v187
 v_exp_f32 v188, v188
 v_exp_f32 v189, v189
 v_mfma_f32_16x16x32_bf16 v[232:235], v[96:99], v[64:67], v[232:235]
 v_mfma_f32_16x16x32_bf16 v[232:235], v[100:103], v[68:71], v[232:235]
 v_exp_f32 v190, v190
 v_exp_f32 v191, v191
 v_exp_f32 v160, v160
 v_exp_f32 v161, v161
 v_smfmac_f32_32x32x32_bf16 v[48:63], v[132:135], v[184:191], v112
 ds_read_b128 v[104:107], v113 offset:24576
 v_exp_f32 v162, v162
 v_exp_f32 v163, v163
 v_exp_f32 v164, v164
 v_mfma_f32_32x32x16_bf16 v[176:191], v[108:111], v[148:151], 0
 ds_read_b64_tr_b16 v[88:89], v2 offset:32768
 ds_read_b64_tr_b16 v[90:91], v2 offset:34816
 v_exp_f32 v165, v165
 v_exp_f32 v166, v166
 v_exp_f32 v167, v167
 v_exp_f32 v168, v168
 v_exp_f32 v169, v169
 v_smfmac_f32_32x32x32_bf16 v[32:47], v[136:139], v[160:167], v112
 ds_read_b64_tr_b16 v[92:93], v2 offset:36864
 ds_read_b64_tr_b16 v[94:95], v2 offset:38912
 s_mov_b64 exec, s[96:97]
 ds_read_b128 v[128:131], v114 offset:25600
 ds_read_b128 v[132:135], v114 offset:26112
 s_mov_b64 exec, -1
 v_exp_f32 v170, v170
 v_exp_f32 v171, v171
 v_exp_f32 v172, v172
 v_exp_f32 v173, v173
 v_mfma_f32_16x16x32_bf16 v[236:239], v[96:99], v[72:75], v[236:239]
 v_mfma_f32_16x16x32_bf16 v[236:239], v[100:103], v[76:79], v[236:239]
 s_add_u32 s83, s81, 5
 s_cmp_ge_u32 s83, 7
 s_cselect_b32 s63, 7, 0
 s_sub_u32 s83, s83, s63
 s_lshl_b32 s83, s83, 12
 s_add_u32 s83, s83, s69
 buffer_load_dwordx4 v[16:19], v122, s[28:31], s83 offen offset:0 sc1
 v_exp_f32 v174, v174
 v_exp_f32 v175, v175
 v_exp_f32 v176, v176
 v_exp_f32 v177, v177
 v_smfmac_f32_32x32x32_bf16 v[32:47], v[140:143], v[168:175], v112
 s_waitcnt lgkmcnt(0)
 s_setprio 1
 v_exp_f32 v178, v178
 v_exp_f32 v179, v179
 v_exp_f32 v180, v180
 v_mfma_f32_32x32x16_bf16 v[160:175], v[104:107], v[144:147], 0
 buffer_load_dwordx4 v[20:23], v122, s[28:31], s83 offen offset:2048 sc1
 v_exp_f32 v181, v181
 v_exp_f32 v182, v182
 v_exp_f32 v183, v183
 v_exp_f32 v184, v184
 v_exp_f32 v185, v185
 v_smfmac_f32_32x32x32_bf16 v[48:63], v[136:139], v[176:183], v112
 buffer_load_dwordx4 v[24:27], v122, s[28:31], s83 offen offset:256 sc1
 v_exp_f32 v186, v186
 v_exp_f32 v187, v187
 v_exp_f32 v188, v188
 v_exp_f32 v189, v189
 v_mfma_f32_16x16x32_bf16 v[240:243], v[88:91], v[64:67], v[240:243]
 v_mfma_f32_16x16x32_bf16 v[240:243], v[92:95], v[68:71], v[240:243]
 v_exp_f32 v190, v190
 v_exp_f32 v191, v191
 v_exp_f32 v160, v160
 v_exp_f32 v161, v161
 v_smfmac_f32_32x32x32_bf16 v[48:63], v[140:143], v[184:191], v112
 ds_read_b128 v[108:111], v113 offset:28672
 v_exp_f32 v162, v162
 v_exp_f32 v163, v163
 v_exp_f32 v164, v164
 v_mfma_f32_32x32x16_bf16 v[176:191], v[104:107], v[148:151], 0
 ds_read_b64_tr_b16 v[96:97], v3 offset:32768
 ds_read_b64_tr_b16 v[98:99], v3 offset:34816
 v_exp_f32 v165, v165
 v_exp_f32 v166, v166
 v_exp_f32 v167, v167
 v_exp_f32 v168, v168
 v_exp_f32 v169, v169
 v_smfmac_f32_32x32x32_bf16 v[32:47], v[128:131], v[160:167], v112
 ds_read_b64_tr_b16 v[100:101], v3 offset:36864
 ds_read_b64_tr_b16 v[102:103], v3 offset:38912
 s_mov_b64 exec, s[96:97]
 ds_read_b128 v[136:139], v114 offset:29696
 ds_read_b128 v[140:143], v114 offset:30208
 s_mov_b64 exec, -1
 v_exp_f32 v170, v170
 v_exp_f32 v171, v171
 v_exp_f32 v172, v172
 v_exp_f32 v173, v173
 v_mfma_f32_16x16x32_bf16 v[244:247], v[88:91], v[72:75], v[244:247]
 v_mfma_f32_16x16x32_bf16 v[244:247], v[92:95], v[76:79], v[244:247]
 buffer_load_dwordx4 v[28:31], v122, s[28:31], s83 offen offset:2304 sc1
 v_exp_f32 v174, v174
 v_exp_f32 v175, v175
 v_exp_f32 v176, v176
 v_exp_f32 v177, v177
 v_smfmac_f32_32x32x32_bf16 v[32:47], v[132:135], v[168:175], v112
 s_waitcnt lgkmcnt(0)
 v_exp_f32 v178, v178
 v_exp_f32 v179, v179
 v_exp_f32 v180, v180
 v_mfma_f32_32x32x16_bf16 v[160:175], v[108:111], v[144:147], 0
 v_exp_f32 v181, v181
 v_exp_f32 v182, v182
 v_exp_f32 v183, v183
 v_exp_f32 v184, v184
 v_exp_f32 v185, v185
 v_smfmac_f32_32x32x32_bf16 v[48:63], v[128:131], v[176:183], v112
 s_setprio 0
 v_exp_f32 v186, v186
 v_exp_f32 v187, v187
 v_exp_f32 v188, v188
 v_exp_f32 v189, v189
 v_mfma_f32_16x16x32_bf16 v[248:251], v[96:99], v[64:67], v[248:251]
 v_mfma_f32_16x16x32_bf16 v[248:251], v[100:103], v[68:71], v[248:251]
 v_exp_f32 v190, v190
 v_exp_f32 v191, v191
 s_waitcnt vmcnt(10)
 s_barrier
 v_exp_f32 v160, v160
 v_exp_f32 v161, v161
 v_smfmac_f32_32x32x32_bf16 v[48:63], v[132:135], v[184:191], v112
 ds_read_b128 v[104:107], v113 offset:32768
 s_setprio 3
 v_exp_f32 v162, v162
 v_exp_f32 v163, v163
 v_exp_f32 v164, v164
 v_mfma_f32_32x32x16_bf16 v[176:191], v[108:111], v[148:151], 0
 ds_read_b64_tr_b16 v[88:89], v5 offset:32768
 ds_read_b64_tr_b16 v[90:91], v5 offset:34816
 v_exp_f32 v165, v165
 v_exp_f32 v166, v166
 v_exp_f32 v167, v167
 v_exp_f32 v168, v168
 v_exp_f32 v169, v169
 v_smfmac_f32_32x32x32_bf16 v[32:47], v[136:139], v[160:167], v112
 ds_read_b64_tr_b16 v[92:93], v5 offset:36864
 ds_read_b64_tr_b16 v[94:95], v5 offset:38912
 s_mov_b64 exec, s[96:97]
 ds_read_b128 v[128:131], v114 offset:33792
 ds_read_b128 v[132:135], v114 offset:34304
 s_mov_b64 exec, -1
 v_exp_f32 v170, v170
 v_exp_f32 v171, v171
 v_exp_f32 v172, v172
 v_exp_f32 v173, v173
 v_mfma_f32_16x16x32_bf16 v[252:255], v[96:99], v[72:75], v[252:255]
 v_mfma_f32_16x16x32_bf16 v[252:255], v[100:103], v[76:79], v[252:255]
 v_exp_f32 v174, v174
 v_exp_f32 v175, v175
 v_exp_f32 v176, v176
 v_exp_f32 v177, v177
 v_smfmac_f32_32x32x32_bf16 v[32:47], v[140:143], v[168:175], v112
 s_waitcnt lgkmcnt(0)
 v_exp_f32 v178, v178
 v_exp_f32 v179, v179
 v_exp_f32 v180, v180
 v_mfma_f32_32x32x16_bf16 v[160:175], v[104:107], v[144:147], 0
 s_add_u32 s82, s81, 3
 s_cmp_ge_u32 s82, 7
 s_cselect_b32 s63, 7, 0
 s_sub_u32 s82, s82, s63
 s_add_u32 m0, s53, 0
 s_lshl_b32 s82, s82, 16
 buffer_load_dwordx4 v116, s[32:35], s82 offen lds
 v_exp_f32 v181, v181
 v_exp_f32 v182, v182
 v_exp_f32 v183, v183
 v_exp_f32 v184, v184
 v_exp_f32 v185, v185
 v_smfmac_f32_32x32x32_bf16 v[48:63], v[136:139], v[176:183], v112
 s_add_u32 m0, s53, 8192
 s_add_u32 s82, s82, 458752
 buffer_load_dwordx4 v116, s[32:35], s82 offen lds
 v_exp_f32 v186, v186
 v_exp_f32 v187, v187
 v_exp_f32 v188, v188
 v_exp_f32 v189, v189
 v_mfma_f32_16x16x32_bf16 v[224:227], v[88:91], v[80:83], v[224:227]
 v_mfma_f32_16x16x32_bf16 v[224:227], v[92:95], v[84:87], v[224:227]
 v_exp_f32 v190, v190
 v_exp_f32 v191, v191
 v_exp_f32 v160, v160
 v_exp_f32 v161, v161
 v_smfmac_f32_32x32x32_bf16 v[48:63], v[140:143], v[184:191], v112
 ds_read_b128 v[108:111], v113 offset:36864
 v_exp_f32 v162, v162
 v_exp_f32 v163, v163
 v_exp_f32 v164, v164
 v_mfma_f32_32x32x16_bf16 v[176:191], v[104:107], v[148:151], 0
 ds_read_b64_tr_b16 v[96:97], v6 offset:32768
 ds_read_b64_tr_b16 v[98:99], v6 offset:34816
 v_exp_f32 v165, v165
 v_exp_f32 v166, v166
 v_exp_f32 v167, v167
 v_exp_f32 v168, v168
 v_exp_f32 v169, v169
 v_smfmac_f32_32x32x32_bf16 v[32:47], v[128:131], v[160:167], v112
 ds_read_b64_tr_b16 v[100:101], v6 offset:36864
 ds_read_b64_tr_b16 v[102:103], v6 offset:38912
 s_mov_b64 exec, s[96:97]
 ds_read_b128 v[136:139], v114 offset:37888
 ds_read_b128 v[140:143], v114 offset:38400
 s_mov_b64 exec, -1
 v_exp_f32 v170, v170
 v_exp_f32 v171, v171
 v_exp_f32 v172, v172
 v_exp_f32 v173, v173
 v_mfma_f32_16x16x32_bf16 v[228:231], v[88:91], v[152:155], v[228:231]
 v_mfma_f32_16x16x32_bf16 v[228:231], v[92:95], v[156:159], v[228:231]
 s_add_u32 s83, s81, 6
 s_cmp_ge_u32 s83, 7
 s_cselect_b32 s63, 7, 0
 s_sub_u32 s83, s83, s63
 s_lshl_b32 s83, s83, 12
 s_add_u32 s83, s83, s69
 buffer_load_dwordx4 v[64:67], v122, s[28:31], s83 offen offset:0 sc1
 v_exp_f32 v174, v174
 v_exp_f32 v175, v175
 v_exp_f32 v176, v176
 v_exp_f32 v177, v177
 v_smfmac_f32_32x32x32_bf16 v[32:47], v[132:135], v[168:175], v112
 s_waitcnt lgkmcnt(0)
 v_exp_f32 v178, v178
 v_exp_f32 v179, v179
 v_exp_f32 v180, v180
 v_mfma_f32_32x32x16_bf16 v[160:175], v[108:111], v[144:147], 0
 s_add_u32 m0, s53, 16384
 s_add_u32 s82, s82, 458752
 buffer_load_dwordx4 v116, s[32:35], s82 offen lds
 v_exp_f32 v181, v181
 v_exp_f32 v182, v182
 v_exp_f32 v183, v183
 v_exp_f32 v184, v184
 v_exp_f32 v185, v185
 v_smfmac_f32_32x32x32_bf16 v[48:63], v[128:131], v[176:183], v112
 s_add_u32 m0, s53, 24576
 s_add_u32 s82, s82, 458752
 buffer_load_dwordx4 v116, s[32:35], s82 offen lds
 v_exp_f32 v186, v186
 v_exp_f32 v187, v187
 v_exp_f32 v188, v188
 v_exp_f32 v189, v189
 v_mfma_f32_16x16x32_bf16 v[232:235], v[96:99], v[80:83], v[232:235]
 v_mfma_f32_16x16x32_bf16 v[232:235], v[100:103], v[84:87], v[232:235]
 v_exp_f32 v190, v190
 v_exp_f32 v191, v191
 v_exp_f32 v160, v160
 v_exp_f32 v161, v161
 v_smfmac_f32_32x32x32_bf16 v[48:63], v[132:135], v[184:191], v112
 ds_read_b128 v[104:107], v113 offset:40960
 s_setprio 2
 v_exp_f32 v162, v162
 v_exp_f32 v163, v163
 v_exp_f32 v164, v164
 v_mfma_f32_32x32x16_bf16 v[176:191], v[108:111], v[148:151], 0
 ds_read_b64_tr_b16 v[88:89], v14 offset:32768
 ds_read_b64_tr_b16 v[90:91], v14 offset:34816
 v_exp_f32 v165, v165
 v_exp_f32 v166, v166
 v_exp_f32 v167, v167
 v_exp_f32 v168, v168
 v_exp_f32 v169, v169
 v_smfmac_f32_32x32x32_bf16 v[32:47], v[136:139], v[160:167], v112
 ds_read_b64_tr_b16 v[92:93], v14 offset:36864
 ds_read_b64_tr_b16 v[94:95], v14 offset:38912
 s_mov_b64 exec, s[96:97]
 ds_read_b128 v[128:131], v114 offset:41984
 ds_read_b128 v[132:135], v114 offset:42496
 s_mov_b64 exec, -1
 v_exp_f32 v170, v170
 v_exp_f32 v171, v171
 v_exp_f32 v172, v172
 v_exp_f32 v173, v173
 v_mfma_f32_16x16x32_bf16 v[236:239], v[96:99], v[152:155], v[236:239]
 v_mfma_f32_16x16x32_bf16 v[236:239], v[100:103], v[156:159], v[236:239]
 buffer_load_dwordx4 v[68:71], v122, s[28:31], s83 offen offset:2048 sc1
 v_exp_f32 v174, v174
 v_exp_f32 v175, v175
 v_exp_f32 v176, v176
 v_exp_f32 v177, v177
 v_smfmac_f32_32x32x32_bf16 v[32:47], v[140:143], v[168:175], v112
 s_waitcnt lgkmcnt(0)
 v_exp_f32 v178, v178
 v_exp_f32 v179, v179
 v_exp_f32 v180, v180
 v_mfma_f32_32x32x16_bf16 v[160:175], v[104:107], v[144:147], 0
 s_add_u32 s82, s81, 4
 s_cmp_ge_u32 s82, 7
 s_cselect_b32 s63, 7, 0
 s_sub_u32 s82, s82, s63
 s_add_u32 m0, s53, 32768
 s_lshl_b32 s82, s82, 16
 buffer_load_dwordx4 v116, s[32:35], s82 offen lds
 v_exp_f32 v181, v181
 v_exp_f32 v182, v182
 v_exp_f32 v183, v183
 v_exp_f32 v184, v184
 v_exp_f32 v185, v185
 v_smfmac_f32_32x32x32_bf16 v[48:63], v[136:139], v[176:183], v112
 s_add_u32 m0, s53, 40960
 s_add_u32 s82, s82, 458752
 buffer_load_dwordx4 v116, s[32:35], s82 offen lds
 v_exp_f32 v186, v186
 v_exp_f32 v187, v187
 v_exp_f32 v188, v188
 v_exp_f32 v189, v189
 v_mfma_f32_16x16x32_bf16 v[240:243], v[88:91], v[80:83], v[240:243]
 v_mfma_f32_16x16x32_bf16 v[240:243], v[92:95], v[84:87], v[240:243]
 v_exp_f32 v190, v190
 v_exp_f32 v191, v191
 v_exp_f32 v160, v160
 v_exp_f32 v161, v161
 v_smfmac_f32_32x32x32_bf16 v[48:63], v[140:143], v[184:191], v112
 ds_read_b128 v[108:111], v113 offset:45056
 v_exp_f32 v162, v162
 v_exp_f32 v163, v163
 v_exp_f32 v164, v164
 v_mfma_f32_32x32x16_bf16 v[176:191], v[104:107], v[148:151], 0
 ds_read_b64_tr_b16 v[96:97], v15 offset:32768
 ds_read_b64_tr_b16 v[98:99], v15 offset:34816
 v_exp_f32 v165, v165
 v_exp_f32 v166, v166
 v_exp_f32 v167, v167
 v_exp_f32 v168, v168
 v_exp_f32 v169, v169
 v_smfmac_f32_32x32x32_bf16 v[32:47], v[128:131], v[160:167], v112
 ds_read_b64_tr_b16 v[100:101], v15 offset:36864
 ds_read_b64_tr_b16 v[102:103], v15 offset:38912
 s_mov_b64 exec, s[96:97]
 ds_read_b128 v[136:139], v114 offset:46080
 ds_read_b128 v[140:143], v114 offset:46592
 s_mov_b64 exec, -1
 v_exp_f32 v170, v170
 v_exp_f32 v171, v171
 v_exp_f32 v172, v172
 v_exp_f32 v173, v173
 v_mfma_f32_16x16x32_bf16 v[244:247], v[88:91], v[152:155], v[244:247]
 v_mfma_f32_16x16x32_bf16 v[244:247], v[92:95], v[156:159], v[244:247]
 buffer_load_dwordx4 v[72:75], v122, s[28:31], s83 offen offset:256 sc1
 v_exp_f32 v174, v174
 v_exp_f32 v175, v175
 v_exp_f32 v176, v176
 v_exp_f32 v177, v177
 v_smfmac_f32_32x32x32_bf16 v[32:47], v[132:135], v[168:175], v112
 s_waitcnt lgkmcnt(0)
 s_setprio 1
 v_exp_f32 v178, v178
 v_exp_f32 v179, v179
 v_exp_f32 v180, v180
 v_mfma_f32_32x32x16_bf16 v[160:175], v[108:111], v[144:147], 0
 s_add_u32 m0, s53, 49152
 s_add_u32 s82, s82, 458752
 buffer_load_dwordx4 v116, s[32:35], s82 offen lds
 v_exp_f32 v181, v181
 v_exp_f32 v182, v182
 v_exp_f32 v183, v183
 v_exp_f32 v184, v184
 v_exp_f32 v185, v185
 v_smfmac_f32_32x32x32_bf16 v[48:63], v[128:131], v[176:183], v112
 s_add_u32 m0, s53, 57344
 s_add_u32 s82, s82, 458752
 buffer_load_dwordx4 v116, s[32:35], s82 offen lds
 v_exp_f32 v186, v186
 v_exp_f32 v187, v187
 v_exp_f32 v188, v188
 v_exp_f32 v189, v189
 v_mfma_f32_16x16x32_bf16 v[248:251], v[96:99], v[80:83], v[248:251]
 v_mfma_f32_16x16x32_bf16 v[248:251], v[100:103], v[84:87], v[248:251]
 v_exp_f32 v190, v190
 v_exp_f32 v191, v191
 v_exp_f32 v160, v160
 v_exp_f32 v161, v161
 v_smfmac_f32_32x32x32_bf16 v[48:63], v[132:135], v[184:191], v112
 ds_read_b128 v[104:107], v113 offset:49152
 v_exp_f32 v162, v162
 v_exp_f32 v163, v163
 v_exp_f32 v164, v164
 v_mfma_f32_32x32x16_bf16 v[176:191], v[108:111], v[148:151], 0
 v_exp_f32 v165, v165
 v_exp_f32 v166, v166
 v_exp_f32 v167, v167
 v_exp_f32 v168, v168
 v_exp_f32 v169, v169
 v_smfmac_f32_32x32x32_bf16 v[32:47], v[136:139], v[160:167], v112
 s_mov_b64 exec, s[96:97]
 ds_read_b128 v[128:131], v114 offset:50176
 ds_read_b128 v[132:135], v114 offset:50688
 s_mov_b64 exec, -1
 v_exp_f32 v170, v170
 v_exp_f32 v171, v171
 v_exp_f32 v172, v172
 v_exp_f32 v173, v173
 v_mfma_f32_16x16x32_bf16 v[252:255], v[96:99], v[152:155], v[252:255]
 v_mfma_f32_16x16x32_bf16 v[252:255], v[100:103], v[156:159], v[252:255]
 buffer_load_dwordx4 v[76:79], v122, s[28:31], s83 offen offset:2304 sc1
 v_exp_f32 v174, v174
 v_exp_f32 v175, v175
 v_exp_f32 v176, v176
 v_exp_f32 v177, v177
 v_smfmac_f32_32x32x32_bf16 v[32:47], v[140:143], v[168:175], v112
 s_waitcnt lgkmcnt(0)
 v_exp_f32 v178, v178
 v_exp_f32 v179, v179
 v_exp_f32 v180, v180
 v_mfma_f32_32x32x16_bf16 v[160:175], v[104:107], v[144:147], 0
 s_add_u32 s82, s81, 6
 s_cmp_ge_u32 s82, 7
 s_cselect_b32 s63, 7, 0
 s_sub_u32 s82, s82, s63
 s_add_u32 m0, s53, 65536
 s_lshl_b32 s82, s82, 16
 buffer_load_dwordx4 v116, s[32:35], s82 offen lds
 v_exp_f32 v181, v181
 v_exp_f32 v182, v182
 v_exp_f32 v183, v183
 v_exp_f32 v184, v184
 v_exp_f32 v185, v185
 v_smfmac_f32_32x32x32_bf16 v[48:63], v[136:139], v[176:183], v112
 s_setprio 0
 s_add_u32 m0, s53, 73728
 s_add_u32 s82, s82, 458752
 buffer_load_dwordx4 v116, s[32:35], s82 offen lds
 v_exp_f32 v186, v186
 v_exp_f32 v187, v187
 v_exp_f32 v188, v188
 v_exp_f32 v189, v189
 v_exp_f32 v190, v190
 v_exp_f32 v191, v191
 s_barrier
 v_exp_f32 v160, v160
 v_exp_f32 v161, v161
 v_smfmac_f32_32x32x32_bf16 v[48:63], v[140:143], v[184:191], v112
 ds_read_b128 v[108:111], v113 offset:53248
 s_setprio 3
 v_exp_f32 v162, v162
 v_exp_f32 v163, v163
 v_exp_f32 v164, v164
 v_mfma_f32_32x32x16_bf16 v[176:191], v[104:107], v[148:151], 0
 v_exp_f32 v165, v165
 v_exp_f32 v166, v166
 v_exp_f32 v167, v167
 v_exp_f32 v168, v168
 v_exp_f32 v169, v169
 v_smfmac_f32_32x32x32_bf16 v[32:47], v[128:131], v[160:167], v112
 s_mov_b64 exec, s[96:97]
 ds_read_b128 v[136:139], v114 offset:54272
 ds_read_b128 v[140:143], v114 offset:54784
 s_mov_b64 exec, -1
 v_exp_f32 v170, v170
 v_exp_f32 v171, v171
 v_exp_f32 v172, v172
 v_exp_f32 v173, v173
 v_exp_f32 v174, v174
 v_exp_f32 v175, v175
 v_exp_f32 v176, v176
 v_exp_f32 v177, v177
 v_smfmac_f32_32x32x32_bf16 v[32:47], v[132:135], v[168:175], v112
 s_waitcnt lgkmcnt(0)
 v_exp_f32 v178, v178
 v_exp_f32 v179, v179
 v_exp_f32 v180, v180
 v_mfma_f32_32x32x16_bf16 v[160:175], v[108:111], v[144:147], 0
 s_add_u32 m0, s53, 81920
 s_add_u32 s82, s82, 458752
 buffer_load_dwordx4 v116, s[32:35], s82 offen lds
 v_exp_f32 v181, v181
 v_exp_f32 v182, v182
 v_exp_f32 v183, v183
 v_exp_f32 v184, v184
 v_exp_f32 v185, v185
 v_smfmac_f32_32x32x32_bf16 v[48:63], v[128:131], v[176:183], v112
 s_add_u32 m0, s53, 90112
 s_add_u32 s82, s82, 458752
 buffer_load_dwordx4 v116, s[32:35], s82 offen lds
 v_exp_f32 v186, v186
 v_exp_f32 v187, v187
 v_exp_f32 v188, v188
 v_exp_f32 v189, v189
 v_exp_f32 v190, v190
 v_exp_f32 v191, v191
 v_exp_f32 v160, v160
 v_exp_f32 v161, v161
 v_smfmac_f32_32x32x32_bf16 v[48:63], v[132:135], v[184:191], v112
 ds_read_b128 v[104:107], v113 offset:57344
 s_setprio 2
 v_exp_f32 v162, v162
 v_exp_f32 v163, v163
 v_exp_f32 v164, v164
 v_mfma_f32_32x32x16_bf16 v[176:191], v[108:111], v[148:151], 0
 v_exp_f32 v165, v165
 v_exp_f32 v166, v166
 v_exp_f32 v167, v167
 v_exp_f32 v168, v168
 v_exp_f32 v169, v169
 v_smfmac_f32_32x32x32_bf16 v[32:47], v[136:139], v[160:167], v112
 s_mov_b64 exec, s[96:97]
 ds_read_b128 v[128:131], v114 offset:58368
 ds_read_b128 v[132:135], v114 offset:58880
 s_mov_b64 exec, -1
 v_exp_f32 v170, v170
 v_exp_f32 v171, v171
 v_exp_f32 v172, v172
 v_exp_f32 v173, v173
 v_exp_f32 v174, v174
 v_exp_f32 v175, v175
 v_exp_f32 v176, v176
 v_exp_f32 v177, v177
 v_smfmac_f32_32x32x32_bf16 v[32:47], v[140:143], v[168:175], v112
 s_waitcnt lgkmcnt(0)
 v_exp_f32 v178, v178
 v_exp_f32 v179, v179
 v_exp_f32 v180, v180
 v_mfma_f32_32x32x16_bf16 v[160:175], v[104:107], v[144:147], 0
 ds_read_b128 v[108:111], v113 offset:61440
 s_add_u32 s82, s81, 5
 s_cmp_ge_u32 s82, 7
 s_cselect_b32 s63, 7, 0
 s_sub_u32 s82, s82, s63
 s_add_u32 m0, s53, 131072
 s_lshl_b32 s82, s82, 16
 buffer_load_dwordx4 v116, s[32:35], s82 offen lds
 v_exp_f32 v181, v181
 v_exp_f32 v182, v182
 v_exp_f32 v183, v183
 v_exp_f32 v184, v184
 v_exp_f32 v185, v185
 v_smfmac_f32_32x32x32_bf16 v[48:63], v[136:139], v[176:183], v112
 s_add_u32 m0, s53, 139264
 s_add_u32 s82, s82, 458752
 buffer_load_dwordx4 v116, s[32:35], s82 offen lds
 v_exp_f32 v186, v186
 v_exp_f32 v187, v187
 v_exp_f32 v188, v188
 v_exp_f32 v189, v189
 v_exp_f32 v190, v190
 v_exp_f32 v191, v191
 v_exp_f32 v160, v160
 v_exp_f32 v161, v161
 v_smfmac_f32_32x32x32_bf16 v[48:63], v[140:143], v[184:191], v112
 s_waitcnt lgkmcnt(0)
 s_setprio 1
 v_exp_f32 v162, v162
 v_exp_f32 v163, v163
 v_exp_f32 v164, v164
 v_mfma_f32_32x32x16_bf16 v[176:191], v[108:111], v[144:147], 0
 v_exp_f32 v165, v165
 v_exp_f32 v166, v166
 v_exp_f32 v167, v167
 v_exp_f32 v168, v168
 v_exp_f32 v169, v169
 v_smfmac_f32_32x32x32_bf16 v[32:47], v[128:131], v[160:167], v112
 s_mov_b64 exec, s[96:97]
 ds_read_b128 v[136:139], v114 offset:62464
 ds_read_b128 v[140:143], v114 offset:62976
 s_mov_b64 exec, -1
 v_exp_f32 v170, v170
 v_exp_f32 v171, v171
 v_exp_f32 v172, v172
 v_exp_f32 v173, v173
 v_exp_f32 v174, v174
 v_exp_f32 v175, v175
 v_exp_f32 v176, v176
 v_exp_f32 v177, v177
 v_smfmac_f32_32x32x32_bf16 v[32:47], v[132:135], v[168:175], v112
 s_waitcnt lgkmcnt(0)
 v_exp_f32 v178, v178
 v_exp_f32 v179, v179
 v_exp_f32 v180, v180
 v_mfma_f32_32x32x16_bf16 v[160:175], v[104:107], v[148:151], 0
 s_add_u32 m0, s53, 147456
 s_add_u32 s82, s82, 458752
 buffer_load_dwordx4 v116, s[32:35], s82 offen lds
 v_exp_f32 v181, v181
 v_exp_f32 v182, v182
 v_exp_f32 v183, v183
 v_exp_f32 v184, v184
 v_exp_f32 v185, v185
 v_smfmac_f32_32x32x32_bf16 v[32:47], v[136:139], v[176:183], v112
 s_setprio 0
 s_add_u32 m0, s53, 155648
 s_add_u32 s82, s82, 458752
 buffer_load_dwordx4 v116, s[32:35], s82 offen lds
 v_exp_f32 v186, v186
 v_exp_f32 v187, v187
 v_exp_f32 v188, v188
 v_exp_f32 v189, v189
 v_exp_f32 v190, v190
 v_exp_f32 v191, v191
 v_exp_f32 v160, v160
 v_exp_f32 v161, v161
 v_smfmac_f32_32x32x32_bf16 v[32:47], v[140:143], v[184:191], v112
 v_exp_f32 v162, v162
 v_exp_f32 v163, v163
 v_exp_f32 v164, v164
 v_mfma_f32_32x32x16_bf16 v[176:191], v[108:111], v[148:151], 0
 v_exp_f32 v165, v165
 v_exp_f32 v166, v166
 v_exp_f32 v167, v167
 v_exp_f32 v168, v168
 v_exp_f32 v169, v169
 v_smfmac_f32_32x32x32_bf16 v[48:63], v[128:131], v[160:167], v112
 v_exp_f32 v170, v170
 v_exp_f32 v171, v171
 v_exp_f32 v172, v172
 ds_write_b128 v7, v[32:35] offset:0
 ds_write_b128 v7, v[36:39] offset:1024
 ds_write_b32 v119, v40 offset:2048
 v_exp_f32 v173, v173
 v_exp_f32 v174, v174
 v_exp_f32 v175, v175
 v_exp_f32 v176, v176
 v_exp_f32 v177, v177
 v_smfmac_f32_32x32x32_bf16 v[48:63], v[132:135], v[168:175], v112
 s_waitcnt vmcnt(9) lgkmcnt(0)
 s_barrier
 ds_read_b128 v[160:163], v8
 ds_read_b128 v[164:167], v8 offset:1024
 ds_read_b32 v168, v4 offset:2048
 v_exp_f32 v178, v178
 v_exp_f32 v179, v179
 v_exp_f32 v180, v180
 v_exp_f32 v181, v181
 v_exp_f32 v182, v182
 v_exp_f32 v183, v183
 v_exp_f32 v184, v184
 v_exp_f32 v185, v185
 v_smfmac_f32_32x32x32_bf16 v[48:63], v[136:139], v[176:183], v112
 v_exp_f32 v186, v186
 v_exp_f32 v187, v187
 v_exp_f32 v188, v188
 v_exp_f32 v189, v189
 v_exp_f32 v190, v190
 v_exp_f32 v191, v191
 s_lshl_b32 s62, s76, 5
 s_add_u32 s62, s62, s64
 v_smfmac_f32_32x32x32_bf16 v[48:63], v[140:143], v[184:191], v112
 s_lshl_b32 s68, s62, 10
 s_add_u32 s68, s68, 7340032
 ds_read_b64_tr_b16 v[88:89], v124 offset:0
 ds_read_b64_tr_b16 v[90:91], v124 offset:2048
 ds_read_b64_tr_b16 v[92:93], v124 offset:4096
 ds_read_b64_tr_b16 v[94:95], v124 offset:6144
 ds_read_b64_tr_b16 v[96:97], v1 offset:0
 ds_read_b64_tr_b16 v[98:99], v1 offset:2048
 ds_read_b64_tr_b16 v[100:101], v1 offset:4096
 ds_read_b64_tr_b16 v[102:103], v1 offset:6144
 s_waitcnt lgkmcnt(8)
 s_nop 0
 v_add_f32 v48, v48, v160
 v_add_f32 v49, v49, v161
 v_add_f32 v50, v50, v162
 v_add_f32 v51, v51, v163
 v_add_f32 v52, v52, v164
 v_add_f32 v53, v53, v165
 v_add_f32 v54, v54, v166
 v_add_f32 v55, v55, v167
 v_add_f32 v56, v56, v168
 v_fma_f32 v108, 0, v48, v56
 v_fmac_f32 v108, 0, v49
 v_fmac_f32 v108, 0, v50
 v_fmac_f32 v108, 0, v51
 v_fmac_f32 v108, 0, v52
 v_fmac_f32 v108, 0, v53
 v_fmac_f32 v108, 0, v54
 v_fmac_f32 v108, 0, v55
 v_cmp_lt_f32 vcc, 0x2b800000, v108
 s_nop 0
 s_mov_b64 s[98:99], vcc
 v_cmp_gt_f32 vcc, 0x5d800000, v108
 s_nop 0
 s_and_b64 vcc, vcc, s[98:99]
 s_cmp_eq_u64 vcc, -1
 s_cbranch_scc0 L_slow2
L_slowret2:
 v_rcp_f32 v108, v56
 s_nop 0
 v_mul_f32 v108, v108, v118
 v_mul_f32 v48, v48, v108
 v_mul_f32 v49, v49, v108
 v_mul_f32 v50, v50, v108
 v_mul_f32 v51, v51, v108
 v_mul_f32 v52, v52, v108
 v_mul_f32 v53, v53, v108
 v_mul_f32 v54, v54, v108
 v_mul_f32 v55, v55, v108
 v_cvt_pk_bf16_f32 v108, v48, v49
 v_cvt_pk_bf16_f32 v109, v50, v51
 v_cvt_pk_bf16_f32 v110, v52, v53
 v_cvt_pk_bf16_f32 v111, v54, v55
 v_min_u32 v108, -2, v108
 v_min_u32 v109, -2, v109
 v_min_u32 v110, -2, v110
 v_min_u32 v111, -2, v111
 buffer_store_dwordx4 v[108:111], v126, s[28:31], s68 offen sc1
 s_and_b32 s62, s52, 1
 s_bfe_u32 s63, s52, 0x10001
 s_sub_u32 s62, s62, s63
 s_lshl_b32 s62, s62, 13
 v_add_u32 v116, s62, v116
 s_waitcnt lgkmcnt(4)
 v_mfma_f32_16x16x32_bf16 v[224:227], v[88:91], v[192:195], v[224:227]
 s_setprio 1
 ds_read_b64_tr_b16 v[32:33], v2 offset:0
 ds_read_b64_tr_b16 v[34:35], v2 offset:2048
 v_mfma_f32_16x16x32_bf16 v[224:227], v[92:95], v[196:199], v[224:227]
 ds_read_b64_tr_b16 v[36:37], v2 offset:4096
 ds_read_b64_tr_b16 v[38:39], v2 offset:6144
 v_mfma_f32_16x16x32_bf16 v[228:231], v[88:91], v[200:203], v[228:231]
 ds_read_b64_tr_b16 v[40:41], v3 offset:0
 ds_read_b64_tr_b16 v[42:43], v3 offset:2048
 v_mfma_f32_16x16x32_bf16 v[228:231], v[92:95], v[204:207], v[228:231]
 s_setprio 0
 ds_read_b64_tr_b16 v[44:45], v3 offset:4096
 ds_read_b64_tr_b16 v[46:47], v3 offset:6144
 s_lshl_b32 s62, s71, 2
 s_add_u32 s62, s62, s72
 s_lshl_b32 s67, s62, 13
 s_lshr_b32 s68, s0, 4
 s_add_u32 s67, s67, s68
 s_add_u32 s67, s67, 7340032
 s_xor_b32 s70, s67, 4096
 v_and_b32 v13, 15, v0
 v_lshrrev_b32 v11, 4, v0
 v_xor_b32 v11, v11, v13
 s_waitcnt lgkmcnt(8)
 v_mfma_f32_16x16x32_bf16 v[232:235], v[96:99], v[192:195], v[232:235]
 s_setprio 1
 v_mfma_f32_16x16x32_bf16 v[232:235], v[100:103], v[196:199], v[232:235]
 v_mfma_f32_16x16x32_bf16 v[236:239], v[96:99], v[200:203], v[236:239]
 v_mfma_f32_16x16x32_bf16 v[236:239], v[100:103], v[204:207], v[236:239]
 s_setprio 0
 v_lshlrev_b32 v11, 4, v11
 v_lshl_add_u32 v11, v13, 8, v11
 s_lshl_b32 s68, s52, 13
 s_add_u32 s68, s68, 32768
 v_add_u32 v104, s68, v11
 v_xor_b32 v105, 64, v104
 v_xor_b32 v106, 128, v104
 s_waitcnt vmcnt(1) lgkmcnt(0)
 s_barrier
 v_mfma_f32_16x16x32_bf16 v[240:243], v[32:35], v[192:195], v[240:243]
 s_setprio 1
 ds_read_b64_tr_b16 v[144:145], v124 offset:32768
 v_mfma_f32_16x16x32_bf16 v[240:243], v[36:39], v[196:199], v[240:243]
 ds_read_b64_tr_b16 v[146:147], v124 offset:34816
 v_mfma_f32_16x16x32_bf16 v[244:247], v[32:35], v[200:203], v[244:247]
 ds_read_b64_tr_b16 v[148:149], v124 offset:36864
 v_mfma_f32_16x16x32_bf16 v[244:247], v[36:39], v[204:207], v[244:247]
 s_setprio 0
 ds_read_b64_tr_b16 v[150:151], v124 offset:38912
 s_add_u32 m0, s53, 98304
 s_xor_b32 s82, s0, 0
 buffer_load_dwordx4 v116, s[36:39], s82 offen lds
 s_add_u32 m0, s53, 106496
 s_xor_b32 s82, s0, 131072
 buffer_load_dwordx4 v116, s[36:39], s82 offen lds
 v_xor_b32 v107, 192, v104
 v_lshrrev_b32 v13, 3, v0
 s_lshl_b32 s68, s72, 3
 v_add_u32 v13, s68, v13
 v_and_b32 v11, 7, v0
 v_lshlrev_b32 v9, 1, v11
 v_and_b32 v8, 15, v13
 v_mfma_f32_16x16x32_bf16 v[248:251], v[40:43], v[192:195], v[248:251]
 s_setprio 1
 ds_read_b64_tr_b16 v[88:89], v1 offset:32768
 v_mfma_f32_16x16x32_bf16 v[248:251], v[44:47], v[196:199], v[248:251]
 ds_read_b64_tr_b16 v[90:91], v1 offset:34816
 v_mfma_f32_16x16x32_bf16 v[252:255], v[40:43], v[200:203], v[252:255]
 ds_read_b64_tr_b16 v[92:93], v1 offset:36864
 v_mfma_f32_16x16x32_bf16 v[252:255], v[44:47], v[204:207], v[252:255]
 s_setprio 0
 ds_read_b64_tr_b16 v[94:95], v1 offset:38912
 s_add_u32 m0, s53, 114688
 s_xor_b32 s82, s0, 262144
 buffer_load_dwordx4 v116, s[36:39], s82 offen lds
 s_add_u32 m0, s53, 122880
 s_xor_b32 s82, s0, 393216
 buffer_load_dwordx4 v116, s[36:39], s82 offen lds
 v_xor_b32 v9, v9, v8
 v_lshlrev_b32 v9, 4, v9
 v_lshl_add_u32 v9, v13, 8, v9
 s_and_b32 s68, s52, 1
 s_lshl_b32 s68, s68, 13
 s_add_u32 s68, s68, 32768
 v_add_u32 v10, s68, v9
 v_xor_b32 v9, 16, v10
 s_waitcnt lgkmcnt(4)
 v_mfma_f32_16x16x32_bf16 v[224:227], v[144:147], v[208:211], v[224:227]
 s_setprio 1
 ds_read_b64_tr_b16 v[96:97], v2 offset:32768
 v_mfma_f32_16x16x32_bf16 v[224:227], v[148:151], v[212:215], v[224:227]
 ds_read_b64_tr_b16 v[98:99], v2 offset:34816
 v_mfma_f32_16x16x32_bf16 v[228:231], v[144:147], v[216:219], v[228:231]
 ds_read_b64_tr_b16 v[100:101], v2 offset:36864
 v_mfma_f32_16x16x32_bf16 v[228:231], v[148:151], v[220:223], v[228:231]
 s_setprio 0
 ds_read_b64_tr_b16 v[102:103], v2 offset:38912
 s_add_u32 m0, s53, 0
 s_xor_b32 s82, s0, 65536
 buffer_load_dwordx4 v116, s[36:39], s82 offen lds
 s_add_u32 m0, s53, 8192
 s_xor_b32 s82, s0, 196608
 buffer_load_dwordx4 v116, s[36:39], s82 offen lds
 v_lshlrev_b32 v11, 4, v11
 v_lshl_add_u32 v12, v13, 10, v11
 s_lshl_b32 s62, s71, 15
 s_lshl_b32 s68, s73, 7
 s_add_u32 s77, s62, s68
 s_waitcnt lgkmcnt(4)
 v_mfma_f32_16x16x32_bf16 v[232:235], v[88:91], v[208:211], v[232:235]
 s_setprio 1
 ds_read_b64_tr_b16 v[144:145], v3 offset:32768
 v_mfma_f32_16x16x32_bf16 v[232:235], v[92:95], v[212:215], v[232:235]
 ds_read_b64_tr_b16 v[146:147], v3 offset:34816
 v_mfma_f32_16x16x32_bf16 v[236:239], v[88:91], v[216:219], v[236:239]
 ds_read_b64_tr_b16 v[148:149], v3 offset:36864
 v_mfma_f32_16x16x32_bf16 v[236:239], v[92:95], v[220:223], v[236:239]
 s_setprio 0
 ds_read_b64_tr_b16 v[150:151], v3 offset:38912
 s_add_u32 m0, s53, 16384
 s_xor_b32 s82, s0, 327680
 buffer_load_dwordx4 v116, s[36:39], s82 offen lds
 s_waitcnt lgkmcnt(4)
 v_mfma_f32_16x16x32_bf16 v[240:243], v[96:99], v[208:211], v[240:243]
 s_setprio 1
 ds_read_b64_tr_b16 v[88:89], v5 offset:32768
 v_mfma_f32_16x16x32_bf16 v[240:243], v[100:103], v[212:215], v[240:243]
 ds_read_b64_tr_b16 v[90:91], v5 offset:34816
 v_mfma_f32_16x16x32_bf16 v[244:247], v[96:99], v[216:219], v[244:247]
 ds_read_b64_tr_b16 v[92:93], v5 offset:36864
 v_mfma_f32_16x16x32_bf16 v[244:247], v[100:103], v[220:223], v[244:247]
 s_setprio 0
 ds_read_b64_tr_b16 v[94:95], v5 offset:38912
 v_add_u32 v5, 4294934528, v5
 s_add_u32 m0, s53, 24576
 s_xor_b32 s82, s0, 458752
 buffer_load_dwordx4 v116, s[36:39], s82 offen lds
 s_waitcnt lgkmcnt(4)
 v_mfma_f32_16x16x32_bf16 v[248:251], v[144:147], v[208:211], v[248:251]
 s_setprio 1
 ds_read_b64_tr_b16 v[96:97], v6 offset:32768
 v_mfma_f32_16x16x32_bf16 v[248:251], v[148:151], v[212:215], v[248:251]
 ds_read_b64_tr_b16 v[98:99], v6 offset:34816
 v_mfma_f32_16x16x32_bf16 v[252:255], v[144:147], v[216:219], v[252:255]
 ds_read_b64_tr_b16 v[100:101], v6 offset:36864
 v_mfma_f32_16x16x32_bf16 v[252:255], v[148:151], v[220:223], v[252:255]
 s_setprio 0
 ds_read_b64_tr_b16 v[102:103], v6 offset:38912
 v_add_u32 v6, 4294934528, v6
 buffer_load_dwordx4 v[160:163], v122, s[28:31], s67 offen offset:0 sc1
 s_waitcnt lgkmcnt(4)
 v_mfma_f32_16x16x32_bf16 v[224:227], v[88:91], v[16:19], v[224:227]
 s_setprio 1
 ds_read_b64_tr_b16 v[144:145], v14 offset:32768
 v_mfma_f32_16x16x32_bf16 v[224:227], v[92:95], v[20:23], v[224:227]
 ds_read_b64_tr_b16 v[146:147], v14 offset:34816
 v_mfma_f32_16x16x32_bf16 v[228:231], v[88:91], v[24:27], v[228:231]
 ds_read_b64_tr_b16 v[148:149], v14 offset:36864
 v_mfma_f32_16x16x32_bf16 v[228:231], v[92:95], v[28:31], v[228:231]
 s_setprio 0
 ds_read_b64_tr_b16 v[150:151], v14 offset:38912
 v_add_u32 v14, 4294934528, v14
 buffer_load_dwordx4 v[164:167], v122, s[28:31], s67 offen offset:2048 sc1
 s_waitcnt lgkmcnt(4)
 v_mfma_f32_16x16x32_bf16 v[232:235], v[96:99], v[16:19], v[232:235]
 s_setprio 1
 ds_read_b64_tr_b16 v[88:89], v15 offset:32768
 v_mfma_f32_16x16x32_bf16 v[232:235], v[100:103], v[20:23], v[232:235]
 ds_read_b64_tr_b16 v[90:91], v15 offset:34816
 v_mfma_f32_16x16x32_bf16 v[236:239], v[96:99], v[24:27], v[236:239]
 ds_read_b64_tr_b16 v[92:93], v15 offset:36864
 v_mfma_f32_16x16x32_bf16 v[236:239], v[100:103], v[28:31], v[236:239]
 s_setprio 0
 ds_read_b64_tr_b16 v[94:95], v15 offset:38912
 v_add_u32 v15, 4294934528, v15
 buffer_load_dwordx4 v[168:171], v122, s[28:31], s67 offen offset:256 sc1
 s_waitcnt lgkmcnt(4)
 v_mfma_f32_16x16x32_bf16 v[240:243], v[144:147], v[16:19], v[240:243]
 s_setprio 1
 ds_read_b64_tr_b16 v[96:97], v5 offset:0
 v_mfma_f32_16x16x32_bf16 v[240:243], v[148:151], v[20:23], v[240:243]
 ds_read_b64_tr_b16 v[98:99], v5 offset:2048
 v_mfma_f32_16x16x32_bf16 v[244:247], v[144:147], v[24:27], v[244:247]
 ds_read_b64_tr_b16 v[100:101], v5 offset:4096
 v_mfma_f32_16x16x32_bf16 v[244:247], v[148:151], v[28:31], v[244:247]
 s_setprio 0
 ds_read_b64_tr_b16 v[102:103], v5 offset:6144
 buffer_load_dwordx4 v[172:175], v122, s[28:31], s67 offen offset:2304 sc1
 s_waitcnt lgkmcnt(4)
 v_mfma_f32_16x16x32_bf16 v[248:251], v[88:91], v[16:19], v[248:251]
 s_setprio 1
 ds_read_b64_tr_b16 v[144:145], v6 offset:0
 v_mfma_f32_16x16x32_bf16 v[248:251], v[92:95], v[20:23], v[248:251]
 ds_read_b64_tr_b16 v[146:147], v6 offset:2048
 v_mfma_f32_16x16x32_bf16 v[252:255], v[88:91], v[24:27], v[252:255]
 ds_read_b64_tr_b16 v[148:149], v6 offset:4096
 v_mfma_f32_16x16x32_bf16 v[252:255], v[92:95], v[28:31], v[252:255]
 s_setprio 0
 ds_read_b64_tr_b16 v[150:151], v6 offset:6144
 buffer_load_dwordx4 v[176:179], v122, s[28:31], s70 offen offset:0 sc1
 s_waitcnt lgkmcnt(4)
 v_mfma_f32_16x16x32_bf16 v[224:227], v[96:99], v[64:67], v[224:227]
 s_setprio 1
 ds_read_b64_tr_b16 v[88:89], v14 offset:0
 v_mfma_f32_16x16x32_bf16 v[224:227], v[100:103], v[68:71], v[224:227]
 ds_read_b64_tr_b16 v[90:91], v14 offset:2048
 v_mfma_f32_16x16x32_bf16 v[228:231], v[96:99], v[72:75], v[228:231]
 ds_read_b64_tr_b16 v[92:93], v14 offset:4096
 v_mfma_f32_16x16x32_bf16 v[228:231], v[100:103], v[76:79], v[228:231]
 s_setprio 0
 ds_read_b64_tr_b16 v[94:95], v14 offset:6144
 buffer_load_dwordx4 v[180:183], v122, s[28:31], s70 offen offset:2048 sc1
 s_waitcnt lgkmcnt(4)
 v_mfma_f32_16x16x32_bf16 v[232:235], v[144:147], v[64:67], v[232:235]
 s_setprio 1
 ds_read_b64_tr_b16 v[96:97], v15 offset:0
 v_mfma_f32_16x16x32_bf16 v[232:235], v[148:151], v[68:71], v[232:235]
 ds_read_b64_tr_b16 v[98:99], v15 offset:2048
 v_mfma_f32_16x16x32_bf16 v[236:239], v[144:147], v[72:75], v[236:239]
 ds_read_b64_tr_b16 v[100:101], v15 offset:4096
 v_mfma_f32_16x16x32_bf16 v[236:239], v[148:151], v[76:79], v[236:239]
 s_setprio 0
 ds_read_b64_tr_b16 v[102:103], v15 offset:6144
 buffer_load_dwordx4 v[184:187], v122, s[28:31], s70 offen offset:256 sc1
 s_waitcnt vmcnt(7) lgkmcnt(0)
 s_barrier
 v_mfma_f32_16x16x32_bf16 v[240:243], v[88:91], v[64:67], v[240:243]
 s_setprio 1
 ds_read_b64_tr_b16 v[144:145], v5 offset:32768
 v_mfma_f32_16x16x32_bf16 v[240:243], v[92:95], v[68:71], v[240:243]
 ds_read_b64_tr_b16 v[146:147], v5 offset:34816
 v_mfma_f32_16x16x32_bf16 v[244:247], v[88:91], v[72:75], v[244:247]
 ds_read_b64_tr_b16 v[148:149], v5 offset:36864
 v_mfma_f32_16x16x32_bf16 v[244:247], v[92:95], v[76:79], v[244:247]
 s_setprio 0
 ds_read_b64_tr_b16 v[150:151], v5 offset:38912
 buffer_load_dwordx4 v[188:191], v122, s[28:31], s70 offen offset:2304 sc1
 v_mfma_f32_16x16x32_bf16 v[248:251], v[96:99], v[64:67], v[248:251]
 s_setprio 1
 ds_read_b64_tr_b16 v[88:89], v6 offset:32768
 v_mfma_f32_16x16x32_bf16 v[248:251], v[100:103], v[68:71], v[248:251]
 ds_read_b64_tr_b16 v[90:91], v6 offset:34816
 v_mfma_f32_16x16x32_bf16 v[252:255], v[96:99], v[72:75], v[252:255]
 ds_read_b64_tr_b16 v[92:93], v6 offset:36864
 v_mfma_f32_16x16x32_bf16 v[252:255], v[100:103], v[76:79], v[252:255]
 s_setprio 0
 ds_read_b64_tr_b16 v[94:95], v6 offset:38912
 s_waitcnt vmcnt(4)
 v_max3_u32 v13, v160, v161, v162
 v_max3_u32 v13, v13, v163, v164
 v_max3_u32 v13, v13, v165, v166
 v_max3_u32 v13, v13, v167, v168
 v_max3_u32 v13, v13, v169, v170
 v_max3_u32 v13, v13, v171, v172
 v_max3_u32 v13, v13, v173, v174
 v_max_u32 v13, v13, v175
 v_cmp_eq_u32 vcc, -1, v13
 s_nop 0
 s_cmp_lg_u64 vcc, 0
 s_cbranch_scc1 L_x_3025
L_r_3026:
 s_waitcnt lgkmcnt(4)
 v_mfma_f32_16x16x32_bf16 v[224:227], v[144:147], v[160:163], v[224:227]
 s_setprio 1
 ds_read_b64_tr_b16 v[96:97], v14 offset:32768
 v_mfma_f32_16x16x32_bf16 v[224:227], v[148:151], v[164:167], v[224:227]
 ds_read_b64_tr_b16 v[98:99], v14 offset:34816
 v_mfma_f32_16x16x32_bf16 v[228:231], v[144:147], v[168:171], v[228:231]
 ds_read_b64_tr_b16 v[100:101], v14 offset:36864
 v_mfma_f32_16x16x32_bf16 v[228:231], v[148:151], v[172:175], v[228:231]
 s_setprio 0
 ds_read_b64_tr_b16 v[102:103], v14 offset:38912
 s_waitcnt lgkmcnt(4)
 v_mfma_f32_16x16x32_bf16 v[232:235], v[88:91], v[160:163], v[232:235]
 s_setprio 1
 ds_read_b64_tr_b16 v[144:145], v15 offset:32768
 v_mfma_f32_16x16x32_bf16 v[232:235], v[92:95], v[164:167], v[232:235]
 ds_read_b64_tr_b16 v[146:147], v15 offset:34816
 v_mfma_f32_16x16x32_bf16 v[236:239], v[88:91], v[168:171], v[236:239]
 ds_read_b64_tr_b16 v[148:149], v15 offset:36864
 v_mfma_f32_16x16x32_bf16 v[236:239], v[92:95], v[172:175], v[236:239]
 s_setprio 0
 ds_read_b64_tr_b16 v[150:151], v15 offset:38912
 s_waitcnt lgkmcnt(4)
 v_mfma_f32_16x16x32_bf16 v[240:243], v[96:99], v[160:163], v[240:243]
 s_setprio 1
 ds_read_b64_tr_b16 v[88:89], v124 offset:0
 v_mfma_f32_16x16x32_bf16 v[240:243], v[100:103], v[164:167], v[240:243]
 ds_read_b64_tr_b16 v[90:91], v124 offset:2048
 v_mfma_f32_16x16x32_bf16 v[244:247], v[96:99], v[168:171], v[244:247]
 ds_read_b64_tr_b16 v[92:93], v124 offset:4096
 v_mfma_f32_16x16x32_bf16 v[244:247], v[100:103], v[172:175], v[244:247]
 s_setprio 0
 ds_read_b64_tr_b16 v[94:95], v124 offset:6144
 s_waitcnt lgkmcnt(4)
 v_mfma_f32_16x16x32_bf16 v[248:251], v[144:147], v[160:163], v[248:251]
 s_setprio 1
 ds_read_b64_tr_b16 v[96:97], v1 offset:0
 v_mfma_f32_16x16x32_bf16 v[248:251], v[148:151], v[164:167], v[248:251]
 ds_read_b64_tr_b16 v[98:99], v1 offset:2048
 v_mfma_f32_16x16x32_bf16 v[252:255], v[144:147], v[168:171], v[252:255]
 ds_read_b64_tr_b16 v[100:101], v1 offset:4096
 v_mfma_f32_16x16x32_bf16 v[252:255], v[148:151], v[172:175], v[252:255]
 s_setprio 0
 ds_read_b64_tr_b16 v[102:103], v1 offset:6144
 s_waitcnt vmcnt(0)
 v_max3_u32 v13, v176, v177, v178
 v_max3_u32 v13, v13, v179, v180
 v_max3_u32 v13, v13, v181, v182
 v_max3_u32 v13, v13, v183, v184
 v_max3_u32 v13, v13, v185, v186
 v_max3_u32 v13, v13, v187, v188
 v_max3_u32 v13, v13, v189, v190
 v_max_u32 v13, v13, v191
 v_cmp_eq_u32 vcc, -1, v13
 s_nop 0
 s_cmp_lg_u64 vcc, 0
 s_cbranch_scc1 L_x_3028
L_r_3029:
 s_waitcnt lgkmcnt(4)
 v_mfma_f32_16x16x32_bf16 v[224:227], v[88:91], v[176:179], v[224:227]
 s_setprio 1
 ds_read_b64_tr_b16 v[144:145], v2 offset:0
 v_mfma_f32_16x16x32_bf16 v[224:227], v[92:95], v[180:183], v[224:227]
 ds_read_b64_tr_b16 v[146:147], v2 offset:2048
 v_mfma_f32_16x16x32_bf16 v[228:231], v[88:91], v[184:187], v[228:231]
 ds_read_b64_tr_b16 v[148:149], v2 offset:4096
 v_mfma_f32_16x16x32_bf16 v[228:231], v[92:95], v[188:191], v[228:231]
 s_setprio 0
 ds_read_b64_tr_b16 v[150:151], v2 offset:6144
 s_waitcnt lgkmcnt(4)
 v_mfma_f32_16x16x32_bf16 v[232:235], v[96:99], v[176:179], v[232:235]
 s_setprio 1
 ds_read_b64_tr_b16 v[88:89], v3 offset:0
 v_mfma_f32_16x16x32_bf16 v[232:235], v[100:103], v[180:183], v[232:235]
 ds_read_b64_tr_b16 v[90:91], v3 offset:2048
 v_mfma_f32_16x16x32_bf16 v[236:239], v[96:99], v[184:187], v[236:239]
 ds_read_b64_tr_b16 v[92:93], v3 offset:4096
 ds_write_b128 v104, v[224:227] offset:0
 v_mfma_f32_16x16x32_bf16 v[236:239], v[100:103], v[188:191], v[236:239]
 s_setprio 0
 ds_read_b64_tr_b16 v[94:95], v3 offset:6144
 ds_write_b128 v104, v[228:231] offset:4096
 s_waitcnt lgkmcnt(6)
 v_mfma_f32_16x16x32_bf16 v[240:243], v[144:147], v[176:179], v[240:243]
 s_setprio 1
 v_mfma_f32_16x16x32_bf16 v[240:243], v[148:151], v[180:183], v[240:243]
 v_mfma_f32_16x16x32_bf16 v[244:247], v[144:147], v[184:187], v[244:247]
 ds_write_b128 v105, v[232:235] offset:0
 v_mfma_f32_16x16x32_bf16 v[244:247], v[148:151], v[188:191], v[244:247]
 s_setprio 0
 ds_write_b128 v105, v[236:239] offset:4096
 s_waitcnt lgkmcnt(3)
 v_mfma_f32_16x16x32_bf16 v[248:251], v[88:91], v[176:179], v[248:251]
 s_setprio 1
 v_mfma_f32_16x16x32_bf16 v[248:251], v[92:95], v[180:183], v[248:251]
 v_mfma_f32_16x16x32_bf16 v[252:255], v[88:91], v[184:187], v[252:255]
 ds_write_b128 v106, v[240:243] offset:0
 v_mfma_f32_16x16x32_bf16 v[252:255], v[92:95], v[188:191], v[252:255]
 s_setprio 0
 ds_write_b128 v106, v[244:247] offset:4096
 s_nop 2
 ds_write_b128 v107, v[248:251] offset:0
 s_nop 1
 ds_write_b128 v107, v[252:255] offset:4096
 s_waitcnt lgkmcnt(0)
 s_barrier
 ds_read_b128 v[128:131], v10 offset:0
 ds_read_b128 v[132:135], v9 offset:0
 ds_read_b128 v[136:139], v10 offset:16384
 ds_read_b128 v[140:143], v9 offset:16384
 ds_read_b128 v[144:147], v10 offset:32768
 ds_read_b128 v[148:151], v9 offset:32768
 ds_read_b128 v[152:155], v10 offset:49152
 ds_read_b128 v[156:159], v9 offset:49152
 s_waitcnt lgkmcnt(4)
 v_add_f32 v128, v128, v136
 v_add_f32 v129, v129, v137
 v_add_f32 v130, v130, v138
 v_add_f32 v131, v131, v139
 v_add_f32 v132, v132, v140
 v_add_f32 v133, v133, v141
 v_add_f32 v134, v134, v142
 v_add_f32 v135, v135, v143
 s_waitcnt lgkmcnt(2)
 v_add_f32 v128, v128, v144
 v_add_f32 v129, v129, v145
 v_add_f32 v130, v130, v146
 v_add_f32 v131, v131, v147
 v_add_f32 v132, v132, v148
 v_add_f32 v133, v133, v149
 v_add_f32 v134, v134, v150
 v_add_f32 v135, v135, v151
 s_waitcnt lgkmcnt(0)
 v_add_f32 v128, v128, v152
 v_add_f32 v129, v129, v153
 v_add_f32 v130, v130, v154
 v_add_f32 v131, v131, v155
 v_add_f32 v132, v132, v156
 v_add_f32 v133, v133, v157
 v_add_f32 v134, v134, v158
 v_add_f32 v135, v135, v159
 v_cvt_pk_bf16_f32 v92, v128, v129
 v_cvt_pk_bf16_f32 v93, v130, v131
 v_cvt_pk_bf16_f32 v94, v132, v133
 v_cvt_pk_bf16_f32 v95, v134, v135
 buffer_store_dwordx4 v[92:95], v12, s[40:43], s77 offen sc1
 s_endpgm
L_x_3001:
 s_mov_b64 exec, 1
 buffer_store_dword v112, v126, s[44:47], 0 offen sc1
 s_mov_b64 exec, -1
 s_branch L_r_3002
L_x_3005:
 s_mov_b32 s92, 200000
L_spin_3007:
 buffer_load_dword v121, v118, s[44:47], 0 offen sc1
 s_waitcnt vmcnt(0)
 v_cmp_eq_u32 vcc, 0, v121
 s_sub_u32 s92, s92, 1
 s_cbranch_scc1 L_r_3006
 s_cmp_lg_u64 vcc, 0
 s_cbranch_scc1 L_spin_3007
 s_branch L_r_3006
L_x_3008:
 s_mov_b32 s92, 200000
L_spin_3010:
 buffer_load_dword v14, v119, s[28:31], 0 offen sc1
 buffer_load_dword v15, v119, s[28:31], 0 offen offset:64 sc1
 s_waitcnt vmcnt(0)
 v_min_u32 v13, v14, v15
 v_cmp_eq_u32 vcc, 0, v13
 s_sub_u32 s92, s92, 1
 s_cbranch_scc1 L_r_3009
 s_cmp_lg_u64 vcc, 0
 s_cbranch_scc1 L_spin_3010
 s_branch L_r_3009
L_x_3012:
 s_mov_b32 s92, 200000
L_spin_3014:
 buffer_load_dword v121, v120, s[28:31], 0 offen sc1
 s_waitcnt vmcnt(0)
 v_cmp_eq_u32 vcc, 0, v121
 s_sub_u32 s92, s92, 1
 s_cbranch_scc1 L_r_3013
 s_cmp_lg_u64 vcc, 0
 s_cbranch_scc1 L_spin_3014
 s_branch L_r_3013
L_x_3015:
 s_mov_b32 s92, 200000
L_spin_3017:
 buffer_load_dwordx4 v[148:151], v126, s[28:31], s85 offen sc1
 buffer_load_dwordx4 v[144:147], v126, s[28:31], s3 offen sc1
 s_waitcnt vmcnt(0)
 v_max3_u32 v13, v144, v145, v146
 v_max3_u32 v13, v13, v147, v148
 v_max3_u32 v13, v13, v149, v150
 v_max_u32 v13, v13, v151
 v_cmp_eq_u32 vcc, -1, v13
 s_sub_u32 s92, s92, 1
 s_cbranch_scc1 L_r_3016
 s_cmp_lg_u64 vcc, 0
 s_cbranch_scc1 L_spin_3017
 s_branch L_r_3016
L_x_3018:
 s_mov_b32 s92, 200000
L_spin_3020:
 buffer_load_dword v121, v115, s[28:31], 0 offen sc1
 s_waitcnt vmcnt(0)
 v_cmp_eq_u32 vcc, 0, v121
 s_sub_u32 s92, s92, 1
 s_cbranch_scc1 L_r_3019
 s_cmp_lg_u64 vcc, 0
 s_cbranch_scc1 L_spin_3020
 s_branch L_r_3019
L_x_3021:
 s_mov_b32 s92, 200000
L_spin_3023:
 buffer_load_dword v118, v123, s[28:31], 0 offen sc1
 s_waitcnt vmcnt(0)
 v_cmp_eq_u32 vcc, 0, v118
 s_sub_u32 s92, s92, 1
 s_cbranch_scc1 L_r_3022
 s_cmp_lg_u64 vcc, 0
 s_cbranch_scc1 L_spin_3023
 s_branch L_r_3022
L_x_3025:
 s_mov_b32 s92, 200000
L_spin_3027:
 buffer_load_dwordx4 v[160:163], v122, s[28:31], s67 offen offset:0 sc1
 buffer_load_dwordx4 v[164:167], v122, s[28:31], s67 offen offset:2048 sc1
 buffer_load_dwordx4 v[168:171], v122, s[28:31], s67 offen offset:256 sc1
 buffer_load_dwordx4 v[172:175], v122, s[28:31], s67 offen offset:2304 sc1
 s_waitcnt vmcnt(0)
 v_max3_u32 v13, v160, v161, v162
 v_max3_u32 v13, v13, v163, v164
 v_max3_u32 v13, v13, v165, v166
 v_max3_u32 v13, v13, v167, v168
 v_max3_u32 v13, v13, v169, v170
 v_max3_u32 v13, v13, v171, v172
 v_max3_u32 v13, v13, v173, v174
 v_max_u32 v13, v13, v175
 v_cmp_eq_u32 vcc, -1, v13
 s_sub_u32 s92, s92, 1
 s_cbranch_scc1 L_r_3026
 s_cmp_lg_u64 vcc, 0
 s_cbranch_scc1 L_spin_3027
 buffer_load_dwordx4 v[176:179], v122, s[28:31], s70 offen offset:0 sc1
 buffer_load_dwordx4 v[180:183], v122, s[28:31], s70 offen offset:2048 sc1
 buffer_load_dwordx4 v[184:187], v122, s[28:31], s70 offen offset:256 sc1
 buffer_load_dwordx4 v[188:191], v122, s[28:31], s70 offen offset:2304 sc1
 s_branch L_r_3026
L_x_3028:
 s_mov_b32 s92, 200000
L_spin_3030:
 buffer_load_dwordx4 v[176:179], v122, s[28:31], s70 offen offset:0 sc1
 buffer_load_dwordx4 v[180:183], v122, s[28:31], s70 offen offset:2048 sc1
 buffer_load_dwordx4 v[184:187], v122, s[28:31], s70 offen offset:256 sc1
 buffer_load_dwordx4 v[188:191], v122, s[28:31], s70 offen offset:2304 sc1
 s_waitcnt vmcnt(0)
 v_max3_u32 v13, v176, v177, v178
 v_max3_u32 v13, v13, v179, v180
 v_max3_u32 v13, v13, v181, v182
 v_max3_u32 v13, v13, v183, v184
 v_max3_u32 v13, v13, v185, v186
 v_max3_u32 v13, v13, v187, v188
 v_max3_u32 v13, v13, v189, v190
 v_max_u32 v13, v13, v191
 v_cmp_eq_u32 vcc, -1, v13
 s_sub_u32 s92, s92, 1
 s_cbranch_scc1 L_r_3029
 s_cmp_lg_u64 vcc, 0
 s_cbranch_scc1 L_spin_3030
 s_branch L_r_3029
L_slow2:
 s_nop 11
 s_lshl_b32 s62, s94, 11
 s_add_u32 s62, s62, 0x10000
 v_subrev_u32 v108, s62, v113
 v_subrev_u32 v109, s62, v114
 s_sub_u32 s67, s66, s53
 s_mov_b32 s62, s67
 s_mov_b32 s92, 64
 v_mov_b32 v110, 0xff800000
L_slowA2:
 buffer_load_dwordx4 v[104:107], v108, s[28:31], s62 offen sc1
 s_waitcnt vmcnt(0)
 v_mfma_f32_32x32x16_bf16 v[160:175], v[104:107], v[148:151], 0
 s_add_u32 s62, s62, 2048
 s_nop 10
 v_max3_f32 v110, v110, v160, v161
 v_max3_f32 v110, v110, v162, v163
 v_max3_f32 v110, v110, v164, v165
 v_max3_f32 v110, v110, v166, v167
 v_max3_f32 v110, v110, v168, v169
 v_max3_f32 v110, v110, v170, v171
 v_max3_f32 v110, v110, v172, v173
 v_max3_f32 v110, v110, v174, v175
 s_sub_u32 s92, s92, 1
 s_cmp_lg_u32 s92, 0
 s_cbranch_scc1 L_slowA2
 v_mov_b32 v111, v110
 s_nop 1
 v_permlane32_swap_b32 v111, v110
 v_max_f32 v110, v110, v111
 v_sub_f32 v176, 0, v110
 v_mov_b32 v48, 0
 v_sub_f32 v177, 0, v110
 v_mov_b32 v49, 0
 v_sub_f32 v178, 0, v110
 v_mov_b32 v50, 0
 v_sub_f32 v179, 0, v110
 v_mov_b32 v51, 0
 v_sub_f32 v180, 0, v110
 v_mov_b32 v52, 0
 v_sub_f32 v181, 0, v110
 v_mov_b32 v53, 0
 v_sub_f32 v182, 0, v110
 v_mov_b32 v54, 0
 v_sub_f32 v183, 0, v110
 v_mov_b32 v55, 0
 v_sub_f32 v184, 0, v110
 v_mov_b32 v56, 0
 v_sub_f32 v185, 0, v110
 v_mov_b32 v57, 0
 v_sub_f32 v186, 0, v110
 v_mov_b32 v58, 0
 v_sub_f32 v187, 0, v110
 v_mov_b32 v59, 0
 v_sub_f32 v188, 0, v110
 v_mov_b32 v60, 0
 v_sub_f32 v189, 0, v110
 v_mov_b32 v61, 0
 v_sub_f32 v190, 0, v110
 v_mov_b32 v62, 0
 v_sub_f32 v191, 0, v110
 v_mov_b32 v63, 0
 s_mov_b32 s62, s67
 s_mov_b32 s92, 64
L_slowB2:
 buffer_load_dwordx4 v[104:107], v108, s[28:31], s62 offen sc1
 s_mov_b64 exec, s[96:97]
 buffer_load_dwordx4 v[128:131], v109, s[28:31], s62 offen offset:1024 sc1
 buffer_load_dwordx4 v[132:135], v109, s[28:31], s62 offen offset:1536 sc1
 s_mov_b64 exec, -1
 s_waitcnt vmcnt(0)
 v_mfma_f32_32x32x16_bf16 v[160:175], v[104:107], v[148:151], v[176:191]
 s_add_u32 s62, s62, 2048
 s_nop 10
 v_exp_f32 v160, v160
 v_exp_f32 v161, v161
 v_exp_f32 v162, v162
 v_exp_f32 v163, v163
 v_exp_f32 v164, v164
 v_exp_f32 v165, v165
 v_exp_f32 v166, v166
 v_exp_f32 v167, v167
 v_exp_f32 v168, v168
 v_exp_f32 v169, v169
 v_exp_f32 v170, v170
 v_exp_f32 v171, v171
 v_exp_f32 v172, v172
 v_exp_f32 v173, v173
 v_exp_f32 v174, v174
 v_exp_f32 v175, v175
 v_smfmac_f32_32x32x32_bf16 v[48:63], v[128:131], v[160:167], v112
 s_nop 0
 v_smfmac_f32_32x32x32_bf16 v[48:63], v[132:135], v[168:175], v112
 s_sub_u32 s92, s92, 1
 s_cmp_lg_u32 s92, 0
 s_nop 11
 s_cbranch_scc1 L_slowB2
 s_branch L_slowret2
.p2align 12
.skip 1024
L_v3:
 s_waitcnt vmcnt(5)
 s_barrier
 ds_read_b128 v[128:131], v5 offset:0
 ds_read_b128 v[132:135], v5 offset:2048
 ds_read_b128 v[136:139], v6 offset:0
 ds_read_b128 v[140:143], v6 offset:2048
 ds_read_b64_tr_b16 v[80:81], v7 offset:0
 ds_read_b64_tr_b16 v[82:83], v7 offset:512
 ds_read_b64_tr_b16 v[84:85], v7 offset:4096
 ds_read_b64_tr_b16 v[86:87], v7 offset:4608
 ds_read_b64_tr_b16 v[88:89], v8 offset:0
 ds_read_b64_tr_b16 v[90:91], v8 offset:512
 ds_read_b64_tr_b16 v[92:93], v8 offset:4096
 ds_read_b64_tr_b16 v[94:95], v8 offset:4608
 s_waitcnt lgkmcnt(4)
 v_mfma_f32_16x16x32_bf16 v[16:19], v[128:131], v[80:83], 0
 s_setprio 1
 ds_read_b64_tr_b16 v[96:97], v9 offset:0
 v_mfma_f32_16x16x32_bf16 v[16:19], v[136:139], v[84:87], v[16:19]
 ds_read_b64_tr_b16 v[98:99], v9 offset:512
 v_mfma_f32_16x16x32_bf16 v[20:23], v[132:135], v[80:83], 0
 ds_read_b64_tr_b16 v[100:101], v9 offset:4096
 v_mfma_f32_16x16x32_bf16 v[20:23], v[140:143], v[84:87], v[20:23]
 s_setprio 0
 ds_read_b64_tr_b16 v[102:103], v9 offset:4608
 s_add_u32 s91, s60, 2
 s_and_b32 s91, s91, 7
 s_add_u32 m0, s53, 32768
 s_lshl_b32 s86, s91, 7
 buffer_load_dwordx4 v1, s[4:7], s86 offen lds
 s_waitcnt lgkmcnt(4)
 v_mfma_f32_16x16x32_bf16 v[24:27], v[128:131], v[88:91], 0
 s_setprio 1
 ds_read_b64_tr_b16 v[80:81], v10 offset:0
 v_mfma_f32_16x16x32_bf16 v[24:27], v[136:139], v[92:95], v[24:27]
 ds_read_b64_tr_b16 v[82:83], v10 offset:512
 v_mfma_f32_16x16x32_bf16 v[28:31], v[132:135], v[88:91], 0
 ds_read_b64_tr_b16 v[84:85], v10 offset:4096
 v_mfma_f32_16x16x32_bf16 v[28:31], v[140:143], v[92:95], v[28:31]
 s_setprio 0
 ds_read_b64_tr_b16 v[86:87], v10 offset:4608
 s_add_u32 m0, s53, 40960
 s_add_u32 s86, s86, 65536
 buffer_load_dwordx4 v1, s[4:7], s86 offen lds
 s_waitcnt lgkmcnt(4)
 v_mfma_f32_16x16x32_bf16 v[32:35], v[96:99], v[128:131], 0
 s_setprio 1
 ds_read_b64_tr_b16 v[88:89], v9 offset:8192
 v_mfma_f32_16x16x32_bf16 v[32:35], v[100:103], v[136:139], v[32:35]
 ds_read_b64_tr_b16 v[90:91], v9 offset:8704
 v_mfma_f32_16x16x32_bf16 v[36:39], v[96:99], v[132:135], 0
 ds_read_b64_tr_b16 v[92:93], v9 offset:12288
 v_mfma_f32_16x16x32_bf16 v[36:39], v[100:103], v[140:143], v[36:39]
 s_setprio 0
 ds_read_b64_tr_b16 v[94:95], v9 offset:12800
 s_and_b32 s62, s55, 7
 s_mul_i32 s62, s62, 229376
 s_bitcmp1_b32 s54, 0
 s_cselect_b32 s62, 0x10000000, s62
 buffer_load_dword v125, v4, s[20:23], s62 offen
 buffer_load_dword v125, v4, s[24:27], s62 offen
 s_waitcnt lgkmcnt(4)
 v_mfma_f32_16x16x32_bf16 v[40:43], v[80:83], v[128:131], 0
 s_setprio 1
 ds_read_b64_tr_b16 v[96:97], v10 offset:8192
 v_mfma_f32_16x16x32_bf16 v[40:43], v[84:87], v[136:139], v[40:43]
 ds_read_b64_tr_b16 v[98:99], v10 offset:8704
 v_mfma_f32_16x16x32_bf16 v[44:47], v[80:83], v[132:135], 0
 ds_read_b64_tr_b16 v[100:101], v10 offset:12288
 v_mfma_f32_16x16x32_bf16 v[44:47], v[84:87], v[140:143], v[44:47]
 s_setprio 0
 ds_read_b64_tr_b16 v[102:103], v10 offset:12800
 s_add_u32 m0, s53, 81920
 s_mul_i32 s88, s91, 196608
 buffer_load_dwordx4 v2, s[8:11], s88 offen lds
 s_waitcnt vmcnt(7)
 s_barrier
 s_or_b32 s62, s2, s52
 s_cbranch_scc0 L_x_4001
L_r_4002:
 s_waitcnt lgkmcnt(4)
 v_mfma_f32_16x16x32_bf16 v[48:51], v[88:91], v[128:131], 0
 s_setprio 1
 ds_read_b128 v[144:147], v5 offset:16384
 ds_read_b64_tr_b16 v[80:81], v7 offset:8192
 v_mfma_f32_16x16x32_bf16 v[48:51], v[92:95], v[136:139], v[48:51]
 ds_read_b128 v[148:151], v5 offset:18432
 ds_read_b64_tr_b16 v[82:83], v7 offset:8704
 v_mfma_f32_16x16x32_bf16 v[52:55], v[88:91], v[132:135], 0
 ds_read_b128 v[152:155], v6 offset:16384
 ds_read_b64_tr_b16 v[84:85], v7 offset:12288
 v_mfma_f32_16x16x32_bf16 v[52:55], v[92:95], v[140:143], v[52:55]
 s_setprio 0
 ds_read_b128 v[156:159], v6 offset:18432
 ds_read_b64_tr_b16 v[86:87], v7 offset:12800
 s_add_u32 m0, s53, 131072
 s_mul_i32 s89, s91, s61
 buffer_load_dwordx4 v3, s[12:15], s89 offen lds
 s_add_u32 m0, s53, 139264
 s_add_u32 s89, s89, s87
 buffer_load_dwordx4 v3, s[16:19], s89 offen lds
 s_waitcnt lgkmcnt(8)
 v_mfma_f32_16x16x32_bf16 v[56:59], v[96:99], v[128:131], 0
 s_setprio 1
 ds_read_b64_tr_b16 v[88:89], v8 offset:8192
 v_mfma_f32_16x16x32_bf16 v[56:59], v[100:103], v[136:139], v[56:59]
 ds_read_b64_tr_b16 v[90:91], v8 offset:8704
 v_mfma_f32_16x16x32_bf16 v[60:63], v[96:99], v[132:135], 0
 ds_read_b64_tr_b16 v[92:93], v8 offset:12288
 v_mfma_f32_16x16x32_bf16 v[60:63], v[100:103], v[140:143], v[60:63]
 s_setprio 0
 ds_read_b64_tr_b16 v[94:95], v8 offset:12800
 s_add_u32 s91, s60, 3
 s_and_b32 s91, s91, 7
 s_add_u32 m0, s53, 49152
 s_lshl_b32 s86, s91, 7
 buffer_load_dwordx4 v1, s[4:7], s86 offen lds
 s_waitcnt vmcnt(8)
 s_barrier
 s_waitcnt lgkmcnt(4)
 v_mfma_f32_16x16x32_bf16 v[16:19], v[144:147], v[80:83], v[16:19]
 s_setprio 1
 ds_read_b64_tr_b16 v[96:97], v9 offset:16384
 v_mfma_f32_16x16x32_bf16 v[16:19], v[152:155], v[84:87], v[16:19]
 ds_read_b64_tr_b16 v[98:99], v9 offset:16896
 v_mfma_f32_16x16x32_bf16 v[20:23], v[148:151], v[80:83], v[20:23]
 ds_read_b64_tr_b16 v[100:101], v9 offset:20480
 v_mfma_f32_16x16x32_bf16 v[20:23], v[156:159], v[84:87], v[20:23]
 s_setprio 0
 ds_read_b64_tr_b16 v[102:103], v9 offset:20992
 s_add_u32 m0, s53, 57344
 s_add_u32 s86, s86, 65536
 buffer_load_dwordx4 v1, s[4:7], s86 offen lds
 buffer_load_dwordx4 v[64:67], v126, s[4:7], s80 offen
 buffer_load_dwordx4 v[68:71], v126, s[48:51], 0 offen
 s_waitcnt lgkmcnt(4)
 v_mfma_f32_16x16x32_bf16 v[24:27], v[144:147], v[88:91], v[24:27]
 s_setprio 1
 ds_read_b64_tr_b16 v[80:81], v10 offset:16384
 v_mfma_f32_16x16x32_bf16 v[24:27], v[152:155], v[92:95], v[24:27]
 ds_read_b64_tr_b16 v[82:83], v10 offset:16896
 v_mfma_f32_16x16x32_bf16 v[28:31], v[148:151], v[88:91], v[28:31]
 ds_read_b64_tr_b16 v[84:85], v10 offset:20480
 v_mfma_f32_16x16x32_bf16 v[28:31], v[156:159], v[92:95], v[28:31]
 s_setprio 0
 ds_read_b64_tr_b16 v[86:87], v10 offset:20992
 s_add_u32 m0, s53, 90112
 s_mul_i32 s88, s91, 196608
 buffer_load_dwordx4 v2, s[8:11], s88 offen lds
 s_waitcnt lgkmcnt(4)
 v_mfma_f32_16x16x32_bf16 v[32:35], v[96:99], v[144:147], v[32:35]
 s_setprio 1
 ds_read_b64_tr_b16 v[88:89], v9 offset:24576
 v_mfma_f32_16x16x32_bf16 v[32:35], v[100:103], v[152:155], v[32:35]
 ds_read_b64_tr_b16 v[90:91], v9 offset:25088
 v_mfma_f32_16x16x32_bf16 v[36:39], v[96:99], v[148:151], v[36:39]
 ds_read_b64_tr_b16 v[92:93], v9 offset:28672
 v_mfma_f32_16x16x32_bf16 v[36:39], v[100:103], v[156:159], v[36:39]
 s_setprio 0
 ds_read_b64_tr_b16 v[94:95], v9 offset:29184
 s_add_u32 m0, s53, 147456
 s_mul_i32 s89, s91, s61
 buffer_load_dwordx4 v3, s[12:15], s89 offen lds
 s_waitcnt lgkmcnt(4)
 v_mfma_f32_16x16x32_bf16 v[40:43], v[80:83], v[144:147], v[40:43]
 s_setprio 1
 ds_read_b64_tr_b16 v[96:97], v10 offset:24576
 v_mfma_f32_16x16x32_bf16 v[40:43], v[84:87], v[152:155], v[40:43]
 ds_read_b64_tr_b16 v[98:99], v10 offset:25088
 v_mfma_f32_16x16x32_bf16 v[44:47], v[80:83], v[148:151], v[44:47]
 ds_read_b64_tr_b16 v[100:101], v10 offset:28672
 v_mfma_f32_16x16x32_bf16 v[44:47], v[84:87], v[156:159], v[44:47]
 s_setprio 0
 ds_read_b64_tr_b16 v[102:103], v10 offset:29184
 s_add_u32 m0, s53, 155648
 s_add_u32 s89, s89, s87
 buffer_load_dwordx4 v3, s[16:19], s89 offen lds
 s_waitcnt vmcnt(7)
 s_barrier
 s_waitcnt lgkmcnt(4)
 v_mfma_f32_16x16x32_bf16 v[48:51], v[88:91], v[144:147], v[48:51]
 s_setprio 1
 ds_read_b128 v[160:163], v5 offset:32768
 ds_read_b64_tr_b16 v[80:81], v7 offset:16384
 v_mfma_f32_16x16x32_bf16 v[48:51], v[92:95], v[152:155], v[48:51]
 ds_read_b128 v[164:167], v5 offset:34816
 ds_read_b64_tr_b16 v[82:83], v7 offset:16896
 v_mfma_f32_16x16x32_bf16 v[52:55], v[88:91], v[148:151], v[52:55]
 ds_read_b128 v[168:171], v6 offset:32768
 ds_read_b64_tr_b16 v[84:85], v7 offset:20480
 v_mfma_f32_16x16x32_bf16 v[52:55], v[92:95], v[156:159], v[52:55]
 s_setprio 0
 ds_read_b128 v[172:175], v6 offset:34816
 ds_read_b64_tr_b16 v[86:87], v7 offset:20992
 s_add_u32 s91, s60, 4
 s_and_b32 s91, s91, 7
 s_add_u32 m0, s53, 0
 s_lshl_b32 s86, s91, 7
 buffer_load_dwordx4 v1, s[4:7], s86 offen lds
 s_waitcnt lgkmcnt(8)
 v_mfma_f32_16x16x32_bf16 v[56:59], v[96:99], v[144:147], v[56:59]
 s_setprio 1
 ds_read_b64_tr_b16 v[88:89], v8 offset:16384
 v_mfma_f32_16x16x32_bf16 v[56:59], v[100:103], v[152:155], v[56:59]
 ds_read_b64_tr_b16 v[90:91], v8 offset:16896
 v_mfma_f32_16x16x32_bf16 v[60:63], v[96:99], v[148:151], v[60:63]
 ds_read_b64_tr_b16 v[92:93], v8 offset:20480
 v_mfma_f32_16x16x32_bf16 v[60:63], v[100:103], v[156:159], v[60:63]
 s_setprio 0
 ds_read_b64_tr_b16 v[94:95], v8 offset:20992
 s_add_u32 m0, s53, 8192
 s_add_u32 s86, s86, 65536
 buffer_load_dwordx4 v1, s[4:7], s86 offen lds
 s_waitcnt lgkmcnt(4)
 v_mfma_f32_16x16x32_bf16 v[16:19], v[160:163], v[80:83], v[16:19]
 s_setprio 1
 ds_read_b64_tr_b16 v[96:97], v9 offset:32768
 v_mfma_f32_16x16x32_bf16 v[16:19], v[168:171], v[84:87], v[16:19]
 ds_read_b64_tr_b16 v[98:99], v9 offset:33280
 v_mfma_f32_16x16x32_bf16 v[20:23], v[164:167], v[80:83], v[20:23]
 ds_read_b64_tr_b16 v[100:101], v9 offset:36864
 v_mfma_f32_16x16x32_bf16 v[20:23], v[172:175], v[84:87], v[20:23]
 s_setprio 0
 ds_read_b64_tr_b16 v[102:103], v9 offset:37376
 s_add_u32 m0, s53, 65536
 s_mul_i32 s88, s91, 196608
 buffer_load_dwordx4 v2, s[8:11], s88 offen lds
 s_waitcnt lgkmcnt(4)
 v_mfma_f32_16x16x32_bf16 v[24:27], v[160:163], v[88:91], v[24:27]
 s_setprio 1
 ds_read_b64_tr_b16 v[80:81], v10 offset:32768
 v_mfma_f32_16x16x32_bf16 v[24:27], v[168:171], v[92:95], v[24:27]
 ds_read_b64_tr_b16 v[82:83], v10 offset:33280
 v_mfma_f32_16x16x32_bf16 v[28:31], v[164:167], v[88:91], v[28:31]
 ds_read_b64_tr_b16 v[84:85], v10 offset:36864
 v_mfma_f32_16x16x32_bf16 v[28:31], v[172:175], v[92:95], v[28:31]
 s_setprio 0
 ds_read_b64_tr_b16 v[86:87], v10 offset:37376
 s_add_u32 m0, s53, 98304
 s_mul_i32 s89, s91, s61
 buffer_load_dwordx4 v3, s[12:15], s89 offen lds
 s_waitcnt lgkmcnt(4)
 v_mfma_f32_16x16x32_bf16 v[32:35], v[96:99], v[160:163], v[32:35]
 s_setprio 1
 ds_read_b64_tr_b16 v[88:89], v9 offset:40960
 v_mfma_f32_16x16x32_bf16 v[32:35], v[100:103], v[168:171], v[32:35]
 ds_read_b64_tr_b16 v[90:91], v9 offset:41472
 v_mfma_f32_16x16x32_bf16 v[36:39], v[96:99], v[164:167], v[36:39]
 ds_read_b64_tr_b16 v[92:93], v9 offset:45056
 v_mfma_f32_16x16x32_bf16 v[36:39], v[100:103], v[172:175], v[36:39]
 s_setprio 0
 ds_read_b64_tr_b16 v[94:95], v9 offset:45568
 s_add_u32 m0, s53, 106496
 s_add_u32 s89, s89, s87
 buffer_load_dwordx4 v3, s[16:19], s89 offen lds
 v_mov_b32 v76, -1
 v_mov_b32 v77, -1
 v_mov_b32 v78, -1
 v_mov_b32 v79, -1
 s_lshl_b32 s67, s58, 3
 s_add_u32 s67, s67, s52
 s_waitcnt lgkmcnt(4)
 v_mfma_f32_16x16x32_bf16 v[40:43], v[80:83], v[160:163], v[40:43]
 s_setprio 1
 ds_read_b64_tr_b16 v[96:97], v10 offset:40960
 v_mfma_f32_16x16x32_bf16 v[40:43], v[84:87], v[168:171], v[40:43]
 ds_read_b64_tr_b16 v[98:99], v10 offset:41472
 v_mfma_f32_16x16x32_bf16 v[44:47], v[80:83], v[164:167], v[44:47]
 ds_read_b64_tr_b16 v[100:101], v10 offset:45056
 v_mfma_f32_16x16x32_bf16 v[44:47], v[84:87], v[172:175], v[44:47]
 s_setprio 0
 ds_read_b64_tr_b16 v[102:103], v10 offset:45568
 s_lshl_b32 s67, s67, 4
 s_add_u32 s67, s67, s56
 s_lshl_b32 s67, s67, 2
 s_add_u32 s67, s67, s59
 s_lshl_b32 s67, s67, 10
 s_add_u32 s67, s67, 1048576
 buffer_store_dwordx4 v[76:79], v126, s[28:31], s67 offen offset:0 sc1
 s_waitcnt vmcnt(2)
 s_barrier
 s_waitcnt lgkmcnt(4)
 v_mfma_f32_16x16x32_bf16 v[48:51], v[88:91], v[160:163], v[48:51]
 s_setprio 1
 ds_read_b128 v[176:179], v5 offset:49152
 ds_read_b64_tr_b16 v[80:81], v7 offset:24576
 v_mfma_f32_16x16x32_bf16 v[48:51], v[92:95], v[168:171], v[48:51]
 ds_read_b128 v[180:183], v5 offset:51200
 ds_read_b64_tr_b16 v[82:83], v7 offset:25088
 v_mfma_f32_16x16x32_bf16 v[52:55], v[88:91], v[164:167], v[52:55]
 ds_read_b128 v[184:187], v6 offset:49152
 ds_read_b64_tr_b16 v[84:85], v7 offset:28672
 v_mfma_f32_16x16x32_bf16 v[52:55], v[92:95], v[172:175], v[52:55]
 s_setprio 0
 ds_read_b128 v[188:191], v6 offset:51200
 ds_read_b64_tr_b16 v[86:87], v7 offset:29184
 s_add_u32 s91, s60, 5
 s_and_b32 s91, s91, 7
 s_add_u32 m0, s53, 16384
 s_lshl_b32 s86, s91, 7
 buffer_load_dwordx4 v1, s[4:7], s86 offen lds
 s_waitcnt lgkmcnt(8)
 v_mfma_f32_16x16x32_bf16 v[56:59], v[96:99], v[160:163], v[56:59]
 s_setprio 1
 ds_read_b64_tr_b16 v[88:89], v8 offset:24576
 v_mfma_f32_16x16x32_bf16 v[56:59], v[100:103], v[168:171], v[56:59]
 ds_read_b64_tr_b16 v[90:91], v8 offset:25088
 v_mfma_f32_16x16x32_bf16 v[60:63], v[96:99], v[164:167], v[60:63]
 ds_read_b64_tr_b16 v[92:93], v8 offset:28672
 v_mfma_f32_16x16x32_bf16 v[60:63], v[100:103], v[172:175], v[60:63]
 s_setprio 0
 ds_read_b64_tr_b16 v[94:95], v8 offset:29184
 s_add_u32 m0, s53, 24576
 s_add_u32 s86, s86, 65536
 buffer_load_dwordx4 v1, s[4:7], s86 offen lds
 v_mov_b32 v13, 0
 v_lshlrev_b32 v73, 16, v68
 v_and_b32 v75, 0xffff0000, v68
 v_lshlrev_b32 v72, 16, v64
 v_and_b32 v74, 0xffff0000, v64
 v_fmac_f32 v13, v72, v73
 v_fmac_f32 v13, v74, v75
 v_lshlrev_b32 v73, 16, v69
 v_and_b32 v75, 0xffff0000, v69
 s_waitcnt lgkmcnt(4)
 v_mfma_f32_16x16x32_bf16 v[16:19], v[176:179], v[80:83], v[16:19]
 s_setprio 1
 ds_read_b64_tr_b16 v[96:97], v9 offset:49152
 v_mfma_f32_16x16x32_bf16 v[16:19], v[184:187], v[84:87], v[16:19]
 ds_read_b64_tr_b16 v[98:99], v9 offset:49664
 v_mfma_f32_16x16x32_bf16 v[20:23], v[180:183], v[80:83], v[20:23]
 ds_read_b64_tr_b16 v[100:101], v9 offset:53248
 v_mfma_f32_16x16x32_bf16 v[20:23], v[188:191], v[84:87], v[20:23]
 s_setprio 0
 ds_read_b64_tr_b16 v[102:103], v9 offset:53760
 s_add_u32 m0, s53, 73728
 s_mul_i32 s88, s91, 196608
 buffer_load_dwordx4 v2, s[8:11], s88 offen lds
 v_lshlrev_b32 v72, 16, v65
 v_and_b32 v74, 0xffff0000, v65
 v_fmac_f32 v13, v72, v73
 v_fmac_f32 v13, v74, v75
 v_lshlrev_b32 v73, 16, v70
 v_and_b32 v75, 0xffff0000, v70
 v_lshlrev_b32 v72, 16, v66
 v_and_b32 v74, 0xffff0000, v66
 v_fmac_f32 v13, v72, v73
 s_waitcnt lgkmcnt(4)
 v_mfma_f32_16x16x32_bf16 v[24:27], v[176:179], v[88:91], v[24:27]
 s_setprio 1
 ds_read_b64_tr_b16 v[80:81], v10 offset:49152
 v_mfma_f32_16x16x32_bf16 v[24:27], v[184:187], v[92:95], v[24:27]
 ds_read_b64_tr_b16 v[82:83], v10 offset:49664
 v_mfma_f32_16x16x32_bf16 v[28:31], v[180:183], v[88:91], v[28:31]
 ds_read_b64_tr_b16 v[84:85], v10 offset:53248
 v_mfma_f32_16x16x32_bf16 v[28:31], v[188:191], v[92:95], v[28:31]
 s_setprio 0
 ds_read_b64_tr_b16 v[86:87], v10 offset:53760
 s_add_u32 m0, s53, 114688
 s_mul_i32 s89, s91, s61
 buffer_load_dwordx4 v3, s[12:15], s89 offen lds
 v_fmac_f32 v13, v74, v75
 v_lshlrev_b32 v73, 16, v71
 v_and_b32 v75, 0xffff0000, v71
 v_lshlrev_b32 v72, 16, v67
 v_and_b32 v74, 0xffff0000, v67
 v_fmac_f32 v13, v72, v73
 v_fmac_f32 v13, v74, v75
 s_nop 1
 v_add_f32_dpp v13, v13, v13 row_shr:1 row_mask:0xf bank_mask:0xf
 s_waitcnt lgkmcnt(4)
 v_mfma_f32_16x16x32_bf16 v[32:35], v[96:99], v[176:179], v[32:35]
 s_setprio 1
 ds_read_b64_tr_b16 v[88:89], v9 offset:57344
 v_mfma_f32_16x16x32_bf16 v[32:35], v[100:103], v[184:187], v[32:35]
 ds_read_b64_tr_b16 v[90:91], v9 offset:57856
 v_mfma_f32_16x16x32_bf16 v[36:39], v[96:99], v[180:183], v[36:39]
 ds_read_b64_tr_b16 v[92:93], v9 offset:61440
 v_mfma_f32_16x16x32_bf16 v[36:39], v[100:103], v[188:191], v[36:39]
 s_setprio 0
 ds_read_b64_tr_b16 v[94:95], v9 offset:61952
 s_add_u32 m0, s53, 122880
 s_add_u32 s89, s89, s87
 buffer_load_dwordx4 v3, s[16:19], s89 offen lds
 v_add_f32_dpp v13, v13, v13 row_shr:2 row_mask:0xf bank_mask:0xf
 s_waitcnt lgkmcnt(4)
 v_mfma_f32_16x16x32_bf16 v[40:43], v[80:83], v[176:179], v[40:43]
 s_setprio 1
 ds_read_b64_tr_b16 v[96:97], v10 offset:57344
 v_mfma_f32_16x16x32_bf16 v[40:43], v[84:87], v[184:187], v[40:43]
 ds_read_b64_tr_b16 v[98:99], v10 offset:57856
 v_mfma_f32_16x16x32_bf16 v[44:47], v[80:83], v[180:183], v[44:47]
 ds_read_b64_tr_b16 v[100:101], v10 offset:61440
 v_mfma_f32_16x16x32_bf16 v[44:47], v[84:87], v[188:191], v[44:47]
 s_setprio 0
 ds_read_b64_tr_b16 v[102:103], v10 offset:61952
 v_add_f32_dpp v13, v13, v13 row_shr:4 row_mask:0xf bank_mask:0xf
 s_waitcnt vmcnt(6)
 s_barrier
 s_cmp_lg_u32 s52, 0
 s_cbranch_scc1 L_s_4003
 buffer_load_dword v121, v118, s[44:47], 0 offen sc1
L_s_4003:
 s_waitcnt lgkmcnt(4)
 v_mfma_f32_16x16x32_bf16 v[48:51], v[88:91], v[176:179], v[48:51]
 s_setprio 1
 ds_read_b128 v[192:195], v5 offset:0
 ds_read_b64_tr_b16 v[80:81], v7 offset:0
 v_mfma_f32_16x16x32_bf16 v[48:51], v[92:95], v[184:187], v[48:51]
 ds_read_b128 v[196:199], v5 offset:2048
 ds_read_b64_tr_b16 v[82:83], v7 offset:512
 v_mfma_f32_16x16x32_bf16 v[52:55], v[88:91], v[180:183], v[52:55]
 ds_read_b128 v[200:203], v6 offset:0
 ds_read_b64_tr_b16 v[84:85], v7 offset:4096
 v_mfma_f32_16x16x32_bf16 v[52:55], v[92:95], v[188:191], v[52:55]
 s_setprio 0
 ds_read_b128 v[204:207], v6 offset:2048
 ds_read_b64_tr_b16 v[86:87], v7 offset:4608
 s_add_u32 s91, s60, 6
 s_and_b32 s91, s91, 7
 s_add_u32 m0, s53, 32768
 s_lshl_b32 s86, s91, 7
 buffer_load_dwordx4 v1, s[4:7], s86 offen lds
 s_waitcnt lgkmcnt(8)
 v_mfma_f32_16x16x32_bf16 v[56:59], v[96:99], v[176:179], v[56:59]
 s_setprio 1
 ds_read_b64_tr_b16 v[88:89], v8 offset:0
 v_mfma_f32_16x16x32_bf16 v[56:59], v[100:103], v[184:187], v[56:59]
 ds_read_b64_tr_b16 v[90:91], v8 offset:512
 v_mfma_f32_16x16x32_bf16 v[60:63], v[96:99], v[180:183], v[60:63]
 ds_read_b64_tr_b16 v[92:93], v8 offset:4096
 v_mfma_f32_16x16x32_bf16 v[60:63], v[100:103], v[188:191], v[60:63]
 s_setprio 0
 ds_read_b64_tr_b16 v[94:95], v8 offset:4608
 s_add_u32 m0, s53, 40960
 s_add_u32 s86, s86, 65536
 buffer_load_dwordx4 v1, s[4:7], s86 offen lds
 v_add_f32_dpp v13, v13, v13 row_shr:8 row_mask:0xf bank_mask:0xf
 s_waitcnt lgkmcnt(4)
 v_mfma_f32_16x16x32_bf16 v[16:19], v[192:195], v[80:83], v[16:19]
 s_setprio 1
 ds_read_b64_tr_b16 v[96:97], v9 offset:0
 v_mfma_f32_16x16x32_bf16 v[16:19], v[200:203], v[84:87], v[16:19]
 ds_read_b64_tr_b16 v[98:99], v9 offset:512
 v_mfma_f32_16x16x32_bf16 v[20:23], v[196:199], v[80:83], v[20:23]
 ds_read_b64_tr_b16 v[100:101], v9 offset:4096
 v_mfma_f32_16x16x32_bf16 v[20:23], v[204:207], v[84:87], v[20:23]
 s_setprio 0
 ds_read_b64_tr_b16 v[102:103], v9 offset:4608
 s_add_u32 m0, s53, 81920
 s_mul_i32 s88, s91, 196608
 buffer_load_dwordx4 v2, s[8:11], s88 offen lds
 v_add_f32_dpp v13, v13, v13 row_bcast:15 row_mask:0xa bank_mask:0xf
 s_waitcnt lgkmcnt(4)
 v_mfma_f32_16x16x32_bf16 v[24:27], v[192:195], v[88:91], v[24:27]
 s_setprio 1
 ds_read_b64_tr_b16 v[80:81], v10 offset:0
 v_mfma_f32_16x16x32_bf16 v[24:27], v[200:203], v[92:95], v[24:27]
 ds_read_b64_tr_b16 v[82:83], v10 offset:512
 v_mfma_f32_16x16x32_bf16 v[28:31], v[196:199], v[88:91], v[28:31]
 ds_read_b64_tr_b16 v[84:85], v10 offset:4096
 v_mfma_f32_16x16x32_bf16 v[28:31], v[204:207], v[92:95], v[28:31]
 s_setprio 0
 ds_read_b64_tr_b16 v[86:87], v10 offset:4608
 s_add_u32 m0, s53, 131072
 s_mul_i32 s89, s91, s61
 buffer_load_dwordx4 v3, s[12:15], s89 offen lds
 v_add_f32_dpp v13, v13, v13 row_bcast:31 row_mask:0xc bank_mask:0xf
 s_waitcnt lgkmcnt(4)
 v_mfma_f32_16x16x32_bf16 v[32:35], v[96:99], v[192:195], v[32:35]
 s_setprio 1
 ds_read_b64_tr_b16 v[88:89], v9 offset:8192
 v_mfma_f32_16x16x32_bf16 v[32:35], v[100:103], v[200:203], v[32:35]
 ds_read_b64_tr_b16 v[90:91], v9 offset:8704
 v_mfma_f32_16x16x32_bf16 v[36:39], v[96:99], v[196:199], v[36:39]
 ds_read_b64_tr_b16 v[92:93], v9 offset:12288
 v_mfma_f32_16x16x32_bf16 v[36:39], v[100:103], v[204:207], v[36:39]
 s_setprio 0
 ds_read_b64_tr_b16 v[94:95], v9 offset:12800
 s_add_u32 m0, s53, 139264
 s_add_u32 s89, s89, s87
 buffer_load_dwordx4 v3, s[16:19], s89 offen lds
 v_mul_f32 v13, 0x3fb8aa3b, v13
 v_or_b32 v13, 1, v13
 s_waitcnt lgkmcnt(4)
 v_mfma_f32_16x16x32_bf16 v[40:43], v[80:83], v[192:195], v[40:43]
 s_setprio 1
 ds_read_b64_tr_b16 v[96:97], v10 offset:8192
 v_mfma_f32_16x16x32_bf16 v[40:43], v[84:87], v[200:203], v[40:43]
 ds_read_b64_tr_b16 v[98:99], v10 offset:8704
 v_mfma_f32_16x16x32_bf16 v[44:47], v[80:83], v[196:199], v[44:47]
 ds_read_b64_tr_b16 v[100:101], v10 offset:12288
 v_mfma_f32_16x16x32_bf16 v[44:47], v[84:87], v[204:207], v[44:47]
 s_setprio 0
 ds_read_b64_tr_b16 v[102:103], v10 offset:12800
 s_cmp_lg_u32 s52, 0
 s_cbranch_scc1 L_s_4004
 s_waitcnt vmcnt(5)
 v_cmp_eq_u32 vcc, 0, v121
 s_nop 0
 s_cmp_lg_u64 vcc, 0
 s_cbranch_scc1 L_x_4005
L_r_4006:
L_s_4004:
 s_waitcnt vmcnt(5)
 s_barrier
 s_mov_b32 exec_lo, 0
 s_mov_b32 exec_hi, 0x80000000
 buffer_store_dword v13, v126, s[28:31], s65 offen sc1
 s_mov_b64 exec, -1
 s_waitcnt lgkmcnt(4)
 v_mfma_f32_16x16x32_bf16 v[48:51], v[88:91], v[192:195], v[48:51]
 s_setprio 1
 ds_read_b128 v[208:211], v5 offset:16384
 ds_read_b64_tr_b16 v[80:81], v7 offset:8192
 v_mfma_f32_16x16x32_bf16 v[48:51], v[92:95], v[200:203], v[48:51]
 ds_read_b128 v[212:215], v5 offset:18432
 ds_read_b64_tr_b16 v[82:83], v7 offset:8704
 v_mfma_f32_16x16x32_bf16 v[52:55], v[88:91], v[196:199], v[52:55]
 ds_read_b128 v[216:219], v6 offset:16384
 ds_read_b64_tr_b16 v[84:85], v7 offset:12288
 v_mfma_f32_16x16x32_bf16 v[52:55], v[92:95], v[204:207], v[52:55]
 s_setprio 0
 ds_read_b128 v[220:223], v6 offset:18432
 ds_read_b64_tr_b16 v[86:87], v7 offset:12800
 s_add_u32 s91, s60, 7
 s_and_b32 s91, s91, 7
 s_add_u32 m0, s53, 49152
 s_lshl_b32 s86, s91, 7
 buffer_load_dwordx4 v1, s[4:7], s86 offen lds
 s_waitcnt lgkmcnt(8)
 v_mfma_f32_16x16x32_bf16 v[56:59], v[96:99], v[192:195], v[56:59]
 s_setprio 1
 ds_read_b64_tr_b16 v[88:89], v8 offset:8192
 v_mfma_f32_16x16x32_bf16 v[56:59], v[100:103], v[200:203], v[56:59]
 ds_read_b64_tr_b16 v[90:91], v8 offset:8704
 v_mfma_f32_16x16x32_bf16 v[60:63], v[96:99], v[196:199], v[60:63]
 ds_read_b64_tr_b16 v[92:93], v8 offset:12288
 v_mfma_f32_16x16x32_bf16 v[60:63], v[100:103], v[204:207], v[60:63]
 s_setprio 0
 ds_read_b64_tr_b16 v[94:95], v8 offset:12800
 s_add_u32 m0, s53, 57344
 s_add_u32 s86, s86, 65536
 buffer_load_dwordx4 v1, s[4:7], s86 offen lds
 s_waitcnt lgkmcnt(4)
 v_mfma_f32_16x16x32_bf16 v[16:19], v[208:211], v[80:83], v[16:19]
 s_setprio 1
 ds_read_b64_tr_b16 v[96:97], v9 offset:16384
 v_mfma_f32_16x16x32_bf16 v[16:19], v[216:219], v[84:87], v[16:19]
 ds_read_b64_tr_b16 v[98:99], v9 offset:16896
 v_mfma_f32_16x16x32_bf16 v[20:23], v[212:215], v[80:83], v[20:23]
 ds_read_b64_tr_b16 v[100:101], v9 offset:20480
 v_mfma_f32_16x16x32_bf16 v[20:23], v[220:223], v[84:87], v[20:23]
 s_setprio 0
 ds_read_b64_tr_b16 v[102:103], v9 offset:20992
 s_add_u32 m0, s53, 90112
 s_mul_i32 s88, s91, 196608
 buffer_load_dwordx4 v2, s[8:11], s88 offen lds
 s_waitcnt lgkmcnt(4)
 v_mfma_f32_16x16x32_bf16 v[24:27], v[208:211], v[88:91], v[24:27]
 s_setprio 1
 ds_read_b64_tr_b16 v[80:81], v10 offset:16384
 v_mfma_f32_16x16x32_bf16 v[24:27], v[216:219], v[92:95], v[24:27]
 ds_read_b64_tr_b16 v[82:83], v10 offset:16896
 v_mfma_f32_16x16x32_bf16 v[28:31], v[212:215], v[88:91], v[28:31]
 ds_read_b64_tr_b16 v[84:85], v10 offset:20480
 v_mfma_f32_16x16x32_bf16 v[28:31], v[220:223], v[92:95], v[28:31]
 s_setprio 0
 ds_read_b64_tr_b16 v[86:87], v10 offset:20992
 s_add_u32 m0, s53, 147456
 s_mul_i32 s89, s91, s61
 buffer_load_dwordx4 v3, s[12:15], s89 offen lds
 s_waitcnt lgkmcnt(4)
 v_mfma_f32_16x16x32_bf16 v[32:35], v[96:99], v[208:211], v[32:35]
 s_setprio 1
 ds_read_b64_tr_b16 v[88:89], v9 offset:24576
 v_mfma_f32_16x16x32_bf16 v[32:35], v[100:103], v[216:219], v[32:35]
 ds_read_b64_tr_b16 v[90:91], v9 offset:25088
 v_mfma_f32_16x16x32_bf16 v[36:39], v[96:99], v[212:215], v[36:39]
 ds_read_b64_tr_b16 v[92:93], v9 offset:28672
 v_mfma_f32_16x16x32_bf16 v[36:39], v[100:103], v[220:223], v[36:39]
 s_setprio 0
 ds_read_b64_tr_b16 v[94:95], v9 offset:29184
 s_add_u32 m0, s53, 155648
 s_add_u32 s89, s89, s87
 buffer_load_dwordx4 v3, s[16:19], s89 offen lds
 s_waitcnt lgkmcnt(4)
 v_mfma_f32_16x16x32_bf16 v[40:43], v[80:83], v[208:211], v[40:43]
 s_setprio 1
 ds_read_b64_tr_b16 v[96:97], v10 offset:24576
 v_mfma_f32_16x16x32_bf16 v[40:43], v[84:87], v[216:219], v[40:43]
 ds_read_b64_tr_b16 v[98:99], v10 offset:25088
 v_mfma_f32_16x16x32_bf16 v[44:47], v[80:83], v[212:215], v[44:47]
 ds_read_b64_tr_b16 v[100:101], v10 offset:28672
 v_mfma_f32_16x16x32_bf16 v[44:47], v[84:87], v[220:223], v[44:47]
 s_setprio 0
 ds_read_b64_tr_b16 v[102:103], v10 offset:29184
 s_waitcnt vmcnt(6)
 s_barrier
 s_waitcnt lgkmcnt(4)
 v_mfma_f32_16x16x32_bf16 v[48:51], v[88:91], v[208:211], v[48:51]
 s_setprio 1
 ds_read_b128 v[224:227], v5 offset:32768
 ds_read_b64_tr_b16 v[80:81], v7 offset:16384
 v_mfma_f32_16x16x32_bf16 v[48:51], v[92:95], v[216:219], v[48:51]
 ds_read_b128 v[228:231], v5 offset:34816
 ds_read_b64_tr_b16 v[82:83], v7 offset:16896
 v_mfma_f32_16x16x32_bf16 v[52:55], v[88:91], v[212:215], v[52:55]
 ds_read_b128 v[232:235], v6 offset:32768
 ds_read_b64_tr_b16 v[84:85], v7 offset:20480
 v_mfma_f32_16x16x32_bf16 v[52:55], v[92:95], v[220:223], v[52:55]
 s_setprio 0
 ds_read_b128 v[236:239], v6 offset:34816
 ds_read_b64_tr_b16 v[86:87], v7 offset:20992
 s_add_u32 s91, s60, 0
 s_and_b32 s91, s91, 7
 s_add_u32 m0, s53, 98304
 s_mul_i32 s90, s91, 229376
 buffer_load_dwordx4 v4, s[20:23], s90 offen lds
 s_waitcnt lgkmcnt(8)
 v_mfma_f32_16x16x32_bf16 v[56:59], v[96:99], v[208:211], v[56:59]
 s_setprio 1
 ds_read_b64_tr_b16 v[88:89], v8 offset:16384
 v_mfma_f32_16x16x32_bf16 v[56:59], v[100:103], v[216:219], v[56:59]
 ds_read_b64_tr_b16 v[90:91], v8 offset:16896
 v_mfma_f32_16x16x32_bf16 v[60:63], v[96:99], v[212:215], v[60:63]
 ds_read_b64_tr_b16 v[92:93], v8 offset:20480
 v_mfma_f32_16x16x32_bf16 v[60:63], v[100:103], v[220:223], v[60:63]
 s_setprio 0
 ds_read_b64_tr_b16 v[94:95], v8 offset:20992
 s_add_u32 m0, s53, 106496
 s_nop 0
 buffer_load_dwordx4 v4, s[24:27], s90 offen lds
 s_waitcnt lgkmcnt(4)
 v_mfma_f32_16x16x32_bf16 v[16:19], v[224:227], v[80:83], v[16:19]
 s_setprio 1
 ds_read_b64_tr_b16 v[96:97], v9 offset:32768
 v_mfma_f32_16x16x32_bf16 v[16:19], v[232:235], v[84:87], v[16:19]
 ds_read_b64_tr_b16 v[98:99], v9 offset:33280
 v_mfma_f32_16x16x32_bf16 v[20:23], v[228:231], v[80:83], v[20:23]
 ds_read_b64_tr_b16 v[100:101], v9 offset:36864
 v_mfma_f32_16x16x32_bf16 v[20:23], v[236:239], v[84:87], v[20:23]
 s_setprio 0
 ds_read_b64_tr_b16 v[102:103], v9 offset:37376
 s_add_u32 s91, s60, 1
 s_and_b32 s91, s91, 7
 s_add_u32 m0, s53, 0
 s_mul_i32 s90, s91, 229376
 buffer_load_dwordx4 v4, s[20:23], s90 offen lds
 s_waitcnt lgkmcnt(4)
 v_mfma_f32_16x16x32_bf16 v[24:27], v[224:227], v[88:91], v[24:27]
 s_setprio 1
 ds_read_b64_tr_b16 v[80:81], v10 offset:32768
 v_mfma_f32_16x16x32_bf16 v[24:27], v[232:235], v[92:95], v[24:27]
 ds_read_b64_tr_b16 v[82:83], v10 offset:33280
 v_mfma_f32_16x16x32_bf16 v[28:31], v[228:231], v[88:91], v[28:31]
 ds_read_b64_tr_b16 v[84:85], v10 offset:36864
 v_mfma_f32_16x16x32_bf16 v[28:31], v[236:239], v[92:95], v[28:31]
 s_setprio 0
 ds_read_b64_tr_b16 v[86:87], v10 offset:37376
 s_add_u32 m0, s53, 8192
 s_nop 0
 buffer_load_dwordx4 v4, s[24:27], s90 offen lds
 s_waitcnt vmcnt(4)
 s_barrier
 s_waitcnt lgkmcnt(4)
 v_mfma_f32_16x16x32_bf16 v[32:35], v[96:99], v[224:227], v[32:35]
 s_setprio 1
 ds_read_b128 v[240:243], v5 offset:49152
 ds_read_b64_tr_b16 v[88:89], v7 offset:24576
 v_mfma_f32_16x16x32_bf16 v[32:35], v[100:103], v[232:235], v[32:35]
 ds_read_b128 v[244:247], v5 offset:51200
 ds_read_b64_tr_b16 v[90:91], v7 offset:25088
 v_mfma_f32_16x16x32_bf16 v[36:39], v[96:99], v[228:231], v[36:39]
 ds_read_b128 v[248:251], v6 offset:49152
 ds_read_b64_tr_b16 v[92:93], v7 offset:28672
 v_mfma_f32_16x16x32_bf16 v[36:39], v[100:103], v[236:239], v[36:39]
 s_setprio 0
 ds_read_b128 v[252:255], v6 offset:51200
 ds_read_b64_tr_b16 v[94:95], v7 offset:29184
 s_add_u32 s91, s60, 2
 s_and_b32 s91, s91, 7
 s_add_u32 m0, s53, 114688
 s_mul_i32 s90, s91, 229376
 buffer_load_dwordx4 v4, s[20:23], s90 offen lds
 s_waitcnt lgkmcnt(8)
 v_mfma_f32_16x16x32_bf16 v[40:43], v[80:83], v[224:227], v[40:43]
 s_setprio 1
 ds_read_b64_tr_b16 v[96:97], v8 offset:24576
 v_mfma_f32_16x16x32_bf16 v[40:43], v[84:87], v[232:235], v[40:43]
 ds_read_b64_tr_b16 v[98:99], v8 offset:25088
 v_mfma_f32_16x16x32_bf16 v[44:47], v[80:83], v[228:231], v[44:47]
 ds_read_b64_tr_b16 v[100:101], v8 offset:28672
 v_mfma_f32_16x16x32_bf16 v[44:47], v[84:87], v[236:239], v[44:47]
 s_setprio 0
 ds_read_b64_tr_b16 v[102:103], v8 offset:29184
 s_add_u32 m0, s53, 122880
 s_nop 0
 buffer_load_dwordx4 v4, s[24:27], s90 offen lds
 buffer_load_dword v14, v119, s[28:31], 0 offen sc1
 buffer_load_dword v15, v119, s[28:31], 0 offen offset:64 sc1
 s_waitcnt lgkmcnt(4)
 v_mfma_f32_16x16x32_bf16 v[16:19], v[240:243], v[88:91], v[16:19]
 s_setprio 1
 ds_read_b64_tr_b16 v[80:81], v9 offset:49152
 v_mfma_f32_16x16x32_bf16 v[16:19], v[248:251], v[92:95], v[16:19]
 ds_read_b64_tr_b16 v[82:83], v9 offset:49664
 v_mfma_f32_16x16x32_bf16 v[20:23], v[244:247], v[88:91], v[20:23]
 ds_read_b64_tr_b16 v[84:85], v9 offset:53248
 v_mfma_f32_16x16x32_bf16 v[20:23], v[252:255], v[92:95], v[20:23]
 s_setprio 0
 ds_read_b64_tr_b16 v[86:87], v9 offset:53760
 s_add_u32 s91, s60, 3
 s_and_b32 s91, s91, 7
 s_add_u32 m0, s53, 16384
 s_mul_i32 s90, s91, 229376
 buffer_load_dwordx4 v4, s[20:23], s90 offen lds
 s_waitcnt lgkmcnt(4)
 v_mfma_f32_16x16x32_bf16 v[24:27], v[240:243], v[96:99], v[24:27]
 s_setprio 1
 ds_read_b64_tr_b16 v[88:89], v10 offset:49152
 v_mfma_f32_16x16x32_bf16 v[24:27], v[248:251], v[100:103], v[24:27]
 ds_read_b64_tr_b16 v[90:91], v10 offset:49664
 v_mfma_f32_16x16x32_bf16 v[28:31], v[244:247], v[96:99], v[28:31]
 ds_read_b64_tr_b16 v[92:93], v10 offset:53248
 v_mfma_f32_16x16x32_bf16 v[28:31], v[252:255], v[100:103], v[28:31]
 s_setprio 0
 ds_read_b64_tr_b16 v[94:95], v10 offset:53760
 s_add_u32 m0, s53, 24576
 s_nop 0
 buffer_load_dwordx4 v4, s[24:27], s90 offen lds
 s_waitcnt lgkmcnt(4)
 v_mfma_f32_16x16x32_bf16 v[32:35], v[80:83], v[240:243], v[32:35]
 s_setprio 1
 ds_read_b64_tr_b16 v[96:97], v9 offset:40960
 v_mfma_f32_16x16x32_bf16 v[32:35], v[84:87], v[248:251], v[32:35]
 ds_read_b64_tr_b16 v[98:99], v9 offset:41472
 v_mfma_f32_16x16x32_bf16 v[36:39], v[80:83], v[244:247], v[36:39]
 ds_read_b64_tr_b16 v[100:101], v9 offset:45056
 v_mfma_f32_16x16x32_bf16 v[36:39], v[84:87], v[252:255], v[36:39]
 s_setprio 0
 ds_read_b64_tr_b16 v[102:103], v9 offset:45568
 s_lshl_b32 s67, s57, 1
 s_add_u32 s67, s67, s94
 s_lshl_b32 s67, s67, 18
 s_lshl_b32 s68, s95, 11
 s_add_u32 s67, s67, s68
 s_sub_u32 s67, s67, 1047552
 s_add_u32 s68, s67, 131072
 v_cvt_pk_bf16_f32 v104, v16, v17
 v_cvt_pk_bf16_f32 v105, v18, v19
 v_cvt_pk_bf16_f32 v106, v20, v21
 s_waitcnt lgkmcnt(4)
 v_mfma_f32_16x16x32_bf16 v[40:43], v[88:91], v[240:243], v[40:43]
 s_setprio 1
 ds_read_b64_tr_b16 v[80:81], v9 offset:57344
 v_mfma_f32_16x16x32_bf16 v[40:43], v[92:95], v[248:251], v[40:43]
 ds_read_b64_tr_b16 v[82:83], v9 offset:57856
 v_mfma_f32_16x16x32_bf16 v[44:47], v[88:91], v[244:247], v[44:47]
 ds_read_b64_tr_b16 v[84:85], v9 offset:61440
 v_mfma_f32_16x16x32_bf16 v[44:47], v[92:95], v[252:255], v[44:47]
 s_setprio 0
 ds_read_b64_tr_b16 v[86:87], v9 offset:61952
 v_cvt_pk_bf16_f32 v107, v22, v23
 v_cvt_pk_bf16_f32 v108, v24, v25
 v_cvt_pk_bf16_f32 v109, v26, v27
 v_cvt_pk_bf16_f32 v110, v28, v29
 v_cvt_pk_bf16_f32 v111, v30, v31
 buffer_store_dwordx4 v[104:107], v126, s[28:31], s67 offen offset:0 sc1
 s_waitcnt lgkmcnt(4)
 v_mfma_f32_16x16x32_bf16 v[48:51], v[96:99], v[224:227], v[48:51]
 s_setprio 1
 ds_read_b64_tr_b16 v[88:89], v10 offset:40960
 v_mfma_f32_16x16x32_bf16 v[48:51], v[100:103], v[232:235], v[48:51]
 ds_read_b64_tr_b16 v[90:91], v10 offset:41472
 v_mfma_f32_16x16x32_bf16 v[52:55], v[96:99], v[228:231], v[52:55]
 ds_read_b64_tr_b16 v[92:93], v10 offset:45056
 v_mfma_f32_16x16x32_bf16 v[52:55], v[100:103], v[236:239], v[52:55]
 s_setprio 0
 ds_read_b64_tr_b16 v[94:95], v10 offset:45568
 buffer_store_dwordx4 v[108:111], v126, s[28:31], s68 offen offset:0 sc1
 s_waitcnt lgkmcnt(4)
 v_mfma_f32_16x16x32_bf16 v[48:51], v[80:83], v[240:243], v[48:51]
 s_setprio 1
 ds_read_b64_tr_b16 v[96:97], v10 offset:57344
 v_mfma_f32_16x16x32_bf16 v[48:51], v[84:87], v[248:251], v[48:51]
 ds_read_b64_tr_b16 v[98:99], v10 offset:57856
 v_mfma_f32_16x16x32_bf16 v[52:55], v[80:83], v[244:247], v[52:55]
 ds_read_b64_tr_b16 v[100:101], v10 offset:61440
 v_mfma_f32_16x16x32_bf16 v[52:55], v[84:87], v[252:255], v[52:55]
 s_setprio 0
 ds_read_b64_tr_b16 v[102:103], v10 offset:61952
 s_waitcnt vmcnt(2) lgkmcnt(4)
 s_barrier
 v_mfma_f32_16x16x32_bf16 v[56:59], v[88:91], v[224:227], v[56:59]
 s_setprio 1
 ds_read_b64_tr_b16 v[80:81], v9 offset:0
 v_mfma_f32_16x16x32_bf16 v[56:59], v[92:95], v[232:235], v[56:59]
 ds_read_b64_tr_b16 v[82:83], v9 offset:512
 v_mfma_f32_16x16x32_bf16 v[60:63], v[88:91], v[228:231], v[60:63]
 ds_read_b64_tr_b16 v[84:85], v9 offset:4096
 v_mfma_f32_16x16x32_bf16 v[60:63], v[92:95], v[236:239], v[60:63]
 s_setprio 0
 ds_read_b64_tr_b16 v[86:87], v9 offset:4608
 s_add_u32 s91, s60, 4
 s_and_b32 s91, s91, 7
 s_add_u32 m0, s53, 131072
 s_mul_i32 s90, s91, 229376
 buffer_load_dwordx4 v4, s[20:23], s90 offen lds
 s_waitcnt lgkmcnt(4)
 v_mfma_f32_16x16x32_bf16 v[56:59], v[96:99], v[240:243], v[56:59]
 s_setprio 1
 ds_read_b64_tr_b16 v[88:89], v10 offset:0
 v_mfma_f32_16x16x32_bf16 v[56:59], v[100:103], v[248:251], v[56:59]
 ds_read_b64_tr_b16 v[90:91], v10 offset:512
 v_mfma_f32_16x16x32_bf16 v[60:63], v[96:99], v[244:247], v[60:63]
 ds_read_b64_tr_b16 v[92:93], v10 offset:4096
 v_mfma_f32_16x16x32_bf16 v[60:63], v[100:103], v[252:255], v[60:63]
 s_setprio 0
 ds_read_b64_tr_b16 v[94:95], v10 offset:4608
 s_add_u32 m0, s53, 139264
 s_nop 0
 buffer_load_dwordx4 v4, s[24:27], s90 offen lds
 s_waitcnt lgkmcnt(4)
 v_mfma_f32_16x16x32_bf16 v[16:19], v[80:83], v[128:131], 0
 s_setprio 1
 ds_read_b64_tr_b16 v[96:97], v9 offset:8192
 v_mfma_f32_16x16x32_bf16 v[16:19], v[84:87], v[136:139], v[16:19]
 ds_read_b64_tr_b16 v[98:99], v9 offset:8704
 v_mfma_f32_16x16x32_bf16 v[20:23], v[80:83], v[132:135], 0
 ds_read_b64_tr_b16 v[100:101], v9 offset:12288
 v_mfma_f32_16x16x32_bf16 v[20:23], v[84:87], v[140:143], v[20:23]
 s_setprio 0
 ds_read_b64_tr_b16 v[102:103], v9 offset:12800
 s_add_u32 s91, s60, 5
 s_and_b32 s91, s91, 7
 s_add_u32 m0, s53, 32768
 s_mul_i32 s90, s91, 229376
 buffer_load_dwordx4 v4, s[20:23], s90 offen lds
 v_min_u32 v13, v14, v15
 v_cmp_eq_u32 vcc, 0, v13
 s_nop 0
 s_cmp_lg_u64 vcc, 0
 s_cbranch_scc1 L_x_4008
L_r_4009:
 v_exp_f32 v14, v14
 v_exp_f32 v15, v15
 v_add_f32 v14, 1.0, v14
 v_add_f32 v15, 1.0, v15
 v_min_f32 v14, 0x71800000, v14
 v_min_f32 v15, 0x71800000, v15
 s_waitcnt lgkmcnt(4)
 v_mfma_f32_16x16x32_bf16 v[24:27], v[88:91], v[128:131], 0
 s_setprio 1
 ds_read_b64_tr_b16 v[80:81], v10 offset:8192
 v_mfma_f32_16x16x32_bf16 v[24:27], v[92:95], v[136:139], v[24:27]
 ds_read_b64_tr_b16 v[82:83], v10 offset:8704
 v_mfma_f32_16x16x32_bf16 v[28:31], v[88:91], v[132:135], 0
 ds_read_b64_tr_b16 v[84:85], v10 offset:12288
 v_mfma_f32_16x16x32_bf16 v[28:31], v[92:95], v[140:143], v[28:31]
 s_setprio 0
 ds_read_b64_tr_b16 v[86:87], v10 offset:12800
 s_add_u32 m0, s53, 40960
 s_nop 0
 buffer_load_dwordx4 v4, s[24:27], s90 offen lds
 s_lshl_b32 s67, s59, 2
 s_add_u32 s67, s67, s94
 s_lshl_b32 s67, s67, 17
 s_lshl_b32 s68, s95, 10
 s_add_u32 s67, s67, s68
 s_add_u32 s67, s67, 1048576
 v_cvt_pk_bf16_f32 v104, v32, v33
 s_waitcnt lgkmcnt(4)
 v_mfma_f32_16x16x32_bf16 v[64:67], v[96:99], v[128:131], 0
 s_setprio 1
 ds_read_b64_tr_b16 v[88:89], v11 offset:0
 v_mfma_f32_16x16x32_bf16 v[64:67], v[100:103], v[136:139], v[64:67]
 ds_read_b64_tr_b16 v[90:91], v11 offset:512
 v_mfma_f32_16x16x32_bf16 v[68:71], v[96:99], v[132:135], 0
 ds_read_b64_tr_b16 v[92:93], v11 offset:4096
 v_mfma_f32_16x16x32_bf16 v[68:71], v[100:103], v[140:143], v[68:71]
 s_setprio 0
 ds_read_b64_tr_b16 v[94:95], v11 offset:4608
 v_cvt_pk_bf16_f32 v105, v34, v35
 v_cvt_pk_bf16_f32 v106, v36, v37
 v_cvt_pk_bf16_f32 v107, v38, v39
 s_add_u32 s68, s67, 0
 v_permlane16_swap_b32 v104, v106
 v_permlane16_swap_b32 v105, v107
 v_min_u32 v104, -2, v104
 v_min_u32 v105, -2, v105
 s_waitcnt lgkmcnt(4)
 v_mfma_f32_16x16x32_bf16 v[72:75], v[80:83], v[128:131], 0
 s_setprio 1
 ds_read_b64_tr_b16 v[96:97], v12 offset:0
 v_mfma_f32_16x16x32_bf16 v[72:75], v[84:87], v[136:139], v[72:75]
 ds_read_b64_tr_b16 v[98:99], v12 offset:512
 v_mfma_f32_16x16x32_bf16 v[76:79], v[80:83], v[132:135], 0
 ds_read_b64_tr_b16 v[100:101], v12 offset:4096
 v_mfma_f32_16x16x32_bf16 v[76:79], v[84:87], v[140:143], v[76:79]
 s_setprio 0
 ds_read_b64_tr_b16 v[102:103], v12 offset:4608
 v_min_u32 v106, -2, v106
 v_min_u32 v107, -2, v107
 buffer_store_dwordx4 v[104:107], v126, s[28:31], s68 offen offset:0 sc1
 v_cvt_pk_bf16_f32 v108, v40, v41
 v_cvt_pk_bf16_f32 v109, v42, v43
 s_waitcnt lgkmcnt(4)
 v_mfma_f32_16x16x32_bf16 v[16:19], v[88:91], v[144:147], v[16:19]
 s_setprio 1
 ds_read_b64_tr_b16 v[80:81], v11 offset:8192
 v_mfma_f32_16x16x32_bf16 v[16:19], v[92:95], v[152:155], v[16:19]
 ds_read_b64_tr_b16 v[82:83], v11 offset:8704
 v_mfma_f32_16x16x32_bf16 v[20:23], v[88:91], v[148:151], v[20:23]
 ds_read_b64_tr_b16 v[84:85], v11 offset:12288
 v_mfma_f32_16x16x32_bf16 v[20:23], v[92:95], v[156:159], v[20:23]
 s_setprio 0
 ds_read_b64_tr_b16 v[86:87], v11 offset:12800
 v_cvt_pk_bf16_f32 v110, v44, v45
 v_cvt_pk_bf16_f32 v111, v46, v47
 s_add_u32 s68, s67, 65536
 v_permlane16_swap_b32 v108, v110
 v_permlane16_swap_b32 v109, v111
 v_min_u32 v108, -2, v108
 v_min_u32 v109, -2, v109
 v_min_u32 v110, -2, v110
 s_waitcnt lgkmcnt(4)
 v_mfma_f32_16x16x32_bf16 v[24:27], v[96:99], v[144:147], v[24:27]
 s_setprio 1
 ds_read_b64_tr_b16 v[88:89], v12 offset:8192
 v_mfma_f32_16x16x32_bf16 v[24:27], v[100:103], v[152:155], v[24:27]
 ds_read_b64_tr_b16 v[90:91], v12 offset:8704
 v_mfma_f32_16x16x32_bf16 v[28:31], v[96:99], v[148:151], v[28:31]
 ds_read_b64_tr_b16 v[92:93], v12 offset:12288
 v_mfma_f32_16x16x32_bf16 v[28:31], v[100:103], v[156:159], v[28:31]
 s_setprio 0
 ds_read_b64_tr_b16 v[94:95], v12 offset:12800
 v_min_u32 v111, -2, v111
 buffer_store_dwordx4 v[108:111], v126, s[28:31], s68 offen offset:0 sc1
 v_cvt_pk_bf16_f32 v104, v48, v49
 v_cvt_pk_bf16_f32 v105, v50, v51
 v_cvt_pk_bf16_f32 v106, v52, v53
 s_waitcnt lgkmcnt(4)
 v_mfma_f32_16x16x32_bf16 v[64:67], v[80:83], v[144:147], v[64:67]
 s_setprio 1
 ds_read_b64_tr_b16 v[96:97], v9 offset:16384
 v_mfma_f32_16x16x32_bf16 v[64:67], v[84:87], v[152:155], v[64:67]
 ds_read_b64_tr_b16 v[98:99], v9 offset:16896
 v_mfma_f32_16x16x32_bf16 v[68:71], v[80:83], v[148:151], v[68:71]
 ds_read_b64_tr_b16 v[100:101], v9 offset:20480
 v_mfma_f32_16x16x32_bf16 v[68:71], v[84:87], v[156:159], v[68:71]
 s_setprio 0
 ds_read_b64_tr_b16 v[102:103], v9 offset:20992
 v_cvt_pk_bf16_f32 v107, v54, v55
 s_add_u32 s68, s67, 262144
 v_permlane16_swap_b32 v104, v106
 v_permlane16_swap_b32 v105, v107
 v_min_u32 v104, -2, v104
 v_min_u32 v105, -2, v105
 v_min_u32 v106, -2, v106
 v_min_u32 v107, -2, v107
 s_waitcnt lgkmcnt(4)
 v_mfma_f32_16x16x32_bf16 v[72:75], v[88:91], v[144:147], v[72:75]
 s_setprio 1
 ds_read_b64_tr_b16 v[80:81], v10 offset:16384
 v_mfma_f32_16x16x32_bf16 v[72:75], v[92:95], v[152:155], v[72:75]
 ds_read_b64_tr_b16 v[82:83], v10 offset:16896
 v_mfma_f32_16x16x32_bf16 v[76:79], v[88:91], v[148:151], v[76:79]
 ds_read_b64_tr_b16 v[84:85], v10 offset:20480
 v_mfma_f32_16x16x32_bf16 v[76:79], v[92:95], v[156:159], v[76:79]
 s_setprio 0
 ds_read_b64_tr_b16 v[86:87], v10 offset:20992
 buffer_store_dwordx4 v[104:107], v126, s[28:31], s68 offen offset:0 sc1
 v_cvt_pk_bf16_f32 v108, v56, v57
 v_cvt_pk_bf16_f32 v109, v58, v59
 v_cvt_pk_bf16_f32 v110, v60, v61
 v_cvt_pk_bf16_f32 v111, v62, v63
 s_waitcnt lgkmcnt(4)
 v_mfma_f32_16x16x32_bf16 v[16:19], v[96:99], v[160:163], v[16:19]
 s_setprio 1
 ds_read_b64_tr_b16 v[88:89], v9 offset:24576
 v_mfma_f32_16x16x32_bf16 v[16:19], v[100:103], v[168:171], v[16:19]
 ds_read_b64_tr_b16 v[90:91], v9 offset:25088
 v_mfma_f32_16x16x32_bf16 v[20:23], v[96:99], v[164:167], v[20:23]
 ds_read_b64_tr_b16 v[92:93], v9 offset:28672
 v_mfma_f32_16x16x32_bf16 v[20:23], v[100:103], v[172:175], v[20:23]
 s_setprio 0
 ds_read_b64_tr_b16 v[94:95], v9 offset:29184
 s_add_u32 s68, s67, 327680
 v_permlane16_swap_b32 v108, v110
 v_permlane16_swap_b32 v109, v111
 v_min_u32 v108, -2, v108
 v_min_u32 v109, -2, v109
 v_min_u32 v110, -2, v110
 v_min_u32 v111, -2, v111
 buffer_store_dwordx4 v[108:111], v126, s[28:31], s68 offen offset:0 sc1
 s_waitcnt vmcnt(4)
 s_barrier
 s_cmp_lg_u32 s52, 0
 s_cbranch_scc1 L_s_4011
 s_lshl_b32 s62, s57, 7
 s_lshl_b32 s63, s56, 2
 s_add_u32 s62, s62, s63
 s_mov_b64 exec, 1
 buffer_store_dword v112, v126, s[28:31], s62 offen sc1
 s_mov_b64 exec, -1
L_s_4011:
 s_waitcnt lgkmcnt(4)
 v_mfma_f32_16x16x32_bf16 v[24:27], v[80:83], v[160:163], v[24:27]
 s_setprio 1
 ds_read_b64_tr_b16 v[96:97], v10 offset:24576
 v_mfma_f32_16x16x32_bf16 v[24:27], v[84:87], v[168:171], v[24:27]
 ds_read_b64_tr_b16 v[98:99], v10 offset:25088
 v_mfma_f32_16x16x32_bf16 v[28:31], v[80:83], v[164:167], v[28:31]
 ds_read_b64_tr_b16 v[100:101], v10 offset:28672
 v_mfma_f32_16x16x32_bf16 v[28:31], v[84:87], v[172:175], v[28:31]
 s_setprio 0
 ds_read_b64_tr_b16 v[102:103], v10 offset:29184
 s_add_u32 s91, s60, 6
 s_and_b32 s91, s91, 7
 s_add_u32 m0, s53, 147456
 s_mul_i32 s90, s91, 229376
 buffer_load_dwordx4 v4, s[20:23], s90 offen lds
 s_waitcnt lgkmcnt(4)
 v_mfma_f32_16x16x32_bf16 v[64:67], v[88:91], v[160:163], v[64:67]
 s_setprio 1
 ds_read_b64_tr_b16 v[80:81], v11 offset:16384
 v_mfma_f32_16x16x32_bf16 v[64:67], v[92:95], v[168:171], v[64:67]
 ds_read_b64_tr_b16 v[82:83], v11 offset:16896
 v_mfma_f32_16x16x32_bf16 v[68:71], v[88:91], v[164:167], v[68:71]
 ds_read_b64_tr_b16 v[84:85], v11 offset:20480
 v_mfma_f32_16x16x32_bf16 v[68:71], v[92:95], v[172:175], v[68:71]
 s_setprio 0
 ds_read_b64_tr_b16 v[86:87], v11 offset:20992
 s_add_u32 m0, s53, 155648
 s_nop 0
 buffer_load_dwordx4 v4, s[24:27], s90 offen lds
 s_waitcnt lgkmcnt(4)
 v_mfma_f32_16x16x32_bf16 v[72:75], v[96:99], v[160:163], v[72:75]
 s_setprio 1
 ds_read_b64_tr_b16 v[88:89], v12 offset:16384
 v_mfma_f32_16x16x32_bf16 v[72:75], v[100:103], v[168:171], v[72:75]
 ds_read_b64_tr_b16 v[90:91], v12 offset:16896
 v_mfma_f32_16x16x32_bf16 v[76:79], v[96:99], v[164:167], v[76:79]
 ds_read_b64_tr_b16 v[92:93], v12 offset:20480
 v_mfma_f32_16x16x32_bf16 v[76:79], v[100:103], v[172:175], v[76:79]
 s_setprio 0
 ds_read_b64_tr_b16 v[94:95], v12 offset:20992
 s_add_u32 s91, s60, 7
 s_and_b32 s91, s91, 7
 s_add_u32 m0, s53, 49152
 s_mul_i32 s90, s91, 229376
 buffer_load_dwordx4 v4, s[20:23], s90 offen lds
 s_waitcnt lgkmcnt(4)
 v_mfma_f32_16x16x32_bf16 v[16:19], v[80:83], v[176:179], v[16:19]
 s_setprio 1
 ds_read_b64_tr_b16 v[96:97], v11 offset:24576
 v_mfma_f32_16x16x32_bf16 v[16:19], v[84:87], v[184:187], v[16:19]
 ds_read_b64_tr_b16 v[98:99], v11 offset:25088
 v_mfma_f32_16x16x32_bf16 v[20:23], v[80:83], v[180:183], v[20:23]
 ds_read_b64_tr_b16 v[100:101], v11 offset:28672
 v_mfma_f32_16x16x32_bf16 v[20:23], v[84:87], v[188:191], v[20:23]
 s_setprio 0
 ds_read_b64_tr_b16 v[102:103], v11 offset:29184
 s_add_u32 m0, s53, 57344
 s_nop 0
 buffer_load_dwordx4 v4, s[24:27], s90 offen lds
 v_and_b32 v129, 0x1b, v0
 v_cmp_eq_u32 vcc, 16, v129
 v_mov_b32 v129, 0x3f803f80
 s_nop 0
 v_cndmask_b32 v128, 0, v129, vcc
 s_waitcnt lgkmcnt(4)
 v_mfma_f32_16x16x32_bf16 v[24:27], v[88:91], v[176:179], v[24:27]
 s_setprio 1
 ds_read_b64_tr_b16 v[80:81], v12 offset:24576
 v_mfma_f32_16x16x32_bf16 v[24:27], v[92:95], v[184:187], v[24:27]
 ds_read_b64_tr_b16 v[82:83], v12 offset:25088
 v_mfma_f32_16x16x32_bf16 v[28:31], v[88:91], v[180:183], v[28:31]
 ds_read_b64_tr_b16 v[84:85], v12 offset:28672
 v_mfma_f32_16x16x32_bf16 v[28:31], v[92:95], v[188:191], v[28:31]
 s_setprio 0
 ds_read_b64_tr_b16 v[86:87], v12 offset:29184
 v_mov_b32 v129, v128
 v_mov_b32 v130, v128
 v_mov_b32 v131, v128
 v_mov_b32 v132, v128
 v_mov_b32 v133, v128
 v_mov_b32 v134, v128
 v_mov_b32 v135, v128
 v_mov_b32 v136, v128
 v_mov_b32 v137, v128
 s_waitcnt lgkmcnt(4)
 v_mfma_f32_16x16x32_bf16 v[64:67], v[96:99], v[176:179], v[64:67]
 s_setprio 1
 ds_read_b64_tr_b16 v[88:89], v9 offset:32768
 v_mfma_f32_16x16x32_bf16 v[64:67], v[100:103], v[184:187], v[64:67]
 ds_read_b64_tr_b16 v[90:91], v9 offset:33280
 v_mfma_f32_16x16x32_bf16 v[68:71], v[96:99], v[180:183], v[68:71]
 ds_read_b64_tr_b16 v[92:93], v9 offset:36864
 v_mfma_f32_16x16x32_bf16 v[68:71], v[100:103], v[188:191], v[68:71]
 s_setprio 0
 ds_read_b64_tr_b16 v[94:95], v9 offset:37376
 v_mov_b32 v138, v128
 v_mov_b32 v139, v128
 v_mov_b32 v140, v128
 v_mov_b32 v141, v128
 v_mov_b32 v142, v128
 v_mov_b32 v143, v128
 v_mov_b32 v152, 0
 v_mov_b32 v153, 0
 v_mov_b32 v154, 0
 s_waitcnt lgkmcnt(4)
 v_mfma_f32_16x16x32_bf16 v[72:75], v[80:83], v[176:179], v[72:75]
 s_setprio 1
 ds_read_b64_tr_b16 v[96:97], v10 offset:32768
 v_mfma_f32_16x16x32_bf16 v[72:75], v[84:87], v[184:187], v[72:75]
 ds_read_b64_tr_b16 v[98:99], v10 offset:33280
 v_mfma_f32_16x16x32_bf16 v[76:79], v[80:83], v[180:183], v[76:79]
 ds_read_b64_tr_b16 v[100:101], v10 offset:36864
 v_mfma_f32_16x16x32_bf16 v[76:79], v[84:87], v[188:191], v[76:79]
 s_setprio 0
 ds_read_b64_tr_b16 v[102:103], v10 offset:37376
 v_mov_b32 v155, 0
 v_xor_b32 v1, 32, v124
 v_xor_b32 v2, 64, v124
 v_xor_b32 v3, 96, v124
 v_add_u32 v5, 98304, v124
 v_add_u32 v6, 98304, v1
 s_xor_b32 s68, s52, 4
 s_mul_i32 s68, s68, 2304
 s_add_u32 s68, s68, 98304
 v_add_u32 v7, s68, v126
 v_lshl_add_u32 v119, v0, 2, s68
 s_waitcnt lgkmcnt(4)
 v_mfma_f32_16x16x32_bf16 v[16:19], v[88:91], v[192:195], v[16:19]
 s_setprio 1
 ds_read_b64_tr_b16 v[80:81], v9 offset:40960
 v_mfma_f32_16x16x32_bf16 v[16:19], v[92:95], v[200:203], v[16:19]
 ds_read_b64_tr_b16 v[82:83], v9 offset:41472
 v_mfma_f32_16x16x32_bf16 v[20:23], v[88:91], v[196:199], v[20:23]
 ds_read_b64_tr_b16 v[84:85], v9 offset:45056
 v_mfma_f32_16x16x32_bf16 v[20:23], v[92:95], v[204:207], v[20:23]
 s_setprio 0
 ds_read_b64_tr_b16 v[86:87], v9 offset:45568
 s_mul_i32 s68, s52, 2304
 s_add_u32 s68, s68, 98304
 v_add_u32 v8, s68, v126
 v_lshl_add_u32 v4, v0, 2, s68
 s_mul_i32 s67, s95, 114688
 s_lshl_b32 s68, s75, 1
 s_add_u32 s68, s68, s94
 s_lshl_b32 s68, s68, 11
 s_add_u32 s67, s67, s68
 s_add_u32 s67, s67, 9437184
 s_waitcnt lgkmcnt(4)
 v_mfma_f32_16x16x32_bf16 v[24:27], v[96:99], v[192:195], v[24:27]
 s_setprio 1
 ds_read_b64_tr_b16 v[88:89], v10 offset:40960
 v_mfma_f32_16x16x32_bf16 v[24:27], v[100:103], v[200:203], v[24:27]
 ds_read_b64_tr_b16 v[90:91], v10 offset:41472
 v_mfma_f32_16x16x32_bf16 v[28:31], v[96:99], v[196:199], v[28:31]
 ds_read_b64_tr_b16 v[92:93], v10 offset:45056
 v_mfma_f32_16x16x32_bf16 v[28:31], v[100:103], v[204:207], v[28:31]
 s_setprio 0
 ds_read_b64_tr_b16 v[94:95], v10 offset:45568
 s_waitcnt vmcnt(0)
 s_barrier
 s_waitcnt lgkmcnt(4)
 v_mfma_f32_16x16x32_bf16 v[64:67], v[80:83], v[192:195], v[64:67]
 s_setprio 1
 ds_read_b64_tr_b16 v[96:97], v11 offset:32768
 v_mfma_f32_16x16x32_bf16 v[64:67], v[84:87], v[200:203], v[64:67]
 ds_read_b64_tr_b16 v[98:99], v11 offset:33280
 v_mfma_f32_16x16x32_bf16 v[68:71], v[80:83], v[196:199], v[68:71]
 ds_read_b64_tr_b16 v[100:101], v11 offset:36864
 v_mfma_f32_16x16x32_bf16 v[68:71], v[84:87], v[204:207], v[68:71]
 s_setprio 0
 ds_read_b64_tr_b16 v[102:103], v11 offset:37376
 s_waitcnt lgkmcnt(4)
 v_mfma_f32_16x16x32_bf16 v[72:75], v[88:91], v[192:195], v[72:75]
 s_setprio 1
 ds_read_b64_tr_b16 v[80:81], v9 offset:49152
 v_mfma_f32_16x16x32_bf16 v[72:75], v[92:95], v[200:203], v[72:75]
 ds_read_b64_tr_b16 v[82:83], v9 offset:49664
 v_mfma_f32_16x16x32_bf16 v[76:79], v[88:91], v[196:199], v[76:79]
 ds_read_b64_tr_b16 v[84:85], v9 offset:53248
 v_mfma_f32_16x16x32_bf16 v[76:79], v[92:95], v[204:207], v[76:79]
 s_setprio 0
 ds_read_b64_tr_b16 v[86:87], v9 offset:53760
 s_waitcnt lgkmcnt(4)
 v_mfma_f32_16x16x32_bf16 v[16:19], v[96:99], v[208:211], v[16:19]
 s_setprio 1
 ds_read_b64_tr_b16 v[88:89], v11 offset:49152
 v_mfma_f32_16x16x32_bf16 v[16:19], v[100:103], v[216:219], v[16:19]
 ds_read_b64_tr_b16 v[90:91], v11 offset:49664
 v_mfma_f32_16x16x32_bf16 v[20:23], v[96:99], v[212:215], v[20:23]
 ds_read_b64_tr_b16 v[92:93], v11 offset:53248
 v_mfma_f32_16x16x32_bf16 v[20:23], v[100:103], v[220:223], v[20:23]
 s_setprio 0
 ds_read_b64_tr_b16 v[94:95], v11 offset:53760
 s_waitcnt lgkmcnt(4)
 v_mfma_f32_16x16x32_bf16 v[16:19], v[80:83], v[224:227], v[16:19]
 s_setprio 1
 ds_read_b64_tr_b16 v[96:97], v12 offset:32768
 v_mfma_f32_16x16x32_bf16 v[16:19], v[84:87], v[232:235], v[16:19]
 ds_read_b64_tr_b16 v[98:99], v12 offset:33280
 v_mfma_f32_16x16x32_bf16 v[20:23], v[80:83], v[228:231], v[20:23]
 ds_read_b64_tr_b16 v[100:101], v12 offset:36864
 v_mfma_f32_16x16x32_bf16 v[20:23], v[84:87], v[236:239], v[20:23]
 s_setprio 0
 ds_read_b64_tr_b16 v[102:103], v12 offset:37376
 s_waitcnt lgkmcnt(4)
 v_mfma_f32_16x16x32_bf16 v[16:19], v[88:91], v[240:243], v[16:19]
 s_setprio 1
 ds_read_b64_tr_b16 v[80:81], v10 offset:49152
 v_mfma_f32_16x16x32_bf16 v[16:19], v[92:95], v[248:251], v[16:19]
 ds_read_b64_tr_b16 v[82:83], v10 offset:49664
 v_mfma_f32_16x16x32_bf16 v[20:23], v[88:91], v[244:247], v[20:23]
 ds_read_b64_tr_b16 v[84:85], v10 offset:53248
 v_mfma_f32_16x16x32_bf16 v[20:23], v[92:95], v[252:255], v[20:23]
 s_setprio 0
 ds_read_b64_tr_b16 v[86:87], v10 offset:53760
 buffer_load_dword v121, v120, s[28:31], 0 offen sc1
 s_waitcnt lgkmcnt(4)
 v_mfma_f32_16x16x32_bf16 v[24:27], v[96:99], v[208:211], v[24:27]
 s_setprio 1
 ds_read_b64_tr_b16 v[88:89], v12 offset:49152
 v_mfma_f32_16x16x32_bf16 v[24:27], v[100:103], v[216:219], v[24:27]
 ds_read_b64_tr_b16 v[90:91], v12 offset:49664
 v_mfma_f32_16x16x32_bf16 v[28:31], v[96:99], v[212:215], v[28:31]
 ds_read_b64_tr_b16 v[92:93], v12 offset:53248
 v_mfma_f32_16x16x32_bf16 v[28:31], v[100:103], v[220:223], v[28:31]
 s_setprio 0
 ds_read_b64_tr_b16 v[94:95], v12 offset:53760
 v_mul_f32 v16, 0xbfb8aa3b, v16
 v_mul_f32 v17, 0xbfb8aa3b, v17
 v_mul_f32 v18, 0xbfb8aa3b, v18
 v_mul_f32 v19, 0xbfb8aa3b, v19
 v_mul_f32 v20, 0xbfb8aa3b, v20
 v_mul_f32 v21, 0xbfb8aa3b, v21
 v_mul_f32 v22, 0xbfb8aa3b, v22
 v_mul_f32 v23, 0xbfb8aa3b, v23
 v_exp_f32 v16, v16
 v_exp_f32 v17, v17
 s_waitcnt lgkmcnt(4)
 v_mfma_f32_16x16x32_bf16 v[24:27], v[80:83], v[224:227], v[24:27]
 s_setprio 1
 ds_read_b64_tr_b16 v[96:97], v11 offset:40960
 v_mfma_f32_16x16x32_bf16 v[24:27], v[84:87], v[232:235], v[24:27]
 ds_read_b64_tr_b16 v[98:99], v11 offset:41472
 v_mfma_f32_16x16x32_bf16 v[28:31], v[80:83], v[228:231], v[28:31]
 ds_read_b64_tr_b16 v[100:101], v11 offset:45056
 v_mfma_f32_16x16x32_bf16 v[28:31], v[84:87], v[236:239], v[28:31]
 s_setprio 0
 ds_read_b64_tr_b16 v[102:103], v11 offset:45568
 v_exp_f32 v18, v18
 v_exp_f32 v19, v19
 v_exp_f32 v20, v20
 v_exp_f32 v21, v21
 v_exp_f32 v22, v22
 v_exp_f32 v23, v23
 s_waitcnt lgkmcnt(4)
 v_mfma_f32_16x16x32_bf16 v[24:27], v[88:91], v[240:243], v[24:27]
 s_setprio 1
 ds_read_b64_tr_b16 v[80:81], v9 offset:57344
 v_mfma_f32_16x16x32_bf16 v[24:27], v[92:95], v[248:251], v[24:27]
 ds_read_b64_tr_b16 v[82:83], v9 offset:57856
 v_mfma_f32_16x16x32_bf16 v[28:31], v[88:91], v[244:247], v[28:31]
 ds_read_b64_tr_b16 v[84:85], v9 offset:61440
 v_mfma_f32_16x16x32_bf16 v[28:31], v[92:95], v[252:255], v[28:31]
 s_setprio 0
 ds_read_b64_tr_b16 v[86:87], v9 offset:61952
 v_fma_f32 v16, v16, v14, v14
 v_fma_f32 v17, v17, v14, v14
 v_fma_f32 v18, v18, v14, v14
 v_fma_f32 v19, v19, v14, v14
 v_fma_f32 v20, v20, v15, v15
 v_fma_f32 v21, v21, v15, v15
 v_fma_f32 v22, v22, v15, v15
 v_fma_f32 v23, v23, v15, v15
 v_rcp_f32 v16, v16
 v_rcp_f32 v17, v17
 s_waitcnt vmcnt(0)
 v_cmp_eq_u32 vcc, 0, v121
 s_nop 0
 s_cmp_lg_u64 vcc, 0
 s_cbranch_scc1 L_x_4012
L_r_4013:
 s_waitcnt lgkmcnt(4)
 v_mfma_f32_16x16x32_bf16 v[64:67], v[96:99], v[208:211], v[64:67]
 s_setprio 1
 ds_read_b64_tr_b16 v[88:89], v11 offset:57344
 v_mfma_f32_16x16x32_bf16 v[64:67], v[100:103], v[216:219], v[64:67]
 ds_read_b64_tr_b16 v[90:91], v11 offset:57856
 v_mfma_f32_16x16x32_bf16 v[68:71], v[96:99], v[212:215], v[68:71]
 ds_read_b64_tr_b16 v[92:93], v11 offset:61440
 v_mfma_f32_16x16x32_bf16 v[68:71], v[100:103], v[220:223], v[68:71]
 s_setprio 0
 ds_read_b64_tr_b16 v[94:95], v11 offset:61952
 s_add_u32 m0, s53, 65536
 s_add_u32 s63, s66, 0
 buffer_load_dwordx4 v126, s[28:31], s63 offen sc1 lds
 v_rcp_f32 v18, v18
 v_rcp_f32 v19, v19
 v_rcp_f32 v20, v20
 s_waitcnt lgkmcnt(4)
 v_mfma_f32_16x16x32_bf16 v[64:67], v[80:83], v[224:227], v[64:67]
 s_setprio 1
 ds_read_b64_tr_b16 v[96:97], v12 offset:40960
 v_mfma_f32_16x16x32_bf16 v[64:67], v[84:87], v[232:235], v[64:67]
 ds_read_b64_tr_b16 v[98:99], v12 offset:41472
 v_mfma_f32_16x16x32_bf16 v[68:71], v[80:83], v[228:231], v[68:71]
 ds_read_b64_tr_b16 v[100:101], v12 offset:45056
 v_mfma_f32_16x16x32_bf16 v[68:71], v[84:87], v[236:239], v[68:71]
 s_setprio 0
 ds_read_b64_tr_b16 v[102:103], v12 offset:45568
 s_add_u32 m0, s53, 73728
 s_add_u32 s63, s66, 8192
 buffer_load_dwordx4 v126, s[28:31], s63 offen sc1 lds
 v_rcp_f32 v21, v21
 v_rcp_f32 v22, v22
 v_rcp_f32 v23, v23
 s_waitcnt lgkmcnt(4)
 v_mfma_f32_16x16x32_bf16 v[64:67], v[88:91], v[240:243], v[64:67]
 s_setprio 1
 ds_read_b64_tr_b16 v[80:81], v10 offset:57344
 v_mfma_f32_16x16x32_bf16 v[64:67], v[92:95], v[248:251], v[64:67]
 ds_read_b64_tr_b16 v[82:83], v10 offset:57856
 v_mfma_f32_16x16x32_bf16 v[68:71], v[88:91], v[244:247], v[68:71]
 ds_read_b64_tr_b16 v[84:85], v10 offset:61440
 v_mfma_f32_16x16x32_bf16 v[68:71], v[92:95], v[252:255], v[68:71]
 s_setprio 0
 ds_read_b64_tr_b16 v[86:87], v10 offset:61952
 buffer_load_dwordx4 v[148:151], v126, s[28:31], s85 offen sc1
 buffer_load_dwordx4 v[144:147], v126, s[28:31], s3 offen sc1
 v_mul_f32 v24, 0xbfb8aa3b, v24
 v_mul_f32 v25, 0xbfb8aa3b, v25
 v_mul_f32 v26, 0xbfb8aa3b, v26
 v_mul_f32 v27, 0xbfb8aa3b, v27
 v_mul_f32 v28, 0xbfb8aa3b, v28
 v_mul_f32 v29, 0xbfb8aa3b, v29
 s_waitcnt lgkmcnt(4)
 v_mfma_f32_16x16x32_bf16 v[72:75], v[96:99], v[208:211], v[72:75]
 s_setprio 1
 ds_read_b64_tr_b16 v[88:89], v12 offset:57344
 v_mfma_f32_16x16x32_bf16 v[72:75], v[100:103], v[216:219], v[72:75]
 ds_read_b64_tr_b16 v[90:91], v12 offset:57856
 v_mfma_f32_16x16x32_bf16 v[76:79], v[96:99], v[212:215], v[76:79]
 ds_read_b64_tr_b16 v[92:93], v12 offset:61440
 v_mfma_f32_16x16x32_bf16 v[76:79], v[100:103], v[220:223], v[76:79]
 s_setprio 0
 ds_read_b64_tr_b16 v[94:95], v12 offset:61952
 s_add_u32 m0, s53, 81920
 s_add_u32 s63, s66, 16384
 buffer_load_dwordx4 v126, s[28:31], s63 offen sc1 lds
 v_mul_f32 v30, 0xbfb8aa3b, v30
 v_mul_f32 v31, 0xbfb8aa3b, v31
 v_exp_f32 v24, v24
 v_exp_f32 v25, v25
 s_waitcnt lgkmcnt(4)
 v_mfma_f32_16x16x32_bf16 v[72:75], v[80:83], v[224:227], v[72:75]
 s_setprio 1
 v_mfma_f32_16x16x32_bf16 v[72:75], v[84:87], v[232:235], v[72:75]
 v_mfma_f32_16x16x32_bf16 v[76:79], v[80:83], v[228:231], v[76:79]
 v_mfma_f32_16x16x32_bf16 v[76:79], v[84:87], v[236:239], v[76:79]
 s_setprio 0
 s_add_u32 m0, s53, 90112
 s_add_u32 s63, s66, 24576
 buffer_load_dwordx4 v126, s[28:31], s63 offen sc1 lds
 v_exp_f32 v26, v26
 v_exp_f32 v27, v27
 v_exp_f32 v28, v28
 s_waitcnt lgkmcnt(0)
 v_mfma_f32_16x16x32_bf16 v[72:75], v[88:91], v[240:243], v[72:75]
 s_setprio 1
 v_mfma_f32_16x16x32_bf16 v[72:75], v[92:95], v[248:251], v[72:75]
 v_mfma_f32_16x16x32_bf16 v[76:79], v[88:91], v[244:247], v[76:79]
 v_mfma_f32_16x16x32_bf16 v[76:79], v[92:95], v[252:255], v[76:79]
 s_setprio 0
 v_exp_f32 v29, v29
 v_exp_f32 v30, v30
 v_exp_f32 v31, v31
 v_fma_f32 v24, v24, v14, v14
 v_fma_f32 v25, v25, v14, v14
 v_fma_f32 v26, v26, v14, v14
 v_fma_f32 v27, v27, v14, v14
 v_fma_f32 v28, v28, v15, v15
 v_fma_f32 v29, v29, v15, v15
 v_fma_f32 v30, v30, v15, v15
 v_fma_f32 v31, v31, v15, v15
 v_rcp_f32 v24, v24
 v_rcp_f32 v25, v25
 v_rcp_f32 v26, v26
 v_rcp_f32 v27, v27
 v_rcp_f32 v28, v28
 v_rcp_f32 v29, v29
 v_rcp_f32 v30, v30
 v_rcp_f32 v31, v31
 v_mul_f32 v16, v16, v64
 v_mul_f32 v17, v17, v65
 v_mul_f32 v18, v18, v66
 v_mul_f32 v19, v19, v67
 v_mul_f32 v20, v20, v68
 v_mul_f32 v21, v21, v69
 v_mul_f32 v22, v22, v70
 v_mul_f32 v23, v23, v71
 v_cvt_pk_bf16_f32 v192, v16, v17
 v_cvt_pk_bf16_f32 v193, v18, v19
 v_cvt_pk_bf16_f32 v196, v20, v21
 v_cvt_pk_bf16_f32 v197, v22, v23
 v_mfma_f32_32x32x16_bf16 v[32:47], v[152:155], v[152:155], 0
 v_mfma_f32_32x32x16_bf16 v[48:63], v[152:155], v[152:155], 0
 s_waitcnt vmcnt(2)
 v_max3_u32 v13, v144, v145, v146
 v_max3_u32 v13, v13, v147, v148
 v_max3_u32 v13, v13, v149, v150
 v_max_u32 v13, v13, v151
 v_cmp_eq_u32 vcc, -1, v13
 s_nop 0
 s_cmp_lg_u64 vcc, 0
 s_cbranch_scc1 L_x_4015
L_r_4016:
 s_barrier
 ds_read_b128 v[104:107], v113 offset:0
 s_mov_b64 exec, s[96:97]
 ds_read_b128 v[128:131], v114 offset:1024
 ds_read_b128 v[132:135], v114 offset:1536
 s_mov_b64 exec, -1
 v_mul_f32 v24, v24, v72
 v_mul_f32 v25, v25, v73
 v_mul_f32 v26, v26, v74
 v_mul_f32 v27, v27, v75
 v_mul_f32 v28, v28, v76
 v_mul_f32 v29, v29, v77
 v_mul_f32 v30, v30, v78
 v_mul_f32 v31, v31, v79
 v_cvt_pk_bf16_f32 v194, v24, v25
 v_cvt_pk_bf16_f32 v195, v26, v27
 v_cvt_pk_bf16_f32 v198, v28, v29
 v_cvt_pk_bf16_f32 v199, v30, v31
 s_waitcnt lgkmcnt(2)
 v_mfma_f32_32x32x16_bf16 v[160:175], v[104:107], v[144:147], 0
 v_add_u32 v14, 98304, v2
 v_add_u32 v15, 98304, v3
 v_mov_b32 v152, -1
 v_mov_b32 v153, -1
 v_mov_b32 v154, -1
 v_mov_b32 v155, -1
 s_lshl_b32 s70, s95, 4
 s_add_u32 s70, s70, s57
 s_lshl_b32 s70, s70, 1
 s_add_u32 s70, s70, s94
 s_lshl_b32 s68, s70, 10
 s_add_u32 s68, s68, 7340032
 s_waitcnt lgkmcnt(0)
 v_exp_f32 v160, v160
 v_exp_f32 v161, v161
 ds_read_b128 v[108:111], v113 offset:4096
 s_setprio 3
 v_exp_f32 v162, v162
 v_exp_f32 v163, v163
 v_exp_f32 v164, v164
 v_mfma_f32_32x32x16_bf16 v[176:191], v[104:107], v[148:151], 0
 v_exp_f32 v165, v165
 v_exp_f32 v166, v166
 v_exp_f32 v167, v167
 v_exp_f32 v168, v168
 v_exp_f32 v169, v169
 v_smfmac_f32_32x32x32_bf16 v[32:47], v[128:131], v[160:167], v112
 s_mov_b64 exec, s[96:97]
 ds_read_b128 v[136:139], v114 offset:5120
 ds_read_b128 v[140:143], v114 offset:5632
 s_mov_b64 exec, -1
 v_exp_f32 v170, v170
 v_exp_f32 v171, v171
 v_exp_f32 v172, v172
 v_exp_f32 v173, v173
 buffer_store_dwordx4 v[192:195], v122, s[28:31], s67 offen offset:0 sc1
 v_exp_f32 v174, v174
 v_exp_f32 v175, v175
 v_exp_f32 v176, v176
 v_exp_f32 v177, v177
 v_smfmac_f32_32x32x32_bf16 v[32:47], v[132:135], v[168:175], v112
 s_waitcnt lgkmcnt(0)
 v_exp_f32 v178, v178
 v_exp_f32 v179, v179
 v_exp_f32 v180, v180
 v_mfma_f32_32x32x16_bf16 v[160:175], v[108:111], v[144:147], 0
 buffer_store_dwordx4 v[196:199], v122, s[28:31], s67 offen offset:256 sc1
 v_exp_f32 v181, v181
 v_exp_f32 v182, v182
 v_exp_f32 v183, v183
 v_exp_f32 v184, v184
 v_exp_f32 v185, v185
 v_smfmac_f32_32x32x32_bf16 v[48:63], v[128:131], v[176:183], v112
 buffer_store_dwordx4 v[152:155], v126, s[28:31], s68 offen offset:0 sc1
 v_exp_f32 v186, v186
 v_exp_f32 v187, v187
 v_exp_f32 v188, v188
 v_exp_f32 v189, v189
 v_exp_f32 v190, v190
 v_exp_f32 v191, v191
 v_exp_f32 v160, v160
 v_exp_f32 v161, v161
 v_smfmac_f32_32x32x32_bf16 v[48:63], v[132:135], v[184:191], v112
 ds_read_b128 v[104:107], v113 offset:8192
 s_setprio 2
 v_exp_f32 v162, v162
 v_exp_f32 v163, v163
 v_exp_f32 v164, v164
 v_mfma_f32_32x32x16_bf16 v[176:191], v[108:111], v[148:151], 0
 v_exp_f32 v165, v165
 v_exp_f32 v166, v166
 v_exp_f32 v167, v167
 v_exp_f32 v168, v168
 v_exp_f32 v169, v169
 v_smfmac_f32_32x32x32_bf16 v[32:47], v[136:139], v[160:167], v112
 s_mov_b64 exec, s[96:97]
 ds_read_b128 v[128:131], v114 offset:9216
 ds_read_b128 v[132:135], v114 offset:9728
 s_mov_b64 exec, -1
 v_exp_f32 v170, v170
 v_exp_f32 v171, v171
 v_exp_f32 v172, v172
 v_exp_f32 v173, v173
 s_add_u32 m0, s53, 98304
 s_add_u32 s63, s66, 32768
 buffer_load_dwordx4 v126, s[28:31], s63 offen sc1 lds
 v_exp_f32 v174, v174
 v_exp_f32 v175, v175
 v_exp_f32 v176, v176
 v_exp_f32 v177, v177
 v_smfmac_f32_32x32x32_bf16 v[32:47], v[140:143], v[168:175], v112
 s_waitcnt lgkmcnt(0)
 v_exp_f32 v178, v178
 v_exp_f32 v179, v179
 v_exp_f32 v180, v180
 v_mfma_f32_32x32x16_bf16 v[160:175], v[104:107], v[144:147], 0
 s_add_u32 m0, s53, 106496
 s_add_u32 s63, s66, 40960
 buffer_load_dwordx4 v126, s[28:31], s63 offen sc1 lds
 v_exp_f32 v181, v181
 v_exp_f32 v182, v182
 v_exp_f32 v183, v183
 v_exp_f32 v184, v184
 v_exp_f32 v185, v185
 v_smfmac_f32_32x32x32_bf16 v[48:63], v[136:139], v[176:183], v112
 s_add_u32 m0, s53, 114688
 s_add_u32 s63, s66, 49152
 buffer_load_dwordx4 v126, s[28:31], s63 offen sc1 lds
 v_exp_f32 v186, v186
 v_exp_f32 v187, v187
 v_exp_f32 v188, v188
 v_exp_f32 v189, v189
 v_exp_f32 v190, v190
 v_exp_f32 v191, v191
 v_exp_f32 v160, v160
 v_exp_f32 v161, v161
 v_smfmac_f32_32x32x32_bf16 v[48:63], v[140:143], v[184:191], v112
 ds_read_b128 v[108:111], v113 offset:12288
 s_setprio 1
 v_exp_f32 v162, v162
 v_exp_f32 v163, v163
 v_exp_f32 v164, v164
 v_mfma_f32_32x32x16_bf16 v[176:191], v[104:107], v[148:151], 0
 v_exp_f32 v165, v165
 v_exp_f32 v166, v166
 v_exp_f32 v167, v167
 v_exp_f32 v168, v168
 v_exp_f32 v169, v169
 v_smfmac_f32_32x32x32_bf16 v[32:47], v[128:131], v[160:167], v112
 s_mov_b64 exec, s[96:97]
 ds_read_b128 v[136:139], v114 offset:13312
 ds_read_b128 v[140:143], v114 offset:13824
 s_mov_b64 exec, -1
 v_exp_f32 v170, v170
 v_exp_f32 v171, v171
 v_exp_f32 v172, v172
 v_exp_f32 v173, v173
 v_exp_f32 v174, v174
 v_exp_f32 v175, v175
 v_exp_f32 v176, v176
 v_exp_f32 v177, v177
 v_smfmac_f32_32x32x32_bf16 v[32:47], v[132:135], v[168:175], v112
 s_waitcnt lgkmcnt(0)
 v_exp_f32 v178, v178
 v_exp_f32 v179, v179
 v_exp_f32 v180, v180
 v_mfma_f32_32x32x16_bf16 v[160:175], v[108:111], v[144:147], 0
 s_add_u32 m0, s53, 122880
 s_add_u32 s63, s66, 57344
 buffer_load_dwordx4 v126, s[28:31], s63 offen sc1 lds
 v_exp_f32 v181, v181
 v_exp_f32 v182, v182
 v_exp_f32 v183, v183
 v_exp_f32 v184, v184
 v_exp_f32 v185, v185
 v_smfmac_f32_32x32x32_bf16 v[48:63], v[128:131], v[176:183], v112
 s_setprio 0
 s_add_u32 s82, s81, 0
 s_cmp_ge_u32 s82, 7
 s_cselect_b32 s63, 7, 0
 s_sub_u32 s82, s82, s63
 s_add_u32 m0, s53, 0
 s_lshl_b32 s82, s82, 16
 buffer_load_dwordx4 v116, s[32:35], s82 offen lds
 v_exp_f32 v186, v186
 v_exp_f32 v187, v187
 v_exp_f32 v188, v188
 v_exp_f32 v189, v189
 v_exp_f32 v190, v190
 v_exp_f32 v191, v191
 s_waitcnt vmcnt(8)
 s_barrier
 v_exp_f32 v160, v160
 v_exp_f32 v161, v161
 v_smfmac_f32_32x32x32_bf16 v[48:63], v[132:135], v[184:191], v112
 ds_read_b128 v[104:107], v113 offset:16384
 s_setprio 3
 v_exp_f32 v162, v162
 v_exp_f32 v163, v163
 v_exp_f32 v164, v164
 v_mfma_f32_32x32x16_bf16 v[176:191], v[108:111], v[148:151], 0
 v_exp_f32 v165, v165
 v_exp_f32 v166, v166
 v_exp_f32 v167, v167
 v_exp_f32 v168, v168
 v_exp_f32 v169, v169
 v_smfmac_f32_32x32x32_bf16 v[32:47], v[136:139], v[160:167], v112
 s_mov_b64 exec, s[96:97]
 ds_read_b128 v[128:131], v114 offset:17408
 ds_read_b128 v[132:135], v114 offset:17920
 s_mov_b64 exec, -1
 v_exp_f32 v170, v170
 v_exp_f32 v171, v171
 v_exp_f32 v172, v172
 v_exp_f32 v173, v173
 v_exp_f32 v174, v174
 v_exp_f32 v175, v175
 v_exp_f32 v176, v176
 v_exp_f32 v177, v177
 v_smfmac_f32_32x32x32_bf16 v[32:47], v[140:143], v[168:175], v112
 s_waitcnt lgkmcnt(0)
 v_exp_f32 v178, v178
 v_exp_f32 v179, v179
 v_exp_f32 v180, v180
 v_mfma_f32_32x32x16_bf16 v[160:175], v[104:107], v[144:147], 0
 v_exp_f32 v181, v181
 v_exp_f32 v182, v182
 v_exp_f32 v183, v183
 v_exp_f32 v184, v184
 v_exp_f32 v185, v185
 v_smfmac_f32_32x32x32_bf16 v[48:63], v[136:139], v[176:183], v112
 s_add_u32 m0, s53, 8192
 s_add_u32 s82, s82, 458752
 buffer_load_dwordx4 v116, s[32:35], s82 offen lds
 v_exp_f32 v186, v186
 v_exp_f32 v187, v187
 v_exp_f32 v188, v188
 v_exp_f32 v189, v189
 v_exp_f32 v190, v190
 v_exp_f32 v191, v191
 v_exp_f32 v160, v160
 v_exp_f32 v161, v161
 v_smfmac_f32_32x32x32_bf16 v[48:63], v[140:143], v[184:191], v112
 ds_read_b128 v[108:111], v113 offset:20480
 v_exp_f32 v162, v162
 v_exp_f32 v163, v163
 v_exp_f32 v164, v164
 v_mfma_f32_32x32x16_bf16 v[176:191], v[104:107], v[148:151], 0
 v_exp_f32 v165, v165
 v_exp_f32 v166, v166
 v_exp_f32 v167, v167
 v_exp_f32 v168, v168
 v_exp_f32 v169, v169
 v_smfmac_f32_32x32x32_bf16 v[32:47], v[128:131], v[160:167], v112
 s_mov_b64 exec, s[96:97]
 ds_read_b128 v[136:139], v114 offset:21504
 ds_read_b128 v[140:143], v114 offset:22016
 s_mov_b64 exec, -1
 v_exp_f32 v170, v170
 v_exp_f32 v171, v171
 v_exp_f32 v172, v172
 v_exp_f32 v173, v173
 v_exp_f32 v174, v174
 v_exp_f32 v175, v175
 v_exp_f32 v176, v176
 v_exp_f32 v177, v177
 v_smfmac_f32_32x32x32_bf16 v[32:47], v[132:135], v[168:175], v112
 s_waitcnt lgkmcnt(0)
 v_exp_f32 v178, v178
 v_exp_f32 v179, v179
 v_exp_f32 v180, v180
 v_mfma_f32_32x32x16_bf16 v[160:175], v[108:111], v[144:147], 0
 v_exp_f32 v181, v181
 v_exp_f32 v182, v182
 v_exp_f32 v183, v183
 v_exp_f32 v184, v184
 v_exp_f32 v185, v185
 v_smfmac_f32_32x32x32_bf16 v[48:63], v[128:131], v[176:183], v112
 s_add_u32 m0, s53, 16384
 s_add_u32 s82, s82, 458752
 buffer_load_dwordx4 v116, s[32:35], s82 offen lds
 v_exp_f32 v186, v186
 v_exp_f32 v187, v187
 v_exp_f32 v188, v188
 v_exp_f32 v189, v189
 v_exp_f32 v190, v190
 v_exp_f32 v191, v191
 v_exp_f32 v160, v160
 v_exp_f32 v161, v161
 v_smfmac_f32_32x32x32_bf16 v[48:63], v[132:135], v[184:191], v112
 ds_read_b128 v[104:107], v113 offset:24576
 s_setprio 2
 v_exp_f32 v162, v162
 v_exp_f32 v163, v163
 v_exp_f32 v164, v164
 v_mfma_f32_32x32x16_bf16 v[176:191], v[108:111], v[148:151], 0
 v_exp_f32 v165, v165
 v_exp_f32 v166, v166
 v_exp_f32 v167, v167
 v_exp_f32 v168, v168
 v_exp_f32 v169, v169
 v_smfmac_f32_32x32x32_bf16 v[32:47], v[136:139], v[160:167], v112
 s_mov_b64 exec, s[96:97]
 ds_read_b128 v[128:131], v114 offset:25600
 ds_read_b128 v[132:135], v114 offset:26112
 s_mov_b64 exec, -1
 v_exp_f32 v170, v170
 v_exp_f32 v171, v171
 v_exp_f32 v172, v172
 v_exp_f32 v173, v173
 v_exp_f32 v174, v174
 v_exp_f32 v175, v175
 v_exp_f32 v176, v176
 v_exp_f32 v177, v177
 v_smfmac_f32_32x32x32_bf16 v[32:47], v[140:143], v[168:175], v112
 s_waitcnt lgkmcnt(0)
 v_exp_f32 v178, v178
 v_exp_f32 v179, v179
 v_exp_f32 v180, v180
 v_mfma_f32_32x32x16_bf16 v[160:175], v[104:107], v[144:147], 0
 s_lshl_b32 s62, s70, 2
 s_add_u32 s62, s62, 4096
 s_waitcnt vmcnt(7)
 s_mov_b64 exec, 1
 buffer_store_dword v112, v126, s[28:31], s62 offen sc1
 s_mov_b64 exec, -1
 v_exp_f32 v181, v181
 v_exp_f32 v182, v182
 v_exp_f32 v183, v183
 v_exp_f32 v184, v184
 v_exp_f32 v185, v185
 v_smfmac_f32_32x32x32_bf16 v[48:63], v[136:139], v[176:183], v112
 s_add_u32 m0, s53, 24576
 s_add_u32 s82, s82, 458752
 buffer_load_dwordx4 v116, s[32:35], s82 offen lds
 v_exp_f32 v186, v186
 v_exp_f32 v187, v187
 v_exp_f32 v188, v188
 v_exp_f32 v189, v189
 v_exp_f32 v190, v190
 v_exp_f32 v191, v191
 v_exp_f32 v160, v160
 v_exp_f32 v161, v161
 v_smfmac_f32_32x32x32_bf16 v[48:63], v[140:143], v[184:191], v112
 ds_read_b128 v[108:111], v113 offset:28672
 s_setprio 1
 v_exp_f32 v162, v162
 v_exp_f32 v163, v163
 v_exp_f32 v164, v164
 v_mfma_f32_32x32x16_bf16 v[176:191], v[104:107], v[148:151], 0
 v_exp_f32 v165, v165
 v_exp_f32 v166, v166
 v_exp_f32 v167, v167
 v_exp_f32 v168, v168
 v_exp_f32 v169, v169
 v_smfmac_f32_32x32x32_bf16 v[32:47], v[128:131], v[160:167], v112
 s_mov_b64 exec, s[96:97]
 ds_read_b128 v[136:139], v114 offset:29696
 ds_read_b128 v[140:143], v114 offset:30208
 s_mov_b64 exec, -1
 v_exp_f32 v170, v170
 v_exp_f32 v171, v171
 v_exp_f32 v172, v172
 v_exp_f32 v173, v173
 v_exp_f32 v174, v174
 v_exp_f32 v175, v175
 v_exp_f32 v176, v176
 v_exp_f32 v177, v177
 v_smfmac_f32_32x32x32_bf16 v[32:47], v[132:135], v[168:175], v112
 s_waitcnt lgkmcnt(0)
 v_exp_f32 v178, v178
 v_exp_f32 v179, v179
 v_exp_f32 v180, v180
 v_mfma_f32_32x32x16_bf16 v[160:175], v[108:111], v[144:147], 0
 v_exp_f32 v181, v181
 v_exp_f32 v182, v182
 v_exp_f32 v183, v183
 v_exp_f32 v184, v184
 v_exp_f32 v185, v185
 v_smfmac_f32_32x32x32_bf16 v[48:63], v[128:131], v[176:183], v112
 s_setprio 0
 s_add_u32 s82, s81, 1
 s_cmp_ge_u32 s82, 7
 s_cselect_b32 s63, 7, 0
 s_sub_u32 s82, s82, s63
 s_add_u32 m0, s53, 32768
 s_lshl_b32 s82, s82, 16
 buffer_load_dwordx4 v116, s[32:35], s82 offen lds
 v_exp_f32 v186, v186
 v_exp_f32 v187, v187
 v_exp_f32 v188, v188
 v_exp_f32 v189, v189
 v_exp_f32 v190, v190
 v_exp_f32 v191, v191
 s_waitcnt vmcnt(6)
 s_barrier
 v_exp_f32 v160, v160
 v_exp_f32 v161, v161
 v_smfmac_f32_32x32x32_bf16 v[48:63], v[132:135], v[184:191], v112
 ds_read_b128 v[104:107], v113 offset:32768
 s_setprio 3
 v_exp_f32 v162, v162
 v_exp_f32 v163, v163
 v_exp_f32 v164, v164
 v_mfma_f32_32x32x16_bf16 v[176:191], v[108:111], v[148:151], 0
 v_exp_f32 v165, v165
 v_exp_f32 v166, v166
 v_exp_f32 v167, v167
 v_exp_f32 v168, v168
 v_exp_f32 v169, v169
 v_smfmac_f32_32x32x32_bf16 v[32:47], v[136:139], v[160:167], v112
 s_mov_b64 exec, s[96:97]
 ds_read_b128 v[128:131], v114 offset:33792
 ds_read_b128 v[132:135], v114 offset:34304
 s_mov_b64 exec, -1
 v_exp_f32 v170, v170
 v_exp_f32 v171, v171
 v_exp_f32 v172, v172
 v_exp_f32 v173, v173
 v_exp_f32 v174, v174
 v_exp_f32 v175, v175
 v_exp_f32 v176, v176
 v_exp_f32 v177, v177
 v_smfmac_f32_32x32x32_bf16 v[32:47], v[140:143], v[168:175], v112
 s_waitcnt lgkmcnt(0)
 v_exp_f32 v178, v178
 v_exp_f32 v179, v179
 v_exp_f32 v180, v180
 v_mfma_f32_32x32x16_bf16 v[160:175], v[104:107], v[144:147], 0
 s_add_u32 m0, s53, 65536
 s_add_u32 s63, s66, 65536
 buffer_load_dwordx4 v126, s[28:31], s63 offen sc1 lds
 v_exp_f32 v181, v181
 v_exp_f32 v182, v182
 v_exp_f32 v183, v183
 v_exp_f32 v184, v184
 v_exp_f32 v185, v185
 v_smfmac_f32_32x32x32_bf16 v[48:63], v[136:139], v[176:183], v112
 s_add_u32 m0, s53, 73728
 s_add_u32 s63, s66, 73728
 buffer_load_dwordx4 v126, s[28:31], s63 offen sc1 lds
 v_exp_f32 v186, v186
 v_exp_f32 v187, v187
 v_exp_f32 v188, v188
 v_exp_f32 v189, v189
 v_exp_f32 v190, v190
 v_exp_f32 v191, v191
 v_exp_f32 v160, v160
 v_exp_f32 v161, v161
 v_smfmac_f32_32x32x32_bf16 v[48:63], v[140:143], v[184:191], v112
 ds_read_b128 v[108:111], v113 offset:36864
 v_exp_f32 v162, v162
 v_exp_f32 v163, v163
 v_exp_f32 v164, v164
 v_mfma_f32_32x32x16_bf16 v[176:191], v[104:107], v[148:151], 0
 v_exp_f32 v165, v165
 v_exp_f32 v166, v166
 v_exp_f32 v167, v167
 v_exp_f32 v168, v168
 v_exp_f32 v169, v169
 v_smfmac_f32_32x32x32_bf16 v[32:47], v[128:131], v[160:167], v112
 s_mov_b64 exec, s[96:97]
 ds_read_b128 v[136:139], v114 offset:37888
 ds_read_b128 v[140:143], v114 offset:38400
 s_mov_b64 exec, -1
 v_exp_f32 v170, v170
 v_exp_f32 v171, v171
 v_exp_f32 v172, v172
 v_exp_f32 v173, v173
 v_exp_f32 v174, v174
 v_exp_f32 v175, v175
 v_exp_f32 v176, v176
 v_exp_f32 v177, v177
 v_smfmac_f32_32x32x32_bf16 v[32:47], v[132:135], v[168:175], v112
 s_waitcnt lgkmcnt(0)
 v_exp_f32 v178, v178
 v_exp_f32 v179, v179
 v_exp_f32 v180, v180
 v_mfma_f32_32x32x16_bf16 v[160:175], v[108:111], v[144:147], 0
 s_add_u32 m0, s53, 81920
 s_add_u32 s63, s66, 81920
 buffer_load_dwordx4 v126, s[28:31], s63 offen sc1 lds
 v_exp_f32 v181, v181
 v_exp_f32 v182, v182
 v_exp_f32 v183, v183
 v_exp_f32 v184, v184
 v_exp_f32 v185, v185
 v_smfmac_f32_32x32x32_bf16 v[48:63], v[128:131], v[176:183], v112
 s_add_u32 m0, s53, 90112
 s_add_u32 s63, s66, 90112
 buffer_load_dwordx4 v126, s[28:31], s63 offen sc1 lds
 v_exp_f32 v186, v186
 v_exp_f32 v187, v187
 v_exp_f32 v188, v188
 v_exp_f32 v189, v189
 v_exp_f32 v190, v190
 v_exp_f32 v191, v191
 v_exp_f32 v160, v160
 v_exp_f32 v161, v161
 v_smfmac_f32_32x32x32_bf16 v[48:63], v[132:135], v[184:191], v112
 ds_read_b128 v[104:107], v113 offset:40960
 v_exp_f32 v162, v162
 v_exp_f32 v163, v163
 v_exp_f32 v164, v164
 v_mfma_f32_32x32x16_bf16 v[176:191], v[108:111], v[148:151], 0
 v_exp_f32 v165, v165
 v_exp_f32 v166, v166
 v_exp_f32 v167, v167
 v_exp_f32 v168, v168
 v_exp_f32 v169, v169
 v_smfmac_f32_32x32x32_bf16 v[32:47], v[136:139], v[160:167], v112
 s_mov_b64 exec, s[96:97]
 ds_read_b128 v[128:131], v114 offset:41984
 ds_read_b128 v[132:135], v114 offset:42496
 s_mov_b64 exec, -1
 v_exp_f32 v170, v170
 v_exp_f32 v171, v171
 v_exp_f32 v172, v172
 v_exp_f32 v173, v173
 v_exp_f32 v174, v174
 v_exp_f32 v175, v175
 v_exp_f32 v176, v176
 v_exp_f32 v177, v177
 v_smfmac_f32_32x32x32_bf16 v[32:47], v[140:143], v[168:175], v112
 s_waitcnt lgkmcnt(0)
 v_exp_f32 v178, v178
 v_exp_f32 v179, v179
 v_exp_f32 v180, v180
 v_mfma_f32_32x32x16_bf16 v[160:175], v[104:107], v[144:147], 0
 s_add_u32 m0, s53, 40960
 s_add_u32 s82, s82, 458752
 buffer_load_dwordx4 v116, s[32:35], s82 offen lds
 v_exp_f32 v181, v181
 v_exp_f32 v182, v182
 v_exp_f32 v183, v183
 v_exp_f32 v184, v184
 v_exp_f32 v185, v185
 v_smfmac_f32_32x32x32_bf16 v[48:63], v[136:139], v[176:183], v112
 s_add_u32 m0, s53, 49152
 s_add_u32 s82, s82, 458752
 buffer_load_dwordx4 v116, s[32:35], s82 offen lds
 v_exp_f32 v186, v186
 v_exp_f32 v187, v187
 v_exp_f32 v188, v188
 v_exp_f32 v189, v189
 v_exp_f32 v190, v190
 v_exp_f32 v191, v191
 v_exp_f32 v160, v160
 v_exp_f32 v161, v161
 v_smfmac_f32_32x32x32_bf16 v[48:63], v[140:143], v[184:191], v112
 ds_read_b128 v[108:111], v113 offset:45056
 v_exp_f32 v162, v162
 v_exp_f32 v163, v163
 v_exp_f32 v164, v164
 v_mfma_f32_32x32x16_bf16 v[176:191], v[104:107], v[148:151], 0
 v_exp_f32 v165, v165
 v_exp_f32 v166, v166
 v_exp_f32 v167, v167
 v_exp_f32 v168, v168
 v_exp_f32 v169, v169
 v_smfmac_f32_32x32x32_bf16 v[32:47], v[128:131], v[160:167], v112
 s_mov_b64 exec, s[96:97]
 ds_read_b128 v[136:139], v114 offset:46080
 ds_read_b128 v[140:143], v114 offset:46592
 s_mov_b64 exec, -1
 v_exp_f32 v170, v170
 v_exp_f32 v171, v171
 v_exp_f32 v172, v172
 v_exp_f32 v173, v173
 v_exp_f32 v174, v174
 v_exp_f32 v175, v175
 v_exp_f32 v176, v176
 v_exp_f32 v177, v177
 v_smfmac_f32_32x32x32_bf16 v[32:47], v[132:135], v[168:175], v112
 s_waitcnt lgkmcnt(0)
 v_exp_f32 v178, v178
 v_exp_f32 v179, v179
 v_exp_f32 v180, v180
 v_mfma_f32_32x32x16_bf16 v[160:175], v[108:111], v[144:147], 0
 buffer_load_dword v118, v123, s[28:31], 0 offen sc1
 buffer_load_dword v121, v115, s[28:31], 0 offen sc1
 s_add_u32 m0, s53, 57344
 s_add_u32 s82, s82, 458752
 buffer_load_dwordx4 v116, s[32:35], s82 offen lds
 v_exp_f32 v181, v181
 v_exp_f32 v182, v182
 v_exp_f32 v183, v183
 v_exp_f32 v184, v184
 v_exp_f32 v185, v185
 v_smfmac_f32_32x32x32_bf16 v[48:63], v[128:131], v[176:183], v112
 s_add_u32 s82, s81, 2
 s_cmp_ge_u32 s82, 7
 s_cselect_b32 s63, 7, 0
 s_sub_u32 s82, s82, s63
 s_add_u32 m0, s53, 131072
 s_lshl_b32 s82, s82, 16
 buffer_load_dwordx4 v116, s[32:35], s82 offen lds
 v_exp_f32 v186, v186
 v_exp_f32 v187, v187
 v_exp_f32 v188, v188
 v_exp_f32 v189, v189
 v_exp_f32 v190, v190
 v_exp_f32 v191, v191
 v_exp_f32 v160, v160
 v_exp_f32 v161, v161
 v_smfmac_f32_32x32x32_bf16 v[48:63], v[132:135], v[184:191], v112
 ds_read_b128 v[104:107], v113 offset:49152
 s_setprio 2
 v_exp_f32 v162, v162
 v_exp_f32 v163, v163
 v_exp_f32 v164, v164
 v_mfma_f32_32x32x16_bf16 v[176:191], v[108:111], v[148:151], 0
 v_exp_f32 v165, v165
 v_exp_f32 v166, v166
 v_exp_f32 v167, v167
 v_exp_f32 v168, v168
 v_exp_f32 v169, v169
 v_smfmac_f32_32x32x32_bf16 v[32:47], v[136:139], v[160:167], v112
 s_mov_b64 exec, s[96:97]
 ds_read_b128 v[128:131], v114 offset:50176
 ds_read_b128 v[132:135], v114 offset:50688
 s_mov_b64 exec, -1
 v_exp_f32 v170, v170
 v_exp_f32 v171, v171
 v_exp_f32 v172, v172
 v_exp_f32 v173, v173
 v_exp_f32 v174, v174
 v_exp_f32 v175, v175
 v_exp_f32 v176, v176
 v_exp_f32 v177, v177
 v_smfmac_f32_32x32x32_bf16 v[32:47], v[140:143], v[168:175], v112
 s_waitcnt lgkmcnt(0)
 v_exp_f32 v178, v178
 v_exp_f32 v179, v179
 v_exp_f32 v180, v180
 v_mfma_f32_32x32x16_bf16 v[160:175], v[104:107], v[144:147], 0
 s_add_u32 m0, s53, 139264
 s_add_u32 s82, s82, 458752
 buffer_load_dwordx4 v116, s[32:35], s82 offen lds
 v_exp_f32 v181, v181
 v_exp_f32 v182, v182
 v_exp_f32 v183, v183
 v_exp_f32 v184, v184
 v_exp_f32 v185, v185
 v_smfmac_f32_32x32x32_bf16 v[48:63], v[136:139], v[176:183], v112
 s_add_u32 m0, s53, 147456
 s_add_u32 s82, s82, 458752
 buffer_load_dwordx4 v116, s[32:35], s82 offen lds
 v_exp_f32 v186, v186
 v_exp_f32 v187, v187
 v_exp_f32 v188, v188
 v_exp_f32 v189, v189
 v_exp_f32 v190, v190
 v_exp_f32 v191, v191
 s_waitcnt vmcnt(4)
 v_cmp_eq_u32 vcc, 0, v121
 s_nop 0
 s_cmp_lg_u64 vcc, 0
 s_cbranch_scc1 L_x_4018
L_r_4019:
 v_cmp_eq_u32 vcc, 0, v118
 s_nop 0
 s_cmp_lg_u64 vcc, 0
 s_cbranch_scc1 L_x_4021
L_r_4022:
 v_exp_f32 v160, v160
 v_exp_f32 v161, v161
 v_smfmac_f32_32x32x32_bf16 v[48:63], v[140:143], v[184:191], v112
 ds_read_b128 v[108:111], v113 offset:53248
 v_exp_f32 v162, v162
 v_exp_f32 v163, v163
 v_exp_f32 v164, v164
 v_mfma_f32_32x32x16_bf16 v[176:191], v[104:107], v[148:151], 0
 v_exp_f32 v165, v165
 v_exp_f32 v166, v166
 v_exp_f32 v167, v167
 v_exp_f32 v168, v168
 v_exp_f32 v169, v169
 v_smfmac_f32_32x32x32_bf16 v[32:47], v[128:131], v[160:167], v112
 s_mov_b64 exec, s[96:97]
 ds_read_b128 v[136:139], v114 offset:54272
 ds_read_b128 v[140:143], v114 offset:54784
 s_mov_b64 exec, -1
 v_exp_f32 v170, v170
 v_exp_f32 v171, v171
 v_exp_f32 v172, v172
 v_exp_f32 v173, v173
 v_exp_f32 v174, v174
 v_exp_f32 v175, v175
 v_exp_f32 v118, -v118
 v_exp_f32 v176, v176
 v_exp_f32 v177, v177
 v_smfmac_f32_32x32x32_bf16 v[32:47], v[132:135], v[168:175], v112
 s_waitcnt lgkmcnt(0)
 v_exp_f32 v178, v178
 v_exp_f32 v179, v179
 v_exp_f32 v180, v180
 v_mfma_f32_32x32x16_bf16 v[160:175], v[108:111], v[144:147], 0
 s_add_u32 s83, s81, 0
 s_cmp_ge_u32 s83, 7
 s_cselect_b32 s63, 7, 0
 s_sub_u32 s83, s83, s63
 s_lshl_b32 s83, s83, 12
 s_add_u32 s83, s83, s69
 buffer_load_dwordx4 v[16:19], v122, s[28:31], s83 offen offset:0 sc1
 v_exp_f32 v181, v181
 v_exp_f32 v182, v182
 v_exp_f32 v183, v183
 v_exp_f32 v184, v184
 v_exp_f32 v185, v185
 v_smfmac_f32_32x32x32_bf16 v[48:63], v[128:131], v[176:183], v112
 buffer_load_dwordx4 v[20:23], v122, s[28:31], s83 offen offset:2048 sc1
 v_add_f32 v118, 1.0, v118
 v_rcp_f32 v118, v118
 v_exp_f32 v186, v186
 v_exp_f32 v187, v187
 v_exp_f32 v188, v188
 v_exp_f32 v189, v189
 v_exp_f32 v190, v190
 v_exp_f32 v191, v191
 v_exp_f32 v160, v160
 v_exp_f32 v161, v161
 v_smfmac_f32_32x32x32_bf16 v[48:63], v[132:135], v[184:191], v112
 ds_read_b128 v[104:107], v113 offset:57344
 v_exp_f32 v162, v162
 v_exp_f32 v163, v163
 v_exp_f32 v164, v164
 v_mfma_f32_32x32x16_bf16 v[176:191], v[108:111], v[148:151], 0
 v_exp_f32 v165, v165
 v_exp_f32 v166, v166
 v_exp_f32 v167, v167
 v_exp_f32 v168, v168
 v_exp_f32 v169, v169
 v_smfmac_f32_32x32x32_bf16 v[32:47], v[136:139], v[160:167], v112
 s_mov_b64 exec, s[96:97]
 ds_read_b128 v[128:131], v114 offset:58368
 ds_read_b128 v[132:135], v114 offset:58880
 s_mov_b64 exec, -1
 v_exp_f32 v170, v170
 v_exp_f32 v171, v171
 v_exp_f32 v172, v172
 v_exp_f32 v173, v173
 v_exp_f32 v174, v174
 v_exp_f32 v175, v175
 v_exp_f32 v176, v176
 v_exp_f32 v177, v177
 v_smfmac_f32_32x32x32_bf16 v[32:47], v[140:143], v[168:175], v112
 s_waitcnt lgkmcnt(0)
 s_setprio 1
 v_exp_f32 v178, v178
 v_exp_f32 v179, v179
 v_exp_f32 v180, v180
 v_mfma_f32_32x32x16_bf16 v[160:175], v[104:107], v[144:147], 0
 s_cmp_lg_u32 s72, 1
 s_cbranch_scc1 L_s_4024
 s_and_b32 s62, s71, 7
 s_lshl_b32 s62, s62, 16
 buffer_load_dword v125, v117, s[36:39], s62 offen
L_s_4024:
 buffer_load_dwordx4 v[24:27], v122, s[28:31], s83 offen offset:256 sc1
 v_exp_f32 v181, v181
 v_exp_f32 v182, v182
 v_exp_f32 v183, v183
 v_exp_f32 v184, v184
 v_exp_f32 v185, v185
 v_smfmac_f32_32x32x32_bf16 v[48:63], v[136:139], v[176:183], v112
 buffer_load_dwordx4 v[28:31], v122, s[28:31], s83 offen offset:2304 sc1
 v_exp_f32 v186, v186
 v_exp_f32 v187, v187
 v_exp_f32 v188, v188
 v_exp_f32 v189, v189
 v_exp_f32 v190, v190
 v_exp_f32 v191, v191
 v_exp_f32 v160, v160
 v_exp_f32 v161, v161
 v_smfmac_f32_32x32x32_bf16 v[48:63], v[140:143], v[184:191], v112
 ds_read_b128 v[108:111], v113 offset:61440
 v_exp_f32 v162, v162
 v_exp_f32 v163, v163
 v_exp_f32 v164, v164
 v_mfma_f32_32x32x16_bf16 v[176:191], v[104:107], v[148:151], 0
 v_exp_f32 v165, v165
 v_exp_f32 v166, v166
 v_exp_f32 v167, v167
 v_exp_f32 v168, v168
 v_exp_f32 v169, v169
 v_smfmac_f32_32x32x32_bf16 v[32:47], v[128:131], v[160:167], v112
 s_mov_b64 exec, s[96:97]
 ds_read_b128 v[136:139], v114 offset:62464
 ds_read_b128 v[140:143], v114 offset:62976
 s_mov_b64 exec, -1
 v_exp_f32 v170, v170
 v_exp_f32 v171, v171
 v_exp_f32 v172, v172
 v_exp_f32 v173, v173
 s_add_u32 s83, s81, 1
 s_cmp_ge_u32 s83, 7
 s_cselect_b32 s63, 7, 0
 s_sub_u32 s83, s83, s63
 s_lshl_b32 s83, s83, 12
 s_add_u32 s83, s83, s69
 buffer_load_dwordx4 v[64:67], v122, s[28:31], s83 offen offset:0 sc1
 v_exp_f32 v174, v174
 v_exp_f32 v175, v175
 v_exp_f32 v176, v176
 v_exp_f32 v177, v177
 v_smfmac_f32_32x32x32_bf16 v[32:47], v[132:135], v[168:175], v112
 s_waitcnt lgkmcnt(0)
 v_exp_f32 v178, v178
 v_exp_f32 v179, v179
 v_exp_f32 v180, v180
 v_mfma_f32_32x32x16_bf16 v[160:175], v[108:111], v[144:147], 0
 buffer_load_dwordx4 v[68:71], v122, s[28:31], s83 offen offset:2048 sc1
 v_exp_f32 v181, v181
 v_exp_f32 v182, v182
 v_exp_f32 v183, v183
 v_exp_f32 v184, v184
 v_exp_f32 v185, v185
 v_smfmac_f32_32x32x32_bf16 v[48:63], v[128:131], v[176:183], v112
 s_setprio 0
 s_add_u32 m0, s53, 155648
 s_add_u32 s82, s82, 458752
 buffer_load_dwordx4 v116, s[32:35], s82 offen lds
 v_exp_f32 v186, v186
 v_exp_f32 v187, v187
 v_exp_f32 v188, v188
 v_exp_f32 v189, v189
 v_exp_f32 v190, v190
 v_exp_f32 v191, v191
 s_waitcnt vmcnt(10)
 s_barrier
 v_exp_f32 v160, v160
 v_exp_f32 v161, v161
 v_smfmac_f32_32x32x32_bf16 v[48:63], v[132:135], v[184:191], v112
 ds_read_b128 v[104:107], v113 offset:0
 s_setprio 3
 v_exp_f32 v162, v162
 v_exp_f32 v163, v163
 v_exp_f32 v164, v164
 v_mfma_f32_32x32x16_bf16 v[176:191], v[108:111], v[148:151], 0
 ds_read_b64_tr_b16 v[88:89], v124 offset:0
 ds_read_b64_tr_b16 v[90:91], v124 offset:2048
 v_exp_f32 v165, v165
 v_exp_f32 v166, v166
 v_exp_f32 v167, v167
 v_exp_f32 v168, v168
 v_exp_f32 v169, v169
 v_smfmac_f32_32x32x32_bf16 v[32:47], v[136:139], v[160:167], v112
 ds_read_b64_tr_b16 v[92:93], v124 offset:4096
 ds_read_b64_tr_b16 v[94:95], v124 offset:6144
 s_mov_b64 exec, s[96:97]
 ds_read_b128 v[128:131], v114 offset:1024
 ds_read_b128 v[132:135], v114 offset:1536
 s_mov_b64 exec, -1
 v_exp_f32 v170, v170
 v_exp_f32 v171, v171
 v_exp_f32 v172, v172
 v_exp_f32 v173, v173
 buffer_load_dwordx4 v[72:75], v122, s[28:31], s83 offen offset:256 sc1
 v_exp_f32 v174, v174
 v_exp_f32 v175, v175
 v_exp_f32 v176, v176
 v_exp_f32 v177, v177
 v_smfmac_f32_32x32x32_bf16 v[32:47], v[140:143], v[168:175], v112
 s_waitcnt lgkmcnt(0)
 v_exp_f32 v178, v178
 v_exp_f32 v179, v179
 v_exp_f32 v180, v180
 v_mfma_f32_32x32x16_bf16 v[160:175], v[104:107], v[144:147], 0
 buffer_load_dwordx4 v[76:79], v122, s[28:31], s83 offen offset:2304 sc1
 v_exp_f32 v181, v181
 v_exp_f32 v182, v182
 v_exp_f32 v183, v183
 v_exp_f32 v184, v184
 v_exp_f32 v185, v185
 v_smfmac_f32_32x32x32_bf16 v[48:63], v[136:139], v[176:183], v112
 s_add_u32 m0, s53, 98304
 s_add_u32 s63, s66, 98304
 buffer_load_dwordx4 v126, s[28:31], s63 offen sc1 lds
 v_exp_f32 v186, v186
 v_exp_f32 v187, v187
 v_exp_f32 v188, v188
 v_exp_f32 v189, v189
 s_waitcnt vmcnt(8)
 v_mfma_f32_16x16x32_bf16 v[224:227], v[88:91], v[16:19], 0
 v_mfma_f32_16x16x32_bf16 v[224:227], v[92:95], v[20:23], v[224:227]
 v_exp_f32 v190, v190
 v_exp_f32 v191, v191
 v_exp_f32 v160, v160
 v_exp_f32 v161, v161
 v_smfmac_f32_32x32x32_bf16 v[48:63], v[140:143], v[184:191], v112
 ds_read_b128 v[108:111], v113 offset:4096
 v_exp_f32 v162, v162
 v_exp_f32 v163, v163
 v_exp_f32 v164, v164
 v_mfma_f32_32x32x16_bf16 v[176:191], v[104:107], v[148:151], 0
 ds_read_b64_tr_b16 v[96:97], v1 offset:0
 ds_read_b64_tr_b16 v[98:99], v1 offset:2048
 v_exp_f32 v165, v165
 v_exp_f32 v166, v166
 v_exp_f32 v167, v167
 v_exp_f32 v168, v168
 v_exp_f32 v169, v169
 v_smfmac_f32_32x32x32_bf16 v[32:47], v[128:131], v[160:167], v112
 ds_read_b64_tr_b16 v[100:101], v1 offset:4096
 ds_read_b64_tr_b16 v[102:103], v1 offset:6144
 s_mov_b64 exec, s[96:97]
 ds_read_b128 v[136:139], v114 offset:5120
 ds_read_b128 v[140:143], v114 offset:5632
 s_mov_b64 exec, -1
 v_exp_f32 v170, v170
 v_exp_f32 v171, v171
 v_exp_f32 v172, v172
 v_exp_f32 v173, v173
 s_waitcnt vmcnt(6)
 v_mfma_f32_16x16x32_bf16 v[228:231], v[88:91], v[24:27], 0
 v_mfma_f32_16x16x32_bf16 v[228:231], v[92:95], v[28:31], v[228:231]
 s_add_u32 s83, s81, 2
 s_cmp_ge_u32 s83, 7
 s_cselect_b32 s63, 7, 0
 s_sub_u32 s83, s83, s63
 s_lshl_b32 s83, s83, 12
 s_add_u32 s83, s83, s69
 buffer_load_dwordx4 v[80:83], v122, s[28:31], s83 offen offset:0 sc1
 v_exp_f32 v174, v174
 v_exp_f32 v175, v175
 v_exp_f32 v176, v176
 v_exp_f32 v177, v177
 v_smfmac_f32_32x32x32_bf16 v[32:47], v[132:135], v[168:175], v112
 s_waitcnt lgkmcnt(0)
 v_exp_f32 v178, v178
 v_exp_f32 v179, v179
 v_exp_f32 v180, v180
 v_mfma_f32_32x32x16_bf16 v[160:175], v[108:111], v[144:147], 0
 buffer_load_dwordx4 v[84:87], v122, s[28:31], s83 offen offset:2048 sc1
 v_exp_f32 v181, v181
 v_exp_f32 v182, v182
 v_exp_f32 v183, v183
 v_exp_f32 v184, v184
 v_exp_f32 v185, v185
 v_smfmac_f32_32x32x32_bf16 v[48:63], v[128:131], v[176:183], v112
 s_add_u32 m0, s53, 106496
 s_add_u32 s63, s66, 106496
 buffer_load_dwordx4 v126, s[28:31], s63 offen sc1 lds
 v_exp_f32 v186, v186
 v_exp_f32 v187, v187
 v_exp_f32 v188, v188
 v_exp_f32 v189, v189
 v_mfma_f32_16x16x32_bf16 v[232:235], v[96:99], v[16:19], 0
 v_mfma_f32_16x16x32_bf16 v[232:235], v[100:103], v[20:23], v[232:235]
 v_exp_f32 v190, v190
 v_exp_f32 v191, v191
 v_exp_f32 v160, v160
 v_exp_f32 v161, v161
 v_smfmac_f32_32x32x32_bf16 v[48:63], v[132:135], v[184:191], v112
 ds_read_b128 v[104:107], v113 offset:8192
 v_exp_f32 v162, v162
 v_exp_f32 v163, v163
 v_exp_f32 v164, v164
 v_mfma_f32_32x32x16_bf16 v[176:191], v[108:111], v[148:151], 0
 ds_read_b64_tr_b16 v[88:89], v2 offset:0
 ds_read_b64_tr_b16 v[90:91], v2 offset:2048
 v_exp_f32 v165, v165
 v_exp_f32 v166, v166
 v_exp_f32 v167, v167
 v_exp_f32 v168, v168
 v_exp_f32 v169, v169
 v_smfmac_f32_32x32x32_bf16 v[32:47], v[136:139], v[160:167], v112
 ds_read_b64_tr_b16 v[92:93], v2 offset:4096
 ds_read_b64_tr_b16 v[94:95], v2 offset:6144
 s_mov_b64 exec, s[96:97]
 ds_read_b128 v[128:131], v114 offset:9216
 ds_read_b128 v[132:135], v114 offset:9728
 s_mov_b64 exec, -1
 v_exp_f32 v170, v170
 v_exp_f32 v171, v171
 v_exp_f32 v172, v172
 v_exp_f32 v173, v173
 v_mfma_f32_16x16x32_bf16 v[236:239], v[96:99], v[24:27], 0
 v_mfma_f32_16x16x32_bf16 v[236:239], v[100:103], v[28:31], v[236:239]
 buffer_load_dwordx4 v[152:155], v122, s[28:31], s83 offen offset:256 sc1
 v_exp_f32 v174, v174
 v_exp_f32 v175, v175
 v_exp_f32 v176, v176
 v_exp_f32 v177, v177
 v_smfmac_f32_32x32x32_bf16 v[32:47], v[140:143], v[168:175], v112
 s_waitcnt lgkmcnt(0)
 v_exp_f32 v178, v178
 v_exp_f32 v179, v179
 v_exp_f32 v180, v180
 v_mfma_f32_32x32x16_bf16 v[160:175], v[104:107], v[144:147], 0
 buffer_load_dwordx4 v[156:159], v122, s[28:31], s83 offen offset:2304 sc1
 v_exp_f32 v181, v181
 v_exp_f32 v182, v182
 v_exp_f32 v183, v183
 v_exp_f32 v184, v184
 v_exp_f32 v185, v185
 v_smfmac_f32_32x32x32_bf16 v[48:63], v[136:139], v[176:183], v112
 s_add_u32 m0, s53, 114688
 s_add_u32 s63, s66, 114688
 buffer_load_dwordx4 v126, s[28:31], s63 offen sc1 lds
 v_exp_f32 v186, v186
 v_exp_f32 v187, v187
 v_exp_f32 v188, v188
 v_exp_f32 v189, v189
 v_mfma_f32_16x16x32_bf16 v[240:243], v[88:91], v[16:19], 0
 v_mfma_f32_16x16x32_bf16 v[240:243], v[92:95], v[20:23], v[240:243]
 v_exp_f32 v190, v190
 v_exp_f32 v191, v191
 v_exp_f32 v160, v160
 v_exp_f32 v161, v161
 v_smfmac_f32_32x32x32_bf16 v[48:63], v[140:143], v[184:191], v112
 ds_read_b128 v[108:111], v113 offset:12288
 v_exp_f32 v162, v162
 v_exp_f32 v163, v163
 v_exp_f32 v164, v164
 v_mfma_f32_32x32x16_bf16 v[176:191], v[104:107], v[148:151], 0
 ds_read_b64_tr_b16 v[96:97], v3 offset:0
 ds_read_b64_tr_b16 v[98:99], v3 offset:2048
 v_exp_f32 v165, v165
 v_exp_f32 v166, v166
 v_exp_f32 v167, v167
 v_exp_f32 v168, v168
 v_exp_f32 v169, v169
 v_smfmac_f32_32x32x32_bf16 v[32:47], v[128:131], v[160:167], v112
 ds_read_b64_tr_b16 v[100:101], v3 offset:4096
 ds_read_b64_tr_b16 v[102:103], v3 offset:6144
 s_mov_b64 exec, s[96:97]
 ds_read_b128 v[136:139], v114 offset:13312
 ds_read_b128 v[140:143], v114 offset:13824
 s_mov_b64 exec, -1
 v_exp_f32 v170, v170
 v_exp_f32 v171, v171
 v_exp_f32 v172, v172
 v_exp_f32 v173, v173
 v_mfma_f32_16x16x32_bf16 v[244:247], v[88:91], v[24:27], 0
 v_mfma_f32_16x16x32_bf16 v[244:247], v[92:95], v[28:31], v[244:247]
 s_add_u32 s83, s81, 3
 s_cmp_ge_u32 s83, 7
 s_cselect_b32 s63, 7, 0
 s_sub_u32 s83, s83, s63
 s_lshl_b32 s83, s83, 12
 s_add_u32 s83, s83, s69
 buffer_load_dwordx4 v[192:195], v122, s[28:31], s83 offen offset:0 sc1
 v_exp_f32 v174, v174
 v_exp_f32 v175, v175
 v_exp_f32 v176, v176
 v_exp_f32 v177, v177
 v_smfmac_f32_32x32x32_bf16 v[32:47], v[132:135], v[168:175], v112
 s_waitcnt lgkmcnt(0)
 v_exp_f32 v178, v178
 v_exp_f32 v179, v179
 v_exp_f32 v180, v180
 v_mfma_f32_32x32x16_bf16 v[160:175], v[108:111], v[144:147], 0
 buffer_load_dwordx4 v[196:199], v122, s[28:31], s83 offen offset:2048 sc1
 v_exp_f32 v181, v181
 v_exp_f32 v182, v182
 v_exp_f32 v183, v183
 v_exp_f32 v184, v184
 v_exp_f32 v185, v185
 v_smfmac_f32_32x32x32_bf16 v[48:63], v[128:131], v[176:183], v112
 s_add_u32 m0, s53, 122880
 s_add_u32 s63, s66, 122880
 buffer_load_dwordx4 v126, s[28:31], s63 offen sc1 lds
 v_exp_f32 v186, v186
 v_exp_f32 v187, v187
 v_exp_f32 v188, v188
 v_exp_f32 v189, v189
 v_mfma_f32_16x16x32_bf16 v[248:251], v[96:99], v[16:19], 0
 v_mfma_f32_16x16x32_bf16 v[248:251], v[100:103], v[20:23], v[248:251]
 v_exp_f32 v190, v190
 v_exp_f32 v191, v191
 v_exp_f32 v160, v160
 v_exp_f32 v161, v161
 v_smfmac_f32_32x32x32_bf16 v[48:63], v[132:135], v[184:191], v112
 ds_read_b128 v[104:107], v113 offset:16384
 s_setprio 2
 v_exp_f32 v162, v162
 v_exp_f32 v163, v163
 v_exp_f32 v164, v164
 v_mfma_f32_32x32x16_bf16 v[176:191], v[108:111], v[148:151], 0
 ds_read_b64_tr_b16 v[88:89], v124 offset:32768
 ds_read_b64_tr_b16 v[90:91], v124 offset:34816
 v_exp_f32 v165, v165
 v_exp_f32 v166, v166
 v_exp_f32 v167, v167
 v_exp_f32 v168, v168
 v_exp_f32 v169, v169
 v_smfmac_f32_32x32x32_bf16 v[32:47], v[136:139], v[160:167], v112
 ds_read_b64_tr_b16 v[92:93], v124 offset:36864
 ds_read_b64_tr_b16 v[94:95], v124 offset:38912
 s_mov_b64 exec, s[96:97]
 ds_read_b128 v[128:131], v114 offset:17408
 ds_read_b128 v[132:135], v114 offset:17920
 s_mov_b64 exec, -1
 v_exp_f32 v170, v170
 v_exp_f32 v171, v171
 v_exp_f32 v172, v172
 v_exp_f32 v173, v173
 v_mfma_f32_16x16x32_bf16 v[252:255], v[96:99], v[24:27], 0
 v_mfma_f32_16x16x32_bf16 v[252:255], v[100:103], v[28:31], v[252:255]
 buffer_load_dwordx4 v[200:203], v122, s[28:31], s83 offen offset:256 sc1
 v_exp_f32 v174, v174
 v_exp_f32 v175, v175
 v_exp_f32 v176, v176
 v_exp_f32 v177, v177
 v_smfmac_f32_32x32x32_bf16 v[32:47], v[140:143], v[168:175], v112
 s_waitcnt lgkmcnt(0)
 v_exp_f32 v178, v178
 v_exp_f32 v179, v179
 v_exp_f32 v180, v180
 v_mfma_f32_32x32x16_bf16 v[160:175], v[104:107], v[144:147], 0
 buffer_load_dwordx4 v[204:207], v122, s[28:31], s83 offen offset:2304 sc1
 v_exp_f32 v181, v181
 v_exp_f32 v182, v182
 v_exp_f32 v183, v183
 v_exp_f32 v184, v184
 v_exp_f32 v185, v185
 v_smfmac_f32_32x32x32_bf16 v[48:63], v[136:139], v[176:183], v112
 s_add_u32 s83, s81, 4
 s_cmp_ge_u32 s83, 7
 s_cselect_b32 s63, 7, 0
 s_sub_u32 s83, s83, s63
 s_lshl_b32 s83, s83, 12
 s_add_u32 s83, s83, s69
 buffer_load_dwordx4 v[208:211], v122, s[28:31], s83 offen offset:0 sc1
 v_exp_f32 v186, v186
 v_exp_f32 v187, v187
 v_exp_f32 v188, v188
 v_exp_f32 v189, v189
 s_waitcnt vmcnt(16)
 v_mfma_f32_16x16x32_bf16 v[224:227], v[88:91], v[64:67], v[224:227]
 v_mfma_f32_16x16x32_bf16 v[224:227], v[92:95], v[68:71], v[224:227]
 v_exp_f32 v190, v190
 v_exp_f32 v191, v191
 v_exp_f32 v160, v160
 v_exp_f32 v161, v161
 v_smfmac_f32_32x32x32_bf16 v[48:63], v[140:143], v[184:191], v112
 ds_read_b128 v[108:111], v113 offset:20480
 v_exp_f32 v162, v162
 v_exp_f32 v163, v163
 v_exp_f32 v164, v164
 v_mfma_f32_32x32x16_bf16 v[176:191], v[104:107], v[148:151], 0
 ds_read_b64_tr_b16 v[96:97], v1 offset:32768
 ds_read_b64_tr_b16 v[98:99], v1 offset:34816
 v_exp_f32 v165, v165
 v_exp_f32 v166, v166
 v_exp_f32 v167, v167
 v_exp_f32 v168, v168
 v_exp_f32 v169, v169
 v_smfmac_f32_32x32x32_bf16 v[32:47], v[128:131], v[160:167], v112
 ds_read_b64_tr_b16 v[100:101], v1 offset:36864
 ds_read_b64_tr_b16 v[102:103], v1 offset:38912
 s_mov_b64 exec, s[96:97]
 ds_read_b128 v[136:139], v114 offset:21504
 ds_read_b128 v[140:143], v114 offset:22016
 s_mov_b64 exec, -1
 v_exp_f32 v170, v170
 v_exp_f32 v171, v171
 v_exp_f32 v172, v172
 v_exp_f32 v173, v173
 s_waitcnt vmcnt(13)
 v_mfma_f32_16x16x32_bf16 v[228:231], v[88:91], v[72:75], v[228:231]
 v_mfma_f32_16x16x32_bf16 v[228:231], v[92:95], v[76:79], v[228:231]
 buffer_load_dwordx4 v[212:215], v122, s[28:31], s83 offen offset:2048 sc1
 v_exp_f32 v174, v174
 v_exp_f32 v175, v175
 v_exp_f32 v176, v176
 v_exp_f32 v177, v177
 v_smfmac_f32_32x32x32_bf16 v[32:47], v[132:135], v[168:175], v112
 s_waitcnt lgkmcnt(0)
 v_exp_f32 v178, v178
 v_exp_f32 v179, v179
 v_exp_f32 v180, v180
 v_mfma_f32_32x32x16_bf16 v[160:175], v[108:111], v[144:147], 0
 buffer_load_dwordx4 v[216:219], v122, s[28:31], s83 offen offset:256 sc1
 v_exp_f32 v181, v181
 v_exp_f32 v182, v182
 v_exp_f32 v183, v183
 v_exp_f32 v184, v184
 v_exp_f32 v185, v185
 v_smfmac_f32_32x32x32_bf16 v[48:63], v[128:131], v[176:183], v112
 buffer_load_dwordx4 v[220:223], v122, s[28:31], s83 offen offset:2304 sc1
 v_exp_f32 v186, v186
 v_exp_f32 v187, v187
 v_exp_f32 v188, v188
 v_exp_f32 v189, v189
 v_mfma_f32_16x16x32_bf16 v[232:235], v[96:99], v[64:67], v[232:235]
 v_mfma_f32_16x16x32_bf16 v[232:235], v[100:103], v[68:71], v[232:235]
 v_exp_f32 v190, v190
 v_exp_f32 v191, v191
 v_exp_f32 v160, v160
 v_exp_f32 v161, v161
 v_smfmac_f32_32x32x32_bf16 v[48:63], v[132:135], v[184:191], v112
 ds_read_b128 v[104:107], v113 offset:24576
 v_exp_f32 v162, v162
 v_exp_f32 v163, v163
 v_exp_f32 v164, v164
 v_mfma_f32_32x32x16_bf16 v[176:191], v[108:111], v[148:151], 0
 ds_read_b64_tr_b16 v[88:89], v2 offset:32768
 ds_read_b64_tr_b16 v[90:91], v2 offset:34816
 v_exp_f32 v165, v165
 v_exp_f32 v166, v166
 v_exp_f32 v167, v167
 v_exp_f32 v168, v168
 v_exp_f32 v169, v169
 v_smfmac_f32_32x32x32_bf16 v[32:47], v[136:139], v[160:167], v112
 ds_read_b64_tr_b16 v[92:93], v2 offset:36864
 ds_read_b64_tr_b16 v[94:95], v2 offset:38912
 s_mov_b64 exec, s[96:97]
 ds_read_b128 v[128:131], v114 offset:25600
 ds_read_b128 v[132:135], v114 offset:26112
 s_mov_b64 exec, -1
 v_exp_f32 v170, v170
 v_exp_f32 v171, v171
 v_exp_f32 v172, v172
 v_exp_f32 v173, v173
 v_mfma_f32_16x16x32_bf16 v[236:239], v[96:99], v[72:75], v[236:239]
 v_mfma_f32_16x16x32_bf16 v[236:239], v[100:103], v[76:79], v[236:239]
 s_add_u32 s83, s81, 5
 s_cmp_ge_u32 s83, 7
 s_cselect_b32 s63, 7, 0
 s_sub_u32 s83, s83, s63
 s_lshl_b32 s83, s83, 12
 s_add_u32 s83, s83, s69
 buffer_load_dwordx4 v[16:19], v122, s[28:31], s83 offen offset:0 sc1
 v_exp_f32 v174, v174
 v_exp_f32 v175, v175
 v_exp_f32 v176, v176
 v_exp_f32 v177, v177
 v_smfmac_f32_32x32x32_bf16 v[32:47], v[140:143], v[168:175], v112
 s_waitcnt lgkmcnt(0)
 s_setprio 1
 v_exp_f32 v178, v178
 v_exp_f32 v179, v179
 v_exp_f32 v180, v180
 v_mfma_f32_32x32x16_bf16 v[160:175], v[104:107], v[144:147], 0
 buffer_load_dwordx4 v[20:23], v122, s[28:31], s83 offen offset:2048 sc1
 v_exp_f32 v181, v181
 v_exp_f32 v182, v182
 v_exp_f32 v183, v183
 v_exp_f32 v184, v184
 v_exp_f32 v185, v185
 v_smfmac_f32_32x32x32_bf16 v[48:63], v[136:139], v[176:183], v112
 buffer_load_dwordx4 v[24:27], v122, s[28:31], s83 offen offset:256 sc1
 v_exp_f32 v186, v186
 v_exp_f32 v187, v187
 v_exp_f32 v188, v188
 v_exp_f32 v189, v189
 v_mfma_f32_16x16x32_bf16 v[240:243], v[88:91], v[64:67], v[240:243]
 v_mfma_f32_16x16x32_bf16 v[240:243], v[92:95], v[68:71], v[240:243]
 v_exp_f32 v190, v190
 v_exp_f32 v191, v191
 v_exp_f32 v160, v160
 v_exp_f32 v161, v161
 v_smfmac_f32_32x32x32_bf16 v[48:63], v[140:143], v[184:191], v112
 ds_read_b128 v[108:111], v113 offset:28672
 v_exp_f32 v162, v162
 v_exp_f32 v163, v163
 v_exp_f32 v164, v164
 v_mfma_f32_32x32x16_bf16 v[176:191], v[104:107], v[148:151], 0
 ds_read_b64_tr_b16 v[96:97], v3 offset:32768
 ds_read_b64_tr_b16 v[98:99], v3 offset:34816
 v_exp_f32 v165, v165
 v_exp_f32 v166, v166
 v_exp_f32 v167, v167
 v_exp_f32 v168, v168
 v_exp_f32 v169, v169
 v_smfmac_f32_32x32x32_bf16 v[32:47], v[128:131], v[160:167], v112
 ds_read_b64_tr_b16 v[100:101], v3 offset:36864
 ds_read_b64_tr_b16 v[102:103], v3 offset:38912
 s_mov_b64 exec, s[96:97]
 ds_read_b128 v[136:139], v114 offset:29696
 ds_read_b128 v[140:143], v114 offset:30208
 s_mov_b64 exec, -1
 v_exp_f32 v170, v170
 v_exp_f32 v171, v171
 v_exp_f32 v172, v172
 v_exp_f32 v173, v173
 v_mfma_f32_16x16x32_bf16 v[244:247], v[88:91], v[72:75], v[244:247]
 v_mfma_f32_16x16x32_bf16 v[244:247], v[92:95], v[76:79], v[244:247]
 buffer_load_dwordx4 v[28:31], v122, s[28:31], s83 offen offset:2304 sc1
 v_exp_f32 v174, v174
 v_exp_f32 v175, v175
 v_exp_f32 v176, v176
 v_exp_f32 v177, v177
 v_smfmac_f32_32x32x32_bf16 v[32:47], v[132:135], v[168:175], v112
 s_waitcnt lgkmcnt(0)
 v_exp_f32 v178, v178
 v_exp_f32 v179, v179
 v_exp_f32 v180, v180
 v_mfma_f32_32x32x16_bf16 v[160:175], v[108:111], v[144:147], 0
 v_exp_f32 v181, v181
 v_exp_f32 v182, v182
 v_exp_f32 v183, v183
 v_exp_f32 v184, v184
 v_exp_f32 v185, v185
 v_smfmac_f32_32x32x32_bf16 v[48:63], v[128:131], v[176:183], v112
 s_setprio 0
 v_exp_f32 v186, v186
 v_exp_f32 v187, v187
 v_exp_f32 v188, v188
 v_exp_f32 v189, v189
 v_mfma_f32_16x16x32_bf16 v[248:251], v[96:99], v[64:67], v[248:251]
 v_mfma_f32_16x16x32_bf16 v[248:251], v[100:103], v[68:71], v[248:251]
 v_exp_f32 v190, v190
 v_exp_f32 v191, v191
 s_waitcnt vmcnt(10)
 s_barrier
 v_exp_f32 v160, v160
 v_exp_f32 v161, v161
 v_smfmac_f32_32x32x32_bf16 v[48:63], v[132:135], v[184:191], v112
 ds_read_b128 v[104:107], v113 offset:32768
 s_setprio 3
 v_exp_f32 v162, v162
 v_exp_f32 v163, v163
 v_exp_f32 v164, v164
 v_mfma_f32_32x32x16_bf16 v[176:191], v[108:111], v[148:151], 0
 ds_read_b64_tr_b16 v[88:89], v5 offset:32768
 ds_read_b64_tr_b16 v[90:91], v5 offset:34816
 v_exp_f32 v165, v165
 v_exp_f32 v166, v166
 v_exp_f32 v167, v167
 v_exp_f32 v168, v168
 v_exp_f32 v169, v169
 v_smfmac_f32_32x32x32_bf16 v[32:47], v[136:139], v[160:167], v112
 ds_read_b64_tr_b16 v[92:93], v5 offset:36864
 ds_read_b64_tr_b16 v[94:95], v5 offset:38912
 s_mov_b64 exec, s[96:97]
 ds_read_b128 v[128:131], v114 offset:33792
 ds_read_b128 v[132:135], v114 offset:34304
 s_mov_b64 exec, -1
 v_exp_f32 v170, v170
 v_exp_f32 v171, v171
 v_exp_f32 v172, v172
 v_exp_f32 v173, v173
 v_mfma_f32_16x16x32_bf16 v[252:255], v[96:99], v[72:75], v[252:255]
 v_mfma_f32_16x16x32_bf16 v[252:255], v[100:103], v[76:79], v[252:255]
 v_exp_f32 v174, v174
 v_exp_f32 v175, v175
 v_exp_f32 v176, v176
 v_exp_f32 v177, v177
 v_smfmac_f32_32x32x32_bf16 v[32:47], v[140:143], v[168:175], v112
 s_waitcnt lgkmcnt(0)
 v_exp_f32 v178, v178
 v_exp_f32 v179, v179
 v_exp_f32 v180, v180
 v_mfma_f32_32x32x16_bf16 v[160:175], v[104:107], v[144:147], 0
 s_add_u32 s82, s81, 3
 s_cmp_ge_u32 s82, 7
 s_cselect_b32 s63, 7, 0
 s_sub_u32 s82, s82, s63
 s_add_u32 m0, s53, 0
 s_lshl_b32 s82, s82, 16
 buffer_load_dwordx4 v116, s[32:35], s82 offen lds
 v_exp_f32 v181, v181
 v_exp_f32 v182, v182
 v_exp_f32 v183, v183
 v_exp_f32 v184, v184
 v_exp_f32 v185, v185
 v_smfmac_f32_32x32x32_bf16 v[48:63], v[136:139], v[176:183], v112
 s_add_u32 m0, s53, 8192
 s_add_u32 s82, s82, 458752
 buffer_load_dwordx4 v116, s[32:35], s82 offen lds
 v_exp_f32 v186, v186
 v_exp_f32 v187, v187
 v_exp_f32 v188, v188
 v_exp_f32 v189, v189
 v_mfma_f32_16x16x32_bf16 v[224:227], v[88:91], v[80:83], v[224:227]
 v_mfma_f32_16x16x32_bf16 v[224:227], v[92:95], v[84:87], v[224:227]
 v_exp_f32 v190, v190
 v_exp_f32 v191, v191
 v_exp_f32 v160, v160
 v_exp_f32 v161, v161
 v_smfmac_f32_32x32x32_bf16 v[48:63], v[140:143], v[184:191], v112
 ds_read_b128 v[108:111], v113 offset:36864
 v_exp_f32 v162, v162
 v_exp_f32 v163, v163
 v_exp_f32 v164, v164
 v_mfma_f32_32x32x16_bf16 v[176:191], v[104:107], v[148:151], 0
 ds_read_b64_tr_b16 v[96:97], v6 offset:32768
 ds_read_b64_tr_b16 v[98:99], v6 offset:34816
 v_exp_f32 v165, v165
 v_exp_f32 v166, v166
 v_exp_f32 v167, v167
 v_exp_f32 v168, v168
 v_exp_f32 v169, v169
 v_smfmac_f32_32x32x32_bf16 v[32:47], v[128:131], v[160:167], v112
 ds_read_b64_tr_b16 v[100:101], v6 offset:36864
 ds_read_b64_tr_b16 v[102:103], v6 offset:38912
 s_mov_b64 exec, s[96:97]
 ds_read_b128 v[136:139], v114 offset:37888
 ds_read_b128 v[140:143], v114 offset:38400
 s_mov_b64 exec, -1
 v_exp_f32 v170, v170
 v_exp_f32 v171, v171
 v_exp_f32 v172, v172
 v_exp_f32 v173, v173
 v_mfma_f32_16x16x32_bf16 v[228:231], v[88:91], v[152:155], v[228:231]
 v_mfma_f32_16x16x32_bf16 v[228:231], v[92:95], v[156:159], v[228:231]
 s_add_u32 s83, s81, 6
 s_cmp_ge_u32 s83, 7
 s_cselect_b32 s63, 7, 0
 s_sub_u32 s83, s83, s63
 s_lshl_b32 s83, s83, 12
 s_add_u32 s83, s83, s69
 buffer_load_dwordx4 v[64:67], v122, s[28:31], s83 offen offset:0 sc1
 v_exp_f32 v174, v174
 v_exp_f32 v175, v175
 v_exp_f32 v176, v176
 v_exp_f32 v177, v177
 v_smfmac_f32_32x32x32_bf16 v[32:47], v[132:135], v[168:175], v112
 s_waitcnt lgkmcnt(0)
 v_exp_f32 v178, v178
 v_exp_f32 v179, v179
 v_exp_f32 v180, v180
 v_mfma_f32_32x32x16_bf16 v[160:175], v[108:111], v[144:147], 0
 s_add_u32 m0, s53, 16384
 s_add_u32 s82, s82, 458752
 buffer_load_dwordx4 v116, s[32:35], s82 offen lds
 v_exp_f32 v181, v181
 v_exp_f32 v182, v182
 v_exp_f32 v183, v183
 v_exp_f32 v184, v184
 v_exp_f32 v185, v185
 v_smfmac_f32_32x32x32_bf16 v[48:63], v[128:131], v[176:183], v112
 s_add_u32 m0, s53, 24576
 s_add_u32 s82, s82, 458752
 buffer_load_dwordx4 v116, s[32:35], s82 offen lds
 v_exp_f32 v186, v186
 v_exp_f32 v187, v187
 v_exp_f32 v188, v188
 v_exp_f32 v189, v189
 v_mfma_f32_16x16x32_bf16 v[232:235], v[96:99], v[80:83], v[232:235]
 v_mfma_f32_16x16x32_bf16 v[232:235], v[100:103], v[84:87], v[232:235]
 v_exp_f32 v190, v190
 v_exp_f32 v191, v191
 v_exp_f32 v160, v160
 v_exp_f32 v161, v161
 v_smfmac_f32_32x32x32_bf16 v[48:63], v[132:135], v[184:191], v112
 ds_read_b128 v[104:107], v113 offset:40960
 s_setprio 2
 v_exp_f32 v162, v162
 v_exp_f32 v163, v163
 v_exp_f32 v164, v164
 v_mfma_f32_32x32x16_bf16 v[176:191], v[108:111], v[148:151], 0
 ds_read_b64_tr_b16 v[88:89], v14 offset:32768
 ds_read_b64_tr_b16 v[90:91], v14 offset:34816
 v_exp_f32 v165, v165
 v_exp_f32 v166, v166
 v_exp_f32 v167, v167
 v_exp_f32 v168, v168
 v_exp_f32 v169, v169
 v_smfmac_f32_32x32x32_bf16 v[32:47], v[136:139], v[160:167], v112
 ds_read_b64_tr_b16 v[92:93], v14 offset:36864
 ds_read_b64_tr_b16 v[94:95], v14 offset:38912
 s_mov_b64 exec, s[96:97]
 ds_read_b128 v[128:131], v114 offset:41984
 ds_read_b128 v[132:135], v114 offset:42496
 s_mov_b64 exec, -1
 v_exp_f32 v170, v170
 v_exp_f32 v171, v171
 v_exp_f32 v172, v172
 v_exp_f32 v173, v173
 v_mfma_f32_16x16x32_bf16 v[236:239], v[96:99], v[152:155], v[236:239]
 v_mfma_f32_16x16x32_bf16 v[236:239], v[100:103], v[156:159], v[236:239]
 buffer_load_dwordx4 v[68:71], v122, s[28:31], s83 offen offset:2048 sc1
 v_exp_f32 v174, v174
 v_exp_f32 v175, v175
 v_exp_f32 v176, v176
 v_exp_f32 v177, v177
 v_smfmac_f32_32x32x32_bf16 v[32:47], v[140:143], v[168:175], v112
 s_waitcnt lgkmcnt(0)
 v_exp_f32 v178, v178
 v_exp_f32 v179, v179
 v_exp_f32 v180, v180
 v_mfma_f32_32x32x16_bf16 v[160:175], v[104:107], v[144:147], 0
 s_add_u32 s82, s81, 4
 s_cmp_ge_u32 s82, 7
 s_cselect_b32 s63, 7, 0
 s_sub_u32 s82, s82, s63
 s_add_u32 m0, s53, 32768
 s_lshl_b32 s82, s82, 16
 buffer_load_dwordx4 v116, s[32:35], s82 offen lds
 v_exp_f32 v181, v181
 v_exp_f32 v182, v182
 v_exp_f32 v183, v183
 v_exp_f32 v184, v184
 v_exp_f32 v185, v185
 v_smfmac_f32_32x32x32_bf16 v[48:63], v[136:139], v[176:183], v112
 s_add_u32 m0, s53, 40960
 s_add_u32 s82, s82, 458752
 buffer_load_dwordx4 v116, s[32:35], s82 offen lds
 v_exp_f32 v186, v186
 v_exp_f32 v187, v187
 v_exp_f32 v188, v188
 v_exp_f32 v189, v189
 v_mfma_f32_16x16x32_bf16 v[240:243], v[88:91], v[80:83], v[240:243]
 v_mfma_f32_16x16x32_bf16 v[240:243], v[92:95], v[84:87], v[240:243]
 v_exp_f32 v190, v190
 v_exp_f32 v191, v191
 v_exp_f32 v160, v160
 v_exp_f32 v161, v161
 v_smfmac_f32_32x32x32_bf16 v[48:63], v[140:143], v[184:191], v112
 ds_read_b128 v[108:111], v113 offset:45056
 v_exp_f32 v162, v162
 v_exp_f32 v163, v163
 v_exp_f32 v164, v164
 v_mfma_f32_32x32x16_bf16 v[176:191], v[104:107], v[148:151], 0
 ds_read_b64_tr_b16 v[96:97], v15 offset:32768
 ds_read_b64_tr_b16 v[98:99], v15 offset:34816
 v_exp_f32 v165, v165
 v_exp_f32 v166, v166
 v_exp_f32 v167, v167
 v_exp_f32 v168, v168
 v_exp_f32 v169, v169
 v_smfmac_f32_32x32x32_bf16 v[32:47], v[128:131], v[160:167], v112
 ds_read_b64_tr_b16 v[100:101], v15 offset:36864
 ds_read_b64_tr_b16 v[102:103], v15 offset:38912
 s_mov_b64 exec, s[96:97]
 ds_read_b128 v[136:139], v114 offset:46080
 ds_read_b128 v[140:143], v114 offset:46592
 s_mov_b64 exec, -1
 v_exp_f32 v170, v170
 v_exp_f32 v171, v171
 v_exp_f32 v172, v172
 v_exp_f32 v173, v173
 v_mfma_f32_16x16x32_bf16 v[244:247], v[88:91], v[152:155], v[244:247]
 v_mfma_f32_16x16x32_bf16 v[244:247], v[92:95], v[156:159], v[244:247]
 buffer_load_dwordx4 v[72:75], v122, s[28:31], s83 offen offset:256 sc1
 v_exp_f32 v174, v174
 v_exp_f32 v175, v175
 v_exp_f32 v176, v176
 v_exp_f32 v177, v177
 v_smfmac_f32_32x32x32_bf16 v[32:47], v[132:135], v[168:175], v112
 s_waitcnt lgkmcnt(0)
 s_setprio 1
 v_exp_f32 v178, v178
 v_exp_f32 v179, v179
 v_exp_f32 v180, v180
 v_mfma_f32_32x32x16_bf16 v[160:175], v[108:111], v[144:147], 0
 s_add_u32 m0, s53, 49152
 s_add_u32 s82, s82, 458752
 buffer_load_dwordx4 v116, s[32:35], s82 offen lds
 v_exp_f32 v181, v181
 v_exp_f32 v182, v182
 v_exp_f32 v183, v183
 v_exp_f32 v184, v184
 v_exp_f32 v185, v185
 v_smfmac_f32_32x32x32_bf16 v[48:63], v[128:131], v[176:183], v112
 s_add_u32 m0, s53, 57344
 s_add_u32 s82, s82, 458752
 buffer_load_dwordx4 v116, s[32:35], s82 offen lds
 v_exp_f32 v186, v186
 v_exp_f32 v187, v187
 v_exp_f32 v188, v188
 v_exp_f32 v189, v189
 v_mfma_f32_16x16x32_bf16 v[248:251], v[96:99], v[80:83], v[248:251]
 v_mfma_f32_16x16x32_bf16 v[248:251], v[100:103], v[84:87], v[248:251]
 v_exp_f32 v190, v190
 v_exp_f32 v191, v191
 v_exp_f32 v160, v160
 v_exp_f32 v161, v161
 v_smfmac_f32_32x32x32_bf16 v[48:63], v[132:135], v[184:191], v112
 ds_read_b128 v[104:107], v113 offset:49152
 v_exp_f32 v162, v162
 v_exp_f32 v163, v163
 v_exp_f32 v164, v164
 v_mfma_f32_32x32x16_bf16 v[176:191], v[108:111], v[148:151], 0
 v_exp_f32 v165, v165
 v_exp_f32 v166, v166
 v_exp_f32 v167, v167
 v_exp_f32 v168, v168
 v_exp_f32 v169, v169
 v_smfmac_f32_32x32x32_bf16 v[32:47], v[136:139], v[160:167], v112
 s_mov_b64 exec, s[96:97]
 ds_read_b128 v[128:131], v114 offset:50176
 ds_read_b128 v[132:135], v114 offset:50688
 s_mov_b64 exec, -1
 v_exp_f32 v170, v170
 v_exp_f32 v171, v171
 v_exp_f32 v172, v172
 v_exp_f32 v173, v173
 v_mfma_f32_16x16x32_bf16 v[252:255], v[96:99], v[152:155], v[252:255]
 v_mfma_f32_16x16x32_bf16 v[252:255], v[100:103], v[156:159], v[252:255]
 buffer_load_dwordx4 v[76:79], v122, s[28:31], s83 offen offset:2304 sc1
 v_exp_f32 v174, v174
 v_exp_f32 v175, v175
 v_exp_f32 v176, v176
 v_exp_f32 v177, v177
 v_smfmac_f32_32x32x32_bf16 v[32:47], v[140:143], v[168:175], v112
 s_waitcnt lgkmcnt(0)
 v_exp_f32 v178, v178
 v_exp_f32 v179, v179
 v_exp_f32 v180, v180
 v_mfma_f32_32x32x16_bf16 v[160:175], v[104:107], v[144:147], 0
 s_add_u32 s82, s81, 6
 s_cmp_ge_u32 s82, 7
 s_cselect_b32 s63, 7, 0
 s_sub_u32 s82, s82, s63
 s_add_u32 m0, s53, 65536
 s_lshl_b32 s82, s82, 16
 buffer_load_dwordx4 v116, s[32:35], s82 offen lds
 v_exp_f32 v181, v181
 v_exp_f32 v182, v182
 v_exp_f32 v183, v183
 v_exp_f32 v184, v184
 v_exp_f32 v185, v185
 v_smfmac_f32_32x32x32_bf16 v[48:63], v[136:139], v[176:183], v112
 s_setprio 0
 s_add_u32 m0, s53, 73728
 s_add_u32 s82, s82, 458752
 buffer_load_dwordx4 v116, s[32:35], s82 offen lds
 v_exp_f32 v186, v186
 v_exp_f32 v187, v187
 v_exp_f32 v188, v188
 v_exp_f32 v189, v189
 v_exp_f32 v190, v190
 v_exp_f32 v191, v191
 s_barrier
 v_exp_f32 v160, v160
 v_exp_f32 v161, v161
 v_smfmac_f32_32x32x32_bf16 v[48:63], v[140:143], v[184:191], v112
 ds_read_b128 v[108:111], v113 offset:53248
 s_setprio 3
 v_exp_f32 v162, v162
 v_exp_f32 v163, v163
 v_exp_f32 v164, v164
 v_mfma_f32_32x32x16_bf16 v[176:191], v[104:107], v[148:151], 0
 v_exp_f32 v165, v165
 v_exp_f32 v166, v166
 v_exp_f32 v167, v167
 v_exp_f32 v168, v168
 v_exp_f32 v169, v169
 v_smfmac_f32_32x32x32_bf16 v[32:47], v[128:131], v[160:167], v112
 s_mov_b64 exec, s[96:97]
 ds_read_b128 v[136:139], v114 offset:54272
 ds_read_b128 v[140:143], v114 offset:54784
 s_mov_b64 exec, -1
 v_exp_f32 v170, v170
 v_exp_f32 v171, v171
 v_exp_f32 v172, v172
 v_exp_f32 v173, v173
 v_exp_f32 v174, v174
 v_exp_f32 v175, v175
 v_exp_f32 v176, v176
 v_exp_f32 v177, v177
 v_smfmac_f32_32x32x32_bf16 v[32:47], v[132:135], v[168:175], v112
 s_waitcnt lgkmcnt(0)
 v_exp_f32 v178, v178
 v_exp_f32 v179, v179
 v_exp_f32 v180, v180
 v_mfma_f32_32x32x16_bf16 v[160:175], v[108:111], v[144:147], 0
 s_add_u32 m0, s53, 81920
 s_add_u32 s82, s82, 458752
 buffer_load_dwordx4 v116, s[32:35], s82 offen lds
 v_exp_f32 v181, v181
 v_exp_f32 v182, v182
 v_exp_f32 v183, v183
 v_exp_f32 v184, v184
 v_exp_f32 v185, v185
 v_smfmac_f32_32x32x32_bf16 v[48:63], v[128:131], v[176:183], v112
 s_add_u32 m0, s53, 90112
 s_add_u32 s82, s82, 458752
 buffer_load_dwordx4 v116, s[32:35], s82 offen lds
 v_exp_f32 v186, v186
 v_exp_f32 v187, v187
 v_exp_f32 v188, v188
 v_exp_f32 v189, v189
 v_exp_f32 v190, v190
 v_exp_f32 v191, v191
 v_exp_f32 v160, v160
 v_exp_f32 v161, v161
 v_smfmac_f32_32x32x32_bf16 v[48:63], v[132:135], v[184:191], v112
 ds_read_b128 v[104:107], v113 offset:57344
 s_setprio 2
 v_exp_f32 v162, v162
 v_exp_f32 v163, v163
 v_exp_f32 v164, v164
 v_mfma_f32_32x32x16_bf16 v[176:191], v[108:111], v[148:151], 0
 v_exp_f32 v165, v165
 v_exp_f32 v166, v166
 v_exp_f32 v167, v167
 v_exp_f32 v168, v168
 v_exp_f32 v169, v169
 v_smfmac_f32_32x32x32_bf16 v[32:47], v[136:139], v[160:167], v112
 s_mov_b64 exec, s[96:97]
 ds_read_b128 v[128:131], v114 offset:58368
 ds_read_b128 v[132:135], v114 offset:58880
 s_mov_b64 exec, -1
 v_exp_f32 v170, v170
 v_exp_f32 v171, v171
 v_exp_f32 v172, v172
 v_exp_f32 v173, v173
 v_exp_f32 v174, v174
 v_exp_f32 v175, v175
 v_exp_f32 v176, v176
 v_exp_f32 v177, v177
 v_smfmac_f32_32x32x32_bf16 v[32:47], v[140:143], v[168:175], v112
 s_waitcnt lgkmcnt(0)
 v_exp_f32 v178, v178
 v_exp_f32 v179, v179
 v_exp_f32 v180, v180
 v_mfma_f32_32x32x16_bf16 v[160:175], v[104:107], v[144:147], 0
 ds_read_b128 v[108:111], v113 offset:61440
 s_add_u32 s82, s81, 5
 s_cmp_ge_u32 s82, 7
 s_cselect_b32 s63, 7, 0
 s_sub_u32 s82, s82, s63
 s_add_u32 m0, s53, 131072
 s_lshl_b32 s82, s82, 16
 buffer_load_dwordx4 v116, s[32:35], s82 offen lds
 v_exp_f32 v181, v181
 v_exp_f32 v182, v182
 v_exp_f32 v183, v183
 v_exp_f32 v184, v184
 v_exp_f32 v185, v185
 v_smfmac_f32_32x32x32_bf16 v[48:63], v[136:139], v[176:183], v112
 s_add_u32 m0, s53, 139264
 s_add_u32 s82, s82, 458752
 buffer_load_dwordx4 v116, s[32:35], s82 offen lds
 v_exp_f32 v186, v186
 v_exp_f32 v187, v187
 v_exp_f32 v188, v188
 v_exp_f32 v189, v189
 v_exp_f32 v190, v190
 v_exp_f32 v191, v191
 v_exp_f32 v160, v160
 v_exp_f32 v161, v161
 v_smfmac_f32_32x32x32_bf16 v[48:63], v[140:143], v[184:191], v112
 s_waitcnt lgkmcnt(0)
 s_setprio 1
 v_exp_f32 v162, v162
 v_exp_f32 v163, v163
 v_exp_f32 v164, v164
 v_mfma_f32_32x32x16_bf16 v[176:191], v[108:111], v[144:147], 0
 v_exp_f32 v165, v165
 v_exp_f32 v166, v166
 v_exp_f32 v167, v167
 v_exp_f32 v168, v168
 v_exp_f32 v169, v169
 v_smfmac_f32_32x32x32_bf16 v[32:47], v[128:131], v[160:167], v112
 s_mov_b64 exec, s[96:97]
 ds_read_b128 v[136:139], v114 offset:62464
 ds_read_b128 v[140:143], v114 offset:62976
 s_mov_b64 exec, -1
 v_exp_f32 v170, v170
 v_exp_f32 v171, v171
 v_exp_f32 v172, v172
 v_exp_f32 v173, v173
 v_exp_f32 v174, v174
 v_exp_f32 v175, v175
 v_exp_f32 v176, v176
 v_exp_f32 v177, v177
 v_smfmac_f32_32x32x32_bf16 v[32:47], v[132:135], v[168:175], v112
 s_waitcnt lgkmcnt(0)
 v_exp_f32 v178, v178
 v_exp_f32 v179, v179
 v_exp_f32 v180, v180
 v_mfma_f32_32x32x16_bf16 v[160:175], v[104:107], v[148:151], 0
 s_add_u32 m0, s53, 147456
 s_add_u32 s82, s82, 458752
 buffer_load_dwordx4 v116, s[32:35], s82 offen lds
 v_exp_f32 v181, v181
 v_exp_f32 v182, v182
 v_exp_f32 v183, v183
 v_exp_f32 v184, v184
 v_exp_f32 v185, v185
 v_smfmac_f32_32x32x32_bf16 v[32:47], v[136:139], v[176:183], v112
 s_setprio 0
 s_add_u32 m0, s53, 155648
 s_add_u32 s82, s82, 458752
 buffer_load_dwordx4 v116, s[32:35], s82 offen lds
 v_exp_f32 v186, v186
 v_exp_f32 v187, v187
 v_exp_f32 v188, v188
 v_exp_f32 v189, v189
 v_exp_f32 v190, v190
 v_exp_f32 v191, v191
 v_exp_f32 v160, v160
 v_exp_f32 v161, v161
 v_smfmac_f32_32x32x32_bf16 v[32:47], v[140:143], v[184:191], v112
 v_exp_f32 v162, v162
 v_exp_f32 v163, v163
 v_exp_f32 v164, v164
 v_mfma_f32_32x32x16_bf16 v[176:191], v[108:111], v[148:151], 0
 v_exp_f32 v165, v165
 v_exp_f32 v166, v166
 v_exp_f32 v167, v167
 v_exp_f32 v168, v168
 v_exp_f32 v169, v169
 v_smfmac_f32_32x32x32_bf16 v[48:63], v[128:131], v[160:167], v112
 v_exp_f32 v170, v170
 v_exp_f32 v171, v171
 v_exp_f32 v172, v172
 ds_write_b128 v7, v[32:35] offset:0
 ds_write_b128 v7, v[36:39] offset:1024
 ds_write_b32 v119, v40 offset:2048
 v_exp_f32 v173, v173
 v_exp_f32 v174, v174
 v_exp_f32 v175, v175
 v_exp_f32 v176, v176
 v_exp_f32 v177, v177
 v_smfmac_f32_32x32x32_bf16 v[48:63], v[132:135], v[168:175], v112
 s_waitcnt vmcnt(9) lgkmcnt(0)
 s_barrier
 ds_read_b128 v[160:163], v8
 ds_read_b128 v[164:167], v8 offset:1024
 ds_read_b32 v168, v4 offset:2048
 v_exp_f32 v178, v178
 v_exp_f32 v179, v179
 v_exp_f32 v180, v180
 v_exp_f32 v181, v181
 v_exp_f32 v182, v182
 v_exp_f32 v183, v183
 v_exp_f32 v184, v184
 v_exp_f32 v185, v185
 v_smfmac_f32_32x32x32_bf16 v[48:63], v[136:139], v[176:183], v112
 v_exp_f32 v186, v186
 v_exp_f32 v187, v187
 v_exp_f32 v188, v188
 v_exp_f32 v189, v189
 v_exp_f32 v190, v190
 v_exp_f32 v191, v191
 s_lshl_b32 s62, s76, 5
 s_add_u32 s62, s62, s64
 v_smfmac_f32_32x32x32_bf16 v[48:63], v[140:143], v[184:191], v112
 s_lshl_b32 s68, s62, 10
 s_add_u32 s68, s68, 7340032
 ds_read_b64_tr_b16 v[88:89], v124 offset:0
 ds_read_b64_tr_b16 v[90:91], v124 offset:2048
 ds_read_b64_tr_b16 v[92:93], v124 offset:4096
 ds_read_b64_tr_b16 v[94:95], v124 offset:6144
 ds_read_b64_tr_b16 v[96:97], v1 offset:0
 ds_read_b64_tr_b16 v[98:99], v1 offset:2048
 ds_read_b64_tr_b16 v[100:101], v1 offset:4096
 ds_read_b64_tr_b16 v[102:103], v1 offset:6144
 s_waitcnt lgkmcnt(8)
 s_nop 0
 v_add_f32 v48, v48, v160
 v_add_f32 v49, v49, v161
 v_add_f32 v50, v50, v162
 v_add_f32 v51, v51, v163
 v_add_f32 v52, v52, v164
 v_add_f32 v53, v53, v165
 v_add_f32 v54, v54, v166
 v_add_f32 v55, v55, v167
 v_add_f32 v56, v56, v168
 v_fma_f32 v108, 0, v48, v56
 v_fmac_f32 v108, 0, v49
 v_fmac_f32 v108, 0, v50
 v_fmac_f32 v108, 0, v51
 v_fmac_f32 v108, 0, v52
 v_fmac_f32 v108, 0, v53
 v_fmac_f32 v108, 0, v54
 v_fmac_f32 v108, 0, v55
 v_cmp_lt_f32 vcc, 0x2b800000, v108
 s_nop 0
 s_mov_b64 s[98:99], vcc
 v_cmp_gt_f32 vcc, 0x5d800000, v108
 s_nop 0
 s_and_b64 vcc, vcc, s[98:99]
 s_cmp_eq_u64 vcc, -1
 s_cbranch_scc0 L_slow3
L_slowret3:
 v_rcp_f32 v108, v56
 s_nop 0
 v_mul_f32 v108, v108, v118
 v_mul_f32 v48, v48, v108
 v_mul_f32 v49, v49, v108
 v_mul_f32 v50, v50, v108
 v_mul_f32 v51, v51, v108
 v_mul_f32 v52, v52, v108
 v_mul_f32 v53, v53, v108
 v_mul_f32 v54, v54, v108
 v_mul_f32 v55, v55, v108
 v_cvt_pk_bf16_f32 v108, v48, v49
 v_cvt_pk_bf16_f32 v109, v50, v51
 v_cvt_pk_bf16_f32 v110, v52, v53
 v_cvt_pk_bf16_f32 v111, v54, v55
 v_min_u32 v108, -2, v108
 v_min_u32 v109, -2, v109
 v_min_u32 v110, -2, v110
 v_min_u32 v111, -2, v111
 buffer_store_dwordx4 v[108:111], v126, s[28:31], s68 offen sc1
 s_and_b32 s62, s52, 1
 s_bfe_u32 s63, s52, 0x10001
 s_sub_u32 s62, s62, s63
 s_lshl_b32 s62, s62, 13
 v_add_u32 v116, s62, v116
 s_waitcnt lgkmcnt(4)
 v_mfma_f32_16x16x32_bf16 v[224:227], v[88:91], v[192:195], v[224:227]
 s_setprio 1
 ds_read_b64_tr_b16 v[32:33], v2 offset:0
 ds_read_b64_tr_b16 v[34:35], v2 offset:2048
 v_mfma_f32_16x16x32_bf16 v[224:227], v[92:95], v[196:199], v[224:227]
 ds_read_b64_tr_b16 v[36:37], v2 offset:4096
 ds_read_b64_tr_b16 v[38:39], v2 offset:6144
 v_mfma_f32_16x16x32_bf16 v[228:231], v[88:91], v[200:203], v[228:231]
 ds_read_b64_tr_b16 v[40:41], v3 offset:0
 ds_read_b64_tr_b16 v[42:43], v3 offset:2048
 v_mfma_f32_16x16x32_bf16 v[228:231], v[92:95], v[204:207], v[228:231]
 s_setprio 0
 ds_read_b64_tr_b16 v[44:45], v3 offset:4096
 ds_read_b64_tr_b16 v[46:47], v3 offset:6144
 s_lshl_b32 s62, s71, 2
 s_add_u32 s62, s62, s72
 s_lshl_b32 s67, s62, 13
 s_lshr_b32 s68, s0, 4
 s_add_u32 s67, s67, s68
 s_add_u32 s67, s67, 7340032
 s_xor_b32 s70, s67, 4096
 v_and_b32 v13, 15, v0
 v_lshrrev_b32 v11, 4, v0
 v_xor_b32 v11, v11, v13
 s_waitcnt lgkmcnt(8)
 v_mfma_f32_16x16x32_bf16 v[232:235], v[96:99], v[192:195], v[232:235]
 s_setprio 1
 v_mfma_f32_16x16x32_bf16 v[232:235], v[100:103], v[196:199], v[232:235]
 v_mfma_f32_16x16x32_bf16 v[236:239], v[96:99], v[200:203], v[236:239]
 v_mfma_f32_16x16x32_bf16 v[236:239], v[100:103], v[204:207], v[236:239]
 s_setprio 0
 v_lshlrev_b32 v11, 4, v11
 v_lshl_add_u32 v11, v13, 8, v11
 s_lshl_b32 s68, s52, 13
 s_add_u32 s68, s68, 32768
 v_add_u32 v104, s68, v11
 v_xor_b32 v105, 64, v104
 v_xor_b32 v106, 128, v104
 s_waitcnt vmcnt(1) lgkmcnt(0)
 s_barrier
 v_mfma_f32_16x16x32_bf16 v[240:243], v[32:35], v[192:195], v[240:243]
 s_setprio 1
 ds_read_b64_tr_b16 v[144:145], v124 offset:32768
 v_mfma_f32_16x16x32_bf16 v[240:243], v[36:39], v[196:199], v[240:243]
 ds_read_b64_tr_b16 v[146:147], v124 offset:34816
 v_mfma_f32_16x16x32_bf16 v[244:247], v[32:35], v[200:203], v[244:247]
 ds_read_b64_tr_b16 v[148:149], v124 offset:36864
 v_mfma_f32_16x16x32_bf16 v[244:247], v[36:39], v[204:207], v[244:247]
 s_setprio 0
 ds_read_b64_tr_b16 v[150:151], v124 offset:38912
 s_add_u32 m0, s53, 98304
 s_xor_b32 s82, s0, 0
 buffer_load_dwordx4 v116, s[36:39], s82 offen lds
 s_add_u32 m0, s53, 106496
 s_xor_b32 s82, s0, 131072
 buffer_load_dwordx4 v116, s[36:39], s82 offen lds
 v_xor_b32 v107, 192, v104
 v_lshrrev_b32 v13, 3, v0
 s_lshl_b32 s68, s72, 3
 v_add_u32 v13, s68, v13
 v_and_b32 v11, 7, v0
 v_lshlrev_b32 v9, 1, v11
 v_and_b32 v8, 15, v13
 v_mfma_f32_16x16x32_bf16 v[248:251], v[40:43], v[192:195], v[248:251]
 s_setprio 1
 ds_read_b64_tr_b16 v[88:89], v1 offset:32768
 v_mfma_f32_16x16x32_bf16 v[248:251], v[44:47], v[196:199], v[248:251]
 ds_read_b64_tr_b16 v[90:91], v1 offset:34816
 v_mfma_f32_16x16x32_bf16 v[252:255], v[40:43], v[200:203], v[252:255]
 ds_read_b64_tr_b16 v[92:93], v1 offset:36864
 v_mfma_f32_16x16x32_bf16 v[252:255], v[44:47], v[204:207], v[252:255]
 s_setprio 0
 ds_read_b64_tr_b16 v[94:95], v1 offset:38912
 s_add_u32 m0, s53, 114688
 s_xor_b32 s82, s0, 262144
 buffer_load_dwordx4 v116, s[36:39], s82 offen lds
 s_add_u32 m0, s53, 122880
 s_xor_b32 s82, s0, 393216
 buffer_load_dwordx4 v116, s[36:39], s82 offen lds
 v_xor_b32 v9, v9, v8
 v_lshlrev_b32 v9, 4, v9
 v_lshl_add_u32 v9, v13, 8, v9
 s_and_b32 s68, s52, 1
 s_lshl_b32 s68, s68, 13
 s_add_u32 s68, s68, 32768
 v_add_u32 v10, s68, v9
 v_xor_b32 v9, 16, v10
 s_waitcnt lgkmcnt(4)
 v_mfma_f32_16x16x32_bf16 v[224:227], v[144:147], v[208:211], v[224:227]
 s_setprio 1
 ds_read_b64_tr_b16 v[96:97], v2 offset:32768
 v_mfma_f32_16x16x32_bf16 v[224:227], v[148:151], v[212:215], v[224:227]
 ds_read_b64_tr_b16 v[98:99], v2 offset:34816
 v_mfma_f32_16x16x32_bf16 v[228:231], v[144:147], v[216:219], v[228:231]
 ds_read_b64_tr_b16 v[100:101], v2 offset:36864
 v_mfma_f32_16x16x32_bf16 v[228:231], v[148:151], v[220:223], v[228:231]
 s_setprio 0
 ds_read_b64_tr_b16 v[102:103], v2 offset:38912
 s_add_u32 m0, s53, 0
 s_xor_b32 s82, s0, 65536
 buffer_load_dwordx4 v116, s[36:39], s82 offen lds
 s_add_u32 m0, s53, 8192
 s_xor_b32 s82, s0, 196608
 buffer_load_dwordx4 v116, s[36:39], s82 offen lds
 v_lshlrev_b32 v11, 4, v11
 v_lshl_add_u32 v12, v13, 10, v11
 s_lshl_b32 s62, s71, 15
 s_lshl_b32 s68, s73, 7
 s_add_u32 s77, s62, s68
 s_waitcnt lgkmcnt(4)
 v_mfma_f32_16x16x32_bf16 v[232:235], v[88:91], v[208:211], v[232:235]
 s_setprio 1
 ds_read_b64_tr_b16 v[144:145], v3 offset:32768
 v_mfma_f32_16x16x32_bf16 v[232:235], v[92:95], v[212:215], v[232:235]
 ds_read_b64_tr_b16 v[146:147], v3 offset:34816
 v_mfma_f32_16x16x32_bf16 v[236:239], v[88:91], v[216:219], v[236:239]
 ds_read_b64_tr_b16 v[148:149], v3 offset:36864
 v_mfma_f32_16x16x32_bf16 v[236:239], v[92:95], v[220:223], v[236:239]
 s_setprio 0
 ds_read_b64_tr_b16 v[150:151], v3 offset:38912
 s_add_u32 m0, s53, 16384
 s_xor_b32 s82, s0, 327680
 buffer_load_dwordx4 v116, s[36:39], s82 offen lds
 s_waitcnt lgkmcnt(4)
 v_mfma_f32_16x16x32_bf16 v[240:243], v[96:99], v[208:211], v[240:243]
 s_setprio 1
 ds_read_b64_tr_b16 v[88:89], v5 offset:32768
 v_mfma_f32_16x16x32_bf16 v[240:243], v[100:103], v[212:215], v[240:243]
 ds_read_b64_tr_b16 v[90:91], v5 offset:34816
 v_mfma_f32_16x16x32_bf16 v[244:247], v[96:99], v[216:219], v[244:247]
 ds_read_b64_tr_b16 v[92:93], v5 offset:36864
 v_mfma_f32_16x16x32_bf16 v[244:247], v[100:103], v[220:223], v[244:247]
 s_setprio 0
 ds_read_b64_tr_b16 v[94:95], v5 offset:38912
 v_add_u32 v5, 4294934528, v5
 s_add_u32 m0, s53, 24576
 s_xor_b32 s82, s0, 458752
 buffer_load_dwordx4 v116, s[36:39], s82 offen lds
 s_waitcnt lgkmcnt(4)
 v_mfma_f32_16x16x32_bf16 v[248:251], v[144:147], v[208:211], v[248:251]
 s_setprio 1
 ds_read_b64_tr_b16 v[96:97], v6 offset:32768
 v_mfma_f32_16x16x32_bf16 v[248:251], v[148:151], v[212:215], v[248:251]
 ds_read_b64_tr_b16 v[98:99], v6 offset:34816
 v_mfma_f32_16x16x32_bf16 v[252:255], v[144:147], v[216:219], v[252:255]
 ds_read_b64_tr_b16 v[100:101], v6 offset:36864
 v_mfma_f32_16x16x32_bf16 v[252:255], v[148:151], v[220:223], v[252:255]
 s_setprio 0
 ds_read_b64_tr_b16 v[102:103], v6 offset:38912
 v_add_u32 v6, 4294934528, v6
 buffer_load_dwordx4 v[160:163], v122, s[28:31], s67 offen offset:0 sc1
 s_waitcnt lgkmcnt(4)
 v_mfma_f32_16x16x32_bf16 v[224:227], v[88:91], v[16:19], v[224:227]
 s_setprio 1
 ds_read_b64_tr_b16 v[144:145], v14 offset:32768
 v_mfma_f32_16x16x32_bf16 v[224:227], v[92:95], v[20:23], v[224:227]
 ds_read_b64_tr_b16 v[146:147], v14 offset:34816
 v_mfma_f32_16x16x32_bf16 v[228:231], v[88:91], v[24:27], v[228:231]
 ds_read_b64_tr_b16 v[148:149], v14 offset:36864
 v_mfma_f32_16x16x32_bf16 v[228:231], v[92:95], v[28:31], v[228:231]
 s_setprio 0
 ds_read_b64_tr_b16 v[150:151], v14 offset:38912
 v_add_u32 v14, 4294934528, v14
 buffer_load_dwordx4 v[164:167], v122, s[28:31], s67 offen offset:2048 sc1
 s_waitcnt lgkmcnt(4)
 v_mfma_f32_16x16x32_bf16 v[232:235], v[96:99], v[16:19], v[232:235]
 s_setprio 1
 ds_read_b64_tr_b16 v[88:89], v15 offset:32768
 v_mfma_f32_16x16x32_bf16 v[232:235], v[100:103], v[20:23], v[232:235]
 ds_read_b64_tr_b16 v[90:91], v15 offset:34816
 v_mfma_f32_16x16x32_bf16 v[236:239], v[96:99], v[24:27], v[236:239]
 ds_read_b64_tr_b16 v[92:93], v15 offset:36864
 v_mfma_f32_16x16x32_bf16 v[236:239], v[100:103], v[28:31], v[236:239]
 s_setprio 0
 ds_read_b64_tr_b16 v[94:95], v15 offset:38912
 v_add_u32 v15, 4294934528, v15
 buffer_load_dwordx4 v[168:171], v122, s[28:31], s67 offen offset:256 sc1
 s_waitcnt lgkmcnt(4)
 v_mfma_f32_16x16x32_bf16 v[240:243], v[144:147], v[16:19], v[240:243]
 s_setprio 1
 ds_read_b64_tr_b16 v[96:97], v5 offset:0
 v_mfma_f32_16x16x32_bf16 v[240:243], v[148:151], v[20:23], v[240:243]
 ds_read_b64_tr_b16 v[98:99], v5 offset:2048
 v_mfma_f32_16x16x32_bf16 v[244:247], v[144:147], v[24:27], v[244:247]
 ds_read_b64_tr_b16 v[100:101], v5 offset:4096
 v_mfma_f32_16x16x32_bf16 v[244:247], v[148:151], v[28:31], v[244:247]
 s_setprio 0
 ds_read_b64_tr_b16 v[102:103], v5 offset:6144
 buffer_load_dwordx4 v[172:175], v122, s[28:31], s67 offen offset:2304 sc1
 s_waitcnt lgkmcnt(4)
 v_mfma_f32_16x16x32_bf16 v[248:251], v[88:91], v[16:19], v[248:251]
 s_setprio 1
 ds_read_b64_tr_b16 v[144:145], v6 offset:0
 v_mfma_f32_16x16x32_bf16 v[248:251], v[92:95], v[20:23], v[248:251]
 ds_read_b64_tr_b16 v[146:147], v6 offset:2048
 v_mfma_f32_16x16x32_bf16 v[252:255], v[88:91], v[24:27], v[252:255]
 ds_read_b64_tr_b16 v[148:149], v6 offset:4096
 v_mfma_f32_16x16x32_bf16 v[252:255], v[92:95], v[28:31], v[252:255]
 s_setprio 0
 ds_read_b64_tr_b16 v[150:151], v6 offset:6144
 buffer_load_dwordx4 v[176:179], v122, s[28:31], s70 offen offset:0 sc1
 s_waitcnt lgkmcnt(4)
 v_mfma_f32_16x16x32_bf16 v[224:227], v[96:99], v[64:67], v[224:227]
 s_setprio 1
 ds_read_b64_tr_b16 v[88:89], v14 offset:0
 v_mfma_f32_16x16x32_bf16 v[224:227], v[100:103], v[68:71], v[224:227]
 ds_read_b64_tr_b16 v[90:91], v14 offset:2048
 v_mfma_f32_16x16x32_bf16 v[228:231], v[96:99], v[72:75], v[228:231]
 ds_read_b64_tr_b16 v[92:93], v14 offset:4096
 v_mfma_f32_16x16x32_bf16 v[228:231], v[100:103], v[76:79], v[228:231]
 s_setprio 0
 ds_read_b64_tr_b16 v[94:95], v14 offset:6144
 buffer_load_dwordx4 v[180:183], v122, s[28:31], s70 offen offset:2048 sc1
 s_waitcnt lgkmcnt(4)
 v_mfma_f32_16x16x32_bf16 v[232:235], v[144:147], v[64:67], v[232:235]
 s_setprio 1
 ds_read_b64_tr_b16 v[96:97], v15 offset:0
 v_mfma_f32_16x16x32_bf16 v[232:235], v[148:151], v[68:71], v[232:235]
 ds_read_b64_tr_b16 v[98:99], v15 offset:2048
 v_mfma_f32_16x16x32_bf16 v[236:239], v[144:147], v[72:75], v[236:239]
 ds_read_b64_tr_b16 v[100:101], v15 offset:4096
 v_mfma_f32_16x16x32_bf16 v[236:239], v[148:151], v[76:79], v[236:239]
 s_setprio 0
 ds_read_b64_tr_b16 v[102:103], v15 offset:6144
 buffer_load_dwordx4 v[184:187], v122, s[28:31], s70 offen offset:256 sc1
 s_waitcnt vmcnt(7) lgkmcnt(0)
 s_barrier
 v_mfma_f32_16x16x32_bf16 v[240:243], v[88:91], v[64:67], v[240:243]
 s_setprio 1
 ds_read_b64_tr_b16 v[144:145], v5 offset:32768
 v_mfma_f32_16x16x32_bf16 v[240:243], v[92:95], v[68:71], v[240:243]
 ds_read_b64_tr_b16 v[146:147], v5 offset:34816
 v_mfma_f32_16x16x32_bf16 v[244:247], v[88:91], v[72:75], v[244:247]
 ds_read_b64_tr_b16 v[148:149], v5 offset:36864
 v_mfma_f32_16x16x32_bf16 v[244:247], v[92:95], v[76:79], v[244:247]
 s_setprio 0
 ds_read_b64_tr_b16 v[150:151], v5 offset:38912
 buffer_load_dwordx4 v[188:191], v122, s[28:31], s70 offen offset:2304 sc1
 v_mfma_f32_16x16x32_bf16 v[248:251], v[96:99], v[64:67], v[248:251]
 s_setprio 1
 ds_read_b64_tr_b16 v[88:89], v6 offset:32768
 v_mfma_f32_16x16x32_bf16 v[248:251], v[100:103], v[68:71], v[248:251]
 ds_read_b64_tr_b16 v[90:91], v6 offset:34816
 v_mfma_f32_16x16x32_bf16 v[252:255], v[96:99], v[72:75], v[252:255]
 ds_read_b64_tr_b16 v[92:93], v6 offset:36864
 v_mfma_f32_16x16x32_bf16 v[252:255], v[100:103], v[76:79], v[252:255]
 s_setprio 0
 ds_read_b64_tr_b16 v[94:95], v6 offset:38912
 s_waitcnt vmcnt(4)
 v_max3_u32 v13, v160, v161, v162
 v_max3_u32 v13, v13, v163, v164
 v_max3_u32 v13, v13, v165, v166
 v_max3_u32 v13, v13, v167, v168
 v_max3_u32 v13, v13, v169, v170
 v_max3_u32 v13, v13, v171, v172
 v_max3_u32 v13, v13, v173, v174
 v_max_u32 v13, v13, v175
 v_cmp_eq_u32 vcc, -1, v13
 s_nop 0
 s_cmp_lg_u64 vcc, 0
 s_cbranch_scc1 L_x_4025
L_r_4026:
 s_waitcnt lgkmcnt(4)
 v_mfma_f32_16x16x32_bf16 v[224:227], v[144:147], v[160:163], v[224:227]
 s_setprio 1
 ds_read_b64_tr_b16 v[96:97], v14 offset:32768
 v_mfma_f32_16x16x32_bf16 v[224:227], v[148:151], v[164:167], v[224:227]
 ds_read_b64_tr_b16 v[98:99], v14 offset:34816
 v_mfma_f32_16x16x32_bf16 v[228:231], v[144:147], v[168:171], v[228:231]
 ds_read_b64_tr_b16 v[100:101], v14 offset:36864
 v_mfma_f32_16x16x32_bf16 v[228:231], v[148:151], v[172:175], v[228:231]
 s_setprio 0
 ds_read_b64_tr_b16 v[102:103], v14 offset:38912
 s_waitcnt lgkmcnt(4)
 v_mfma_f32_16x16x32_bf16 v[232:235], v[88:91], v[160:163], v[232:235]
 s_setprio 1
 ds_read_b64_tr_b16 v[144:145], v15 offset:32768
 v_mfma_f32_16x16x32_bf16 v[232:235], v[92:95], v[164:167], v[232:235]
 ds_read_b64_tr_b16 v[146:147], v15 offset:34816
 v_mfma_f32_16x16x32_bf16 v[236:239], v[88:91], v[168:171], v[236:239]
 ds_read_b64_tr_b16 v[148:149], v15 offset:36864
 v_mfma_f32_16x16x32_bf16 v[236:239], v[92:95], v[172:175], v[236:239]
 s_setprio 0
 ds_read_b64_tr_b16 v[150:151], v15 offset:38912
 s_waitcnt lgkmcnt(4)
 v_mfma_f32_16x16x32_bf16 v[240:243], v[96:99], v[160:163], v[240:243]
 s_setprio 1
 ds_read_b64_tr_b16 v[88:89], v124 offset:0
 v_mfma_f32_16x16x32_bf16 v[240:243], v[100:103], v[164:167], v[240:243]
 ds_read_b64_tr_b16 v[90:91], v124 offset:2048
 v_mfma_f32_16x16x32_bf16 v[244:247], v[96:99], v[168:171], v[244:247]
 ds_read_b64_tr_b16 v[92:93], v124 offset:4096
 v_mfma_f32_16x16x32_bf16 v[244:247], v[100:103], v[172:175], v[244:247]
 s_setprio 0
 ds_read_b64_tr_b16 v[94:95], v124 offset:6144
 s_waitcnt lgkmcnt(4)
 v_mfma_f32_16x16x32_bf16 v[248:251], v[144:147], v[160:163], v[248:251]
 s_setprio 1
 ds_read_b64_tr_b16 v[96:97], v1 offset:0
 v_mfma_f32_16x16x32_bf16 v[248:251], v[148:151], v[164:167], v[248:251]
 ds_read_b64_tr_b16 v[98:99], v1 offset:2048
 v_mfma_f32_16x16x32_bf16 v[252:255], v[144:147], v[168:171], v[252:255]
 ds_read_b64_tr_b16 v[100:101], v1 offset:4096
 v_mfma_f32_16x16x32_bf16 v[252:255], v[148:151], v[172:175], v[252:255]
 s_setprio 0
 ds_read_b64_tr_b16 v[102:103], v1 offset:6144
 s_waitcnt vmcnt(0)
 v_max3_u32 v13, v176, v177, v178
 v_max3_u32 v13, v13, v179, v180
 v_max3_u32 v13, v13, v181, v182
 v_max3_u32 v13, v13, v183, v184
 v_max3_u32 v13, v13, v185, v186
 v_max3_u32 v13, v13, v187, v188
 v_max3_u32 v13, v13, v189, v190
 v_max_u32 v13, v13, v191
 v_cmp_eq_u32 vcc, -1, v13
 s_nop 0
 s_cmp_lg_u64 vcc, 0
 s_cbranch_scc1 L_x_4028
L_r_4029:
 s_waitcnt lgkmcnt(4)
 v_mfma_f32_16x16x32_bf16 v[224:227], v[88:91], v[176:179], v[224:227]
 s_setprio 1
 ds_read_b64_tr_b16 v[144:145], v2 offset:0
 v_mfma_f32_16x16x32_bf16 v[224:227], v[92:95], v[180:183], v[224:227]
 ds_read_b64_tr_b16 v[146:147], v2 offset:2048
 v_mfma_f32_16x16x32_bf16 v[228:231], v[88:91], v[184:187], v[228:231]
 ds_read_b64_tr_b16 v[148:149], v2 offset:4096
 v_mfma_f32_16x16x32_bf16 v[228:231], v[92:95], v[188:191], v[228:231]
 s_setprio 0
 ds_read_b64_tr_b16 v[150:151], v2 offset:6144
 s_waitcnt lgkmcnt(4)
 v_mfma_f32_16x16x32_bf16 v[232:235], v[96:99], v[176:179], v[232:235]
 s_setprio 1
 ds_read_b64_tr_b16 v[88:89], v3 offset:0
 v_mfma_f32_16x16x32_bf16 v[232:235], v[100:103], v[180:183], v[232:235]
 ds_read_b64_tr_b16 v[90:91], v3 offset:2048
 v_mfma_f32_16x16x32_bf16 v[236:239], v[96:99], v[184:187], v[236:239]
 ds_read_b64_tr_b16 v[92:93], v3 offset:4096
 ds_write_b128 v104, v[224:227] offset:0
 v_mfma_f32_16x16x32_bf16 v[236:239], v[100:103], v[188:191], v[236:239]
 s_setprio 0
 ds_read_b64_tr_b16 v[94:95], v3 offset:6144
 ds_write_b128 v104, v[228:231] offset:4096
 s_waitcnt lgkmcnt(6)
 v_mfma_f32_16x16x32_bf16 v[240:243], v[144:147], v[176:179], v[240:243]
 s_setprio 1
 v_mfma_f32_16x16x32_bf16 v[240:243], v[148:151], v[180:183], v[240:243]
 v_mfma_f32_16x16x32_bf16 v[244:247], v[144:147], v[184:187], v[244:247]
 ds_write_b128 v105, v[232:235] offset:0
 v_mfma_f32_16x16x32_bf16 v[244:247], v[148:151], v[188:191], v[244:247]
 s_setprio 0
 ds_write_b128 v105, v[236:239] offset:4096
 s_waitcnt lgkmcnt(3)
 v_mfma_f32_16x16x32_bf16 v[248:251], v[88:91], v[176:179], v[248:251]
 s_setprio 1
 v_mfma_f32_16x16x32_bf16 v[248:251], v[92:95], v[180:183], v[248:251]
 v_mfma_f32_16x16x32_bf16 v[252:255], v[88:91], v[184:187], v[252:255]
 ds_write_b128 v106, v[240:243] offset:0
 v_mfma_f32_16x16x32_bf16 v[252:255], v[92:95], v[188:191], v[252:255]
 s_setprio 0
 ds_write_b128 v106, v[244:247] offset:4096
 s_nop 2
 ds_write_b128 v107, v[248:251] offset:0
 s_nop 1
 ds_write_b128 v107, v[252:255] offset:4096
 s_waitcnt lgkmcnt(0)
 s_barrier
 ds_read_b128 v[128:131], v10 offset:0
 ds_read_b128 v[132:135], v9 offset:0
 ds_read_b128 v[136:139], v10 offset:16384
 ds_read_b128 v[140:143], v9 offset:16384
 ds_read_b128 v[144:147], v10 offset:32768
 ds_read_b128 v[148:151], v9 offset:32768
 ds_read_b128 v[152:155], v10 offset:49152
 ds_read_b128 v[156:159], v9 offset:49152
 s_waitcnt lgkmcnt(4)
 v_add_f32 v128, v128, v136
 v_add_f32 v129, v129, v137
 v_add_f32 v130, v130, v138
 v_add_f32 v131, v131, v139
 v_add_f32 v132, v132, v140
 v_add_f32 v133, v133, v141
 v_add_f32 v134, v134, v142
 v_add_f32 v135, v135, v143
 s_waitcnt lgkmcnt(2)
 v_add_f32 v128, v128, v144
 v_add_f32 v129, v129, v145
 v_add_f32 v130, v130, v146
 v_add_f32 v131, v131, v147
 v_add_f32 v132, v132, v148
 v_add_f32 v133, v133, v149
 v_add_f32 v134, v134, v150
 v_add_f32 v135, v135, v151
 s_waitcnt lgkmcnt(0)
 v_add_f32 v128, v128, v152
 v_add_f32 v129, v129, v153
 v_add_f32 v130, v130, v154
 v_add_f32 v131, v131, v155
 v_add_f32 v132, v132, v156
 v_add_f32 v133, v133, v157
 v_add_f32 v134, v134, v158
 v_add_f32 v135, v135, v159
 v_cvt_pk_bf16_f32 v92, v128, v129
 v_cvt_pk_bf16_f32 v93, v130, v131
 v_cvt_pk_bf16_f32 v94, v132, v133
 v_cvt_pk_bf16_f32 v95, v134, v135
 buffer_store_dwordx4 v[92:95], v12, s[40:43], s77 offen sc1
 s_endpgm
L_x_4001:
 s_mov_b64 exec, 1
 buffer_store_dword v112, v126, s[44:47], 0 offen sc1
 s_mov_b64 exec, -1
 s_branch L_r_4002
L_x_4005:
 s_mov_b32 s92, 200000
L_spin_4007:
 buffer_load_dword v121, v118, s[44:47], 0 offen sc1
 s_waitcnt vmcnt(0)
 v_cmp_eq_u32 vcc, 0, v121
 s_sub_u32 s92, s92, 1
 s_cbranch_scc1 L_r_4006
 s_cmp_lg_u64 vcc, 0
 s_cbranch_scc1 L_spin_4007
 s_branch L_r_4006
L_x_4008:
 s_mov_b32 s92, 200000
L_spin_4010:
 buffer_load_dword v14, v119, s[28:31], 0 offen sc1
 buffer_load_dword v15, v119, s[28:31], 0 offen offset:64 sc1
 s_waitcnt vmcnt(0)
 v_min_u32 v13, v14, v15
 v_cmp_eq_u32 vcc, 0, v13
 s_sub_u32 s92, s92, 1
 s_cbranch_scc1 L_r_4009
 s_cmp_lg_u64 vcc, 0
 s_cbranch_scc1 L_spin_4010
 s_branch L_r_4009
L_x_4012:
 s_mov_b32 s92, 200000
L_spin_4014:
 buffer_load_dword v121, v120, s[28:31], 0 offen sc1
 s_waitcnt vmcnt(0)
 v_cmp_eq_u32 vcc, 0, v121
 s_sub_u32 s92, s92, 1
 s_cbranch_scc1 L_r_4013
 s_cmp_lg_u64 vcc, 0
 s_cbranch_scc1 L_spin_4014
 s_branch L_r_4013
L_x_4015:
 s_mov_b32 s92, 200000
L_spin_4017:
 buffer_load_dwordx4 v[148:151], v126, s[28:31], s85 offen sc1
 buffer_load_dwordx4 v[144:147], v126, s[28:31], s3 offen sc1
 s_waitcnt vmcnt(0)
 v_max3_u32 v13, v144, v145, v146
 v_max3_u32 v13, v13, v147, v148
 v_max3_u32 v13, v13, v149, v150
 v_max_u32 v13, v13, v151
 v_cmp_eq_u32 vcc, -1, v13
 s_sub_u32 s92, s92, 1
 s_cbranch_scc1 L_r_4016
 s_cmp_lg_u64 vcc, 0
 s_cbranch_scc1 L_spin_4017
 s_branch L_r_4016
L_x_4018:
 s_mov_b32 s92, 200000
L_spin_4020:
 buffer_load_dword v121, v115, s[28:31], 0 offen sc1
 s_waitcnt vmcnt(0)
 v_cmp_eq_u32 vcc, 0, v121
 s_sub_u32 s92, s92, 1
 s_cbranch_scc1 L_r_4019
 s_cmp_lg_u64 vcc, 0
 s_cbranch_scc1 L_spin_4020
 s_branch L_r_4019
L_x_4021:
 s_mov_b32 s92, 200000
L_spin_4023:
 buffer_load_dword v118, v123, s[28:31], 0 offen sc1
 s_waitcnt vmcnt(0)
 v_cmp_eq_u32 vcc, 0, v118
 s_sub_u32 s92, s92, 1
 s_cbranch_scc1 L_r_4022
 s_cmp_lg_u64 vcc, 0
 s_cbranch_scc1 L_spin_4023
 s_branch L_r_4022
L_x_4025:
 s_mov_b32 s92, 200000
L_spin_4027:
 buffer_load_dwordx4 v[160:163], v122, s[28:31], s67 offen offset:0 sc1
 buffer_load_dwordx4 v[164:167], v122, s[28:31], s67 offen offset:2048 sc1
 buffer_load_dwordx4 v[168:171], v122, s[28:31], s67 offen offset:256 sc1
 buffer_load_dwordx4 v[172:175], v122, s[28:31], s67 offen offset:2304 sc1
 s_waitcnt vmcnt(0)
 v_max3_u32 v13, v160, v161, v162
 v_max3_u32 v13, v13, v163, v164
 v_max3_u32 v13, v13, v165, v166
 v_max3_u32 v13, v13, v167, v168
 v_max3_u32 v13, v13, v169, v170
 v_max3_u32 v13, v13, v171, v172
 v_max3_u32 v13, v13, v173, v174
 v_max_u32 v13, v13, v175
 v_cmp_eq_u32 vcc, -1, v13
 s_sub_u32 s92, s92, 1
 s_cbranch_scc1 L_r_4026
 s_cmp_lg_u64 vcc, 0
 s_cbranch_scc1 L_spin_4027
 buffer_load_dwordx4 v[176:179], v122, s[28:31], s70 offen offset:0 sc1
 buffer_load_dwordx4 v[180:183], v122, s[28:31], s70 offen offset:2048 sc1
 buffer_load_dwordx4 v[184:187], v122, s[28:31], s70 offen offset:256 sc1
 buffer_load_dwordx4 v[188:191], v122, s[28:31], s70 offen offset:2304 sc1
 s_branch L_r_4026
L_x_4028:
 s_mov_b32 s92, 200000
L_spin_4030:
 buffer_load_dwordx4 v[176:179], v122, s[28:31], s70 offen offset:0 sc1
 buffer_load_dwordx4 v[180:183], v122, s[28:31], s70 offen offset:2048 sc1
 buffer_load_dwordx4 v[184:187], v122, s[28:31], s70 offen offset:256 sc1
 buffer_load_dwordx4 v[188:191], v122, s[28:31], s70 offen offset:2304 sc1
 s_waitcnt vmcnt(0)
 v_max3_u32 v13, v176, v177, v178
 v_max3_u32 v13, v13, v179, v180
 v_max3_u32 v13, v13, v181, v182
 v_max3_u32 v13, v13, v183, v184
 v_max3_u32 v13, v13, v185, v186
 v_max3_u32 v13, v13, v187, v188
 v_max3_u32 v13, v13, v189, v190
 v_max_u32 v13, v13, v191
 v_cmp_eq_u32 vcc, -1, v13
 s_sub_u32 s92, s92, 1
 s_cbranch_scc1 L_r_4029
 s_cmp_lg_u64 vcc, 0
 s_cbranch_scc1 L_spin_4030
 s_branch L_r_4029
L_slow3:
 s_nop 11
 s_lshl_b32 s62, s94, 11
 s_add_u32 s62, s62, 0x10000
 v_subrev_u32 v108, s62, v113
 v_subrev_u32 v109, s62, v114
 s_sub_u32 s67, s66, s53
 s_mov_b32 s62, s67
 s_mov_b32 s92, 64
 v_mov_b32 v110, 0xff800000
L_slowA3:
 buffer_load_dwordx4 v[104:107], v108, s[28:31], s62 offen sc1
 s_waitcnt vmcnt(0)
 v_mfma_f32_32x32x16_bf16 v[160:175], v[104:107], v[148:151], 0
 s_add_u32 s62, s62, 2048
 s_nop 10
 v_max3_f32 v110, v110, v160, v161
 v_max3_f32 v110, v110, v162, v163
 v_max3_f32 v110, v110, v164, v165
 v_max3_f32 v110, v110, v166, v167
 v_max3_f32 v110, v110, v168, v169
 v_max3_f32 v110, v110, v170, v171
 v_max3_f32 v110, v110, v172, v173
 v_max3_f32 v110, v110, v174, v175
 s_sub_u32 s92, s92, 1
 s_cmp_lg_u32 s92, 0
 s_cbranch_scc1 L_slowA3
 v_mov_b32 v111, v110
 s_nop 1
 v_permlane32_swap_b32 v111, v110
 v_max_f32 v110, v110, v111
 v_sub_f32 v176, 0, v110
 v_mov_b32 v48, 0
 v_sub_f32 v177, 0, v110
 v_mov_b32 v49, 0
 v_sub_f32 v178, 0, v110
 v_mov_b32 v50, 0
 v_sub_f32 v179, 0, v110
 v_mov_b32 v51, 0
 v_sub_f32 v180, 0, v110
 v_mov_b32 v52, 0
 v_sub_f32 v181, 0, v110
 v_mov_b32 v53, 0
 v_sub_f32 v182, 0, v110
 v_mov_b32 v54, 0
 v_sub_f32 v183, 0, v110
 v_mov_b32 v55, 0
 v_sub_f32 v184, 0, v110
 v_mov_b32 v56, 0
 v_sub_f32 v185, 0, v110
 v_mov_b32 v57, 0
 v_sub_f32 v186, 0, v110
 v_mov_b32 v58, 0
 v_sub_f32 v187, 0, v110
 v_mov_b32 v59, 0
 v_sub_f32 v188, 0, v110
 v_mov_b32 v60, 0
 v_sub_f32 v189, 0, v110
 v_mov_b32 v61, 0
 v_sub_f32 v190, 0, v110
 v_mov_b32 v62, 0
 v_sub_f32 v191, 0, v110
 v_mov_b32 v63, 0
 s_mov_b32 s62, s67
 s_mov_b32 s92, 64
L_slowB3:
 buffer_load_dwordx4 v[104:107], v108, s[28:31], s62 offen sc1
 s_mov_b64 exec, s[96:97]
 buffer_load_dwordx4 v[128:131], v109, s[28:31], s62 offen offset:1024 sc1
 buffer_load_dwordx4 v[132:135], v109, s[28:31], s62 offen offset:1536 sc1
 s_mov_b64 exec, -1
 s_waitcnt vmcnt(0)
 v_mfma_f32_32x32x16_bf16 v[160:175], v[104:107], v[148:151], v[176:191]
 s_add_u32 s62, s62, 2048
 s_nop 10
 v_exp_f32 v160, v160
 v_exp_f32 v161, v161
 v_exp_f32 v162, v162
 v_exp_f32 v163, v163
 v_exp_f32 v164, v164
 v_exp_f32 v165, v165
 v_exp_f32 v166, v166
 v_exp_f32 v167, v167
 v_exp_f32 v168, v168
 v_exp_f32 v169, v169
 v_exp_f32 v170, v170
 v_exp_f32 v171, v171
 v_exp_f32 v172, v172
 v_exp_f32 v173, v173
 v_exp_f32 v174, v174
 v_exp_f32 v175, v175
 v_smfmac_f32_32x32x32_bf16 v[48:63], v[128:131], v[160:167], v112
 s_nop 0
 v_smfmac_f32_32x32x32_bf16 v[48:63], v[132:135], v[168:175], v112
 s_sub_u32 s92, s92, 1
 s_cmp_lg_u32 s92, 0
 s_nop 11
 s_cbranch_scc1 L_slowB3
 s_branch L_slowret3
L_codeend:
.section .rodata,"a"
.p2align 6
.amdhsa_kernel gated_mix__mha_block__glu_gated_glu__prompt_kernel
  .amdhsa_next_free_vgpr 256
  .amdhsa_next_free_sgpr 102
  .amdhsa_accum_offset 256
  .amdhsa_group_segment_fixed_size 0
  .amdhsa_kernarg_size 88
  .amdhsa_user_sgpr_count 2
  .amdhsa_user_sgpr_kernarg_segment_ptr 1
  .amdhsa_system_sgpr_workgroup_id_x 1
.end_amdhsa_kernel
```
